```python
import torch

def _softmax(x, axis=-1):
    return torch.softmax(x, dim=axis)
def _gelu(x):
    return torch.nn.functional.gelu(x, approximate="tanh")
def _silu(x):
    return torch.nn.functional.silu(x)
def _sigmoid(x):
    return torch.sigmoid(x)
def _layernorm(x, axis=-1, eps=1e-5):
    m = x.mean(dim=axis, keepdim=True)
    v = x.var(dim=axis, keepdim=True, unbiased=False)
    return (x - m) / torch.sqrt(v + eps)
def _scatter_add(tgt, idx, src, axis=0):
    return tgt.clone().index_add_(axis, idx, src)
def _segment_sum(src, seg, n):
    out = torch.zeros((n,) + src.shape[1:], dtype=src.dtype)
    return out.index_add_(0, seg, src)
def _pad(x, pw):
    flat = tuple(v for pair in reversed(pw) for v in pair)
    return torch.nn.functional.pad(x, flat)

kernel_name = 'recurrent_scan__linear_attn_block__mixer_s_mlp__prompt'

def setup_inputs():

    _w = (lambda a: (lambda t: t.to(torch.bfloat16) if t.is_floating_point() else t)(torch.as_tensor(a)))
    def _A_setup():
        B, S, D = 1, 2048, 640
        return {
            "x": _w((lambda *s: torch.randn(*s, dtype=torch.bfloat16) * 0.05)(B, S, D)),
            "wqkv": _w((lambda *s: torch.randn(*s, dtype=torch.bfloat16) * 0.05)(D, 3 * D)),
            "wo": _w((lambda *s: torch.randn(*s, dtype=torch.bfloat16) * 0.05)(D, D)),
        }
    _A_in = _A_setup()

    def _B_setup():
        B, S, D, F = 1, 2048, 640, 1536
        return {
            "x":  _w((lambda *s: torch.randn(*s, dtype=torch.bfloat16) * 0.05)(B, S, D)),
            "w1": _w((lambda *s: torch.randn(*s, dtype=torch.bfloat16) * 3.2)(D, D) * (D ** -0.5)),
            "w2": _w((lambda *s: torch.randn(*s, dtype=torch.bfloat16) * 3.2)(D, D) * (D ** -0.5)),
            "w3": _w((lambda *s: torch.randn(*s, dtype=torch.bfloat16) * 3.2)(D, F) * (D ** -0.5)),
            "w4": _w((lambda *s: torch.randn(*s, dtype=torch.bfloat16) * 1.6)(F, D) * (F ** -0.5)),
        }
    _B_in = _B_setup()

    return {
        "A_x": _A_in["x"],
        "A_wqkv": _A_in["wqkv"],
        "A_wo": _A_in["wo"],
        "B_x": _B_in["x"],
        "B_w1": _B_in["w1"],
        "B_w2": _B_in["w2"],
        "B_w3": _B_in["w3"],
        "B_w4": _B_in["w4"],
    }

def reference(A_x, A_wqkv, A_wo, B_x, B_w1, B_w2, B_w3, B_w4):
    def _A_ref(x, wqkv, wo):
        B, S, D = x.shape
        H = 32; Dh = D // H
        qkv = (lambda x, *d: x.permute(*d))((x @ wqkv).reshape(B, S, 3, H, Dh), 2, 0, 3, 1, 4)
        q, k, v = qkv[0], qkv[1], qkv[2]
        phi = lambda t: torch.where(t > 0, t + 1, torch.exp(t)) + 1e-6
        pq, pk = phi(q), phi(k)
        kv = torch.einsum("bhsd,bhse->bhde", pk, v)
        z = torch.einsum("bhsd->bhd", pk)
        num = torch.einsum("bhqd,bhde->bhqe", pq, kv)
        den = torch.einsum("bhqd,bhd->bhq", pq, z)[..., None] + 1e-6
        o = num / den
        return (lambda x, *d: x.permute(*d))(o, 0, 2, 1, 3).reshape(B, S, D) @ wo

    def _B_ref(x, w1, w2, w3, w4):
        B, S, D = x.shape
        h = _gelu(_layernorm(x, axis=-1) @ w1)
        c = D // 4
        g0 = _pad(h[:, :, 0*c:1*c], ((0, 0), (1, 0), (0, 0)))[:, :S, :]
        g1 = _pad(h[:, :, 1*c:2*c], ((0, 0), (0, 1), (0, 0)))[:, 1:, :]
        g2 = _pad(h[:, :, 2*c:3*c], ((0, 0), (2, 0), (0, 0)))[:, :S, :]
        g3 = _pad(h[:, :, 3*c:   ], ((0, 0), (0, 2), (0, 0)))[:, 2:, :]
        hs = torch.concatenate([g0, g1, g2, g3], axis=-1) @ w2
        x1 = x + hs
        h2 = _gelu(_layernorm(x1, axis=-1) @ w3) @ w4
        return x1 + h2

    x = A_x
    xn = _layernorm(x, axis=-1)
    s = _A_ref(xn, A_wqkv, A_wo)
    g = _silu(_B_ref(xn, B_w1, B_w2, B_w3, B_w4))
    return x + s * g
```

```asm
; @launch grid=(256,1,1) block=(512,1,1) lds=163840
.amdgcn_target "amdgcn-amd-amdhsa--gfx950"
.text
.globl recurrent_scan__linear_attn_block__mixer_s_mlp__prompt_kernel
.p2align 8
.type recurrent_scan__linear_attn_block__mixer_s_mlp__prompt_kernel,@function
recurrent_scan__linear_attn_block__mixer_s_mlp__prompt_kernel:
L_CODE0:
    s_cmp_ge_u32 s2, 256
    s_cbranch_scc1 L_END
    s_load_dwordx16 s[16:31], s[0:1], 0
    s_load_dwordx2 s[32:33], s[0:1], 64
    s_load_dwordx2 s[34:35], s[0:1], 80
    v_and_b32 v1, 63, v0
    v_lshrrev_b32 v3, 6, v0
    s_nop 0
    v_readfirstlane_b32 s3, v3
    s_and_b32 s74, s2, 7
    s_lshr_b32 s82, s2, 3
    s_and_b32 s72, s3, 3
    s_and_b32 s85, s82, 1
    s_lshl_b32 s79, s74, 1
    s_add_u32 s79, s79, s85
    s_lshr_b32 s80, s82, 1
    s_sub_u32 s99, s82, 20
    s_and_b32 s81, s74, 4
    s_and_b32 s83, s99, 3
    s_add_u32 s81, s81, s83
    s_mul_i32 s91, s83, 5
    s_lshr_b32 s91, s91, 1
    s_lshr_b32 s83, s99, 2
    s_and_b32 s84, s74, 3
    s_mul_i32 s86, s83, 3
    s_add_u32 s91, s91, s86
    s_lshl_b32 s75, s84, 1
    s_add_u32 s75, s75, s83
    s_add_u32 s84, s84, 8
    s_cmp_lt_u32 s83, 2
    s_cselect_b32 s75, s75, s84
    s_sub_u32 s85, s80, 10
    s_mov_b32 s76, 73728
    s_cmp_ge_u32 s82, 20
    s_cselect_b32 s80, s85, s80
    s_cselect_b32 s76, 159744, s76
    s_getreg_b32 s101, hwreg(HW_REG_XCC_ID, 0, 4)
    s_cmp_lt_u32 s3, 4
    s_cbranch_scc1 L_COMPUTE
    s_cmp_ge_u32 s82, 20
    s_cbranch_scc1 LD_A
    s_lshl_b32 s83, s79, 7
    s_lshl_b32 s84, s72, 5
    s_add_u32 s83, s83, s84
    s_mul_i32 s83, s83, 1280
    v_lshrrev_b32 v3, 3, v1
    v_lshrrev_b32 v4, 4, v1
    v_and_b32 v5, 7, v1
    v_xor_b32 v4, v4, v5
    v_mul_u32_u24 v3, 1280, v3
    v_add_u32_e64 v3, s83, v3
    v_lshl_add_u32 v8, v4, 4, v3
    v_xor_b32_e64 v9, 64, v8
    v_add_u32 v9, 10240, v9
    v_add_u32 v10, 20480, v8
    v_add_u32 v11, 20480, v9
    s_lshl_b32 s89, s72, 12
    s_add_u32 s89, s89, 8192
    s_lshl_b32 s88, s72, 11
    s_lshl_b32 s98, s72, 12
    s_lshl_b32 s83, s80, 7
    v_lshrrev_b32_e64 v3, 3, v1
    v_mul_u32_u24 v3, 1280, v3
    v_bfe_u32 v4, v1, 4, 1
    v_lshlrev_b32 v4, 2, v4
    v_and_b32 v5, 7, v1
    v_xor_b32_e64 v4, v4, v5
    v_lshl_add_u32 v3, v4, 4, v3
    v_add_u32_e64 v12, s83, v3
    v_add_u32 v13, 10240, v12
    v_add_u32 v14, 20480, v12
    v_add_u32 v15, 30720, v12
    s_mul_i32 s96, s72, 20480
    s_mov_b32 s7, s80
    s_bitcmp1_b32 s79, 0
    s_cselect_b32 s8, 1, 1
    s_waitcnt lgkmcnt(0)
    s_mov_b32 s36, s16
    s_mov_b32 s37, s17
    s_mov_b32 s38, 2621440
    s_mov_b32 s39, 0x20000
    s_mov_b32 s40, s24
    s_mov_b32 s41, s25
    s_mov_b32 s42, 819200
    s_mov_b32 s43, 0x20000
    s_mov_b32 s83, 0
    s_add_u32 s84, s96, 0
    s_add_u32 m0, s88, 0
    s_nop 0
    buffer_load_dwordx4 v12, s[40:43], s84 offen lds
    s_add_u32 m0, s88, 1024
    s_nop 0
    buffer_load_dwordx4 v13, s[40:43], s84 offen lds
    s_add_u32 m0, s89, 0
    s_nop 0
    buffer_load_dwordx4 v8, s[36:39], s83 offen lds
    s_add_u32 m0, s89, 1024
    s_nop 0
    buffer_load_dwordx4 v9, s[36:39], s83 offen lds
    s_add_u32 m0, s89, 2048
    s_nop 0
    buffer_load_dwordx4 v10, s[36:39], s83 offen lds
    s_add_u32 m0, s89, 3072
    s_nop 0
    buffer_load_dwordx4 v11, s[36:39], s83 offen lds
    s_load_dword s73, s[34:35], 0
    s_mov_b32 s83, 128
    s_add_u32 s84, s96, 81920
    s_add_u32 m0, s88, 24576
    s_nop 0
    buffer_load_dwordx4 v12, s[40:43], s84 offen lds
    s_add_u32 m0, s88, 25600
    s_nop 0
    buffer_load_dwordx4 v13, s[40:43], s84 offen lds
    s_add_u32 m0, s89, 24576
    s_nop 0
    buffer_load_dwordx4 v8, s[36:39], s83 offen lds
    s_add_u32 m0, s89, 25600
    s_nop 0
    buffer_load_dwordx4 v9, s[36:39], s83 offen lds
    s_add_u32 m0, s89, 26624
    s_nop 0
    buffer_load_dwordx4 v10, s[36:39], s83 offen lds
    s_add_u32 m0, s89, 27648
    s_nop 0
    buffer_load_dwordx4 v11, s[36:39], s83 offen lds
    s_mov_b32 s83, 256
    s_add_u32 s84, s96, 163840
    s_add_u32 m0, s88, 49152
    s_nop 0
    buffer_load_dwordx4 v12, s[40:43], s84 offen lds
    s_add_u32 m0, s88, 50176
    s_nop 0
    buffer_load_dwordx4 v13, s[40:43], s84 offen lds
    s_add_u32 m0, s89, 49152
    s_nop 0
    buffer_load_dwordx4 v8, s[36:39], s83 offen lds
    s_add_u32 m0, s89, 50176
    s_nop 0
    buffer_load_dwordx4 v9, s[36:39], s83 offen lds
    s_add_u32 m0, s89, 51200
    s_nop 0
    buffer_load_dwordx4 v10, s[36:39], s83 offen lds
    s_add_u32 m0, s89, 52224
    s_nop 0
    buffer_load_dwordx4 v11, s[36:39], s83 offen lds
    s_mov_b32 s64, s34
    s_mov_b32 s65, s35
    s_mov_b32 s66, 23068672
    s_mov_b32 s67, 0x20000
    s_mov_b32 s44, s26
    s_mov_b32 s45, s27
    s_mov_b32 s46, 819200
    s_mov_b32 s47, 0x20000
    s_mov_b32 s48, s28
    s_mov_b32 s49, s29
    s_mov_b32 s50, 1966080
    s_mov_b32 s51, 0x20000
    s_mov_b32 s52, s30
    s_mov_b32 s53, s31
    s_mov_b32 s54, 1966080
    s_mov_b32 s55, 0x20000
    s_lshl_b32 s83, s80, 8
    v_lshrrev_b32 v3, 3, v1
    v_mul_u32_u24 v3, 3072, v3
    v_bfe_u32 v4, v1, 4, 1
    v_lshlrev_b32 v4, 2, v4
    v_and_b32 v5, 7, v1
    v_xor_b32_e64 v4, v4, v5
    v_lshl_add_u32 v3, v4, 4, v3
    v_add_u32_e64 v16, s83, v3
    v_add_u32 v17, 24576, v16
    v_add_u32 v18, 49152, v16
    v_add_u32 v19, 73728, v16
    s_mul_i32 s91, s72, 40960
    s_lshl_b32 s83, s80, 6
    s_add_u32 s83, s83, 1920
    v_add_lshl_u32 v6, v1, s83, 2
    s_and_b32 s85, s72, 1
    s_lshl_b32 s85, s85, 6
    s_lshl_b32 s86, s79, 7
    s_add_u32 s85, s85, s86
    v_add_lshl_u32 v7, v1, s85, 3
    s_sub_u32 s83, s83, 16
    s_lshl_b32 s86, s79, 4
    v_mov_b32 v3, s83
    v_mov_b32 v4, s83
    v_cmp_lt_u32 vcc, 39, v1
    s_nop 1
    v_cndmask_b32 v3, v3, v4, vcc
    v_mov_b32 v4, s83
    v_cmp_lt_u32 vcc, 47, v1
    s_nop 1
    v_cndmask_b32 v3, v3, v4, vcc
    v_mov_b32 v4, s83
    v_cmp_lt_u32 vcc, 55, v1
    s_nop 1
    v_cndmask_b32 v3, v3, v4, vcc
    v_bfe_u32 v4, v1, 2, 1
    v_mul_u32_u24 v4, 79, v4
    v_add_u32 v3, v3, v4
    v_lshrrev_b32 v3, 6, v3
    v_min_u32 v3, 39, v3
    v_and_b32 v4, 3, v1
    v_mul_u32_u24 v4, 40, v4
    v_add_u32 v3, v3, v4
    v_and_b32 v5, 15, v1
    v_add_u32 v4, s86, v5
    v_cmp_lt_u32 vcc, 31, v1
    s_nop 1
    v_cndmask_b32 v3, v4, v3, vcc
    v_lshlrev_b32 v3, 7, v3
    v_add_u32 v20, 22020096, v3
    s_and_b32 s85, s72, 1
    s_lshl_b32 s84, s80, 1
    s_add_u32 s85, s85, s84
    s_lshl_b32 s84, s85, 6
    s_add_u32 s84, s84, 2560
    v_add_lshl_u32 v21, v1, s84, 2
    v_and_b32 v4, 3, v1
    v_mul_u32_u24 v4, 24, v4
    v_add_lshl_u32 v3, v4, s85, 7
    v_add_u32 v22, 22257664, v3
    s_mov_b32 s68, s28
    s_mov_b32 s69, s29
    s_mov_b32 s70, 1966080
    s_mov_b32 s71, 0x20000
    s_cmp_ge_u32 s2, 96
    s_cselect_b32 s70, 0, s70
    s_mul_i32 s92, s2, 2731
    s_lshr_b32 s92, s92, 16
    s_mul_i32 s93, s92, 24
    s_sub_u32 s93, s2, s93
    s_mul_i32 s84, s92, 160
    s_mul_i32 s85, s72, 40
    s_add_u32 s84, s84, s85
    s_mul_i32 s84, s84, 3072
    s_lshl_b32 s85, s93, 7
    s_add_u32 s84, s84, s85
    v_lshrrev_b32_e64 v3, 3, v1
    v_mul_u32_u24 v3, 3072, v3
    v_and_b32_e64 v4, 7, v1
    v_lshl_add_u32 v3, v4, 4, v3
    v_add_u32_e64 v44, s84, v3
    s_mov_b32 s87, 77824
    s_waitcnt lgkmcnt(0)
    s_mul_i32 s73, s73, 0x9E3779B1
    s_add_u32 s73, s73, 0x7F4A7C15
    v_mov_b32 v2, s73
    s_mov_b32 s4, 0
    s_lshl_b32 s5, s80, 1
    s_add_u32 s5, s5, s72
    s_mov_b32 s6, s80
    s_waitcnt vmcnt(12)
    s_barrier
    s_cmp_lg_u32 s72, 0
    s_cbranch_scc1 SK_1
    v_lshlrev_b32 v3, 2, v1
    v_add_u32 v4, s76, v3
    ds_read_b32 v56, v4 offset:0
    ds_read_b32 v57, v4 offset:256
    ds_read_b32 v58, v4 offset:512
    ds_read_b32 v59, v4 offset:768
    ds_read_b32 v60, v4 offset:1024
    s_waitcnt lgkmcnt(0)
    v_add_f32 v56, v56, v57
    v_add_f32 v58, v58, v59
    v_add_f32 v56, v56, v58
    s_mul_i32 s83, s2, 1639
    s_lshr_b32 s83, s83, 16
    s_mul_i32 s84, s83, 40
    s_sub_u32 s84, s2, s84
    s_lshl_b32 s83, s83, 14
    s_lshl_b32 s84, s84, 8
    s_add_u32 s83, s83, s84
    s_add_u32 s83, s83, 98304
    buffer_store_dword v56, v3, s[64:67], s83 offen sc1
    s_lshl_b32 s83, s2, 6
    s_add_u32 s83, s83, 65536
    s_mov_b64 exec, 0xffff
    buffer_store_dword v60, v3, s[64:67], s83 offen sc1
    s_mov_b64 exec, -1
SK_1:
    s_mov_b32 s83, 384
    s_add_u32 s84, s96, 245760
    s_add_u32 m0, s88, 81920
    s_nop 0
    buffer_load_dwordx4 v12, s[40:43], s84 offen lds
    s_add_u32 m0, s88, 82944
    s_nop 0
    buffer_load_dwordx4 v13, s[40:43], s84 offen lds
    s_add_u32 m0, s89, 81920
    s_nop 0
    buffer_load_dwordx4 v8, s[36:39], s83 offen lds
    s_add_u32 m0, s89, 82944
    s_nop 0
    buffer_load_dwordx4 v9, s[36:39], s83 offen lds
    s_add_u32 m0, s89, 83968
    s_nop 0
    buffer_load_dwordx4 v10, s[36:39], s83 offen lds
    s_add_u32 m0, s89, 84992
    s_nop 0
    buffer_load_dwordx4 v11, s[36:39], s83 offen lds
    s_waitcnt vmcnt(12)
    s_barrier
    s_mov_b32 s83, 512
    s_add_u32 s84, s96, 327680
    s_add_u32 m0, s88, 106496
    s_nop 0
    buffer_load_dwordx4 v12, s[40:43], s84 offen lds
    s_add_u32 m0, s88, 107520
    s_nop 0
    buffer_load_dwordx4 v13, s[40:43], s84 offen lds
    s_add_u32 m0, s89, 106496
    s_nop 0
    buffer_load_dwordx4 v8, s[36:39], s83 offen lds
    s_add_u32 m0, s89, 107520
    s_nop 0
    buffer_load_dwordx4 v9, s[36:39], s83 offen lds
    s_add_u32 m0, s89, 108544
    s_nop 0
    buffer_load_dwordx4 v10, s[36:39], s83 offen lds
    s_add_u32 m0, s89, 109568
    s_nop 0
    buffer_load_dwordx4 v11, s[36:39], s83 offen lds
    s_waitcnt vmcnt(12)
    s_cmp_lg_u32 s72, 0
    s_cbranch_scc1 SK_2
    s_waitcnt vmcnt(12)
    s_lshl_b32 s83, s2, 7
    s_add_u32 s83, s83, 22020096
    v_mov_b32 v60, s73
    v_mov_b32 v61, s101
    s_mov_b64 exec, 1
    buffer_store_dwordx2 v[60:61], off, s[64:67], s83 sc1
    s_mov_b64 exec, -1
SK_2:
    s_barrier
    s_mov_b32 s83, 640
    s_add_u32 s84, s96, 409600
    s_add_u32 m0, s88, 131072
    s_nop 0
    buffer_load_dwordx4 v12, s[40:43], s84 offen lds
    s_add_u32 m0, s88, 132096
    s_nop 0
    buffer_load_dwordx4 v13, s[40:43], s84 offen lds
    s_add_u32 m0, s89, 131072
    s_nop 0
    buffer_load_dwordx4 v8, s[36:39], s83 offen lds
    s_add_u32 m0, s89, 132096
    s_nop 0
    buffer_load_dwordx4 v9, s[36:39], s83 offen lds
    s_add_u32 m0, s89, 133120
    s_nop 0
    buffer_load_dwordx4 v10, s[36:39], s83 offen lds
    s_add_u32 m0, s89, 134144
    s_nop 0
    buffer_load_dwordx4 v11, s[36:39], s83 offen lds
    s_mov_b32 s84, 0
    buffer_load_dwordx4 v[24:27], v44, s[68:71], s84 offen
    s_mov_b32 s84, 24576
    buffer_load_dwordx4 v[28:31], v44, s[68:71], s84 offen
    s_mov_b32 s84, 49152
    buffer_load_dwordx4 v[32:35], v44, s[68:71], s84 offen
    s_mov_b32 s84, 73728
    buffer_load_dwordx4 v[36:39], v44, s[68:71], s84 offen
    s_mov_b32 s84, 98304
    buffer_load_dwordx4 v[40:43], v44, s[68:71], s84 offen
    s_waitcnt vmcnt(17)
    s_barrier
    s_mov_b32 s83, 768
    s_add_u32 s84, s96, 491520
    s_add_u32 m0, s88, 0
    s_nop 0
    buffer_load_dwordx4 v12, s[40:43], s84 offen lds
    s_add_u32 m0, s88, 1024
    s_nop 0
    buffer_load_dwordx4 v13, s[40:43], s84 offen lds
    s_add_u32 m0, s89, 0
    s_nop 0
    buffer_load_dwordx4 v8, s[36:39], s83 offen lds
    s_add_u32 m0, s89, 1024
    s_nop 0
    buffer_load_dwordx4 v9, s[36:39], s83 offen lds
    s_add_u32 m0, s89, 2048
    s_nop 0
    buffer_load_dwordx4 v10, s[36:39], s83 offen lds
    s_add_u32 m0, s89, 3072
    s_nop 0
    buffer_load_dwordx4 v11, s[36:39], s83 offen lds
    s_waitcnt vmcnt(17)
    s_barrier
    s_mov_b32 s83, 896
    s_add_u32 s84, s96, 573440
    s_add_u32 m0, s88, 24576
    s_nop 0
    buffer_load_dwordx4 v12, s[40:43], s84 offen lds
    s_add_u32 m0, s88, 25600
    s_nop 0
    buffer_load_dwordx4 v13, s[40:43], s84 offen lds
    s_add_u32 m0, s89, 24576
    s_nop 0
    buffer_load_dwordx4 v8, s[36:39], s83 offen lds
    s_add_u32 m0, s89, 25600
    s_nop 0
    buffer_load_dwordx4 v9, s[36:39], s83 offen lds
    s_add_u32 m0, s89, 26624
    s_nop 0
    buffer_load_dwordx4 v10, s[36:39], s83 offen lds
    s_add_u32 m0, s89, 27648
    s_nop 0
    buffer_load_dwordx4 v11, s[36:39], s83 offen lds
    s_getpc_b64 s[12:13]
L_PCT_3:
    s_lshl_b32 s11, s72, 7
    s_add_u32 s11, s11, E1B-L_PCT_3+0
    s_add_u32 s12, s12, s11
    s_addc_u32 s13, s13, 0
    s_load_dword s10, s[12:13], 0
    s_load_dword s10, s[12:13], 512
    s_load_dword s10, s[12:13], 1024
    s_load_dword s10, s[12:13], 1536
    s_load_dword s10, s[12:13], 2048
    s_load_dword s10, s[12:13], 2560
    s_load_dword s10, s[12:13], 3072
    s_load_dword s10, s[12:13], 3584
    s_load_dword s10, s[12:13], 4096
    s_load_dword s10, s[12:13], 4608
    s_load_dword s10, s[12:13], 5120
    s_load_dword s10, s[12:13], 5632
    s_load_dword s10, s[12:13], 6144
    s_load_dword s10, s[12:13], 6656
    s_waitcnt vmcnt(17)
    s_barrier
    s_cmp_lg_u32 s72, 0
    s_cbranch_scc1 SK_4
    buffer_load_dword v23, v20, s[64:67], 0 offen sc1
SK_4:
    s_mov_b32 s83, 1024
    s_add_u32 s84, s96, 655360
    s_add_u32 m0, s88, 49152
    s_nop 0
    buffer_load_dwordx4 v12, s[40:43], s84 offen lds
    s_add_u32 m0, s88, 50176
    s_nop 0
    buffer_load_dwordx4 v13, s[40:43], s84 offen lds
    s_add_u32 m0, s89, 49152
    s_nop 0
    buffer_load_dwordx4 v8, s[36:39], s83 offen lds
    s_add_u32 m0, s89, 50176
    s_nop 0
    buffer_load_dwordx4 v9, s[36:39], s83 offen lds
    s_add_u32 m0, s89, 51200
    s_nop 0
    buffer_load_dwordx4 v10, s[36:39], s83 offen lds
    s_add_u32 m0, s89, 52224
    s_nop 0
    buffer_load_dwordx4 v11, s[36:39], s83 offen lds
    s_waitcnt vmcnt(12)
    s_barrier
    s_mov_b32 s83, 1152
    s_add_u32 s84, s96, 737280
    s_add_u32 m0, s88, 81920
    s_nop 0
    buffer_load_dwordx4 v12, s[40:43], s84 offen lds
    s_add_u32 m0, s88, 82944
    s_nop 0
    buffer_load_dwordx4 v13, s[40:43], s84 offen lds
    s_add_u32 m0, s89, 81920
    s_nop 0
    buffer_load_dwordx4 v8, s[36:39], s83 offen lds
    s_add_u32 m0, s89, 82944
    s_nop 0
    buffer_load_dwordx4 v9, s[36:39], s83 offen lds
    s_add_u32 m0, s89, 83968
    s_nop 0
    buffer_load_dwordx4 v10, s[36:39], s83 offen lds
    s_add_u32 m0, s89, 84992
    s_nop 0
    buffer_load_dwordx4 v11, s[36:39], s83 offen lds
    s_waitcnt vmcnt(12)
    s_cmp_lg_u32 s72, 0
    s_cbranch_scc1 SK_5
    s_waitcnt vmcnt(12)
    v_cmp_ne_u32 vcc, s73, v23
    s_cbranch_vccz P0OK_6
    s_mov_b32 s90, 200000
POLL_7:
    buffer_load_dword v62, v20, s[64:67], 0 offen sc1
    s_waitcnt vmcnt(0)
    v_cmp_ne_u32 vcc, s73, v62
    s_cbranch_vccz POLLD_8
    s_sub_u32 s90, s90, 1
    s_cmp_lg_u32 s90, 0
    s_cbranch_scc1 POLL_7
POLLD_8:
P0OK_6:
SK_5:
    s_barrier
    s_mov_b32 s83, 98304
    buffer_load_dword v56, v6, s[64:67], s83 offen sc1
    s_mov_b32 s83, 114688
    buffer_load_dword v57, v6, s[64:67], s83 offen sc1
    s_mov_b32 s83, 131072
    buffer_load_dword v58, v6, s[64:67], s83 offen sc1
    s_mov_b32 s83, 147456
    buffer_load_dword v59, v6, s[64:67], s83 offen sc1
    s_mov_b32 s83, 65536
    buffer_load_dwordx2 v[60:61], v7, s[64:67], s83 offen sc1
    s_add_u32 s84, s72, 0
    s_mul_i32 s84, s84, 13108
    s_lshr_b32 s84, s84, 16
    s_and_b32 s85, s84, 1
    s_lshl_b32 s85, s85, 1
    s_lshr_b32 s86, s84, 1
    s_or_b32 s85, s85, s86
    s_and_b32 s86, s79, 1
    s_xor_b32 s85, s85, s86
    s_xor_b32 s85, s85, 1
    s_sub_u32 s85, s85, s84
    s_mul_i32 s85, s85, 204800
    s_add_u32 s83, s91, 0
    s_add_u32 s83, s83, s85
    s_add_u32 m0, s98, 114688
    s_nop 0
    buffer_load_dwordx4 v12, s[44:47], s83 offen lds
    s_add_u32 m0, s98, 115712
    s_nop 0
    buffer_load_dwordx4 v13, s[44:47], s83 offen lds
    s_add_u32 m0, s98, 116736
    s_nop 0
    buffer_load_dwordx4 v14, s[44:47], s83 offen lds
    s_add_u32 m0, s98, 117760
    s_nop 0
    buffer_load_dwordx4 v15, s[44:47], s83 offen lds
    s_waitcnt vmcnt(15)
    s_barrier
    s_add_u32 s84, s72, 4
    s_mul_i32 s84, s84, 13108
    s_lshr_b32 s84, s84, 16
    s_and_b32 s85, s84, 1
    s_lshl_b32 s85, s85, 1
    s_lshr_b32 s86, s84, 1
    s_or_b32 s85, s85, s86
    s_and_b32 s86, s79, 1
    s_xor_b32 s85, s85, s86
    s_xor_b32 s85, s85, 1
    s_sub_u32 s85, s85, s84
    s_mul_i32 s85, s85, 204800
    s_add_u32 s83, s91, 163840
    s_add_u32 s83, s83, s85
    s_add_u32 m0, s98, 131072
    s_nop 0
    buffer_load_dwordx4 v12, s[44:47], s83 offen lds
    s_add_u32 m0, s98, 132096
    s_nop 0
    buffer_load_dwordx4 v13, s[44:47], s83 offen lds
    s_add_u32 m0, s98, 133120
    s_nop 0
    buffer_load_dwordx4 v14, s[44:47], s83 offen lds
    s_add_u32 m0, s98, 134144
    s_nop 0
    buffer_load_dwordx4 v15, s[44:47], s83 offen lds
    s_waitcnt vmcnt(13)
    s_waitcnt vmcnt(8)
    v_add_f32 v56, v56, v57
    v_add_f32 v58, v58, v59
    v_add_f32 v56, v56, v58
    v_cvt_pk_bf16_f32 v59, v56, 0
    v_lshlrev_b32 v57, 16, v59
    v_sub_f32 v57, v56, v57
    v_cvt_pk_bf16_f32 v58, v56, v57
    s_lshl_b32 s83, s72, 9
    s_add_u32 s83, s83, s76
    v_lshl_add_u32 v3, v1, 3, s83
    ds_write_b64 v3, v[58:59]
    ds_write_b64 v3, v[60:61] offset:2048
    s_waitcnt lgkmcnt(0)
    s_barrier
    s_add_u32 s84, s72, 8
    s_mul_i32 s84, s84, 13108
    s_lshr_b32 s84, s84, 16
    s_and_b32 s85, s84, 1
    s_lshl_b32 s85, s85, 1
    s_lshr_b32 s86, s84, 1
    s_or_b32 s85, s85, s86
    s_and_b32 s86, s79, 1
    s_xor_b32 s85, s85, s86
    s_xor_b32 s85, s85, 1
    s_sub_u32 s85, s85, s84
    s_mul_i32 s85, s85, 204800
    s_add_u32 s83, s91, 327680
    s_add_u32 s83, s83, s85
    s_add_u32 m0, s98, 147456
    s_nop 0
    buffer_load_dwordx4 v12, s[44:47], s83 offen lds
    s_add_u32 m0, s98, 148480
    s_nop 0
    buffer_load_dwordx4 v13, s[44:47], s83 offen lds
    s_add_u32 m0, s98, 149504
    s_nop 0
    buffer_load_dwordx4 v14, s[44:47], s83 offen lds
    s_add_u32 m0, s98, 150528
    s_nop 0
    buffer_load_dwordx4 v15, s[44:47], s83 offen lds
    s_barrier
    s_add_u32 s84, s72, 12
    s_mul_i32 s84, s84, 13108
    s_lshr_b32 s84, s84, 16
    s_and_b32 s85, s84, 1
    s_lshl_b32 s85, s85, 1
    s_lshr_b32 s86, s84, 1
    s_or_b32 s85, s85, s86
    s_and_b32 s86, s79, 1
    s_xor_b32 s85, s85, s86
    s_xor_b32 s85, s85, 1
    s_sub_u32 s85, s85, s84
    s_mul_i32 s85, s85, 204800
    s_add_u32 s83, s91, 491520
    s_add_u32 s83, s83, s85
    s_add_u32 m0, s98, 81920
    s_nop 0
    buffer_load_dwordx4 v12, s[44:47], s83 offen lds
    s_add_u32 m0, s98, 82944
    s_nop 0
    buffer_load_dwordx4 v13, s[44:47], s83 offen lds
    s_add_u32 m0, s98, 83968
    s_nop 0
    buffer_load_dwordx4 v14, s[44:47], s83 offen lds
    s_add_u32 m0, s98, 84992
    s_nop 0
    buffer_load_dwordx4 v15, s[44:47], s83 offen lds
    s_add_u32 s84, s72, 16
    s_mul_i32 s84, s84, 13108
    s_lshr_b32 s84, s84, 16
    s_and_b32 s85, s84, 1
    s_lshl_b32 s85, s85, 1
    s_lshr_b32 s86, s84, 1
    s_or_b32 s85, s85, s86
    s_and_b32 s86, s79, 1
    s_xor_b32 s85, s85, s86
    s_xor_b32 s85, s85, 1
    s_sub_u32 s85, s85, s84
    s_mul_i32 s85, s85, 204800
    s_add_u32 s83, s91, 655360
    s_add_u32 s83, s83, s85
    s_add_u32 m0, s98, 98304
    s_nop 0
    buffer_load_dwordx4 v12, s[44:47], s83 offen lds
    s_add_u32 m0, s98, 99328
    s_nop 0
    buffer_load_dwordx4 v13, s[44:47], s83 offen lds
    s_add_u32 m0, s98, 100352
    s_nop 0
    buffer_load_dwordx4 v14, s[44:47], s83 offen lds
    s_add_u32 m0, s98, 101376
    s_nop 0
    buffer_load_dwordx4 v15, s[44:47], s83 offen lds
    s_cmp_ge_u32 s2, 96
    s_cbranch_scc1 SK_9
    v_lshlrev_b32 v44, 16, v24
    v_lshlrev_b32 v53, 16, v28
    v_add_f32 v44, v44, v53
    v_lshlrev_b32 v52, 16, v32
    v_add_f32 v44, v44, v52
    v_lshlrev_b32 v53, 16, v36
    v_add_f32 v44, v44, v53
    v_lshlrev_b32 v52, 16, v40
    v_add_f32 v44, v44, v52
    v_and_b32 v45, 0xffff0000, v24
    v_and_b32 v53, 0xffff0000, v28
    v_add_f32_e64 v45, v45, v53
    v_and_b32 v52, 0xffff0000, v32
    v_add_f32_e64 v45, v45, v52
    v_and_b32 v53, 0xffff0000, v36
    v_add_f32_e64 v45, v45, v53
    v_and_b32 v52, 0xffff0000, v40
    v_add_f32 v45, v45, v52
    v_lshlrev_b32 v46, 16, v25
    v_lshlrev_b32 v53, 16, v29
    v_add_f32 v46, v46, v53
    v_lshlrev_b32 v52, 16, v33
    v_add_f32 v46, v46, v52
    v_lshlrev_b32 v53, 16, v37
    v_add_f32 v46, v46, v53
    v_lshlrev_b32 v52, 16, v41
    v_add_f32 v46, v46, v52
    v_and_b32 v47, 0xffff0000, v25
    v_and_b32 v53, 0xffff0000, v29
    v_add_f32_e64 v47, v47, v53
    v_and_b32 v52, 0xffff0000, v33
    v_add_f32_e64 v47, v47, v52
    v_and_b32 v53, 0xffff0000, v37
    v_add_f32_e64 v47, v47, v53
    v_and_b32 v52, 0xffff0000, v41
    v_add_f32 v47, v47, v52
    v_lshlrev_b32 v48, 16, v26
    v_lshlrev_b32 v53, 16, v30
    v_add_f32 v48, v48, v53
    v_lshlrev_b32 v52, 16, v34
    v_add_f32 v48, v48, v52
    v_lshlrev_b32 v53, 16, v38
    v_add_f32 v48, v48, v53
    v_lshlrev_b32 v52, 16, v42
    v_add_f32 v48, v48, v52
    v_and_b32 v49, 0xffff0000, v26
    v_and_b32 v53, 0xffff0000, v30
    v_add_f32_e64 v49, v49, v53
    v_and_b32 v52, 0xffff0000, v34
    v_add_f32_e64 v49, v49, v52
    v_and_b32 v53, 0xffff0000, v38
    v_add_f32_e64 v49, v49, v53
    v_and_b32 v52, 0xffff0000, v42
    v_add_f32 v49, v49, v52
    v_lshlrev_b32 v50, 16, v27
    v_lshlrev_b32 v53, 16, v31
    v_add_f32 v50, v50, v53
    v_lshlrev_b32 v52, 16, v35
    v_add_f32 v50, v50, v52
    v_lshlrev_b32 v53, 16, v39
    v_add_f32 v50, v50, v53
    v_lshlrev_b32 v52, 16, v43
    v_add_f32 v50, v50, v52
    v_and_b32 v51, 0xffff0000, v27
    v_and_b32 v53, 0xffff0000, v31
    v_add_f32_e64 v51, v51, v53
    v_and_b32 v52, 0xffff0000, v35
    v_add_f32_e64 v51, v51, v52
    v_and_b32 v53, 0xffff0000, v39
    v_add_f32_e64 v51, v51, v53
    v_and_b32 v52, 0xffff0000, v43
    v_add_f32 v51, v51, v52
    v_permlane32_swap_b32 v44, v48
    v_permlane32_swap_b32 v45, v49
    v_permlane32_swap_b32 v46, v50
    v_permlane32_swap_b32 v47, v51
    v_add_f32 v44, v44, v48
    v_add_f32 v45, v45, v49
    v_add_f32 v46, v46, v50
    v_add_f32 v47, v47, v51
    s_nop 0
    v_permlane16_swap_b32 v44, v46
    v_permlane16_swap_b32 v45, v47
    v_add_f32 v44, v44, v46
    v_add_f32 v45, v45, v47
    s_nop 0
    v_add_f32_dpp v44, v44, v44 row_ror:8 row_mask:0xf bank_mask:0xf
    v_add_f32_dpp v45, v45, v45 row_ror:8 row_mask:0xf bank_mask:0xf
    v_and_b32 v3, 7, v1
    v_lshlrev_b32 v3, 5, v3
    v_lshrrev_b32 v4, 4, v1
    v_lshl_add_u32 v3, v4, 3, v3
    s_lshl_b32 s83, s72, 8
    s_add_u32 s83, s83, s87
    v_add_u32_e64 v3, s83, v3
    ds_write_b64 v3, v[44:45]
    s_waitcnt lgkmcnt(0)
SK_9:
    s_barrier
    s_cmp_lg_u32 s72, 0
    s_cbranch_scc1 SK_10
    s_cmp_ge_u32 s2, 96
    s_cbranch_scc1 SK_10
    v_lshlrev_b32 v3, 2, v1
    v_add_u32 v4, 77824, v3
    ds_read_b32 v24, v4 offset:0
    ds_read_b32 v25, v4 offset:256
    ds_read_b32 v26, v4 offset:512
    ds_read_b32 v27, v4 offset:768
    s_waitcnt lgkmcnt(0)
    v_add_f32 v24, v24, v25
    v_add_f32 v26, v26, v27
    v_add_f32 v24, v24, v26
    s_lshl_b32 s83, s92, 14
    s_lshl_b32 s84, s93, 8
    s_add_u32 s83, s83, s84
    s_add_u32 s83, s83, 108544
    buffer_store_dword v24, v3, s[64:67], s83 offen sc1
SK_10:
    s_sub_u32 s83, s5, 20
    s_cmp_ge_u32 s5, 20
    s_cselect_b32 s5, s83, s5
    s_mul_i32 s83, s5, 98304
    s_add_u32 m0, s98, 0
    s_nop 0
    buffer_load_dwordx4 v16, s[48:51], s83 offen lds
    s_add_u32 m0, s98, 1024
    s_nop 0
    buffer_load_dwordx4 v17, s[48:51], s83 offen lds
    s_add_u32 m0, s98, 2048
    s_nop 0
    buffer_load_dwordx4 v18, s[48:51], s83 offen lds
    s_add_u32 m0, s98, 3072
    s_nop 0
    buffer_load_dwordx4 v19, s[48:51], s83 offen lds
    s_mul_i32 s83, s5, 98304
    s_add_u32 s83, s83, 128
    s_add_u32 s5, s5, 4
    s_add_u32 m0, s98, 16384
    s_nop 0
    buffer_load_dwordx4 v16, s[48:51], s83 offen lds
    s_add_u32 m0, s98, 17408
    s_nop 0
    buffer_load_dwordx4 v17, s[48:51], s83 offen lds
    s_add_u32 m0, s98, 18432
    s_nop 0
    buffer_load_dwordx4 v18, s[48:51], s83 offen lds
    s_add_u32 m0, s98, 19456
    s_nop 0
    buffer_load_dwordx4 v19, s[48:51], s83 offen lds
    s_waitcnt vmcnt(8)
    s_cmp_lg_u32 s72, 0
    s_cbranch_scc1 SK_11
    s_cmp_ge_u32 s2, 96
    s_cbranch_scc1 SK_11
    s_waitcnt vmcnt(8)
    s_lshl_b32 s83, s2, 7
    s_add_u32 s83, s83, 22257664
    s_mov_b64 exec, 1
    buffer_store_dword v2, off, s[64:67], s83 sc1
    s_mov_b64 exec, -1
SK_11:
    s_barrier
    s_getpc_b64 s[12:13]
L_PCT_12:
    s_lshl_b32 s11, s72, 7
    s_add_u32 s11, s11, E2B-L_PCT_12+0
    s_add_u32 s12, s12, s11
    s_addc_u32 s13, s13, 0
    s_load_dword s10, s[12:13], 0
    s_load_dword s10, s[12:13], 512
    s_load_dword s10, s[12:13], 1024
    s_load_dword s10, s[12:13], 1536
    s_load_dword s10, s[12:13], 2048
    s_load_dword s10, s[12:13], 2560
    s_load_dword s10, s[12:13], 3072
    s_load_dword s10, s[12:13], 3584
    s_load_dword s10, s[12:13], 4096
    s_load_dword s10, s[12:13], 4608
    s_load_dword s10, s[12:13], 5120
    s_load_dword s10, s[12:13], 5632
    s_load_dword s10, s[12:13], 6144
    s_load_dword s10, s[12:13], 6656
    s_waitcnt vmcnt(0)
    s_barrier
    s_mov_b32 s90, 200000
    s_mov_b64 exec, 0xf
POLL_13:
    buffer_load_dword v23, v22, s[64:67], 0 offen sc1
    s_waitcnt vmcnt(0)
    v_cmp_ne_u32 vcc, s73, v23
    s_cbranch_vccz POLLD_14
    s_sub_u32 s90, s90, 1
    s_cmp_lg_u32 s90, 0
    s_cbranch_scc1 POLL_13
POLLD_14:
    s_mov_b64 exec, -1
    s_mov_b32 s83, 98304
    buffer_load_dword v88, v21, s[64:67], s83 offen sc1
    s_mov_b32 s83, 114688
    buffer_load_dword v89, v21, s[64:67], s83 offen sc1
    s_mov_b32 s83, 131072
    buffer_load_dword v90, v21, s[64:67], s83 offen sc1
    s_mov_b32 s83, 147456
    buffer_load_dword v91, v21, s[64:67], s83 offen sc1
    s_sub_u32 s83, s5, 20
    s_cmp_ge_u32 s5, 20
    s_cselect_b32 s5, s83, s5
    s_mul_i32 s83, s5, 98304
    s_add_u32 m0, s98, 32768
    s_nop 0
    buffer_load_dwordx4 v16, s[48:51], s83 offen lds
    s_add_u32 m0, s98, 33792
    s_nop 0
    buffer_load_dwordx4 v17, s[48:51], s83 offen lds
    s_add_u32 m0, s98, 34816
    s_nop 0
    buffer_load_dwordx4 v18, s[48:51], s83 offen lds
    s_add_u32 m0, s98, 35840
    s_nop 0
    buffer_load_dwordx4 v19, s[48:51], s83 offen lds
    s_mul_i32 s83, s5, 98304
    s_add_u32 s83, s83, 128
    s_add_u32 s5, s5, 4
    s_add_u32 m0, s98, 49152
    s_nop 0
    buffer_load_dwordx4 v16, s[48:51], s83 offen lds
    s_add_u32 m0, s98, 50176
    s_nop 0
    buffer_load_dwordx4 v17, s[48:51], s83 offen lds
    s_add_u32 m0, s98, 51200
    s_nop 0
    buffer_load_dwordx4 v18, s[48:51], s83 offen lds
    s_add_u32 m0, s98, 52224
    s_nop 0
    buffer_load_dwordx4 v19, s[48:51], s83 offen lds
    s_sub_u32 s83, s5, 20
    s_cmp_ge_u32 s5, 20
    s_cselect_b32 s5, s83, s5
    s_mul_i32 s83, s5, 98304
    s_add_u32 m0, s98, 65536
    s_nop 0
    buffer_load_dwordx4 v16, s[48:51], s83 offen lds
    s_add_u32 m0, s98, 66560
    s_nop 0
    buffer_load_dwordx4 v17, s[48:51], s83 offen lds
    s_add_u32 m0, s98, 67584
    s_nop 0
    buffer_load_dwordx4 v18, s[48:51], s83 offen lds
    s_add_u32 m0, s98, 68608
    s_nop 0
    buffer_load_dwordx4 v19, s[48:51], s83 offen lds
    s_barrier
    s_mul_i32 s83, s5, 98304
    s_add_u32 s83, s83, 128
    s_add_u32 s5, s5, 4
    s_add_u32 m0, s98, 81920
    s_nop 0
    buffer_load_dwordx4 v16, s[48:51], s83 offen lds
    s_add_u32 m0, s98, 82944
    s_nop 0
    buffer_load_dwordx4 v17, s[48:51], s83 offen lds
    s_add_u32 m0, s98, 83968
    s_nop 0
    buffer_load_dwordx4 v18, s[48:51], s83 offen lds
    s_add_u32 m0, s98, 84992
    s_nop 0
    buffer_load_dwordx4 v19, s[48:51], s83 offen lds
    s_sub_u32 s83, s5, 20
    s_cmp_ge_u32 s5, 20
    s_cselect_b32 s5, s83, s5
    s_mul_i32 s83, s5, 98304
    s_add_u32 m0, s98, 98304
    s_nop 0
    buffer_load_dwordx4 v16, s[48:51], s83 offen lds
    s_add_u32 m0, s98, 99328
    s_nop 0
    buffer_load_dwordx4 v17, s[48:51], s83 offen lds
    s_add_u32 m0, s98, 100352
    s_nop 0
    buffer_load_dwordx4 v18, s[48:51], s83 offen lds
    s_add_u32 m0, s98, 101376
    s_nop 0
    buffer_load_dwordx4 v19, s[48:51], s83 offen lds
    s_mul_i32 s83, s5, 98304
    s_add_u32 s83, s83, 128
    s_add_u32 s5, s5, 4
    s_add_u32 m0, s98, 114688
    s_nop 0
    buffer_load_dwordx4 v16, s[48:51], s83 offen lds
    s_add_u32 m0, s98, 115712
    s_nop 0
    buffer_load_dwordx4 v17, s[48:51], s83 offen lds
    s_add_u32 m0, s98, 116736
    s_nop 0
    buffer_load_dwordx4 v18, s[48:51], s83 offen lds
    s_add_u32 m0, s98, 117760
    s_nop 0
    buffer_load_dwordx4 v19, s[48:51], s83 offen lds
    s_waitcnt vmcnt(24)
    v_add_f32 v88, v88, v89
    v_add_f32 v90, v90, v91
    v_add_f32 v88, v88, v90
    v_cvt_pk_bf16_f32 v91, v88, 0
    v_lshlrev_b32 v89, 16, v91
    v_sub_f32 v89, v88, v89
    v_cvt_pk_bf16_f32 v90, v88, v89
    s_lshl_b32 s83, s72, 9
    s_add_u32 s83, s83, 147456
    v_lshl_add_u32 v3, v1, 3, s83
    ds_write_b64 v3, v[90:91]
    s_waitcnt lgkmcnt(0)
    s_barrier
    s_waitcnt vmcnt(16)
    s_barrier
    s_getpc_b64 s[12:13]
L_PCT_15:
    s_lshl_b32 s11, s72, 7
    s_add_u32 s11, s11, E2B-L_PCT_15+7168
    s_add_u32 s12, s12, s11
    s_addc_u32 s13, s13, 0
    s_load_dword s10, s[12:13], 0
    s_load_dword s10, s[12:13], 512
    s_load_dword s10, s[12:13], 1024
    s_load_dword s10, s[12:13], 1536
    s_load_dword s10, s[12:13], 2048
    s_load_dword s10, s[12:13], 2560
    s_load_dword s10, s[12:13], 3072
    s_load_dword s10, s[12:13], 3584
    s_load_dword s10, s[12:13], 4096
    s_load_dword s10, s[12:13], 4608
    s_load_dword s10, s[12:13], 5120
    s_load_dword s10, s[12:13], 5632
    s_load_dword s10, s[12:13], 6144
    s_load_dword s10, s[12:13], 6656
    s_sub_u32 s83, s5, 20
    s_cmp_ge_u32 s5, 20
    s_cselect_b32 s5, s83, s5
    s_mul_i32 s83, s5, 98304
    s_add_u32 m0, s98, 131072
    s_nop 0
    buffer_load_dwordx4 v16, s[48:51], s83 offen lds
    s_add_u32 m0, s98, 132096
    s_nop 0
    buffer_load_dwordx4 v17, s[48:51], s83 offen lds
    s_add_u32 m0, s98, 133120
    s_nop 0
    buffer_load_dwordx4 v18, s[48:51], s83 offen lds
    s_add_u32 m0, s98, 134144
    s_nop 0
    buffer_load_dwordx4 v19, s[48:51], s83 offen lds
    s_mul_i32 s83, s5, 98304
    s_add_u32 s83, s83, 128
    s_add_u32 s5, s5, 4
    s_add_u32 m0, s98, 147456
    s_nop 0
    buffer_load_dwordx4 v16, s[48:51], s83 offen lds
    s_add_u32 m0, s98, 148480
    s_nop 0
    buffer_load_dwordx4 v17, s[48:51], s83 offen lds
    s_add_u32 m0, s98, 149504
    s_nop 0
    buffer_load_dwordx4 v18, s[48:51], s83 offen lds
    s_add_u32 m0, s98, 150528
    s_nop 0
    buffer_load_dwordx4 v19, s[48:51], s83 offen lds
    s_mul_i32 s83, s6, 163840
    s_add_u32 s83, s83, s91
    s_add_u32 s6, s6, 1
    s_cmp_eq_u32 s6, 10
    s_cselect_b32 s6, 0, s6
    s_add_u32 m0, s98, 0
    s_nop 0
    buffer_load_dwordx4 v12, s[52:55], s83 offen lds
    s_add_u32 m0, s98, 1024
    s_nop 0
    buffer_load_dwordx4 v13, s[52:55], s83 offen lds
    s_add_u32 m0, s98, 2048
    s_nop 0
    buffer_load_dwordx4 v14, s[52:55], s83 offen lds
    s_add_u32 m0, s98, 3072
    s_nop 0
    buffer_load_dwordx4 v15, s[52:55], s83 offen lds
    s_waitcnt vmcnt(20)
    s_barrier
    s_mul_i32 s83, s6, 163840
    s_add_u32 s83, s83, s91
    s_add_u32 s6, s6, 1
    s_cmp_eq_u32 s6, 10
    s_cselect_b32 s6, 0, s6
    s_add_u32 m0, s98, 16384
    s_nop 0
    buffer_load_dwordx4 v12, s[52:55], s83 offen lds
    s_add_u32 m0, s98, 17408
    s_nop 0
    buffer_load_dwordx4 v13, s[52:55], s83 offen lds
    s_add_u32 m0, s98, 18432
    s_nop 0
    buffer_load_dwordx4 v14, s[52:55], s83 offen lds
    s_add_u32 m0, s98, 19456
    s_nop 0
    buffer_load_dwordx4 v15, s[52:55], s83 offen lds
    s_mul_i32 s83, s6, 163840
    s_add_u32 s83, s83, s91
    s_add_u32 s6, s6, 1
    s_cmp_eq_u32 s6, 10
    s_cselect_b32 s6, 0, s6
    s_add_u32 m0, s98, 32768
    s_nop 0
    buffer_load_dwordx4 v12, s[52:55], s83 offen lds
    s_add_u32 m0, s98, 33792
    s_nop 0
    buffer_load_dwordx4 v13, s[52:55], s83 offen lds
    s_add_u32 m0, s98, 34816
    s_nop 0
    buffer_load_dwordx4 v14, s[52:55], s83 offen lds
    s_add_u32 m0, s98, 35840
    s_nop 0
    buffer_load_dwordx4 v15, s[52:55], s83 offen lds
    s_mul_i32 s83, s6, 163840
    s_add_u32 s83, s83, s91
    s_add_u32 s6, s6, 1
    s_cmp_eq_u32 s6, 10
    s_cselect_b32 s6, 0, s6
    s_add_u32 m0, s98, 49152
    s_nop 0
    buffer_load_dwordx4 v12, s[52:55], s83 offen lds
    s_add_u32 m0, s98, 50176
    s_nop 0
    buffer_load_dwordx4 v13, s[52:55], s83 offen lds
    s_add_u32 m0, s98, 51200
    s_nop 0
    buffer_load_dwordx4 v14, s[52:55], s83 offen lds
    s_add_u32 m0, s98, 52224
    s_nop 0
    buffer_load_dwordx4 v15, s[52:55], s83 offen lds
    s_waitcnt vmcnt(24)
    s_barrier
    s_getpc_b64 s[12:13]
L_PCT_16:
    s_lshl_b32 s11, s72, 7
    s_add_u32 s11, s11, E3B-L_PCT_16+0
    s_add_u32 s12, s12, s11
    s_addc_u32 s13, s13, 0
    s_load_dword s10, s[12:13], 0
    s_load_dword s10, s[12:13], 512
    s_load_dword s10, s[12:13], 1024
    s_load_dword s10, s[12:13], 1536
    s_load_dword s10, s[12:13], 2048
    s_load_dword s10, s[12:13], 2560
    s_load_dword s10, s[12:13], 3072
    s_load_dword s10, s[12:13], 3584
    s_load_dword s10, s[12:13], 4096
    s_load_dword s10, s[12:13], 4608
    s_load_dword s10, s[12:13], 5120
    s_load_dword s10, s[12:13], 5632
    s_load_dword s10, s[12:13], 6144
    s_load_dword s10, s[12:13], 6656
    s_add_u32 s83, s91, 1638400
    buffer_load_dwordx4 v[56:59], v12, s[52:55], s83 offen
    buffer_load_dwordx4 v[60:63], v13, s[52:55], s83 offen
    buffer_load_dwordx4 v[64:67], v14, s[52:55], s83 offen
    buffer_load_dwordx4 v[68:71], v15, s[52:55], s83 offen
    s_mul_i32 s83, s6, 163840
    s_add_u32 s83, s83, s91
    s_add_u32 s6, s6, 1
    s_cmp_eq_u32 s6, 10
    s_cselect_b32 s6, 0, s6
    s_add_u32 m0, s98, 65536
    s_nop 0
    buffer_load_dwordx4 v12, s[52:55], s83 offen lds
    s_add_u32 m0, s98, 66560
    s_nop 0
    buffer_load_dwordx4 v13, s[52:55], s83 offen lds
    s_add_u32 m0, s98, 67584
    s_nop 0
    buffer_load_dwordx4 v14, s[52:55], s83 offen lds
    s_add_u32 m0, s98, 68608
    s_nop 0
    buffer_load_dwordx4 v15, s[52:55], s83 offen lds
    s_mul_i32 s83, s6, 163840
    s_add_u32 s83, s83, s91
    s_add_u32 s6, s6, 1
    s_cmp_eq_u32 s6, 10
    s_cselect_b32 s6, 0, s6
    s_add_u32 m0, s98, 81920
    s_nop 0
    buffer_load_dwordx4 v12, s[52:55], s83 offen lds
    s_add_u32 m0, s98, 82944
    s_nop 0
    buffer_load_dwordx4 v13, s[52:55], s83 offen lds
    s_add_u32 m0, s98, 83968
    s_nop 0
    buffer_load_dwordx4 v14, s[52:55], s83 offen lds
    s_add_u32 m0, s98, 84992
    s_nop 0
    buffer_load_dwordx4 v15, s[52:55], s83 offen lds
    s_waitcnt vmcnt(28)
    s_barrier
    s_add_u32 s83, s91, 1802240
    buffer_load_dwordx4 v[72:75], v12, s[52:55], s83 offen
    buffer_load_dwordx4 v[76:79], v13, s[52:55], s83 offen
    buffer_load_dwordx4 v[80:83], v14, s[52:55], s83 offen
    buffer_load_dwordx4 v[84:87], v15, s[52:55], s83 offen
    s_mul_i32 s83, s6, 163840
    s_add_u32 s83, s83, s91
    s_add_u32 s6, s6, 1
    s_cmp_eq_u32 s6, 10
    s_cselect_b32 s6, 0, s6
    s_add_u32 m0, s98, 98304
    s_nop 0
    buffer_load_dwordx4 v12, s[52:55], s83 offen lds
    s_add_u32 m0, s98, 99328
    s_nop 0
    buffer_load_dwordx4 v13, s[52:55], s83 offen lds
    s_add_u32 m0, s98, 100352
    s_nop 0
    buffer_load_dwordx4 v14, s[52:55], s83 offen lds
    s_add_u32 m0, s98, 101376
    s_nop 0
    buffer_load_dwordx4 v15, s[52:55], s83 offen lds
    s_mul_i32 s83, s6, 163840
    s_add_u32 s83, s83, s91
    s_add_u32 s6, s6, 1
    s_cmp_eq_u32 s6, 10
    s_cselect_b32 s6, 0, s6
    s_add_u32 m0, s98, 114688
    s_nop 0
    buffer_load_dwordx4 v12, s[52:55], s83 offen lds
    s_add_u32 m0, s98, 115712
    s_nop 0
    buffer_load_dwordx4 v13, s[52:55], s83 offen lds
    s_add_u32 m0, s98, 116736
    s_nop 0
    buffer_load_dwordx4 v14, s[52:55], s83 offen lds
    s_add_u32 m0, s98, 117760
    s_nop 0
    buffer_load_dwordx4 v15, s[52:55], s83 offen lds
    s_waitcnt vmcnt(32)
    s_barrier
    s_getpc_b64 s[12:13]
L_PCT_17:
    s_lshl_b32 s11, s72, 7
    s_add_u32 s11, s11, E3B-L_PCT_17+7168
    s_add_u32 s12, s12, s11
    s_addc_u32 s13, s13, 0
    s_load_dword s10, s[12:13], 0
    s_load_dword s10, s[12:13], 512
    s_load_dword s10, s[12:13], 1024
    s_load_dword s10, s[12:13], 1536
    s_load_dword s10, s[12:13], 2048
    s_load_dword s10, s[12:13], 2560
    s_load_dword s10, s[12:13], 3072
    s_load_dword s10, s[12:13], 3584
    s_load_dword s10, s[12:13], 4096
    s_load_dword s10, s[12:13], 4608
    s_load_dword s10, s[12:13], 5120
    s_load_dword s10, s[12:13], 5632
    s_load_dword s10, s[12:13], 6144
    s_load_dword s10, s[12:13], 6656
    s_mul_i32 s83, s6, 163840
    s_add_u32 s83, s83, s91
    s_add_u32 s6, s6, 1
    s_cmp_eq_u32 s6, 10
    s_cselect_b32 s6, 0, s6
    s_add_u32 m0, s98, 131072
    s_nop 0
    buffer_load_dwordx4 v12, s[52:55], s83 offen lds
    s_add_u32 m0, s98, 132096
    s_nop 0
    buffer_load_dwordx4 v13, s[52:55], s83 offen lds
    s_add_u32 m0, s98, 133120
    s_nop 0
    buffer_load_dwordx4 v14, s[52:55], s83 offen lds
    s_add_u32 m0, s98, 134144
    s_nop 0
    buffer_load_dwordx4 v15, s[52:55], s83 offen lds
    s_mul_i32 s83, s6, 163840
    s_add_u32 s83, s83, s91
    s_add_u32 s6, s6, 1
    s_cmp_eq_u32 s6, 10
    s_cselect_b32 s6, 0, s6
    s_add_u32 m0, s98, 147456
    s_nop 0
    buffer_load_dwordx4 v12, s[52:55], s83 offen lds
    s_add_u32 m0, s98, 148480
    s_nop 0
    buffer_load_dwordx4 v13, s[52:55], s83 offen lds
    s_add_u32 m0, s98, 149504
    s_nop 0
    buffer_load_dwordx4 v14, s[52:55], s83 offen lds
    s_add_u32 m0, s98, 150528
    s_nop 0
    buffer_load_dwordx4 v15, s[52:55], s83 offen lds
    s_waitcnt vmcnt(0)
    s_barrier
    s_getpc_b64 s[12:13]
L_PCT_18:
    s_lshl_b32 s11, s72, 7
    s_add_u32 s11, s11, E3B-L_PCT_18+14336
    s_add_u32 s12, s12, s11
    s_addc_u32 s13, s13, 0
    s_load_dword s10, s[12:13], 0
    s_load_dword s10, s[12:13], 512
    s_load_dword s10, s[12:13], 1024
    s_load_dword s10, s[12:13], 1536
    s_load_dword s10, s[12:13], 2048
    s_load_dword s10, s[12:13], 2560
    s_load_dword s10, s[12:13], 3072
    s_load_dword s10, s[12:13], 3584
    s_load_dword s10, s[12:13], 4096
    s_load_dword s10, s[12:13], 4608
    s_load_dword s10, s[12:13], 5120
    s_load_dword s10, s[12:13], 5632
    s_load_dword s10, s[12:13], 6144
    s_load_dword s10, s[12:13], 6656
    v_lshl_add_u32 v3, v1, 4, s98
    v_add_u32_e64 v3, 0, v3
    ds_write_b128 v3, v[56:59] offset:0
    ds_write_b128 v3, v[60:63] offset:1024
    ds_write_b128 v3, v[64:67] offset:2048
    ds_write_b128 v3, v[68:71] offset:3072
    v_lshl_add_u32 v3, v1, 4, s98
    v_add_u32 v3, 16384, v3
    ds_write_b128 v3, v[72:75] offset:0
    ds_write_b128 v3, v[76:79] offset:1024
    ds_write_b128 v3, v[80:83] offset:2048
    ds_write_b128 v3, v[84:87] offset:3072
    s_waitcnt lgkmcnt(0)
    s_getpc_b64 s[12:13]
L_PCT_19:
    s_lshl_b32 s11, s72, 7
    s_add_u32 s11, s11, E4B-L_PCT_19+-1024
    s_add_u32 s12, s12, s11
    s_addc_u32 s13, s13, 0
    s_load_dword s10, s[12:13], 0
    s_load_dword s10, s[12:13], 512
    s_load_dword s10, s[12:13], 1024
    s_load_dword s10, s[12:13], 1536
    s_load_dword s10, s[12:13], 2048
    s_load_dword s10, s[12:13], 2560
    s_load_dword s10, s[12:13], 3072
    s_load_dword s10, s[12:13], 3584
    s_load_dword s10, s[12:13], 4096
    s_load_dword s10, s[12:13], 4608
    s_load_dword s10, s[12:13], 5120
    s_load_dword s10, s[12:13], 5632
    s_load_dword s10, s[12:13], 6144
    s_load_dword s10, s[12:13], 6656
    s_barrier
    s_or_b32 s83, s2, s72
    s_cmp_lg_u32 s83, 0
    s_cbranch_scc1 SK_20
    v_lshlrev_b32 v3, 7, v1
    v_add_u32 v20, 22020096, v3
    s_mov_b32 s90, 200000
POLL_21:
    buffer_load_dword v23, v20, s[64:67], 0 offen sc1
    s_waitcnt vmcnt(0)
    v_cmp_ne_u32 vcc, s73, v23
    s_cbranch_vccz POLLD_22
    s_sub_u32 s90, s90, 1
    s_cmp_lg_u32 s90, 0
    s_cbranch_scc1 POLL_21
POLLD_22:
    v_lshlrev_b32_e64 v3, 7, v1
    v_add_u32 v20, 22028288, v3
    s_mov_b32 s90, 200000
POLL_23:
    buffer_load_dword v23, v20, s[64:67], 0 offen sc1
    s_waitcnt vmcnt(0)
    v_cmp_ne_u32 vcc, s73, v23
    s_cbranch_vccz POLLD_24
    s_sub_u32 s90, s90, 1
    s_cmp_lg_u32 s90, 0
    s_cbranch_scc1 POLL_23
POLLD_24:
    v_lshlrev_b32_e64 v3, 7, v1
    v_add_u32 v20, 22036480, v3
    s_mov_b32 s90, 200000
POLL_25:
    buffer_load_dword v23, v20, s[64:67], 0 offen sc1
    s_waitcnt vmcnt(0)
    v_cmp_ne_u32 vcc, s73, v23
    s_cbranch_vccz POLLD_26
    s_sub_u32 s90, s90, 1
    s_cmp_lg_u32 s90, 0
    s_cbranch_scc1 POLL_25
POLLD_26:
    v_lshlrev_b32_e64 v3, 7, v1
    v_add_u32 v20, 22044672, v3
    s_mov_b32 s90, 200000
POLL_27:
    buffer_load_dword v23, v20, s[64:67], 0 offen sc1
    s_waitcnt vmcnt(0)
    v_cmp_ne_u32 vcc, s73, v23
    s_cbranch_vccz POLLD_28
    s_sub_u32 s90, s90, 1
    s_cmp_lg_u32 s90, 0
    s_cbranch_scc1 POLL_27
POLLD_28:
    s_mov_b32 s83, 0
    s_mov_b64 exec, 1
    buffer_store_dword v2, off, s[64:67], s83 sc1
    s_mov_b64 exec, -1
SK_20:
    s_endpgm
LD_A:
    s_lshl_b32 s83, s81, 8
    s_lshl_b32 s84, s72, 6
    s_add_u32 s83, s83, s84
    s_mul_i32 s83, s83, 1280
    v_lshrrev_b32 v3, 3, v1
    v_lshrrev_b32 v4, 4, v1
    v_and_b32 v5, 7, v1
    v_xor_b32_e64 v4, v4, v5
    v_mul_u32_u24 v3, 1280, v3
    v_add_u32_e64 v3, s83, v3
    v_lshl_add_u32 v8, v4, 4, v3
    v_xor_b32_e64 v9, 64, v8
    v_add_u32 v9, 10240, v9
    v_add_u32 v10, 20480, v8
    v_add_u32 v11, 20480, v9
    s_mul_i32 s77, s75, 160
    s_add_u32 s77, s77, 1280
    s_sub_u32 s85, s75, 8
    s_mul_i32 s85, s85, 320
    s_cmp_lt_u32 s75, 8
    s_cselect_b32 s77, s77, s85
    s_cselect_b32 s78, 1120, 0
    s_lshl_b32 s89, s72, 13
    s_add_u32 s89, s89, 20480
    s_mul_i32 s88, s72, 5120
    s_lshl_b32 s98, s72, 12
    s_waitcnt lgkmcnt(0)
    s_mov_b32 s36, s16
    s_mov_b32 s37, s17
    s_mov_b32 s38, 2621440
    s_mov_b32 s39, 0x20000
    s_mov_b32 s40, s18
    s_mov_b32 s41, s19
    s_mov_b32 s42, 2457600
    s_mov_b32 s43, 0x20000
    s_mov_b32 s91, 0
    s_lshl_b32 s83, s91, 7
    s_add_u32 s84, s83, 40960
    s_add_u32 m0, s89, 0
    s_nop 0
    buffer_load_dwordx4 v8, s[36:39], s83 offen lds
    s_add_u32 m0, s89, 1024
    s_nop 0
    buffer_load_dwordx4 v9, s[36:39], s83 offen lds
    s_add_u32 m0, s89, 2048
    s_nop 0
    buffer_load_dwordx4 v10, s[36:39], s83 offen lds
    s_add_u32 m0, s89, 3072
    s_nop 0
    buffer_load_dwordx4 v11, s[36:39], s83 offen lds
    s_add_u32 m0, s89, 4096
    s_nop 0
    buffer_load_dwordx4 v8, s[36:39], s84 offen lds
    s_add_u32 m0, s89, 5120
    s_nop 0
    buffer_load_dwordx4 v9, s[36:39], s84 offen lds
    s_add_u32 m0, s89, 6144
    s_nop 0
    buffer_load_dwordx4 v10, s[36:39], s84 offen lds
    s_add_u32 m0, s89, 7168
    s_nop 0
    buffer_load_dwordx4 v11, s[36:39], s84 offen lds
    s_load_dword s73, s[34:35], 0
    s_mul_i32 s85, s72, 61440
    s_add_u32 s85, s85, s77
    v_add_u32_e64 v3, 0, v1
    v_mul_u32_u24 v4, 3277, v3
    v_lshrrev_b32 v4, 16, v4
    v_mul_u32_u24 v5, 20, v4
    v_sub_u32_e64 v3, v3, v5
    v_mul_u32_u24 v4, 3840, v4
    v_lshl_add_u32 v4, v3, 4, v4
    v_mov_b32 v5, s78
    v_cmp_lt_u32 vcc, 9, v3
    s_nop 1
    v_cndmask_b32 v5, 0, v5, vcc
    v_add3_u32 v6, v4, v5, s85
    v_add_u32_e64 v3, 64, v1
    v_mul_u32_u24 v4, 3277, v3
    v_lshrrev_b32 v4, 16, v4
    v_mul_u32_u24 v5, 20, v4
    v_sub_u32_e64 v3, v3, v5
    v_mul_u32_u24 v4, 3840, v4
    v_lshl_add_u32 v4, v3, 4, v4
    v_mov_b32 v5, s78
    v_cmp_lt_u32 vcc, 9, v3
    s_nop 1
    v_cndmask_b32 v5, 0, v5, vcc
    v_add3_u32 v7, v4, v5, s85
    v_add_u32 v3, 128, v1
    v_mul_u32_u24 v4, 3277, v3
    v_lshrrev_b32 v4, 16, v4
    v_mul_u32_u24 v5, 20, v4
    v_sub_u32_e64 v3, v3, v5
    v_mul_u32_u24 v4, 3840, v4
    v_lshl_add_u32 v4, v3, 4, v4
    v_mov_b32 v5, s78
    v_cmp_lt_u32 vcc, 9, v3
    s_nop 1
    v_cndmask_b32 v5, 0, v5, vcc
    v_add3_u32 v12, v4, v5, s85
    v_add_u32 v3, 192, v1
    v_mul_u32_u24 v4, 3277, v3
    v_lshrrev_b32 v4, 16, v4
    v_mul_u32_u24 v5, 20, v4
    v_sub_u32_e64 v3, v3, v5
    v_mul_u32_u24 v4, 3840, v4
    v_lshl_add_u32 v4, v3, 4, v4
    v_mov_b32 v5, s78
    v_cmp_lt_u32 vcc, 9, v3
    s_nop 1
    v_cndmask_b32 v5, 0, v5, vcc
    v_add3_u32 v13, v4, v5, s85
    v_add_u32 v3, 256, v1
    v_mul_u32_u24 v4, 3277, v3
    v_lshrrev_b32 v4, 16, v4
    v_mul_u32_u24 v5, 20, v4
    v_sub_u32_e64 v3, v3, v5
    v_mul_u32_u24 v4, 3840, v4
    v_lshl_add_u32 v4, v3, 4, v4
    v_mov_b32 v5, s78
    v_cmp_lt_u32 vcc, 9, v3
    s_nop 1
    v_cndmask_b32 v5, 0, v5, vcc
    v_add3_u32 v14, v4, v5, s85
    s_mul_i32 s84, s91, 245760
    s_add_u32 m0, s88, 0
    s_nop 0
    buffer_load_dwordx4 v6, s[40:43], s84 offen lds
    s_add_u32 m0, s88, 1024
    s_nop 0
    buffer_load_dwordx4 v7, s[40:43], s84 offen lds
    s_add_u32 m0, s88, 2048
    s_nop 0
    buffer_load_dwordx4 v12, s[40:43], s84 offen lds
    s_add_u32 m0, s88, 3072
    s_nop 0
    buffer_load_dwordx4 v13, s[40:43], s84 offen lds
    s_add_u32 m0, s88, 4096
    s_nop 0
    buffer_load_dwordx4 v14, s[40:43], s84 offen lds
    s_add_u32 s91, s91, 1
    s_cmp_eq_u32 s91, 10
    s_cselect_b32 s91, 0, s91
    s_mov_b32 s64, s34
    s_mov_b32 s65, s35
    s_mov_b32 s66, 23068672
    s_mov_b32 s67, 0x20000
    s_mov_b32 s56, s20
    s_mov_b32 s57, s21
    s_mov_b32 s58, 819200
    s_mov_b32 s59, 0x20000
    s_lshl_b32 s83, s80, 8
    s_cmp_eq_u32 s80, 5
    s_cselect_b32 s83, 1152, s83
    s_mul_i32 s84, s72, 40960
    s_add_u32 s83, s83, s84
    v_lshrrev_b32_e64 v3, 3, v1
    v_mul_u32_u24 v3, 1280, v3
    v_bfe_u32 v4, v1, 4, 1
    v_lshlrev_b32 v4, 2, v4
    v_and_b32 v5, 7, v1
    v_xor_b32_e64 v4, v4, v5
    v_lshl_add_u32 v3, v4, 4, v3
    v_add_u32_e64 v16, s83, v3
    v_add_u32 v17, 10240, v16
    v_add_u32 v18, 20480, v16
    v_add_u32 v19, 30720, v16
    s_lshl_b32 s83, s72, 6
    v_add_u32 v3, s83, v1
    s_lshr_b32 s83, s77, 1
    s_lshr_b32 s84, s78, 1
    s_add_u32 s84, s84, s83
    v_mov_b32 v4, s83
    v_mov_b32_e64 v5, s84
    v_cmp_lt_u32 vcc, 79, v3
    s_nop 1
    v_cndmask_b32 v4, v4, v5, vcc
    v_add_lshl_u32 v15, v3, v4, 2
    s_lshl_b32 s85, s81, 8
    v_add_lshl_u32 v20, v3, s85, 3
    s_add_u32 s84, s84, 80
    s_lshl_b32 s86, s81, 5
    v_mov_b32 v3, s83
    v_mov_b32 v4, s84
    v_cmp_lt_u32 vcc, 39, v1
    s_nop 1
    v_cndmask_b32 v3, v3, v4, vcc
    v_mov_b32 v4, s83
    v_cmp_lt_u32 vcc, 47, v1
    s_nop 1
    v_cndmask_b32 v3, v3, v4, vcc
    v_mov_b32 v4, s84
    v_cmp_lt_u32 vcc, 55, v1
    s_nop 1
    v_cndmask_b32_e64 v3, v3, v4, vcc
    v_bfe_u32 v4, v1, 2, 1
    v_mul_u32_u24 v4, 79, v4
    v_add_u32 v3, v3, v4
    v_lshrrev_b32 v3, 6, v3
    v_min_u32 v3, 39, v3
    v_and_b32 v4, 3, v1
    v_mul_u32_u24 v4, 40, v4
    v_add_u32 v3, v3, v4
    v_and_b32 v5, 31, v1
    v_add_u32 v4, s86, v5
    v_cmp_lt_u32 vcc, 31, v1
    s_nop 1
    v_cndmask_b32 v3, v4, v3, vcc
    v_lshlrev_b32 v3, 7, v3
    v_add_u32 v21, 22020096, v3
    s_mul_i32 s84, s91, 245760
    s_add_u32 m0, s88, 53248
    s_nop 0
    buffer_load_dwordx4 v6, s[40:43], s84 offen lds
    s_add_u32 m0, s88, 54272
    s_nop 0
    buffer_load_dwordx4 v7, s[40:43], s84 offen lds
    s_add_u32 m0, s88, 55296
    s_nop 0
    buffer_load_dwordx4 v12, s[40:43], s84 offen lds
    s_add_u32 m0, s88, 56320
    s_nop 0
    buffer_load_dwordx4 v13, s[40:43], s84 offen lds
    s_add_u32 m0, s88, 57344
    s_nop 0
    buffer_load_dwordx4 v14, s[40:43], s84 offen lds
    s_lshl_b32 s83, s91, 7
    s_add_u32 s84, s83, 40960
    s_add_u32 m0, s89, 53248
    s_nop 0
    buffer_load_dwordx4 v8, s[36:39], s83 offen lds
    s_add_u32 m0, s89, 54272
    s_nop 0
    buffer_load_dwordx4 v9, s[36:39], s83 offen lds
    s_add_u32 m0, s89, 55296
    s_nop 0
    buffer_load_dwordx4 v10, s[36:39], s83 offen lds
    s_add_u32 m0, s89, 56320
    s_nop 0
    buffer_load_dwordx4 v11, s[36:39], s83 offen lds
    s_add_u32 m0, s89, 57344
    s_nop 0
    buffer_load_dwordx4 v8, s[36:39], s84 offen lds
    s_add_u32 m0, s89, 58368
    s_nop 0
    buffer_load_dwordx4 v9, s[36:39], s84 offen lds
    s_add_u32 m0, s89, 59392
    s_nop 0
    buffer_load_dwordx4 v10, s[36:39], s84 offen lds
    s_add_u32 m0, s89, 60416
    s_nop 0
    buffer_load_dwordx4 v11, s[36:39], s84 offen lds
    s_add_u32 s91, s91, 1
    s_cmp_eq_u32 s91, 10
    s_cselect_b32 s91, 0, s91
    s_mov_b32 s48, s28
    s_mov_b32 s49, s29
    s_mov_b32 s50, 1966080
    s_mov_b32 s51, 0x20000
    s_waitcnt lgkmcnt(0)
    s_mul_i32 s73, s73, 0x9E3779B1
    s_add_u32 s73, s73, 0x7F4A7C15
    v_mov_b32_e64 v2, s73
    v_lshl_add_u32 v27, v1, 4, s98
    s_waitcnt vmcnt(13)
    s_barrier
    s_cmp_lg_u32 s72, 0
    s_cbranch_scc1 SK_29
    v_lshlrev_b32 v3, 2, v1
    v_add_u32 v4, s76, v3
    ds_read_b32 v188, v4 offset:0
    ds_read_b32 v189, v4 offset:256
    ds_read_b32 v190, v4 offset:512
    ds_read_b32 v191, v4 offset:768
    ds_read_b32 v74, v4 offset:1024
    s_waitcnt lgkmcnt(0)
    s_lshl_b32 s83, s2, 6
    s_add_u32 s83, s83, 65536
    s_mov_b64 exec, 0xffff
    buffer_store_dword v74, v3, s[64:67], s83 offen sc1
    s_mov_b64 exec, -1
SK_29:
    s_mul_i32 s84, s91, 245760
    s_add_u32 m0, s88, 106496
    s_nop 0
    buffer_load_dwordx4 v6, s[40:43], s84 offen lds
    s_add_u32 m0, s88, 107520
    s_nop 0
    buffer_load_dwordx4 v7, s[40:43], s84 offen lds
    s_add_u32 m0, s88, 108544
    s_nop 0
    buffer_load_dwordx4 v12, s[40:43], s84 offen lds
    s_add_u32 m0, s88, 109568
    s_nop 0
    buffer_load_dwordx4 v13, s[40:43], s84 offen lds
    s_add_u32 m0, s88, 110592
    s_nop 0
    buffer_load_dwordx4 v14, s[40:43], s84 offen lds
    s_lshl_b32 s83, s91, 7
    s_add_u32 s84, s83, 40960
    s_add_u32 m0, s89, 106496
    s_nop 0
    buffer_load_dwordx4 v8, s[36:39], s83 offen lds
    s_add_u32 m0, s89, 107520
    s_nop 0
    buffer_load_dwordx4 v9, s[36:39], s83 offen lds
    s_add_u32 m0, s89, 108544
    s_nop 0
    buffer_load_dwordx4 v10, s[36:39], s83 offen lds
    s_add_u32 m0, s89, 109568
    s_nop 0
    buffer_load_dwordx4 v11, s[36:39], s83 offen lds
    s_add_u32 m0, s89, 110592
    s_nop 0
    buffer_load_dwordx4 v8, s[36:39], s84 offen lds
    s_add_u32 m0, s89, 111616
    s_nop 0
    buffer_load_dwordx4 v9, s[36:39], s84 offen lds
    s_add_u32 m0, s89, 112640
    s_nop 0
    buffer_load_dwordx4 v10, s[36:39], s84 offen lds
    s_add_u32 m0, s89, 113664
    s_nop 0
    buffer_load_dwordx4 v11, s[36:39], s84 offen lds
    s_add_u32 s91, s91, 1
    s_cmp_eq_u32 s91, 10
    s_cselect_b32 s91, 0, s91
    s_cmp_lg_u32 s72, 0
    s_cbranch_scc1 SK_30
    v_bfe_u32 v22, v1, 4, 1
    v_lshrrev_b32 v23, 5, v1
    v_lshlrev_b32 v22, 2, v22
    v_lshl_add_u32 v22, v23, 4, v22
    s_and_b32 s83, s99, 1
    s_lshl_b32 s83, s83, 4
    v_subrev_u32 v22, s83, v22
    v_add_u32 v60, 0, v22
    v_and_b32 v60, 0xffff, v60
    v_mul_u32_u24 v68, 3277, v60
    v_lshrrev_b32 v68, 16, v68
    v_add_u32 v61, 8, v22
    v_and_b32 v61, 0xffff, v61
    v_mul_u32_u24 v69, 3277, v61
    v_lshrrev_b32 v69, 16, v69
    v_add_u32 v62, 32, v22
    v_and_b32 v62, 0xffff, v62
    v_mul_u32_u24 v70, 3277, v62
    v_lshrrev_b32 v70, 16, v70
    v_add_u32 v63, 40, v22
    v_and_b32 v63, 0xffff, v63
    v_mul_u32_u24 v71, 3277, v63
    v_lshrrev_b32 v71, 16, v71
    v_add_u32 v64, 64, v22
    v_and_b32 v64, 0xffff, v64
    v_mul_u32_u24 v72, 3277, v64
    v_lshrrev_b32_e64 v72, 16, v72
    v_add_u32 v65, 72, v22
    v_and_b32 v65, 0xffff, v65
    v_mul_u32_u24 v73, 3277, v65
    v_lshrrev_b32_e64 v73, 16, v73
    v_mov_b32 v24, 85280
    v_and_b32 v22, 15, v1
    v_add_u32 v22, 0, v22
    v_mul_u32_u24 v25, 3277, v22
    v_lshrrev_b32 v25, 16, v25
    v_sub_u32 v26, v22, v25
    v_mul_u32_u24_e64 v26, 40, v26
    v_add_u32 v26, 81920, v26
    v_lshl_add_u32 v22, v60, 1, v26
    v_cmp_eq_u32 vcc, v68, v25
    s_nop 1
    v_cndmask_b32 v28, v24, v22, vcc
SK_30:
    s_waitcnt vmcnt(13)
    s_cmp_lg_u32 s72, 0
    s_cbranch_scc1 SK_31
    s_waitcnt vmcnt(13)
    s_lshl_b32 s83, s2, 7
    s_add_u32 s83, s83, 22020096
    v_mov_b32 v74, s73
    v_mov_b32 v75, s101
    s_mov_b64 exec, 1
    buffer_store_dwordx2 v[74:75], off, s[64:67], s83 sc1
    s_mov_b64 exec, -1
SK_31:
    s_barrier
    s_mul_i32 s84, s91, 245760
    s_add_u32 m0, s88, 0
    s_nop 0
    buffer_load_dwordx4 v6, s[40:43], s84 offen lds
    s_add_u32 m0, s88, 1024
    s_nop 0
    buffer_load_dwordx4 v7, s[40:43], s84 offen lds
    s_add_u32 m0, s88, 2048
    s_nop 0
    buffer_load_dwordx4 v12, s[40:43], s84 offen lds
    s_add_u32 m0, s88, 3072
    s_nop 0
    buffer_load_dwordx4 v13, s[40:43], s84 offen lds
    s_add_u32 m0, s88, 4096
    s_nop 0
    buffer_load_dwordx4 v14, s[40:43], s84 offen lds
    s_lshl_b32 s83, s91, 7
    s_add_u32 s84, s83, 40960
    s_add_u32 m0, s89, 0
    s_nop 0
    buffer_load_dwordx4 v8, s[36:39], s83 offen lds
    s_add_u32 m0, s89, 1024
    s_nop 0
    buffer_load_dwordx4 v9, s[36:39], s83 offen lds
    s_add_u32 m0, s89, 2048
    s_nop 0
    buffer_load_dwordx4 v10, s[36:39], s83 offen lds
    s_add_u32 m0, s89, 3072
    s_nop 0
    buffer_load_dwordx4 v11, s[36:39], s83 offen lds
    s_add_u32 m0, s89, 4096
    s_nop 0
    buffer_load_dwordx4 v8, s[36:39], s84 offen lds
    s_add_u32 m0, s89, 5120
    s_nop 0
    buffer_load_dwordx4 v9, s[36:39], s84 offen lds
    s_add_u32 m0, s89, 6144
    s_nop 0
    buffer_load_dwordx4 v10, s[36:39], s84 offen lds
    s_add_u32 m0, s89, 7168
    s_nop 0
    buffer_load_dwordx4 v11, s[36:39], s84 offen lds
    s_add_u32 s91, s91, 1
    s_cmp_eq_u32 s91, 10
    s_cselect_b32 s91, 0, s91
    s_cmp_lg_u32 s72, 0
    s_cbranch_scc1 SK_32
    v_lshl_add_u32 v22, v61, 1, v26
    v_cmp_eq_u32 vcc, v69, v25
    s_nop 1
    v_cndmask_b32_e64 v29, v24, v22, vcc
    v_lshl_add_u32 v22, v62, 1, v26
    v_cmp_eq_u32 vcc, v70, v25
    s_nop 1
    v_cndmask_b32_e64 v30, v24, v22, vcc
    v_lshl_add_u32 v22, v63, 1, v26
    v_cmp_eq_u32 vcc, v71, v25
    s_nop 1
    v_cndmask_b32 v31, v24, v22, vcc
    v_and_b32 v22, 15, v1
    v_add_u32_e64 v22, 16, v22
    v_mul_u32_u24 v25, 3277, v22
    v_lshrrev_b32 v25, 16, v25
    v_sub_u32 v26, v22, v25
    v_mul_u32_u24_e64 v26, 40, v26
    v_add_u32 v26, 81920, v26
    v_lshl_add_u32 v22, v60, 1, v26
    v_cmp_eq_u32 vcc, v68, v25
    s_nop 1
    v_cndmask_b32_e64 v32, v24, v22, vcc
    v_lshl_add_u32 v22, v61, 1, v26
    v_cmp_eq_u32 vcc, v69, v25
    s_nop 1
    v_cndmask_b32_e64 v33, v24, v22, vcc
    v_lshl_add_u32 v22, v62, 1, v26
    v_cmp_eq_u32 vcc, v70, v25
    s_nop 1
    v_cndmask_b32_e64 v34, v24, v22, vcc
    v_lshl_add_u32 v22, v63, 1, v26
    v_cmp_eq_u32 vcc, v71, v25
    s_nop 1
    v_cndmask_b32 v35, v24, v22, vcc
SK_32:
    s_waitcnt vmcnt(13)
    s_barrier
    s_mul_i32 s84, s91, 245760
    s_add_u32 m0, s88, 53248
    s_nop 0
    buffer_load_dwordx4 v6, s[40:43], s84 offen lds
    s_add_u32 m0, s88, 54272
    s_nop 0
    buffer_load_dwordx4 v7, s[40:43], s84 offen lds
    s_add_u32 m0, s88, 55296
    s_nop 0
    buffer_load_dwordx4 v12, s[40:43], s84 offen lds
    s_add_u32 m0, s88, 56320
    s_nop 0
    buffer_load_dwordx4 v13, s[40:43], s84 offen lds
    s_add_u32 m0, s88, 57344
    s_nop 0
    buffer_load_dwordx4 v14, s[40:43], s84 offen lds
    s_lshl_b32 s83, s91, 7
    s_add_u32 s84, s83, 40960
    s_add_u32 m0, s89, 53248
    s_nop 0
    buffer_load_dwordx4 v8, s[36:39], s83 offen lds
    s_add_u32 m0, s89, 54272
    s_nop 0
    buffer_load_dwordx4 v9, s[36:39], s83 offen lds
    s_add_u32 m0, s89, 55296
    s_nop 0
    buffer_load_dwordx4 v10, s[36:39], s83 offen lds
    s_add_u32 m0, s89, 56320
    s_nop 0
    buffer_load_dwordx4 v11, s[36:39], s83 offen lds
    s_add_u32 m0, s89, 57344
    s_nop 0
    buffer_load_dwordx4 v8, s[36:39], s84 offen lds
    s_add_u32 m0, s89, 58368
    s_nop 0
    buffer_load_dwordx4 v9, s[36:39], s84 offen lds
    s_add_u32 m0, s89, 59392
    s_nop 0
    buffer_load_dwordx4 v10, s[36:39], s84 offen lds
    s_add_u32 m0, s89, 60416
    s_nop 0
    buffer_load_dwordx4 v11, s[36:39], s84 offen lds
    s_add_u32 s91, s91, 1
    s_cmp_eq_u32 s91, 10
    s_cselect_b32 s91, 0, s91
    s_cmp_lg_u32 s72, 0
    s_cbranch_scc1 SK_33
    v_and_b32 v22, 15, v1
    v_add_u32 v22, 32, v22
    v_mul_u32_u24 v25, 3277, v22
    v_lshrrev_b32 v25, 16, v25
    v_sub_u32 v26, v22, v25
    v_mul_u32_u24_e64 v26, 40, v26
    v_add_u32 v26, 81920, v26
    v_lshl_add_u32 v22, v60, 1, v26
    v_cmp_eq_u32 vcc, v68, v25
    s_nop 1
    v_cndmask_b32_e64 v36, v24, v22, vcc
    v_lshl_add_u32 v22, v61, 1, v26
    v_cmp_eq_u32 vcc, v69, v25
    s_nop 1
    v_cndmask_b32_e64 v37, v24, v22, vcc
    v_lshl_add_u32 v22, v62, 1, v26
    v_cmp_eq_u32 vcc, v70, v25
    s_nop 1
    v_cndmask_b32_e64 v38, v24, v22, vcc
    v_lshl_add_u32 v22, v63, 1, v26
    v_cmp_eq_u32 vcc, v71, v25
    s_nop 1
    v_cndmask_b32_e64 v39, v24, v22, vcc
    v_lshl_add_u32 v22, v64, 1, v26
    v_cmp_eq_u32 vcc, v72, v25
    s_nop 1
    v_cndmask_b32_e64 v40, v24, v22, vcc
    v_lshl_add_u32 v22, v65, 1, v26
    v_cmp_eq_u32 vcc, v73, v25
    s_nop 1
    v_cndmask_b32 v41, v24, v22, vcc
    v_and_b32 v22, 15, v1
    v_add_u32_e64 v22, 48, v22
    v_mul_u32_u24 v25, 3277, v22
    v_lshrrev_b32 v25, 16, v25
    v_sub_u32 v26, v22, v25
    v_mul_u32_u24_e64 v26, 40, v26
    v_add_u32 v26, 81920, v26
    v_lshl_add_u32 v22, v62, 1, v26
    v_cmp_eq_u32 vcc, v70, v25
    s_nop 1
    v_cndmask_b32 v42, v24, v22, vcc
SK_33:
    s_waitcnt vmcnt(13)
    s_barrier
    s_mul_i32 s84, s91, 245760
    s_add_u32 m0, s88, 106496
    s_nop 0
    buffer_load_dwordx4 v6, s[40:43], s84 offen lds
    s_add_u32 m0, s88, 107520
    s_nop 0
    buffer_load_dwordx4 v7, s[40:43], s84 offen lds
    s_add_u32 m0, s88, 108544
    s_nop 0
    buffer_load_dwordx4 v12, s[40:43], s84 offen lds
    s_add_u32 m0, s88, 109568
    s_nop 0
    buffer_load_dwordx4 v13, s[40:43], s84 offen lds
    s_add_u32 m0, s88, 110592
    s_nop 0
    buffer_load_dwordx4 v14, s[40:43], s84 offen lds
    s_lshl_b32 s83, s91, 7
    s_add_u32 s84, s83, 40960
    s_add_u32 m0, s89, 106496
    s_nop 0
    buffer_load_dwordx4 v8, s[36:39], s83 offen lds
    s_add_u32 m0, s89, 107520
    s_nop 0
    buffer_load_dwordx4 v9, s[36:39], s83 offen lds
    s_add_u32 m0, s89, 108544
    s_nop 0
    buffer_load_dwordx4 v10, s[36:39], s83 offen lds
    s_add_u32 m0, s89, 109568
    s_nop 0
    buffer_load_dwordx4 v11, s[36:39], s83 offen lds
    s_add_u32 m0, s89, 110592
    s_nop 0
    buffer_load_dwordx4 v8, s[36:39], s84 offen lds
    s_add_u32 m0, s89, 111616
    s_nop 0
    buffer_load_dwordx4 v9, s[36:39], s84 offen lds
    s_add_u32 m0, s89, 112640
    s_nop 0
    buffer_load_dwordx4 v10, s[36:39], s84 offen lds
    s_add_u32 m0, s89, 113664
    s_nop 0
    buffer_load_dwordx4 v11, s[36:39], s84 offen lds
    s_add_u32 s91, s91, 1
    s_cmp_eq_u32 s91, 10
    s_cselect_b32 s91, 0, s91
    s_cmp_lg_u32 s72, 0
    s_cbranch_scc1 SK_34
    v_lshl_add_u32 v22, v63, 1, v26
    v_cmp_eq_u32 vcc, v71, v25
    s_nop 1
    v_cndmask_b32_e64 v43, v24, v22, vcc
    v_lshl_add_u32 v22, v64, 1, v26
    v_cmp_eq_u32 vcc, v72, v25
    s_nop 1
    v_cndmask_b32_e64 v44, v24, v22, vcc
    v_lshl_add_u32 v22, v65, 1, v26
    v_cmp_eq_u32 vcc, v73, v25
    s_nop 1
    v_cndmask_b32 v45, v24, v22, vcc
    v_and_b32 v22, 15, v1
    v_add_u32_e64 v22, 64, v22
    v_mul_u32_u24 v25, 3277, v22
    v_lshrrev_b32 v25, 16, v25
    v_sub_u32 v26, v22, v25
    v_mul_u32_u24_e64 v26, 40, v26
    v_add_u32 v26, 81920, v26
    v_lshl_add_u32 v22, v62, 1, v26
    v_cmp_eq_u32 vcc, v70, v25
    s_nop 1
    v_cndmask_b32_e64 v46, v24, v22, vcc
    v_lshl_add_u32 v22, v63, 1, v26
    v_cmp_eq_u32 vcc, v71, v25
    s_nop 1
    v_cndmask_b32_e64 v47, v24, v22, vcc
    v_lshl_add_u32 v22, v64, 1, v26
    v_cmp_eq_u32 vcc, v72, v25
    s_nop 1
    v_cndmask_b32_e64 v48, v24, v22, vcc
    v_lshl_add_u32 v22, v65, 1, v26
    v_cmp_eq_u32 vcc, v73, v25
    s_nop 1
    v_cndmask_b32 v49, v24, v22, vcc
SK_34:
    s_waitcnt vmcnt(13)
    s_barrier
    s_cmp_lg_u32 s72, 0
    s_cbranch_scc1 SK_35
    buffer_load_dword v66, v21, s[64:67], 0 offen sc1
SK_35:
    s_mul_i32 s84, s91, 245760
    s_add_u32 m0, s88, 0
    s_nop 0
    buffer_load_dwordx4 v6, s[40:43], s84 offen lds
    s_add_u32 m0, s88, 1024
    s_nop 0
    buffer_load_dwordx4 v7, s[40:43], s84 offen lds
    s_add_u32 m0, s88, 2048
    s_nop 0
    buffer_load_dwordx4 v12, s[40:43], s84 offen lds
    s_add_u32 m0, s88, 3072
    s_nop 0
    buffer_load_dwordx4 v13, s[40:43], s84 offen lds
    s_add_u32 m0, s88, 4096
    s_nop 0
    buffer_load_dwordx4 v14, s[40:43], s84 offen lds
    s_lshl_b32 s83, s91, 7
    s_add_u32 s84, s83, 40960
    s_add_u32 m0, s89, 0
    s_nop 0
    buffer_load_dwordx4 v8, s[36:39], s83 offen lds
    s_add_u32 m0, s89, 1024
    s_nop 0
    buffer_load_dwordx4 v9, s[36:39], s83 offen lds
    s_add_u32 m0, s89, 2048
    s_nop 0
    buffer_load_dwordx4 v10, s[36:39], s83 offen lds
    s_add_u32 m0, s89, 3072
    s_nop 0
    buffer_load_dwordx4 v11, s[36:39], s83 offen lds
    s_add_u32 m0, s89, 4096
    s_nop 0
    buffer_load_dwordx4 v8, s[36:39], s84 offen lds
    s_add_u32 m0, s89, 5120
    s_nop 0
    buffer_load_dwordx4 v9, s[36:39], s84 offen lds
    s_add_u32 m0, s89, 6144
    s_nop 0
    buffer_load_dwordx4 v10, s[36:39], s84 offen lds
    s_add_u32 m0, s89, 7168
    s_nop 0
    buffer_load_dwordx4 v11, s[36:39], s84 offen lds
    s_add_u32 s91, s91, 1
    s_cmp_eq_u32 s91, 10
    s_cselect_b32 s91, 0, s91
    s_cmp_lg_u32 s72, 0
    s_cbranch_scc1 SK_36
    v_and_b32 v22, 3, v1
    v_and_b32 v23, 12, v1
    v_lshl_add_u32 v22, v22, 4, v23
    v_add_u32_e64 v22, 0, v22
    v_mul_u32_u24 v25, 3277, v22
    v_lshrrev_b32_e64 v25, 16, v25
    v_cmp_gt_u32 vcc, 80, v22
    v_mov_b32 v23, 0x7fff
    s_nop 0
    v_cndmask_b32 v25, v23, v25, vcc
    v_mov_b32 v26, 85120
    v_lshl_add_u32 v22, v60, 1, v26
    v_cmp_eq_u32 vcc, v68, v25
    s_nop 1
    v_cndmask_b32_e64 v50, v24, v22, vcc
    v_lshl_add_u32 v22, v61, 1, v26
    v_cmp_eq_u32 vcc, v69, v25
    s_nop 1
    v_cndmask_b32_e64 v51, v24, v22, vcc
    v_lshl_add_u32 v22, v62, 1, v26
    v_cmp_eq_u32 vcc, v70, v25
    s_nop 1
    v_cndmask_b32_e64 v52, v24, v22, vcc
    v_lshl_add_u32 v22, v63, 1, v26
    v_cmp_eq_u32 vcc, v71, v25
    s_nop 1
    v_cndmask_b32_e64 v53, v24, v22, vcc
    v_lshl_add_u32 v22, v64, 1, v26
    v_cmp_eq_u32 vcc, v72, v25
    s_nop 1
    v_cndmask_b32_e64 v54, v24, v22, vcc
    v_lshl_add_u32 v22, v65, 1, v26
    v_cmp_eq_u32 vcc, v73, v25
    s_nop 1
    v_cndmask_b32 v55, v24, v22, vcc
SK_36:
    s_waitcnt vmcnt(13)
    s_cmp_lg_u32 s72, 0
    s_cbranch_scc1 SK_37
    s_waitcnt vmcnt(13)
    v_cmp_ne_u32 vcc, s73, v66
    s_cbranch_vccz P0OK_38
    s_mov_b32 s90, 200000
POLL_39:
    buffer_load_dword v67, v21, s[64:67], 0 offen sc1
    s_waitcnt vmcnt(0)
    v_cmp_ne_u32 vcc, s73, v67
    s_cbranch_vccz POLLD_40
    s_sub_u32 s90, s90, 1
    s_cmp_lg_u32 s90, 0
    s_cbranch_scc1 POLL_39
POLLD_40:
P0OK_38:
SK_37:
    s_barrier
    s_mov_b32 s83, 98304
    buffer_load_dword v188, v15, s[64:67], s83 offen sc1
    s_mov_b32 s83, 114688
    buffer_load_dword v189, v15, s[64:67], s83 offen sc1
    s_mov_b32 s83, 131072
    buffer_load_dword v190, v15, s[64:67], s83 offen sc1
    s_mov_b32 s83, 147456
    buffer_load_dword v191, v15, s[64:67], s83 offen sc1
    s_mov_b32 s83, 65536
    buffer_load_dwordx2 v[74:75], v20, s[64:67], s83 offen sc1
    s_mul_i32 s84, s91, 245760
    s_add_u32 m0, s88, 53248
    s_nop 0
    buffer_load_dwordx4 v6, s[40:43], s84 offen lds
    s_add_u32 m0, s88, 54272
    s_nop 0
    buffer_load_dwordx4 v7, s[40:43], s84 offen lds
    s_add_u32 m0, s88, 55296
    s_nop 0
    buffer_load_dwordx4 v12, s[40:43], s84 offen lds
    s_add_u32 m0, s88, 56320
    s_nop 0
    buffer_load_dwordx4 v13, s[40:43], s84 offen lds
    s_add_u32 m0, s88, 57344
    s_nop 0
    buffer_load_dwordx4 v14, s[40:43], s84 offen lds
    s_lshl_b32 s83, s91, 7
    s_add_u32 s84, s83, 40960
    s_add_u32 m0, s89, 53248
    s_nop 0
    buffer_load_dwordx4 v8, s[36:39], s83 offen lds
    s_add_u32 m0, s89, 54272
    s_nop 0
    buffer_load_dwordx4 v9, s[36:39], s83 offen lds
    s_add_u32 m0, s89, 55296
    s_nop 0
    buffer_load_dwordx4 v10, s[36:39], s83 offen lds
    s_add_u32 m0, s89, 56320
    s_nop 0
    buffer_load_dwordx4 v11, s[36:39], s83 offen lds
    s_add_u32 m0, s89, 57344
    s_nop 0
    buffer_load_dwordx4 v8, s[36:39], s84 offen lds
    s_add_u32 m0, s89, 58368
    s_nop 0
    buffer_load_dwordx4 v9, s[36:39], s84 offen lds
    s_add_u32 m0, s89, 59392
    s_nop 0
    buffer_load_dwordx4 v10, s[36:39], s84 offen lds
    s_add_u32 m0, s89, 60416
    s_nop 0
    buffer_load_dwordx4 v11, s[36:39], s84 offen lds
    s_add_u32 s91, s91, 1
    s_cmp_eq_u32 s91, 10
    s_cselect_b32 s91, 0, s91
    s_cmp_lg_u32 s72, 0
    s_cbranch_scc1 SK_41
    v_and_b32 v22, 3, v1
    v_and_b32_e64 v23, 12, v1
    v_lshl_add_u32 v22, v22, 4, v23
    v_add_u32_e64 v22, 64, v22
    v_mul_u32_u24 v25, 3277, v22
    v_lshrrev_b32_e64 v25, 16, v25
    v_cmp_gt_u32 vcc, 80, v22
    v_mov_b32 v23, 0x7fff
    s_nop 0
    v_cndmask_b32 v25, v23, v25, vcc
    v_mov_b32 v26, 85120
    v_lshl_add_u32 v22, v62, 1, v26
    v_cmp_eq_u32 vcc, v70, v25
    s_nop 1
    v_cndmask_b32_e64 v56, v24, v22, vcc
    v_lshl_add_u32 v22, v63, 1, v26
    v_cmp_eq_u32 vcc, v71, v25
    s_nop 1
    v_cndmask_b32_e64 v57, v24, v22, vcc
    v_lshl_add_u32 v22, v64, 1, v26
    v_cmp_eq_u32 vcc, v72, v25
    s_nop 1
    v_cndmask_b32_e64 v58, v24, v22, vcc
    v_lshl_add_u32 v22, v65, 1, v26
    v_cmp_eq_u32 vcc, v73, v25
    s_nop 1
    v_cndmask_b32 v59, v24, v22, vcc
    v_lshlrev_b32 v22, 4, v1
    v_add_u32 v22, 147456, v22
SK_41:
    s_waitcnt vmcnt(18)
    s_barrier
    s_mul_i32 s84, s91, 245760
    s_add_u32 m0, s88, 106496
    s_nop 0
    buffer_load_dwordx4 v6, s[40:43], s84 offen lds
    s_add_u32 m0, s88, 107520
    s_nop 0
    buffer_load_dwordx4 v7, s[40:43], s84 offen lds
    s_add_u32 m0, s88, 108544
    s_nop 0
    buffer_load_dwordx4 v12, s[40:43], s84 offen lds
    s_add_u32 m0, s88, 109568
    s_nop 0
    buffer_load_dwordx4 v13, s[40:43], s84 offen lds
    s_add_u32 m0, s88, 110592
    s_nop 0
    buffer_load_dwordx4 v14, s[40:43], s84 offen lds
    s_lshl_b32 s83, s91, 7
    s_add_u32 s84, s83, 40960
    s_add_u32 m0, s89, 106496
    s_nop 0
    buffer_load_dwordx4 v8, s[36:39], s83 offen lds
    s_add_u32 m0, s89, 107520
    s_nop 0
    buffer_load_dwordx4 v9, s[36:39], s83 offen lds
    s_add_u32 m0, s89, 108544
    s_nop 0
    buffer_load_dwordx4 v10, s[36:39], s83 offen lds
    s_add_u32 m0, s89, 109568
    s_nop 0
    buffer_load_dwordx4 v11, s[36:39], s83 offen lds
    s_add_u32 m0, s89, 110592
    s_nop 0
    buffer_load_dwordx4 v8, s[36:39], s84 offen lds
    s_add_u32 m0, s89, 111616
    s_nop 0
    buffer_load_dwordx4 v9, s[36:39], s84 offen lds
    s_add_u32 m0, s89, 112640
    s_nop 0
    buffer_load_dwordx4 v10, s[36:39], s84 offen lds
    s_add_u32 m0, s89, 113664
    s_nop 0
    buffer_load_dwordx4 v11, s[36:39], s84 offen lds
    s_add_u32 s91, s91, 1
    s_cmp_eq_u32 s91, 10
    s_cselect_b32 s91, 0, s91
    s_waitcnt vmcnt(13)
    v_add_f32 v188, v188, v189
    v_add_f32 v190, v190, v191
    v_add_f32_e64 v188, v188, v190
    v_cvt_pk_bf16_f32 v191, v188, 0
    v_lshlrev_b32 v189, 16, v191
    v_sub_f32 v189, v188, v189
    v_cvt_pk_bf16_f32 v190, v188, v189
    s_lshl_b32 s83, s72, 9
    s_add_u32 s83, s83, s76
    v_lshl_add_u32 v3, v1, 3, s83
    ds_write_b64 v3, v[190:191]
    ds_write_b64 v3, v[74:75] offset:2048
    s_waitcnt lgkmcnt(0)
    s_barrier
    s_mul_i32 s84, s91, 245760
    s_add_u32 m0, s88, 0
    s_nop 0
    buffer_load_dwordx4 v6, s[40:43], s84 offen lds
    s_add_u32 m0, s88, 1024
    s_nop 0
    buffer_load_dwordx4 v7, s[40:43], s84 offen lds
    s_add_u32 m0, s88, 2048
    s_nop 0
    buffer_load_dwordx4 v12, s[40:43], s84 offen lds
    s_add_u32 m0, s88, 3072
    s_nop 0
    buffer_load_dwordx4 v13, s[40:43], s84 offen lds
    s_add_u32 m0, s88, 4096
    s_nop 0
    buffer_load_dwordx4 v14, s[40:43], s84 offen lds
    s_lshl_b32 s83, s91, 7
    s_add_u32 s84, s83, 40960
    s_add_u32 m0, s89, 0
    s_nop 0
    buffer_load_dwordx4 v8, s[36:39], s83 offen lds
    s_add_u32 m0, s89, 1024
    s_nop 0
    buffer_load_dwordx4 v9, s[36:39], s83 offen lds
    s_add_u32 m0, s89, 2048
    s_nop 0
    buffer_load_dwordx4 v10, s[36:39], s83 offen lds
    s_add_u32 m0, s89, 3072
    s_nop 0
    buffer_load_dwordx4 v11, s[36:39], s83 offen lds
    s_add_u32 m0, s89, 4096
    s_nop 0
    buffer_load_dwordx4 v8, s[36:39], s84 offen lds
    s_add_u32 m0, s89, 5120
    s_nop 0
    buffer_load_dwordx4 v9, s[36:39], s84 offen lds
    s_add_u32 m0, s89, 6144
    s_nop 0
    buffer_load_dwordx4 v10, s[36:39], s84 offen lds
    s_add_u32 m0, s89, 7168
    s_nop 0
    buffer_load_dwordx4 v11, s[36:39], s84 offen lds
    s_add_u32 s91, s91, 1
    s_cmp_eq_u32 s91, 10
    s_cselect_b32 s91, 0, s91
    s_cmp_lt_u32 s75, 8
    s_cbranch_scc1 SK_42
    s_getpc_b64 s[12:13]
L_PCT_43:
    s_lshl_b32 s11, s72, 7
    s_add_u32 s11, s11, E1A-L_PCT_43+0
    s_add_u32 s12, s12, s11
    s_addc_u32 s13, s13, 0
    s_load_dword s10, s[12:13], 0
    s_load_dword s10, s[12:13], 512
    s_load_dword s10, s[12:13], 1024
    s_load_dword s10, s[12:13], 1536
    s_load_dword s10, s[12:13], 2048
    s_load_dword s10, s[12:13], 2560
    s_load_dword s10, s[12:13], 3072
    s_load_dword s10, s[12:13], 3584
    s_load_dword s10, s[12:13], 4096
    s_load_dword s10, s[12:13], 4608
    s_load_dword s10, s[12:13], 5120
    s_load_dword s10, s[12:13], 5632
    s_load_dword s10, s[12:13], 6144
    s_load_dword s10, s[12:13], 6656
SK_42:
    s_cmp_ge_u32 s75, 8
    s_cbranch_scc1 SK_44
    s_getpc_b64 s[12:13]
L_PCT_45:
    s_lshl_b32 s11, s72, 7
    s_add_u32 s11, s11, G1_KV-L_PCT_45+0
    s_add_u32 s12, s12, s11
    s_addc_u32 s13, s13, 0
    s_load_dword s10, s[12:13], 0
    s_load_dword s10, s[12:13], 512
    s_load_dword s10, s[12:13], 1024
    s_load_dword s10, s[12:13], 1536
    s_load_dword s10, s[12:13], 2048
    s_load_dword s10, s[12:13], 2560
    s_load_dword s10, s[12:13], 3072
    s_load_dword s10, s[12:13], 3584
    s_load_dword s10, s[12:13], 4096
    s_load_dword s10, s[12:13], 4608
    s_load_dword s10, s[12:13], 5120
    s_load_dword s10, s[12:13], 5632
    s_load_dword s10, s[12:13], 6144
    s_load_dword s10, s[12:13], 6656
SK_44:
    s_waitcnt vmcnt(13)
    s_barrier
    s_mov_b32 s83, 163968
    s_cmp_ge_u32 s99, 8
    s_cselect_b32 s83, 0, s83
    buffer_load_dwordx4 v[76:79], v16, s[56:59], s83 offen
    buffer_load_dwordx4 v[80:83], v17, s[56:59], s83 offen
    buffer_load_dwordx4 v[84:87], v18, s[56:59], s83 offen
    buffer_load_dwordx4 v[88:91], v19, s[56:59], s83 offen
    s_mov_b32 s83, 327680
    s_cmp_ge_u32 s99, 8
    s_cselect_b32 s83, 163840, s83
    buffer_load_dwordx4 v[92:95], v16, s[56:59], s83 offen
    buffer_load_dwordx4 v[96:99], v17, s[56:59], s83 offen
    buffer_load_dwordx4 v[100:103], v18, s[56:59], s83 offen
    buffer_load_dwordx4 v[104:107], v19, s[56:59], s83 offen
    s_mov_b32 s83, 327808
    s_cmp_ge_u32 s99, 8
    s_cselect_b32 s83, 327680, s83
    buffer_load_dwordx4 v[108:111], v16, s[56:59], s83 offen
    buffer_load_dwordx4 v[112:115], v17, s[56:59], s83 offen
    buffer_load_dwordx4 v[116:119], v18, s[56:59], s83 offen
    buffer_load_dwordx4 v[120:123], v19, s[56:59], s83 offen
    s_waitcnt vmcnt(12)
    s_barrier
    s_getpc_b64 s[12:13]
L_PCT_46:
    s_lshl_b32 s11, s72, 7
    s_add_u32 s11, s11, G1_DONE-L_PCT_46+-1024
    s_add_u32 s12, s12, s11
    s_addc_u32 s13, s13, 0
    s_load_dword s10, s[12:13], 0
    s_load_dword s10, s[12:13], 512
    s_load_dword s10, s[12:13], 1024
    s_load_dword s10, s[12:13], 1536
    s_load_dword s10, s[12:13], 2048
    s_load_dword s10, s[12:13], 2560
    s_load_dword s10, s[12:13], 3072
    s_load_dword s10, s[12:13], 3584
    s_load_dword s10, s[12:13], 4096
    s_load_dword s10, s[12:13], 4608
    s_load_dword s10, s[12:13], 5120
    s_load_dword s10, s[12:13], 5632
    s_load_dword s10, s[12:13], 6144
    s_load_dword s10, s[12:13], 6656
    s_mov_b32 s83, 491520
    s_cmp_ge_u32 s99, 8
    s_cselect_b32 s83, 491520, s83
    buffer_load_dwordx4 v[124:127], v16, s[56:59], s83 offen
    buffer_load_dwordx4 v[128:131], v17, s[56:59], s83 offen
    buffer_load_dwordx4 v[132:135], v18, s[56:59], s83 offen
    buffer_load_dwordx4 v[136:139], v19, s[56:59], s83 offen
    s_mov_b32 s83, 491648
    s_cmp_ge_u32 s99, 8
    s_cselect_b32 s83, 655360, s83
    buffer_load_dwordx4 v[140:143], v16, s[56:59], s83 offen
    buffer_load_dwordx4 v[144:147], v17, s[56:59], s83 offen
    buffer_load_dwordx4 v[148:151], v18, s[56:59], s83 offen
    buffer_load_dwordx4 v[152:155], v19, s[56:59], s83 offen
    s_mov_b32 s83, 655360
    s_cmp_ge_u32 s99, 8
    s_cselect_b32 s83, 655360, s83
    buffer_load_dwordx4 v[156:159], v16, s[56:59], s83 offen
    buffer_load_dwordx4 v[160:163], v17, s[56:59], s83 offen
    buffer_load_dwordx4 v[164:167], v18, s[56:59], s83 offen
    buffer_load_dwordx4 v[168:171], v19, s[56:59], s83 offen
    s_mov_b32 s83, 655488
    s_cmp_ge_u32 s99, 8
    s_cselect_b32 s83, 655360, s83
    buffer_load_dwordx4 v[172:175], v16, s[56:59], s83 offen
    buffer_load_dwordx4 v[176:179], v17, s[56:59], s83 offen
    buffer_load_dwordx4 v[180:183], v18, s[56:59], s83 offen
    buffer_load_dwordx4 v[184:187], v19, s[56:59], s83 offen
    s_barrier
    s_cmp_ge_u32 s99, 8
    s_cbranch_scc1 LD_H
    s_mov_b32 s83, 0
    s_add_u32 m0, s98, 98304
    s_nop 0
    buffer_load_dwordx4 v16, s[56:59], s83 offen lds
    s_add_u32 m0, s98, 99328
    s_nop 0
    buffer_load_dwordx4 v17, s[56:59], s83 offen lds
    s_add_u32 m0, s98, 100352
    s_nop 0
    buffer_load_dwordx4 v18, s[56:59], s83 offen lds
    s_add_u32 m0, s98, 101376
    s_nop 0
    buffer_load_dwordx4 v19, s[56:59], s83 offen lds
    s_mov_b32 s83, 128
    s_add_u32 m0, s98, 114688
    s_nop 0
    buffer_load_dwordx4 v16, s[56:59], s83 offen lds
    s_add_u32 m0, s98, 115712
    s_nop 0
    buffer_load_dwordx4 v17, s[56:59], s83 offen lds
    s_add_u32 m0, s98, 116736
    s_nop 0
    buffer_load_dwordx4 v18, s[56:59], s83 offen lds
    s_add_u32 m0, s98, 117760
    s_nop 0
    buffer_load_dwordx4 v19, s[56:59], s83 offen lds
    s_mov_b32 s83, 163840
    s_add_u32 m0, s98, 131072
    s_nop 0
    buffer_load_dwordx4 v16, s[56:59], s83 offen lds
    s_add_u32 m0, s98, 132096
    s_nop 0
    buffer_load_dwordx4 v17, s[56:59], s83 offen lds
    s_add_u32 m0, s98, 133120
    s_nop 0
    buffer_load_dwordx4 v18, s[56:59], s83 offen lds
    s_add_u32 m0, s98, 134144
    s_nop 0
    buffer_load_dwordx4 v19, s[56:59], s83 offen lds
    v_lshlrev_b32 v3, 4, v1
    v_add_u32 v3, 147456, v3
    s_barrier
    s_cmp_lg_u32 s72, 0
    s_cbranch_scc1 SK_47
    ds_write_b128 v3, v[28:31] offset:0
    ds_write_b128 v3, v[32:35] offset:1024
    ds_write_b128 v3, v[36:39] offset:2048
    ds_write_b128 v3, v[40:43] offset:3072
    ds_write_b128 v3, v[44:47] offset:4096
    ds_write_b128 v3, v[48:51] offset:5120
    ds_write_b128 v3, v[52:55] offset:6144
    ds_write_b128 v3, v[56:59] offset:7168
    s_waitcnt lgkmcnt(0)
SK_47:
    s_barrier
    s_barrier
    s_waitcnt vmcnt(0)
    v_add_u32 v3, 0, v27
    ds_write_b128 v3, v[92:95] offset:0
    ds_write_b128 v3, v[96:99] offset:1024
    ds_write_b128 v3, v[100:103] offset:2048
    ds_write_b128 v3, v[104:107] offset:3072
    v_add_u32 v3, 16384, v27
    ds_write_b128 v3, v[108:111] offset:0
    ds_write_b128 v3, v[112:115] offset:1024
    ds_write_b128 v3, v[116:119] offset:2048
    ds_write_b128 v3, v[120:123] offset:3072
    v_add_u32 v3, 32768, v27
    ds_write_b128 v3, v[124:127] offset:0
    ds_write_b128 v3, v[128:131] offset:1024
    ds_write_b128 v3, v[132:135] offset:2048
    ds_write_b128 v3, v[136:139] offset:3072
    v_add_u32 v3, 49152, v27
    ds_write_b128 v3, v[140:143] offset:0
    ds_write_b128 v3, v[144:147] offset:1024
    ds_write_b128 v3, v[148:151] offset:2048
    ds_write_b128 v3, v[152:155] offset:3072
    v_add_u32 v3, 65536, v27
    ds_write_b128 v3, v[156:159] offset:0
    ds_write_b128 v3, v[160:163] offset:1024
    ds_write_b128 v3, v[164:167] offset:2048
    ds_write_b128 v3, v[168:171] offset:3072
    s_getpc_b64 s[12:13]
L_PCT_48:
    s_lshl_b32 s11, s72, 7
    s_add_u32 s11, s11, DO_T4-L_PCT_48+0
    s_add_u32 s12, s12, s11
    s_addc_u32 s13, s13, 0
    s_load_dword s10, s[12:13], 0
    s_load_dword s10, s[12:13], 512
    s_load_dword s10, s[12:13], 1024
    s_load_dword s10, s[12:13], 1536
    s_load_dword s10, s[12:13], 2048
    s_load_dword s10, s[12:13], 2560
    s_load_dword s10, s[12:13], 3072
    s_load_dword s10, s[12:13], 3584
    s_load_dword s10, s[12:13], 4096
    s_load_dword s10, s[12:13], 4608
    s_load_dword s10, s[12:13], 5120
    s_load_dword s10, s[12:13], 5632
    s_load_dword s10, s[12:13], 6144
    s_load_dword s10, s[12:13], 6656
    s_barrier
    v_add_u32 v3, 147456, v27
    ds_write_b128 v3, v[76:79] offset:0
    ds_write_b128 v3, v[80:83] offset:1024
    ds_write_b128 v3, v[84:87] offset:2048
    ds_write_b128 v3, v[88:91] offset:3072
    s_barrier
    s_waitcnt lgkmcnt(0)
    s_barrier
    v_add_u32 v3, 81920, v27
    ds_write_b128 v3, v[172:175] offset:0
    ds_write_b128 v3, v[176:179] offset:1024
    ds_write_b128 v3, v[180:183] offset:2048
    ds_write_b128 v3, v[184:187] offset:3072
    s_waitcnt lgkmcnt(0)
    s_getpc_b64 s[12:13]
L_PCT_49:
    s_lshl_b32 s11, s72, 7
    s_add_u32 s11, s11, E5A-L_PCT_49+-4096
    s_add_u32 s12, s12, s11
    s_addc_u32 s13, s13, 0
    s_load_dword s10, s[12:13], 0
    s_load_dword s10, s[12:13], 512
    s_load_dword s10, s[12:13], 1024
    s_load_dword s10, s[12:13], 1536
    s_load_dword s10, s[12:13], 2048
    s_load_dword s10, s[12:13], 2560
    s_load_dword s10, s[12:13], 3072
    s_load_dword s10, s[12:13], 3584
    s_load_dword s10, s[12:13], 4096
    s_load_dword s10, s[12:13], 4608
    s_load_dword s10, s[12:13], 5120
    s_load_dword s10, s[12:13], 5632
    s_barrier
    s_endpgm
LD_H:
    s_add_u32 s92, s80, 6
    s_lshl_b32 s83, s92, 8
    s_mul_i32 s84, s72, 98304
    s_add_u32 s83, s83, s84
    v_lshrrev_b32_e64 v3, 3, v1
    v_mul_u32_u24 v3, 3072, v3
    v_bfe_u32 v4, v1, 4, 1
    v_lshlrev_b32 v4, 2, v4
    v_and_b32 v5, 7, v1
    v_xor_b32_e64 v4, v4, v5
    v_lshl_add_u32 v3, v4, 4, v3
    v_add_u32_e64 v28, s83, v3
    v_add_u32 v29, 24576, v28
    v_add_u32 v30, 49152, v28
    v_add_u32 v31, 73728, v28
    s_and_b32 s85, s72, 1
    s_lshl_b32 s84, s92, 1
    s_add_u32 s85, s85, s84
    s_lshl_b32 s84, s85, 6
    s_add_u32 s84, s84, 2560
    v_add_lshl_u32 v36, v1, s84, 2
    v_and_b32 v4, 3, v1
    v_mul_u32_u24 v4, 24, v4
    v_add_lshl_u32 v3, v4, s85, 7
    v_add_u32 v37, 22257664, v3
    s_mov_b32 s90, 200000
    s_mov_b64 exec, 0xf
POLL_50:
    buffer_load_dword v38, v37, s[64:67], 0 offen sc1
    s_waitcnt vmcnt(0)
    v_cmp_ne_u32 vcc, s73, v38
    s_cbranch_vccz POLLD_51
    s_sub_u32 s90, s90, 1
    s_cmp_lg_u32 s90, 0
    s_cbranch_scc1 POLL_50
POLLD_51:
    s_mov_b64 exec, -1
    s_mov_b32 s83, 98304
    buffer_load_dword v32, v36, s[64:67], s83 offen sc1
    s_mov_b32 s83, 114688
    buffer_load_dword v33, v36, s[64:67], s83 offen sc1
    s_mov_b32 s83, 131072
    buffer_load_dword v34, v36, s[64:67], s83 offen sc1
    s_mov_b32 s83, 147456
    buffer_load_dword v35, v36, s[64:67], s83 offen sc1
    s_mov_b32 s83, 0
    s_add_u32 m0, s98, 0
    s_nop 0
    buffer_load_dwordx4 v28, s[48:51], s83 offen lds
    s_add_u32 m0, s98, 1024
    s_nop 0
    buffer_load_dwordx4 v29, s[48:51], s83 offen lds
    s_add_u32 m0, s98, 2048
    s_nop 0
    buffer_load_dwordx4 v30, s[48:51], s83 offen lds
    s_add_u32 m0, s98, 3072
    s_nop 0
    buffer_load_dwordx4 v31, s[48:51], s83 offen lds
    s_mov_b32 s83, 128
    s_add_u32 m0, s98, 16384
    s_nop 0
    buffer_load_dwordx4 v28, s[48:51], s83 offen lds
    s_add_u32 m0, s98, 17408
    s_nop 0
    buffer_load_dwordx4 v29, s[48:51], s83 offen lds
    s_add_u32 m0, s98, 18432
    s_nop 0
    buffer_load_dwordx4 v30, s[48:51], s83 offen lds
    s_add_u32 m0, s98, 19456
    s_nop 0
    buffer_load_dwordx4 v31, s[48:51], s83 offen lds
    s_barrier
    s_mov_b32 s83, 393216
    s_add_u32 m0, s98, 32768
    s_nop 0
    buffer_load_dwordx4 v28, s[48:51], s83 offen lds
    s_add_u32 m0, s98, 33792
    s_nop 0
    buffer_load_dwordx4 v29, s[48:51], s83 offen lds
    s_add_u32 m0, s98, 34816
    s_nop 0
    buffer_load_dwordx4 v30, s[48:51], s83 offen lds
    s_add_u32 m0, s98, 35840
    s_nop 0
    buffer_load_dwordx4 v31, s[48:51], s83 offen lds
    s_mov_b32 s83, 393344
    s_add_u32 m0, s98, 49152
    s_nop 0
    buffer_load_dwordx4 v28, s[48:51], s83 offen lds
    s_add_u32 m0, s98, 50176
    s_nop 0
    buffer_load_dwordx4 v29, s[48:51], s83 offen lds
    s_add_u32 m0, s98, 51200
    s_nop 0
    buffer_load_dwordx4 v30, s[48:51], s83 offen lds
    s_add_u32 m0, s98, 52224
    s_nop 0
    buffer_load_dwordx4 v31, s[48:51], s83 offen lds
    s_mov_b32 s83, 786432
    s_add_u32 m0, s98, 65536
    s_nop 0
    buffer_load_dwordx4 v28, s[48:51], s83 offen lds
    s_add_u32 m0, s98, 66560
    s_nop 0
    buffer_load_dwordx4 v29, s[48:51], s83 offen lds
    s_add_u32 m0, s98, 67584
    s_nop 0
    buffer_load_dwordx4 v30, s[48:51], s83 offen lds
    s_add_u32 m0, s98, 68608
    s_nop 0
    buffer_load_dwordx4 v31, s[48:51], s83 offen lds
    s_mov_b32 s83, 786560
    s_add_u32 m0, s98, 81920
    s_nop 0
    buffer_load_dwordx4 v28, s[48:51], s83 offen lds
    s_add_u32 m0, s98, 82944
    s_nop 0
    buffer_load_dwordx4 v29, s[48:51], s83 offen lds
    s_add_u32 m0, s98, 83968
    s_nop 0
    buffer_load_dwordx4 v30, s[48:51], s83 offen lds
    s_add_u32 m0, s98, 84992
    s_nop 0
    buffer_load_dwordx4 v31, s[48:51], s83 offen lds
    s_mov_b32 s83, 1179648
    s_add_u32 m0, s98, 98304
    s_nop 0
    buffer_load_dwordx4 v28, s[48:51], s83 offen lds
    s_add_u32 m0, s98, 99328
    s_nop 0
    buffer_load_dwordx4 v29, s[48:51], s83 offen lds
    s_add_u32 m0, s98, 100352
    s_nop 0
    buffer_load_dwordx4 v30, s[48:51], s83 offen lds
    s_add_u32 m0, s98, 101376
    s_nop 0
    buffer_load_dwordx4 v31, s[48:51], s83 offen lds
    s_mov_b32 s83, 1179776
    s_add_u32 m0, s98, 114688
    s_nop 0
    buffer_load_dwordx4 v28, s[48:51], s83 offen lds
    s_add_u32 m0, s98, 115712
    s_nop 0
    buffer_load_dwordx4 v29, s[48:51], s83 offen lds
    s_add_u32 m0, s98, 116736
    s_nop 0
    buffer_load_dwordx4 v30, s[48:51], s83 offen lds
    s_add_u32 m0, s98, 117760
    s_nop 0
    buffer_load_dwordx4 v31, s[48:51], s83 offen lds
    s_mov_b32 s83, 1572864
    s_add_u32 m0, s98, 131072
    s_nop 0
    buffer_load_dwordx4 v28, s[48:51], s83 offen lds
    s_add_u32 m0, s98, 132096
    s_nop 0
    buffer_load_dwordx4 v29, s[48:51], s83 offen lds
    s_add_u32 m0, s98, 133120
    s_nop 0
    buffer_load_dwordx4 v30, s[48:51], s83 offen lds
    s_add_u32 m0, s98, 134144
    s_nop 0
    buffer_load_dwordx4 v31, s[48:51], s83 offen lds
    s_waitcnt vmcnt(36)
    v_add_f32 v32, v32, v33
    v_add_f32 v34, v34, v35
    v_add_f32_e64 v32, v32, v34
    v_cvt_pk_bf16_f32 v35, v32, 0
    v_lshlrev_b32 v33, 16, v35
    v_sub_f32 v33, v32, v33
    v_cvt_pk_bf16_f32 v34, v32, v33
    s_lshl_b32 s83, s72, 9
    s_add_u32 s83, s83, 147456
    v_lshl_add_u32 v3, v1, 3, s83
    ds_write_b64 v3, v[34:35]
    s_waitcnt lgkmcnt(0)
    s_waitcnt vmcnt(28)
    s_barrier
    s_waitcnt vmcnt(4)
    s_barrier
    s_mov_b32 s83, 1572992
    s_add_u32 m0, s98, 147456
    s_nop 0
    buffer_load_dwordx4 v28, s[48:51], s83 offen lds
    s_add_u32 m0, s98, 148480
    s_nop 0
    buffer_load_dwordx4 v29, s[48:51], s83 offen lds
    s_add_u32 m0, s98, 149504
    s_nop 0
    buffer_load_dwordx4 v30, s[48:51], s83 offen lds
    s_add_u32 m0, s98, 150528
    s_nop 0
    buffer_load_dwordx4 v31, s[48:51], s83 offen lds
    s_getpc_b64 s[12:13]
L_PCT_52:
    s_lshl_b32 s11, s72, 7
    s_add_u32 s11, s11, E3H-L_PCT_52+0
    s_add_u32 s12, s12, s11
    s_addc_u32 s13, s13, 0
    s_load_dword s10, s[12:13], 0
    s_load_dword s10, s[12:13], 512
    s_load_dword s10, s[12:13], 1024
    s_load_dword s10, s[12:13], 1536
    s_load_dword s10, s[12:13], 2048
    s_load_dword s10, s[12:13], 2560
    s_load_dword s10, s[12:13], 3072
    s_load_dword s10, s[12:13], 3584
    s_load_dword s10, s[12:13], 4096
    s_load_dword s10, s[12:13], 4608
    s_load_dword s10, s[12:13], 5120
    s_load_dword s10, s[12:13], 5632
    s_load_dword s10, s[12:13], 6144
    s_load_dword s10, s[12:13], 6656
    s_waitcnt vmcnt(0)
    s_barrier
    s_barrier
    v_add_u32 v3, 0, v27
    ds_write_b128 v3, v[76:79] offset:0
    ds_write_b128 v3, v[80:83] offset:1024
    ds_write_b128 v3, v[84:87] offset:2048
    ds_write_b128 v3, v[88:91] offset:3072
    v_add_u32 v3, 16384, v27
    ds_write_b128 v3, v[92:95] offset:0
    ds_write_b128 v3, v[96:99] offset:1024
    ds_write_b128 v3, v[100:103] offset:2048
    ds_write_b128 v3, v[104:107] offset:3072
    v_add_u32 v3, 32768, v27
    ds_write_b128 v3, v[108:111] offset:0
    ds_write_b128 v3, v[112:115] offset:1024
    ds_write_b128 v3, v[116:119] offset:2048
    ds_write_b128 v3, v[120:123] offset:3072
    v_add_u32 v3, 49152, v27
    ds_write_b128 v3, v[124:127] offset:0
    ds_write_b128 v3, v[128:131] offset:1024
    ds_write_b128 v3, v[132:135] offset:2048
    ds_write_b128 v3, v[136:139] offset:3072
    v_add_u32 v3, 65536, v27
    ds_write_b128 v3, v[140:143] offset:0
    ds_write_b128 v3, v[144:147] offset:1024
    ds_write_b128 v3, v[148:151] offset:2048
    ds_write_b128 v3, v[152:155] offset:3072
    s_waitcnt lgkmcnt(0)
    s_barrier
    s_endpgm
L_COMPUTE:
    s_cmp_lg_u32 s72, 0
    s_cbranch_scc1 SK_53
    s_getpc_b64 s[14:15]
L_PCREF_54:
    s_sub_u32 s14, s14, L_PCREF_54-L_CODE0
    s_subb_u32 s15, s15, 0
    s_bfe_u32 s84, s2, 0x40003
    s_mul_i32 s84, s84, 5760
    v_lshl_add_u32 v3, v1, 7, s84
    v_min_u32 v3, L_CODE1-L_CODE0-4, v3
    global_load_dword v64, v3, s[14:15]
SK_53:
    s_lshl_b32 s83, s2, 3
    s_lshl_b32 s84, s72, 1
    s_add_u32 s83, s83, s84
    s_mul_i32 s83, s83, 1280
    v_lshrrev_b32_e64 v3, 5, v1
    v_mul_u32_u24 v3, 1280, v3
    v_and_b32_e64 v4, 31, v1
    v_lshl_add_u32 v3, v4, 3, v3
    s_waitcnt lgkmcnt(0)
    s_mov_b32 s36, s16
    s_mov_b32 s37, s17
    s_mov_b32 s38, 2621440
    s_mov_b32 s39, 0x20000
    s_load_dword s73, s[34:35], 0
    buffer_load_dwordx2 v[66:67], v3, s[36:39], s83 offen offset:0
    buffer_load_dwordx2 v[68:69], v3, s[36:39], s83 offen offset:256
    buffer_load_dwordx2 v[70:71], v3, s[36:39], s83 offen offset:512
    buffer_load_dwordx2 v[72:73], v3, s[36:39], s83 offen offset:768
    buffer_load_dwordx2 v[74:75], v3, s[36:39], s83 offen offset:1024
    s_mul_i32 s86, s2, 1639
    s_lshr_b32 s86, s86, 16
    s_mul_i32 s83, s86, 40
    s_sub_u32 s83, s2, s83
    s_cmp_lt_u32 s83, 30
    s_cselect_b32 s68, s18, s24
    s_cselect_b32 s69, s19, s25
    s_mov_b32 s70, 819200
    s_cselect_b32 s70, 2457600, s70
    s_mov_b32 s87, 1280
    s_cselect_b32 s87, 3840, s87
    s_cselect_b32 s84, 0, 30
    s_mov_b32 s71, 0x20000
    s_cmp_ge_u32 s82, 20
    s_cselect_b32 s70, 0, s70
    s_sub_u32 s83, s83, s84
    s_lshl_b32 s83, s83, 7
    s_mul_i32 s84, s86, 160
    s_mul_i32 s85, s72, 40
    s_add_u32 s84, s84, s85
    s_mul_i32 s84, s84, s87
    s_add_u32 s83, s83, s84
    s_lshl_b32 s84, s87, 3
    v_lshrrev_b32 v3, 3, v1
    v_mul_lo_u32 v3, v3, s87
    v_and_b32_e64 v4, 7, v1
    v_lshl_add_u32 v3, v4, 4, v3
    buffer_load_dwordx4 v[76:79], v3, s[68:71], s83 offen
    s_add_u32 s83, s83, s84
    buffer_load_dwordx4 v[80:83], v3, s[68:71], s83 offen
    s_add_u32 s83, s83, s84
    buffer_load_dwordx4 v[84:87], v3, s[68:71], s83 offen
    s_add_u32 s83, s83, s84
    buffer_load_dwordx4 v[88:91], v3, s[68:71], s83 offen
    s_add_u32 s83, s83, s84
    buffer_load_dwordx4 v[92:95], v3, s[68:71], s83 offen
    s_mov_b32 s64, s34
    s_mov_b32 s65, s35
    s_mov_b32 s66, 23068672
    s_mov_b32 s67, 0x20000
    s_mov_b32 s60, s32
    s_mov_b32 s61, s33
    s_mov_b32 s62, 2621440
    s_mov_b32 s63, 0x20000
    s_waitcnt lgkmcnt(0)
    s_mul_i32 s73, s73, 0x9E3779B1
    s_add_u32 s73, s73, 0x7F4A7C15
    v_mov_b32 v2, s73
    s_add_u32 s85, s80, 6
    s_cmp_ge_u32 s82, 20
    s_cselect_b32 s11, s85, s80
    s_lshl_b32 s85, s79, 7
    s_lshl_b32 s84, s72, 5
    s_add_u32 s85, s85, s84
    v_and_b32 v6, 31, v1
    v_add_u32 v6, s85, v6
    v_lshrrev_b32_e64 v4, 5, v1
    v_mul_u32_u24 v3, 33024, v4
    v_lshl_add_u32 v7, v6, 4, v3
    v_mul_u32_u24 v3, 1280, v6
    v_lshl_add_u32 v3, v4, 4, v3
    s_lshl_b32 s84, s80, 7
    v_add_u32 v9, s84, v3
    v_lshrrev_b32_e64 v3, 5, v1
    v_bfe_u32 v4, v1, 2, 2
    v_lshl_add_u32 v3, v3, 2, v4
    v_mul_u32_u24 v3, 128, v3
    v_bfe_u32 v4, v1, 4, 1
    v_lshl_add_u32 v3, v4, 5, v3
    v_and_b32_e64 v4, 3, v1
    v_lshl_add_u32 v30, v4, 3, v3
    v_bfe_u32 v3, v1, 3, 1
    v_lshl_add_u32 v30, v3, 6, v30
    v_xor_b32 v31, 64, v30
    v_lshrrev_b32 v3, 5, v1
    v_bfe_u32 v4, v1, 2, 2
    v_lshl_add_u32 v3, v3, 2, v4
    v_mul_u32_u24 v3, 320, v3
    v_bfe_u32 v4, v1, 4, 1
    v_lshl_add_u32 v3, v4, 5, v3
    v_and_b32_e64 v4, 3, v1
    v_lshl_add_u32 v10, v4, 3, v3
    s_lshl_b32 s83, s72, 12
    s_add_u32 s83, s83, 8192
    s_lshl_b32 s84, s72, 13
    s_add_u32 s84, s84, 20480
    s_cmp_ge_u32 s82, 20
    s_cselect_b32 s83, s84, s83
    v_and_b32_e64 v3, 31, v1
    v_bfe_u32 v4, v1, 1, 3
    v_lshrrev_b32 v5, 5, v1
    v_xor_b32 v4, v4, v5
    v_lshlrev_b32 v3, 7, v3
    v_add_u32 v3, s83, v3
    v_xor_b32_e64 v5, 0, v4
    v_lshl_add_u32 v36, v5, 4, v3
    v_xor_b32_e64 v5, 2, v4
    v_lshl_add_u32 v37, v5, 4, v3
    v_xor_b32_e64 v5, 4, v4
    v_lshl_add_u32 v38, v5, 4, v3
    v_xor_b32_e64 v5, 6, v4
    v_lshl_add_u32 v39, v5, 4, v3
    v_lshrrev_b32_e64 v3, 5, v1
    v_lshl_add_u32 v44, v3, 9, v30
    v_lshl_add_u32 v45, v3, 9, v31
    s_cmp_lt_u32 s82, 20
    s_cbranch_scc1 SK_55
    v_mul_u32_u24 v3, 1280, v3
    v_add_u32 v44, v3, v10
SK_55:
    v_mov_b32 v202, 0
    v_mov_b32 v203, 0
    v_mov_b32 v206, 0
    v_mov_b32 v207, 0
    s_lshl_b32 s86, s80, 1
    s_add_u32 s86, s86, 0
    s_mul_i32 s86, s86, 13108
    s_lshr_b32 s86, s86, 16
    s_lshr_b32 s83, s86, 1
    s_add_u32 s83, s83, 1
    s_sub_u32 s84, 0, s83
    s_bitcmp1_b32 s86, 0
    s_cselect_b32 s83, s84, s83
    v_add_u32 v5, s83, v6
    v_cmp_le_u32 vcc, 2048, v5
    v_and_b32 v5, 2047, v5
    v_sub_u32_e64 v5, v5, v6
    v_lshl_add_u32 v212, v5, 4, v7
    s_mov_b64 s[4:5], vcc
    s_lshl_b32 s86, s80, 1
    s_add_u32 s86, s86, 1
    s_mul_i32 s86, s86, 13108
    s_lshr_b32 s86, s86, 16
    s_lshr_b32 s83, s86, 1
    s_add_u32 s83, s83, 1
    s_sub_u32 s84, 0, s83
    s_bitcmp1_b32 s86, 0
    s_cselect_b32 s83, s84, s83
    v_add_u32 v5, s83, v6
    v_cmp_le_u32 vcc, 2048, v5
    v_and_b32 v5, 2047, v5
    v_sub_u32_e64 v5, v5, v6
    v_lshl_add_u32 v213, v5, 4, v7
    s_mov_b64 s[6:7], vcc
    v_cmp_lt_u32 vcc, 9, v1
    v_mov_b32 v3, 768
    s_nop 0
    v_cndmask_b32 v3, 0, v3, vcc
    v_lshl_add_u32 v3, v1, 7, v3
    s_and_b32 s84, s79, 14
    s_mul_i32 s84, s84, 2048
    s_add_u32 s84, s84, 22183936
    v_add_u32 v8, s84, v3
    s_and_b32 s83, s79, 1
    s_mul_i32 s8, s83, 3
    s_lshl_b32 s84, s83, 1
    s_add_u32 s84, s84, s79
    s_add_u32 s84, s84, 15
    s_and_b32 s84, s84, 15
    s_mul_i32 s84, s84, 2048
    s_add_u32 s84, s84, 22052864
    v_min_u32_e64 v3, 9, v1
    v_lshl_add_u32 v62, v3, 7, s84
    s_xor_b32 s83, s83, 1
    s_mul_i32 s9, s83, 660480
    s_sub_u32 s10, 0, s9
    s_waitcnt vmcnt(5)
    v_lshlrev_b32 v96, 16, v66
    v_and_b32 v97, 0xffff0000, v66
    v_lshlrev_b32_e64 v98, 16, v67
    v_and_b32 v99, 0xffff0000, v67
    v_lshlrev_b32_e64 v100, 16, v68
    v_and_b32 v101, 0xffff0000, v68
    v_lshlrev_b32_e64 v102, 16, v69
    v_and_b32 v103, 0xffff0000, v69
    v_lshlrev_b32_e64 v104, 16, v70
    v_and_b32 v105, 0xffff0000, v70
    v_lshlrev_b32_e64 v106, 16, v71
    v_and_b32 v107, 0xffff0000, v71
    v_lshlrev_b32_e64 v108, 16, v72
    v_and_b32 v109, 0xffff0000, v72
    v_lshlrev_b32_e64 v110, 16, v73
    v_and_b32 v111, 0xffff0000, v73
    v_lshlrev_b32_e64 v112, 16, v74
    v_and_b32 v113, 0xffff0000, v74
    v_lshlrev_b32_e64 v114, 16, v75
    v_and_b32 v115, 0xffff0000, v75
    v_pk_add_f32 v[116:117], v[96:97], v[98:99]
    v_pk_add_f32 v[116:117], v[116:117], v[100:101]
    v_pk_add_f32 v[116:117], v[116:117], v[102:103]
    v_pk_add_f32 v[116:117], v[116:117], v[104:105]
    v_pk_add_f32 v[116:117], v[116:117], v[106:107]
    v_pk_add_f32 v[116:117], v[116:117], v[108:109]
    v_pk_add_f32 v[116:117], v[116:117], v[110:111]
    v_pk_add_f32 v[116:117], v[116:117], v[112:113]
    v_pk_add_f32 v[116:117], v[116:117], v[114:115]
    v_add_f32 v116, v116, v117
    s_nop 1
    v_add_f32_dpp v116, v116, v116 row_ror:8 row_mask:0xf bank_mask:0xf
    s_nop 1
    v_add_f32_dpp v116, v116, v116 row_ror:4 row_mask:0xf bank_mask:0xf
    s_nop 1
    v_add_f32_dpp v116, v116, v116 row_ror:2 row_mask:0xf bank_mask:0xf
    s_nop 1
    v_add_f32_dpp v116, v116, v116 row_ror:1 row_mask:0xf bank_mask:0xf
    v_mov_b32 v3, v116
    s_nop 1
    v_permlane16_swap_b32 v116, v3
    v_add_f32_e64 v116, v116, v3
    v_mul_f32 v116, 0x3acccccd, v116
    v_mov_b32_e64 v117, v116
    v_pk_add_f32 v[96:97], v[96:97], v[116:117] neg_lo:[0,1] neg_hi:[0,1]
    v_pk_add_f32 v[98:99], v[98:99], v[116:117] neg_lo:[0,1] neg_hi:[0,1]
    v_pk_add_f32 v[100:101], v[100:101], v[116:117] neg_lo:[0,1] neg_hi:[0,1]
    v_pk_add_f32 v[102:103], v[102:103], v[116:117] neg_lo:[0,1] neg_hi:[0,1]
    v_pk_add_f32 v[104:105], v[104:105], v[116:117] neg_lo:[0,1] neg_hi:[0,1]
    v_pk_add_f32 v[106:107], v[106:107], v[116:117] neg_lo:[0,1] neg_hi:[0,1]
    v_pk_add_f32 v[108:109], v[108:109], v[116:117] neg_lo:[0,1] neg_hi:[0,1]
    v_pk_add_f32 v[110:111], v[110:111], v[116:117] neg_lo:[0,1] neg_hi:[0,1]
    v_pk_add_f32 v[112:113], v[112:113], v[116:117] neg_lo:[0,1] neg_hi:[0,1]
    v_pk_add_f32 v[114:115], v[114:115], v[116:117] neg_lo:[0,1] neg_hi:[0,1]
    v_pk_mul_f32 v[118:119], v[96:97], v[96:97]
    v_pk_fma_f32 v[118:119], v[98:99], v[98:99], v[118:119]
    v_pk_fma_f32 v[118:119], v[100:101], v[100:101], v[118:119]
    v_pk_fma_f32 v[118:119], v[102:103], v[102:103], v[118:119]
    v_pk_fma_f32 v[118:119], v[104:105], v[104:105], v[118:119]
    v_pk_fma_f32 v[118:119], v[106:107], v[106:107], v[118:119]
    v_pk_fma_f32 v[118:119], v[108:109], v[108:109], v[118:119]
    v_pk_fma_f32 v[118:119], v[110:111], v[110:111], v[118:119]
    v_pk_fma_f32 v[118:119], v[112:113], v[112:113], v[118:119]
    v_pk_fma_f32 v[118:119], v[114:115], v[114:115], v[118:119]
    v_add_f32 v118, v118, v119
    s_nop 1
    v_add_f32_dpp v118, v118, v118 row_ror:8 row_mask:0xf bank_mask:0xf
    s_nop 1
    v_add_f32_dpp v118, v118, v118 row_ror:4 row_mask:0xf bank_mask:0xf
    s_nop 1
    v_add_f32_dpp v118, v118, v118 row_ror:2 row_mask:0xf bank_mask:0xf
    s_nop 1
    v_add_f32_dpp v118, v118, v118 row_ror:1 row_mask:0xf bank_mask:0xf
    v_mov_b32 v3, v118
    s_nop 1
    v_permlane16_swap_b32 v118, v3
    v_add_f32_e64 v118, v118, v3
    v_mov_b32 v3, 0x3727c5ac
    v_fmac_f32 v3, 0x3acccccd, v118
    v_rsq_f32 v117, v3
    v_lshrrev_b32 v3, 5, v1
    v_lshlrev_b32 v3, 3, v3
    s_lshl_b32 s83, s72, 4
    s_add_u32 s83, s83, s76
    s_add_u32 s83, s83, 1024
    v_add_u32 v3, s83, v3
    ds_write_b64 v3, v[116:117]
    s_cmp_ge_u32 s82, 20
    s_cbranch_scc1 P0_NOCS
    s_waitcnt vmcnt(0)
    v_lshlrev_b32 v96, 16, v76
    v_lshlrev_b32 v105, 16, v80
    v_add_f32 v96, v96, v105
    v_lshlrev_b32 v104, 16, v84
    v_add_f32 v96, v96, v104
    v_lshlrev_b32 v105, 16, v88
    v_add_f32 v96, v96, v105
    v_lshlrev_b32 v104, 16, v92
    v_add_f32 v96, v96, v104
    v_and_b32 v97, 0xffff0000, v76
    v_and_b32 v105, 0xffff0000, v80
    v_add_f32_e64 v97, v97, v105
    v_and_b32 v104, 0xffff0000, v84
    v_add_f32_e64 v97, v97, v104
    v_and_b32 v105, 0xffff0000, v88
    v_add_f32_e64 v97, v97, v105
    v_and_b32 v104, 0xffff0000, v92
    v_add_f32 v97, v97, v104
    v_lshlrev_b32 v98, 16, v77
    v_lshlrev_b32 v105, 16, v81
    v_add_f32 v98, v98, v105
    v_lshlrev_b32 v104, 16, v85
    v_add_f32 v98, v98, v104
    v_lshlrev_b32 v105, 16, v89
    v_add_f32 v98, v98, v105
    v_lshlrev_b32 v104, 16, v93
    v_add_f32 v98, v98, v104
    v_and_b32 v99, 0xffff0000, v77
    v_and_b32 v105, 0xffff0000, v81
    v_add_f32_e64 v99, v99, v105
    v_and_b32 v104, 0xffff0000, v85
    v_add_f32_e64 v99, v99, v104
    v_and_b32 v105, 0xffff0000, v89
    v_add_f32_e64 v99, v99, v105
    v_and_b32 v104, 0xffff0000, v93
    v_add_f32 v99, v99, v104
    v_lshlrev_b32 v100, 16, v78
    v_lshlrev_b32 v105, 16, v82
    v_add_f32 v100, v100, v105
    v_lshlrev_b32 v104, 16, v86
    v_add_f32 v100, v100, v104
    v_lshlrev_b32 v105, 16, v90
    v_add_f32 v100, v100, v105
    v_lshlrev_b32 v104, 16, v94
    v_add_f32 v100, v100, v104
    v_and_b32 v101, 0xffff0000, v78
    v_and_b32 v105, 0xffff0000, v82
    v_add_f32_e64 v101, v101, v105
    v_and_b32 v104, 0xffff0000, v86
    v_add_f32_e64 v101, v101, v104
    v_and_b32 v105, 0xffff0000, v90
    v_add_f32_e64 v101, v101, v105
    v_and_b32 v104, 0xffff0000, v94
    v_add_f32 v101, v101, v104
    v_lshlrev_b32 v102, 16, v79
    v_lshlrev_b32 v105, 16, v83
    v_add_f32 v102, v102, v105
    v_lshlrev_b32 v104, 16, v87
    v_add_f32 v102, v102, v104
    v_lshlrev_b32 v105, 16, v91
    v_add_f32 v102, v102, v105
    v_lshlrev_b32 v104, 16, v95
    v_add_f32 v102, v102, v104
    v_and_b32 v103, 0xffff0000, v79
    v_and_b32 v105, 0xffff0000, v83
    v_add_f32_e64 v103, v103, v105
    v_and_b32 v104, 0xffff0000, v87
    v_add_f32_e64 v103, v103, v104
    v_and_b32 v105, 0xffff0000, v91
    v_add_f32_e64 v103, v103, v105
    v_and_b32 v104, 0xffff0000, v95
    v_add_f32 v103, v103, v104
    v_permlane32_swap_b32 v96, v100
    v_permlane32_swap_b32 v97, v101
    v_permlane32_swap_b32 v98, v102
    v_permlane32_swap_b32 v99, v103
    v_add_f32 v96, v96, v100
    v_add_f32 v97, v97, v101
    v_add_f32 v98, v98, v102
    v_add_f32 v99, v99, v103
    s_nop 0
    v_permlane16_swap_b32 v96, v98
    v_permlane16_swap_b32 v97, v99
    v_add_f32 v96, v96, v98
    v_add_f32 v97, v97, v99
    s_nop 0
    v_add_f32_dpp v96, v96, v96 row_ror:8 row_mask:0xf bank_mask:0xf
    v_add_f32_dpp v97, v97, v97 row_ror:8 row_mask:0xf bank_mask:0xf
    v_and_b32 v3, 7, v1
    v_lshlrev_b32 v3, 5, v3
    v_lshrrev_b32 v4, 4, v1
    v_lshl_add_u32 v3, v4, 3, v3
    s_lshl_b32 s83, s72, 8
    s_add_u32 s83, s83, s76
    v_add_u32_e64 v3, s83, v3
    ds_write_b64 v3, v[96:97]
P0_NOCS:
    s_cmp_ge_u32 s82, 20
    s_cbranch_scc1 C_A
    s_waitcnt lgkmcnt(0)
    v_add_u32 v46, 0, v44
    v_add_u32 v47, 0, v45
    v_add_u32 v40, 0, v36
    v_add_u32 v41, 0, v37
    v_add_u32 v42, 0, v38
    v_add_u32 v43, 0, v39
    s_barrier
    ds_read_b128 v[184:187], v40 offset:0
    ds_read_b64_tr_b16 v[64:65], v46 offset:0
    ds_read_b64_tr_b16 v[66:67], v46 offset:512
    ds_read_b64_tr_b16 v[68:69], v47 offset:0
    ds_read_b64_tr_b16 v[70:71], v47 offset:512
    ds_read_b128 v[188:191], v41 offset:0
    ds_read_b64_tr_b16 v[72:73], v46 offset:2048
    ds_read_b64_tr_b16 v[74:75], v46 offset:2560
    ds_read_b64_tr_b16 v[76:77], v47 offset:2048
    ds_read_b64_tr_b16 v[78:79], v47 offset:2560
    s_waitcnt lgkmcnt(9)
    s_waitcnt lgkmcnt(7)
    v_mfma_f32_32x32x16_bf16 v[104:119], v[64:67], v[184:187], 0
    ds_read_b128 v[192:195], v42 offset:0
    ds_read_b64_tr_b16 v[80:81], v46 offset:4096
    ds_read_b64_tr_b16 v[82:83], v46 offset:4608
    s_waitcnt lgkmcnt(8)
    v_mfma_f32_32x32x16_bf16 v[120:135], v[68:71], v[184:187], 0
    ds_read_b64_tr_b16 v[84:85], v47 offset:4096
    ds_read_b64_tr_b16 v[86:87], v47 offset:4608
    s_waitcnt lgkmcnt(9)
    s_waitcnt lgkmcnt(7)
    v_mfma_f32_32x32x16_bf16 v[104:119], v[72:75], v[188:191], v[104:119]
    ds_read_b128 v[184:187], v43 offset:0
    ds_read_b64_tr_b16 v[64:65], v46 offset:6144
    ds_read_b64_tr_b16 v[66:67], v46 offset:6656
    s_waitcnt lgkmcnt(8)
    v_mfma_f32_32x32x16_bf16 v[120:135], v[76:79], v[188:191], v[120:135]
    ds_read_b64_tr_b16 v[68:69], v47 offset:6144
    ds_read_b64_tr_b16 v[70:71], v47 offset:6656
    s_cmp_lg_u32 s80, 0
    s_cbranch_scc1 SK_56
    v_lshrrev_b32 v3, 5, v1
    v_lshlrev_b32 v4, 4, v3
    v_lshlrev_b32 v3, 3, v3
    v_xor_b32 v5, v4, v40
    v_add_u32_e64 v5, v5, v3
    ds_read_b64 v[220:221], v5
    v_xor_b32_e64 v5, 16, v5
    ds_read_b64 v[222:223], v5
    v_xor_b32 v5, v4, v41
    v_add_u32 v5, v5, v3
    ds_read_b64 v[224:225], v5
    v_xor_b32_e64 v5, 16, v5
    ds_read_b64 v[226:227], v5
    v_xor_b32 v5, v4, v42
    v_add_u32 v5, v5, v3
    ds_read_b64 v[228:229], v5
    v_xor_b32_e64 v5, 16, v5
    ds_read_b64 v[230:231], v5
    v_xor_b32 v5, v4, v43
    v_add_u32 v5, v5, v3
    ds_read_b64 v[232:233], v5
    v_xor_b32_e64 v5, 16, v5
    ds_read_b64 v[234:235], v5
SK_56:
    s_waitcnt lgkmcnt(0)
    s_nop 0
    v_add_u32 v46, 24576, v44
    v_add_u32 v47, 24576, v45
    v_add_u32 v40, 24576, v36
    v_add_u32 v41, 24576, v37
    v_add_u32 v42, 24576, v38
    v_add_u32 v43, 24576, v39
    s_barrier
    v_mfma_f32_32x32x16_bf16 v[104:119], v[80:83], v[192:195], v[104:119]
    ds_read_b128 v[188:191], v40 offset:0
    ds_read_b64_tr_b16 v[72:73], v46 offset:0
    ds_read_b64_tr_b16 v[74:75], v46 offset:512
    v_mfma_f32_32x32x16_bf16 v[120:135], v[84:87], v[192:195], v[120:135]
    ds_read_b64_tr_b16 v[76:77], v47 offset:0
    ds_read_b64_tr_b16 v[78:79], v47 offset:512
    v_mfma_f32_32x32x16_bf16 v[104:119], v[64:67], v[184:187], v[104:119]
    ds_read_b128 v[192:195], v41 offset:0
    ds_read_b64_tr_b16 v[80:81], v46 offset:2048
    ds_read_b64_tr_b16 v[82:83], v46 offset:2560
    v_mfma_f32_32x32x16_bf16 v[120:135], v[68:71], v[184:187], v[120:135]
    ds_read_b64_tr_b16 v[84:85], v47 offset:2048
    ds_read_b64_tr_b16 v[86:87], v47 offset:2560
    s_waitcnt lgkmcnt(9)
    s_waitcnt lgkmcnt(7)
    v_mfma_f32_32x32x16_bf16 v[104:119], v[72:75], v[188:191], v[104:119]
    ds_read_b128 v[184:187], v42 offset:0
    ds_read_b64_tr_b16 v[64:65], v46 offset:4096
    ds_read_b64_tr_b16 v[66:67], v46 offset:4608
    s_waitcnt lgkmcnt(8)
    v_mfma_f32_32x32x16_bf16 v[120:135], v[76:79], v[188:191], v[120:135]
    ds_read_b64_tr_b16 v[68:69], v47 offset:4096
    ds_read_b64_tr_b16 v[70:71], v47 offset:4608
    s_waitcnt lgkmcnt(9)
    s_waitcnt lgkmcnt(7)
    v_mfma_f32_32x32x16_bf16 v[104:119], v[80:83], v[192:195], v[104:119]
    ds_read_b128 v[188:191], v43 offset:0
    ds_read_b64_tr_b16 v[72:73], v46 offset:6144
    ds_read_b64_tr_b16 v[74:75], v46 offset:6656
    s_waitcnt lgkmcnt(8)
    v_mfma_f32_32x32x16_bf16 v[120:135], v[84:87], v[192:195], v[120:135]
    ds_read_b64_tr_b16 v[76:77], v47 offset:6144
    ds_read_b64_tr_b16 v[78:79], v47 offset:6656
    s_cmp_lg_u32 s80, 1
    s_cbranch_scc1 SK_57
    v_lshrrev_b32 v3, 5, v1
    v_lshlrev_b32 v4, 4, v3
    v_lshlrev_b32 v3, 3, v3
    v_xor_b32 v5, v4, v40
    v_add_u32 v5, v5, v3
    ds_read_b64 v[220:221], v5
    v_xor_b32_e64 v5, 16, v5
    ds_read_b64 v[222:223], v5
    v_xor_b32 v5, v4, v41
    v_add_u32 v5, v5, v3
    ds_read_b64 v[224:225], v5
    v_xor_b32_e64 v5, 16, v5
    ds_read_b64 v[226:227], v5
    v_xor_b32 v5, v4, v42
    v_add_u32 v5, v5, v3
    ds_read_b64 v[228:229], v5
    v_xor_b32_e64 v5, 16, v5
    ds_read_b64 v[230:231], v5
    v_xor_b32 v5, v4, v43
    v_add_u32 v5, v5, v3
    ds_read_b64 v[232:233], v5
    v_xor_b32_e64 v5, 16, v5
    ds_read_b64 v[234:235], v5
SK_57:
    s_waitcnt lgkmcnt(0)
    s_nop 0
    v_add_u32 v46, 49152, v44
    v_add_u32 v47, 49152, v45
    v_add_u32 v40, 49152, v36
    v_add_u32 v41, 49152, v37
    v_add_u32 v42, 49152, v38
    v_add_u32 v43, 49152, v39
    s_barrier
    v_mfma_f32_32x32x16_bf16 v[104:119], v[64:67], v[184:187], v[104:119]
    ds_read_b128 v[192:195], v40 offset:0
    ds_read_b64_tr_b16 v[80:81], v46 offset:0
    ds_read_b64_tr_b16 v[82:83], v46 offset:512
    v_mfma_f32_32x32x16_bf16 v[120:135], v[68:71], v[184:187], v[120:135]
    ds_read_b64_tr_b16 v[84:85], v47 offset:0
    ds_read_b64_tr_b16 v[86:87], v47 offset:512
    v_mfma_f32_32x32x16_bf16 v[104:119], v[72:75], v[188:191], v[104:119]
    ds_read_b128 v[184:187], v41 offset:0
    ds_read_b64_tr_b16 v[64:65], v46 offset:2048
    ds_read_b64_tr_b16 v[66:67], v46 offset:2560
    v_mfma_f32_32x32x16_bf16 v[120:135], v[76:79], v[188:191], v[120:135]
    ds_read_b64_tr_b16 v[68:69], v47 offset:2048
    ds_read_b64_tr_b16 v[70:71], v47 offset:2560
    s_waitcnt lgkmcnt(9)
    s_waitcnt lgkmcnt(7)
    v_mfma_f32_32x32x16_bf16 v[104:119], v[80:83], v[192:195], v[104:119]
    ds_read_b128 v[188:191], v42 offset:0
    ds_read_b64_tr_b16 v[72:73], v46 offset:4096
    ds_read_b64_tr_b16 v[74:75], v46 offset:4608
    s_waitcnt lgkmcnt(8)
    v_mfma_f32_32x32x16_bf16 v[120:135], v[84:87], v[192:195], v[120:135]
    ds_read_b64_tr_b16 v[76:77], v47 offset:4096
    ds_read_b64_tr_b16 v[78:79], v47 offset:4608
    s_waitcnt lgkmcnt(9)
    s_waitcnt lgkmcnt(7)
    v_mfma_f32_32x32x16_bf16 v[104:119], v[64:67], v[184:187], v[104:119]
    ds_read_b128 v[192:195], v43 offset:0
    ds_read_b64_tr_b16 v[80:81], v46 offset:6144
    ds_read_b64_tr_b16 v[82:83], v46 offset:6656
    s_waitcnt lgkmcnt(8)
    v_mfma_f32_32x32x16_bf16 v[120:135], v[68:71], v[184:187], v[120:135]
    ds_read_b64_tr_b16 v[84:85], v47 offset:6144
    ds_read_b64_tr_b16 v[86:87], v47 offset:6656
    s_cmp_lg_u32 s80, 2
    s_cbranch_scc1 SK_58
    v_lshrrev_b32 v3, 5, v1
    v_lshlrev_b32 v4, 4, v3
    v_lshlrev_b32 v3, 3, v3
    v_xor_b32 v5, v4, v40
    v_add_u32 v5, v5, v3
    ds_read_b64 v[220:221], v5
    v_xor_b32_e64 v5, 16, v5
    ds_read_b64 v[222:223], v5
    v_xor_b32 v5, v4, v41
    v_add_u32 v5, v5, v3
    ds_read_b64 v[224:225], v5
    v_xor_b32_e64 v5, 16, v5
    ds_read_b64 v[226:227], v5
    v_xor_b32 v5, v4, v42
    v_add_u32 v5, v5, v3
    ds_read_b64 v[228:229], v5
    v_xor_b32_e64 v5, 16, v5
    ds_read_b64 v[230:231], v5
    v_xor_b32 v5, v4, v43
    v_add_u32 v5, v5, v3
    ds_read_b64 v[232:233], v5
    v_xor_b32_e64 v5, 16, v5
    ds_read_b64 v[234:235], v5
SK_58:
    s_waitcnt lgkmcnt(0)
    s_nop 0
    v_add_u32 v46, 81920, v44
    v_add_u32 v47, 81920, v45
    v_add_u32 v40, 81920, v36
    v_add_u32 v41, 81920, v37
    v_add_u32 v42, 81920, v38
    v_add_u32 v43, 81920, v39
    s_barrier
    v_mfma_f32_32x32x16_bf16 v[104:119], v[72:75], v[188:191], v[104:119]
    ds_read_b128 v[184:187], v40 offset:0
    ds_read_b64_tr_b16 v[64:65], v46 offset:0
    ds_read_b64_tr_b16 v[66:67], v46 offset:512
    v_mfma_f32_32x32x16_bf16 v[120:135], v[76:79], v[188:191], v[120:135]
    ds_read_b64_tr_b16 v[68:69], v47 offset:0
    ds_read_b64_tr_b16 v[70:71], v47 offset:512
    v_mfma_f32_32x32x16_bf16 v[104:119], v[80:83], v[192:195], v[104:119]
    ds_read_b128 v[188:191], v41 offset:0
    ds_read_b64_tr_b16 v[72:73], v46 offset:2048
    ds_read_b64_tr_b16 v[74:75], v46 offset:2560
    v_mfma_f32_32x32x16_bf16 v[120:135], v[84:87], v[192:195], v[120:135]
    ds_read_b64_tr_b16 v[76:77], v47 offset:2048
    ds_read_b64_tr_b16 v[78:79], v47 offset:2560
    s_waitcnt lgkmcnt(9)
    s_waitcnt lgkmcnt(7)
    v_mfma_f32_32x32x16_bf16 v[104:119], v[64:67], v[184:187], v[104:119]
    ds_read_b128 v[192:195], v42 offset:0
    ds_read_b64_tr_b16 v[80:81], v46 offset:4096
    ds_read_b64_tr_b16 v[82:83], v46 offset:4608
    s_waitcnt lgkmcnt(8)
    v_mfma_f32_32x32x16_bf16 v[120:135], v[68:71], v[184:187], v[120:135]
    ds_read_b64_tr_b16 v[84:85], v47 offset:4096
    ds_read_b64_tr_b16 v[86:87], v47 offset:4608
    s_waitcnt lgkmcnt(9)
    s_waitcnt lgkmcnt(7)
    v_mfma_f32_32x32x16_bf16 v[104:119], v[72:75], v[188:191], v[104:119]
    ds_read_b128 v[184:187], v43 offset:0
    ds_read_b64_tr_b16 v[64:65], v46 offset:6144
    ds_read_b64_tr_b16 v[66:67], v46 offset:6656
    s_waitcnt lgkmcnt(8)
    v_mfma_f32_32x32x16_bf16 v[120:135], v[76:79], v[188:191], v[120:135]
    ds_read_b64_tr_b16 v[68:69], v47 offset:6144
    ds_read_b64_tr_b16 v[70:71], v47 offset:6656
    s_cmp_lg_u32 s80, 3
    s_cbranch_scc1 SK_59
    v_lshrrev_b32 v3, 5, v1
    v_lshlrev_b32 v4, 4, v3
    v_lshlrev_b32 v3, 3, v3
    v_xor_b32 v5, v4, v40
    v_add_u32 v5, v5, v3
    ds_read_b64 v[220:221], v5
    v_xor_b32_e64 v5, 16, v5
    ds_read_b64 v[222:223], v5
    v_xor_b32 v5, v4, v41
    v_add_u32 v5, v5, v3
    ds_read_b64 v[224:225], v5
    v_xor_b32_e64 v5, 16, v5
    ds_read_b64 v[226:227], v5
    v_xor_b32 v5, v4, v42
    v_add_u32 v5, v5, v3
    ds_read_b64 v[228:229], v5
    v_xor_b32_e64 v5, 16, v5
    ds_read_b64 v[230:231], v5
    v_xor_b32 v5, v4, v43
    v_add_u32 v5, v5, v3
    ds_read_b64 v[232:233], v5
    v_xor_b32_e64 v5, 16, v5
    ds_read_b64 v[234:235], v5
SK_59:
    s_waitcnt lgkmcnt(0)
    s_nop 0
    v_add_u32 v46, 106496, v44
    v_add_u32 v47, 106496, v45
    v_add_u32 v40, 106496, v36
    v_add_u32 v41, 106496, v37
    v_add_u32 v42, 106496, v38
    v_add_u32 v43, 106496, v39
    s_barrier
    v_mfma_f32_32x32x16_bf16 v[104:119], v[80:83], v[192:195], v[104:119]
    ds_read_b128 v[188:191], v40 offset:0
    ds_read_b64_tr_b16 v[72:73], v46 offset:0
    ds_read_b64_tr_b16 v[74:75], v46 offset:512
    v_mfma_f32_32x32x16_bf16 v[120:135], v[84:87], v[192:195], v[120:135]
    ds_read_b64_tr_b16 v[76:77], v47 offset:0
    ds_read_b64_tr_b16 v[78:79], v47 offset:512
    v_mfma_f32_32x32x16_bf16 v[104:119], v[64:67], v[184:187], v[104:119]
    ds_read_b128 v[192:195], v41 offset:0
    ds_read_b64_tr_b16 v[80:81], v46 offset:2048
    ds_read_b64_tr_b16 v[82:83], v46 offset:2560
    v_mfma_f32_32x32x16_bf16 v[120:135], v[68:71], v[184:187], v[120:135]
    ds_read_b64_tr_b16 v[84:85], v47 offset:2048
    ds_read_b64_tr_b16 v[86:87], v47 offset:2560
    s_waitcnt lgkmcnt(9)
    s_waitcnt lgkmcnt(7)
    v_mfma_f32_32x32x16_bf16 v[104:119], v[72:75], v[188:191], v[104:119]
    ds_read_b128 v[184:187], v42 offset:0
    ds_read_b64_tr_b16 v[64:65], v46 offset:4096
    ds_read_b64_tr_b16 v[66:67], v46 offset:4608
    s_waitcnt lgkmcnt(8)
    v_mfma_f32_32x32x16_bf16 v[120:135], v[76:79], v[188:191], v[120:135]
    ds_read_b64_tr_b16 v[68:69], v47 offset:4096
    ds_read_b64_tr_b16 v[70:71], v47 offset:4608
    s_waitcnt lgkmcnt(9)
    s_waitcnt lgkmcnt(7)
    v_mfma_f32_32x32x16_bf16 v[104:119], v[80:83], v[192:195], v[104:119]
    ds_read_b128 v[188:191], v43 offset:0
    ds_read_b64_tr_b16 v[72:73], v46 offset:6144
    ds_read_b64_tr_b16 v[74:75], v46 offset:6656
    s_waitcnt lgkmcnt(8)
    v_mfma_f32_32x32x16_bf16 v[120:135], v[84:87], v[192:195], v[120:135]
    ds_read_b64_tr_b16 v[76:77], v47 offset:6144
    ds_read_b64_tr_b16 v[78:79], v47 offset:6656
    s_cmp_lg_u32 s80, 4
    s_cbranch_scc1 SK_60
    v_lshrrev_b32 v3, 5, v1
    v_lshlrev_b32 v4, 4, v3
    v_lshlrev_b32 v3, 3, v3
    v_xor_b32 v5, v4, v40
    v_add_u32 v5, v5, v3
    ds_read_b64 v[220:221], v5
    v_xor_b32_e64 v5, 16, v5
    ds_read_b64 v[222:223], v5
    v_xor_b32 v5, v4, v41
    v_add_u32 v5, v5, v3
    ds_read_b64 v[224:225], v5
    v_xor_b32_e64 v5, 16, v5
    ds_read_b64 v[226:227], v5
    v_xor_b32 v5, v4, v42
    v_add_u32 v5, v5, v3
    ds_read_b64 v[228:229], v5
    v_xor_b32_e64 v5, 16, v5
    ds_read_b64 v[230:231], v5
    v_xor_b32 v5, v4, v43
    v_add_u32 v5, v5, v3
    ds_read_b64 v[232:233], v5
    v_xor_b32_e64 v5, 16, v5
    ds_read_b64 v[234:235], v5
SK_60:
    s_waitcnt lgkmcnt(0)
    s_nop 0
    v_add_u32 v46, 131072, v44
    v_add_u32 v47, 131072, v45
    v_add_u32 v40, 131072, v36
    v_add_u32 v41, 131072, v37
    v_add_u32 v42, 131072, v38
    v_add_u32 v43, 131072, v39
    s_barrier
    v_mfma_f32_32x32x16_bf16 v[104:119], v[64:67], v[184:187], v[104:119]
    ds_read_b128 v[192:195], v40 offset:0
    ds_read_b64_tr_b16 v[80:81], v46 offset:0
    ds_read_b64_tr_b16 v[82:83], v46 offset:512
    v_mfma_f32_32x32x16_bf16 v[120:135], v[68:71], v[184:187], v[120:135]
    ds_read_b64_tr_b16 v[84:85], v47 offset:0
    ds_read_b64_tr_b16 v[86:87], v47 offset:512
    v_mfma_f32_32x32x16_bf16 v[104:119], v[72:75], v[188:191], v[104:119]
    ds_read_b128 v[184:187], v41 offset:0
    ds_read_b64_tr_b16 v[64:65], v46 offset:2048
    ds_read_b64_tr_b16 v[66:67], v46 offset:2560
    v_mfma_f32_32x32x16_bf16 v[120:135], v[76:79], v[188:191], v[120:135]
    ds_read_b64_tr_b16 v[68:69], v47 offset:2048
    ds_read_b64_tr_b16 v[70:71], v47 offset:2560
    s_waitcnt lgkmcnt(9)
    s_waitcnt lgkmcnt(7)
    v_mfma_f32_32x32x16_bf16 v[104:119], v[80:83], v[192:195], v[104:119]
    ds_read_b128 v[188:191], v42 offset:0
    ds_read_b64_tr_b16 v[72:73], v46 offset:4096
    ds_read_b64_tr_b16 v[74:75], v46 offset:4608
    s_waitcnt lgkmcnt(8)
    v_mfma_f32_32x32x16_bf16 v[120:135], v[84:87], v[192:195], v[120:135]
    ds_read_b64_tr_b16 v[76:77], v47 offset:4096
    ds_read_b64_tr_b16 v[78:79], v47 offset:4608
    s_waitcnt lgkmcnt(9)
    s_waitcnt lgkmcnt(7)
    v_mfma_f32_32x32x16_bf16 v[104:119], v[64:67], v[184:187], v[104:119]
    ds_read_b128 v[192:195], v43 offset:0
    ds_read_b64_tr_b16 v[80:81], v46 offset:6144
    ds_read_b64_tr_b16 v[82:83], v46 offset:6656
    s_waitcnt lgkmcnt(8)
    v_mfma_f32_32x32x16_bf16 v[120:135], v[68:71], v[184:187], v[120:135]
    ds_read_b64_tr_b16 v[84:85], v47 offset:6144
    ds_read_b64_tr_b16 v[86:87], v47 offset:6656
    s_cmp_lg_u32 s80, 5
    s_cbranch_scc1 SK_61
    v_lshrrev_b32 v3, 5, v1
    v_lshlrev_b32 v4, 4, v3
    v_lshlrev_b32 v3, 3, v3
    v_xor_b32 v5, v4, v40
    v_add_u32 v5, v5, v3
    ds_read_b64 v[220:221], v5
    v_xor_b32_e64 v5, 16, v5
    ds_read_b64 v[222:223], v5
    v_xor_b32 v5, v4, v41
    v_add_u32 v5, v5, v3
    ds_read_b64 v[224:225], v5
    v_xor_b32_e64 v5, 16, v5
    ds_read_b64 v[226:227], v5
    v_xor_b32 v5, v4, v42
    v_add_u32 v5, v5, v3
    ds_read_b64 v[228:229], v5
    v_xor_b32_e64 v5, 16, v5
    ds_read_b64 v[230:231], v5
    v_xor_b32 v5, v4, v43
    v_add_u32 v5, v5, v3
    ds_read_b64 v[232:233], v5
    v_xor_b32_e64 v5, 16, v5
    ds_read_b64 v[234:235], v5
SK_61:
    s_waitcnt lgkmcnt(0)
    v_add_u32 v46, 0, v44
    v_add_u32 v47, 0, v45
    v_add_u32 v40, 0, v36
    v_add_u32 v41, 0, v37
    v_add_u32 v42, 0, v38
    v_add_u32 v43, 0, v39
    s_barrier
    v_mfma_f32_32x32x16_bf16 v[104:119], v[72:75], v[188:191], v[104:119]
    ds_read_b128 v[184:187], v40 offset:0
    ds_read_b64_tr_b16 v[64:65], v46 offset:0
    ds_read_b64_tr_b16 v[66:67], v46 offset:512
    v_mfma_f32_32x32x16_bf16 v[120:135], v[76:79], v[188:191], v[120:135]
    ds_read_b64_tr_b16 v[68:69], v47 offset:0
    ds_read_b64_tr_b16 v[70:71], v47 offset:512
    v_mfma_f32_32x32x16_bf16 v[104:119], v[80:83], v[192:195], v[104:119]
    ds_read_b128 v[188:191], v41 offset:0
    ds_read_b64_tr_b16 v[72:73], v46 offset:2048
    ds_read_b64_tr_b16 v[74:75], v46 offset:2560
    v_mfma_f32_32x32x16_bf16 v[120:135], v[84:87], v[192:195], v[120:135]
    ds_read_b64_tr_b16 v[76:77], v47 offset:2048
    ds_read_b64_tr_b16 v[78:79], v47 offset:2560
    s_waitcnt lgkmcnt(9)
    s_waitcnt lgkmcnt(7)
    v_mfma_f32_32x32x16_bf16 v[104:119], v[64:67], v[184:187], v[104:119]
    ds_read_b128 v[192:195], v42 offset:0
    ds_read_b64_tr_b16 v[80:81], v46 offset:4096
    ds_read_b64_tr_b16 v[82:83], v46 offset:4608
    s_waitcnt lgkmcnt(8)
    v_mfma_f32_32x32x16_bf16 v[120:135], v[68:71], v[184:187], v[120:135]
    ds_read_b64_tr_b16 v[84:85], v47 offset:4096
    ds_read_b64_tr_b16 v[86:87], v47 offset:4608
    s_waitcnt lgkmcnt(9)
    s_waitcnt lgkmcnt(7)
    v_mfma_f32_32x32x16_bf16 v[104:119], v[72:75], v[188:191], v[104:119]
    ds_read_b128 v[184:187], v43 offset:0
    ds_read_b64_tr_b16 v[64:65], v46 offset:6144
    ds_read_b64_tr_b16 v[66:67], v46 offset:6656
    s_waitcnt lgkmcnt(8)
    v_mfma_f32_32x32x16_bf16 v[120:135], v[76:79], v[188:191], v[120:135]
    ds_read_b64_tr_b16 v[68:69], v47 offset:6144
    ds_read_b64_tr_b16 v[70:71], v47 offset:6656
    s_cmp_lg_u32 s80, 6
    s_cbranch_scc1 SK_62
    v_lshrrev_b32 v3, 5, v1
    v_lshlrev_b32 v4, 4, v3
    v_lshlrev_b32 v3, 3, v3
    v_xor_b32 v5, v4, v40
    v_add_u32_e64 v5, v5, v3
    ds_read_b64 v[220:221], v5
    v_xor_b32_e64 v5, 16, v5
    ds_read_b64 v[222:223], v5
    v_xor_b32 v5, v4, v41
    v_add_u32 v5, v5, v3
    ds_read_b64 v[224:225], v5
    v_xor_b32_e64 v5, 16, v5
    ds_read_b64 v[226:227], v5
    v_xor_b32 v5, v4, v42
    v_add_u32 v5, v5, v3
    ds_read_b64 v[228:229], v5
    v_xor_b32_e64 v5, 16, v5
    ds_read_b64 v[230:231], v5
    v_xor_b32 v5, v4, v43
    v_add_u32 v5, v5, v3
    ds_read_b64 v[232:233], v5
    v_xor_b32_e64 v5, 16, v5
    ds_read_b64 v[234:235], v5
SK_62:
    s_waitcnt lgkmcnt(0)
    s_nop 0
    v_add_u32 v46, 24576, v44
    v_add_u32 v47, 24576, v45
    v_add_u32 v40, 24576, v36
    v_add_u32 v41, 24576, v37
    v_add_u32 v42, 24576, v38
    v_add_u32 v43, 24576, v39
    s_barrier
    v_mfma_f32_32x32x16_bf16 v[104:119], v[80:83], v[192:195], v[104:119]
    ds_read_b128 v[188:191], v40 offset:0
    ds_read_b64_tr_b16 v[72:73], v46 offset:0
    ds_read_b64_tr_b16 v[74:75], v46 offset:512
    v_mfma_f32_32x32x16_bf16 v[120:135], v[84:87], v[192:195], v[120:135]
    ds_read_b64_tr_b16 v[76:77], v47 offset:0
    ds_read_b64_tr_b16 v[78:79], v47 offset:512
    v_mfma_f32_32x32x16_bf16 v[104:119], v[64:67], v[184:187], v[104:119]
    ds_read_b128 v[192:195], v41 offset:0
    ds_read_b64_tr_b16 v[80:81], v46 offset:2048
    ds_read_b64_tr_b16 v[82:83], v46 offset:2560
    v_mfma_f32_32x32x16_bf16 v[120:135], v[68:71], v[184:187], v[120:135]
    ds_read_b64_tr_b16 v[84:85], v47 offset:2048
    ds_read_b64_tr_b16 v[86:87], v47 offset:2560
    s_waitcnt lgkmcnt(9)
    s_waitcnt lgkmcnt(7)
    v_mfma_f32_32x32x16_bf16 v[104:119], v[72:75], v[188:191], v[104:119]
    ds_read_b128 v[184:187], v42 offset:0
    ds_read_b64_tr_b16 v[64:65], v46 offset:4096
    ds_read_b64_tr_b16 v[66:67], v46 offset:4608
    s_waitcnt lgkmcnt(8)
    v_mfma_f32_32x32x16_bf16 v[120:135], v[76:79], v[188:191], v[120:135]
    ds_read_b64_tr_b16 v[68:69], v47 offset:4096
    ds_read_b64_tr_b16 v[70:71], v47 offset:4608
    s_waitcnt lgkmcnt(9)
    s_waitcnt lgkmcnt(7)
    v_mfma_f32_32x32x16_bf16 v[104:119], v[80:83], v[192:195], v[104:119]
    ds_read_b128 v[188:191], v43 offset:0
    ds_read_b64_tr_b16 v[72:73], v46 offset:6144
    ds_read_b64_tr_b16 v[74:75], v46 offset:6656
    s_waitcnt lgkmcnt(8)
    v_mfma_f32_32x32x16_bf16 v[120:135], v[84:87], v[192:195], v[120:135]
    ds_read_b64_tr_b16 v[76:77], v47 offset:6144
    ds_read_b64_tr_b16 v[78:79], v47 offset:6656
    s_cmp_lg_u32 s80, 7
    s_cbranch_scc1 SK_63
    v_lshrrev_b32 v3, 5, v1
    v_lshlrev_b32 v4, 4, v3
    v_lshlrev_b32 v3, 3, v3
    v_xor_b32 v5, v4, v40
    v_add_u32 v5, v5, v3
    ds_read_b64 v[220:221], v5
    v_xor_b32_e64 v5, 16, v5
    ds_read_b64 v[222:223], v5
    v_xor_b32 v5, v4, v41
    v_add_u32 v5, v5, v3
    ds_read_b64 v[224:225], v5
    v_xor_b32_e64 v5, 16, v5
    ds_read_b64 v[226:227], v5
    v_xor_b32 v5, v4, v42
    v_add_u32 v5, v5, v3
    ds_read_b64 v[228:229], v5
    v_xor_b32_e64 v5, 16, v5
    ds_read_b64 v[230:231], v5
    v_xor_b32 v5, v4, v43
    v_add_u32 v5, v5, v3
    ds_read_b64 v[232:233], v5
    v_xor_b32_e64 v5, 16, v5
    ds_read_b64 v[234:235], v5
SK_63:
    s_waitcnt lgkmcnt(0)
    s_nop 0
    v_add_u32 v46, 49152, v44
    v_add_u32 v47, 49152, v45
    v_add_u32 v40, 49152, v36
    v_add_u32 v41, 49152, v37
    v_add_u32 v42, 49152, v38
    v_add_u32 v43, 49152, v39
    s_barrier
    v_mfma_f32_32x32x16_bf16 v[104:119], v[64:67], v[184:187], v[104:119]
    ds_read_b128 v[192:195], v40 offset:0
    ds_read_b64_tr_b16 v[80:81], v46 offset:0
    ds_read_b64_tr_b16 v[82:83], v46 offset:512
    v_mfma_f32_32x32x16_bf16 v[120:135], v[68:71], v[184:187], v[120:135]
    ds_read_b64_tr_b16 v[84:85], v47 offset:0
    ds_read_b64_tr_b16 v[86:87], v47 offset:512
    v_mfma_f32_32x32x16_bf16 v[104:119], v[72:75], v[188:191], v[104:119]
    ds_read_b128 v[184:187], v41 offset:0
    ds_read_b64_tr_b16 v[64:65], v46 offset:2048
    ds_read_b64_tr_b16 v[66:67], v46 offset:2560
    v_mfma_f32_32x32x16_bf16 v[120:135], v[76:79], v[188:191], v[120:135]
    ds_read_b64_tr_b16 v[68:69], v47 offset:2048
    ds_read_b64_tr_b16 v[70:71], v47 offset:2560
    v_and_b32 v11, 31, v1
    v_lshl_add_u32 v11, v11, 3, s74
    v_lshlrev_b32_e64 v11, 7, v11
    v_add_u32 v11, 22020096, v11
    s_cmp_lg_u32 s72, 0
    s_cbranch_scc1 SK_64
    buffer_load_dwordx2 v[50:51], v11, s[64:67], 0 offen sc1
SK_64:
    s_waitcnt lgkmcnt(9)
    s_waitcnt lgkmcnt(7)
    v_mfma_f32_32x32x16_bf16 v[104:119], v[80:83], v[192:195], v[104:119]
    ds_read_b128 v[188:191], v42 offset:0
    ds_read_b64_tr_b16 v[72:73], v46 offset:4096
    ds_read_b64_tr_b16 v[74:75], v46 offset:4608
    s_waitcnt lgkmcnt(8)
    v_mfma_f32_32x32x16_bf16 v[120:135], v[84:87], v[192:195], v[120:135]
    ds_read_b64_tr_b16 v[76:77], v47 offset:4096
    ds_read_b64_tr_b16 v[78:79], v47 offset:4608
    s_waitcnt lgkmcnt(9)
    s_waitcnt lgkmcnt(7)
    v_mfma_f32_32x32x16_bf16 v[104:119], v[64:67], v[184:187], v[104:119]
    ds_read_b128 v[192:195], v43 offset:0
    ds_read_b64_tr_b16 v[80:81], v46 offset:6144
    ds_read_b64_tr_b16 v[82:83], v46 offset:6656
    s_waitcnt lgkmcnt(8)
    v_mfma_f32_32x32x16_bf16 v[120:135], v[68:71], v[184:187], v[120:135]
    ds_read_b64_tr_b16 v[84:85], v47 offset:6144
    ds_read_b64_tr_b16 v[86:87], v47 offset:6656
    s_cmp_lg_u32 s80, 8
    s_cbranch_scc1 SK_65
    v_lshrrev_b32 v3, 5, v1
    v_lshlrev_b32 v4, 4, v3
    v_lshlrev_b32 v3, 3, v3
    v_xor_b32 v5, v4, v40
    v_add_u32_e64 v5, v5, v3
    ds_read_b64 v[220:221], v5
    v_xor_b32_e64 v5, 16, v5
    ds_read_b64 v[222:223], v5
    v_xor_b32 v5, v4, v41
    v_add_u32 v5, v5, v3
    ds_read_b64 v[224:225], v5
    v_xor_b32_e64 v5, 16, v5
    ds_read_b64 v[226:227], v5
    v_xor_b32 v5, v4, v42
    v_add_u32 v5, v5, v3
    ds_read_b64 v[228:229], v5
    v_xor_b32_e64 v5, 16, v5
    ds_read_b64 v[230:231], v5
    v_xor_b32 v5, v4, v43
    v_add_u32 v5, v5, v3
    ds_read_b64 v[232:233], v5
    v_xor_b32_e64 v5, 16, v5
    ds_read_b64 v[234:235], v5
SK_65:
    s_waitcnt lgkmcnt(0)
    s_nop 0
    v_add_u32 v46, 81920, v44
    v_add_u32 v47, 81920, v45
    v_add_u32 v40, 81920, v36
    v_add_u32 v41, 81920, v37
    v_add_u32 v42, 81920, v38
    v_add_u32 v43, 81920, v39
    s_barrier
    v_mfma_f32_32x32x16_bf16 v[104:119], v[72:75], v[188:191], v[104:119]
    ds_read_b128 v[184:187], v40 offset:0
    ds_read_b64_tr_b16 v[64:65], v46 offset:0
    ds_read_b64_tr_b16 v[66:67], v46 offset:512
    v_mfma_f32_32x32x16_bf16 v[120:135], v[76:79], v[188:191], v[120:135]
    ds_read_b64_tr_b16 v[68:69], v47 offset:0
    ds_read_b64_tr_b16 v[70:71], v47 offset:512
    v_and_b32 v5, 31, v1
    v_lshlrev_b32_e64 v5, 3, v5
    v_add_u32 v5, 73728, v5
    ds_read_b64 v[200:201], v5 offset:0
    ds_read_b64 v[204:205], v5 offset:256
    s_lshl_b32 s83, s72, 8
    v_add_u32 v3, s83, v5
    ds_read_b64 v[48:49], v3 offset:2048
    v_mfma_f32_32x32x16_bf16 v[104:119], v[80:83], v[192:195], v[104:119]
    ds_read_b128 v[188:191], v41 offset:0
    ds_read_b64_tr_b16 v[72:73], v46 offset:2048
    ds_read_b64_tr_b16 v[74:75], v46 offset:2560
    v_mfma_f32_32x32x16_bf16 v[120:135], v[84:87], v[192:195], v[120:135]
    ds_read_b64_tr_b16 v[76:77], v47 offset:2048
    ds_read_b64_tr_b16 v[78:79], v47 offset:2560
    s_waitcnt lgkmcnt(12)
    s_waitcnt lgkmcnt(10)
    v_mfma_f32_32x32x16_bf16 v[104:119], v[64:67], v[184:187], v[104:119]
    ds_read_b128 v[192:195], v42 offset:0
    ds_read_b64_tr_b16 v[80:81], v46 offset:4096
    ds_read_b64_tr_b16 v[82:83], v46 offset:4608
    s_waitcnt lgkmcnt(11)
    v_mfma_f32_32x32x16_bf16 v[120:135], v[68:71], v[184:187], v[120:135]
    ds_read_b64_tr_b16 v[84:85], v47 offset:4096
    ds_read_b64_tr_b16 v[86:87], v47 offset:4608
    s_waitcnt lgkmcnt(9)
    s_waitcnt lgkmcnt(7)
    v_mfma_f32_32x32x16_bf16 v[104:119], v[72:75], v[188:191], v[104:119]
    ds_read_b128 v[184:187], v43 offset:0
    ds_read_b64_tr_b16 v[64:65], v46 offset:6144
    ds_read_b64_tr_b16 v[66:67], v46 offset:6656
    s_waitcnt lgkmcnt(8)
    v_mfma_f32_32x32x16_bf16 v[120:135], v[76:79], v[188:191], v[120:135]
    ds_read_b64_tr_b16 v[68:69], v47 offset:6144
    ds_read_b64_tr_b16 v[70:71], v47 offset:6656
    s_cmp_lg_u32 s80, 9
    s_cbranch_scc1 SK_66
    v_lshrrev_b32 v3, 5, v1
    v_lshlrev_b32 v4, 4, v3
    v_lshlrev_b32 v3, 3, v3
    v_xor_b32 v5, v4, v40
    v_add_u32_e64 v5, v5, v3
    ds_read_b64 v[220:221], v5
    v_xor_b32_e64 v5, 16, v5
    ds_read_b64 v[222:223], v5
    v_xor_b32 v5, v4, v41
    v_add_u32 v5, v5, v3
    ds_read_b64 v[224:225], v5
    v_xor_b32_e64 v5, 16, v5
    ds_read_b64 v[226:227], v5
    v_xor_b32 v5, v4, v42
    v_add_u32 v5, v5, v3
    ds_read_b64 v[228:229], v5
    v_xor_b32_e64 v5, 16, v5
    ds_read_b64 v[230:231], v5
    v_xor_b32 v5, v4, v43
    v_add_u32 v5, v5, v3
    ds_read_b64 v[232:233], v5
    v_xor_b32_e64 v5, 16, v5
    ds_read_b64 v[234:235], v5
SK_66:
    s_waitcnt lgkmcnt(0)
E1B:
    s_barrier
    v_sub_f32 v3, 0, v48
    v_cmp_gt_u32 vcc, 32, v1
    s_nop 1
    v_cndmask_b32 v3, 0, v3, vcc
    v_cvt_pk_bf16_f32 v208, v3, v3
    v_and_b32 v4, 0xffff0000, v208
    v_sub_f32_e64 v4, v3, v4
    v_cvt_pk_bf16_f32 v209, v4, 0
    v_mov_b32 v210, 0
    v_mov_b32 v211, 0
    v_mfma_f32_32x32x16_bf16 v[104:119], v[80:83], v[192:195], v[104:119]
    v_mfma_f32_32x32x16_bf16 v[120:135], v[84:87], v[192:195], v[120:135]
    v_mfma_f32_32x32x16_bf16 v[104:119], v[64:67], v[184:187], v[104:119]
    v_mfma_f32_32x32x16_bf16 v[120:135], v[68:71], v[184:187], v[120:135]
    v_mfma_f32_32x32x16_bf16 v[104:119], v[200:203], v[208:211], v[104:119]
    v_mfma_f32_32x32x16_bf16 v[120:135], v[204:207], v[208:211], v[120:135]
    v_mul_f32_e64 v3, v49, v49
    v_mov_b32 v4, 0x3f800054
    v_fmac_f32 v4, 0xb727c5ac, v3
    v_rsq_f32 v4, v4
    s_nop 0
    v_mul_f32_e64 v5, v49, v4
    v_mul_f32 v24, 0xc0135761, v5
    v_mul_f32 v26, v5, v5
    v_rcp_f32 v28, v5
    v_mul_f32_e64 v26, v26, v24
    v_mul_f32 v26, 0x3d372713, v26
    v_mov_b32 v25, v24
    v_mov_b32 v27, v26
    v_mov_b32_e64 v29, v28
    s_mul_i32 s85, s80, 264192
    s_add_u32 s85, s85, 2097152
    v_pk_mul_f32 v[12:13], v[104:105], v[104:105]
    v_pk_mul_f32 v[14:15], v[106:107], v[106:107]
    v_pk_fma_f32 v[12:13], v[12:13], v[26:27], v[24:25]
    v_pk_fma_f32 v[14:15], v[14:15], v[26:27], v[24:25]
    v_pk_mul_f32 v[12:13], v[12:13], v[104:105]
    v_pk_mul_f32 v[14:15], v[14:15], v[106:107]
    v_exp_f32 v12, v12
    v_exp_f32 v13, v13
    v_exp_f32 v14, v14
    v_exp_f32 v15, v15
    v_pk_fma_f32 v[12:13], v[12:13], v[28:29], v[28:29]
    v_pk_fma_f32 v[14:15], v[14:15], v[28:29], v[28:29]
    v_rcp_f32 v12, v12
    v_rcp_f32 v13, v13
    v_rcp_f32 v14, v14
    v_rcp_f32 v15, v15
    v_pk_mul_f32 v[104:105], v[104:105], v[12:13]
    v_pk_mul_f32 v[106:107], v[106:107], v[14:15]
    v_cvt_pk_bf16_f32 v136, v104, v105
    v_cvt_pk_bf16_f32 v137, v106, v107
    v_pk_mul_f32 v[12:13], v[108:109], v[108:109]
    v_pk_mul_f32 v[14:15], v[110:111], v[110:111]
    v_pk_fma_f32 v[12:13], v[12:13], v[26:27], v[24:25]
    v_pk_fma_f32 v[14:15], v[14:15], v[26:27], v[24:25]
    v_pk_mul_f32 v[12:13], v[12:13], v[108:109]
    v_pk_mul_f32 v[14:15], v[14:15], v[110:111]
    v_exp_f32 v12, v12
    v_exp_f32 v13, v13
    v_exp_f32 v14, v14
    v_exp_f32 v15, v15
    v_pk_fma_f32 v[12:13], v[12:13], v[28:29], v[28:29]
    v_pk_fma_f32 v[14:15], v[14:15], v[28:29], v[28:29]
    v_rcp_f32 v12, v12
    v_rcp_f32 v13, v13
    v_rcp_f32 v14, v14
    v_rcp_f32 v15, v15
    v_pk_mul_f32 v[108:109], v[108:109], v[12:13]
    v_pk_mul_f32 v[110:111], v[110:111], v[14:15]
    v_cvt_pk_bf16_f32 v138, v108, v109
    v_cvt_pk_bf16_f32 v139, v110, v111
    v_pk_mul_f32 v[12:13], v[112:113], v[112:113]
    v_pk_mul_f32 v[14:15], v[114:115], v[114:115]
    v_pk_fma_f32 v[12:13], v[12:13], v[26:27], v[24:25]
    v_pk_fma_f32 v[14:15], v[14:15], v[26:27], v[24:25]
    v_pk_mul_f32 v[12:13], v[12:13], v[112:113]
    v_pk_mul_f32 v[14:15], v[14:15], v[114:115]
    v_exp_f32 v12, v12
    v_exp_f32 v13, v13
    v_exp_f32 v14, v14
    v_exp_f32 v15, v15
    v_pk_fma_f32 v[12:13], v[12:13], v[28:29], v[28:29]
    v_pk_fma_f32 v[14:15], v[14:15], v[28:29], v[28:29]
    v_rcp_f32 v12, v12
    v_rcp_f32 v13, v13
    v_rcp_f32 v14, v14
    v_rcp_f32 v15, v15
    v_pk_mul_f32 v[112:113], v[112:113], v[12:13]
    v_pk_mul_f32 v[114:115], v[114:115], v[14:15]
    v_cvt_pk_bf16_f32 v140, v112, v113
    v_cvt_pk_bf16_f32 v141, v114, v115
    v_pk_mul_f32 v[12:13], v[116:117], v[116:117]
    v_pk_mul_f32 v[14:15], v[118:119], v[118:119]
    v_pk_fma_f32 v[12:13], v[12:13], v[26:27], v[24:25]
    v_pk_fma_f32 v[14:15], v[14:15], v[26:27], v[24:25]
    v_pk_mul_f32 v[12:13], v[12:13], v[116:117]
    v_pk_mul_f32 v[14:15], v[14:15], v[118:119]
    v_exp_f32 v12, v12
    v_exp_f32 v13, v13
    v_exp_f32 v14, v14
    v_exp_f32 v15, v15
    v_pk_fma_f32 v[12:13], v[12:13], v[28:29], v[28:29]
    v_pk_fma_f32 v[14:15], v[14:15], v[28:29], v[28:29]
    v_rcp_f32 v12, v12
    v_rcp_f32 v13, v13
    v_rcp_f32 v14, v14
    v_rcp_f32 v15, v15
    v_pk_mul_f32 v[116:117], v[116:117], v[12:13]
    v_pk_mul_f32 v[118:119], v[118:119], v[14:15]
    v_cvt_pk_bf16_f32 v142, v116, v117
    v_cvt_pk_bf16_f32 v143, v118, v119
    s_cmp_eq_u64 s[4:5], 0
    s_cbranch_scc1 SK_67
    s_mov_b64 exec, s[4:5]
    v_mov_b32 v136, 0
    v_mov_b32 v137, 0
    v_mov_b32 v138, 0
    v_mov_b32 v139, 0
    v_mov_b32 v140, 0
    v_mov_b32 v141, 0
    v_mov_b32 v142, 0
    v_mov_b32 v143, 0
    s_mov_b64 exec, -1
SK_67:
    s_add_u32 s83, s85, 0
    s_add_u32 s84, s85, 66048
    buffer_store_dwordx4 v[136:139], v212, s[64:67], s83 offen sc1
    buffer_store_dwordx4 v[140:143], v212, s[64:67], s84 offen sc1
    s_nop 0
    v_pk_mul_f32 v[12:13], v[120:121], v[120:121]
    v_pk_mul_f32 v[14:15], v[122:123], v[122:123]
    v_pk_fma_f32 v[12:13], v[12:13], v[26:27], v[24:25]
    v_pk_fma_f32 v[14:15], v[14:15], v[26:27], v[24:25]
    v_pk_mul_f32 v[12:13], v[12:13], v[120:121]
    v_pk_mul_f32 v[14:15], v[14:15], v[122:123]
    v_exp_f32 v12, v12
    v_exp_f32 v13, v13
    v_exp_f32 v14, v14
    v_exp_f32 v15, v15
    v_pk_fma_f32 v[12:13], v[12:13], v[28:29], v[28:29]
    v_pk_fma_f32 v[14:15], v[14:15], v[28:29], v[28:29]
    v_rcp_f32 v12, v12
    v_rcp_f32 v13, v13
    v_rcp_f32 v14, v14
    v_rcp_f32 v15, v15
    v_pk_mul_f32 v[120:121], v[120:121], v[12:13]
    v_pk_mul_f32 v[122:123], v[122:123], v[14:15]
    v_cvt_pk_bf16_f32 v144, v120, v121
    v_cvt_pk_bf16_f32 v145, v122, v123
    v_pk_mul_f32 v[12:13], v[124:125], v[124:125]
    v_pk_mul_f32 v[14:15], v[126:127], v[126:127]
    v_pk_fma_f32 v[12:13], v[12:13], v[26:27], v[24:25]
    v_pk_fma_f32 v[14:15], v[14:15], v[26:27], v[24:25]
    v_pk_mul_f32 v[12:13], v[12:13], v[124:125]
    v_pk_mul_f32 v[14:15], v[14:15], v[126:127]
    v_exp_f32 v12, v12
    v_exp_f32 v13, v13
    v_exp_f32 v14, v14
    v_exp_f32 v15, v15
    v_pk_fma_f32 v[12:13], v[12:13], v[28:29], v[28:29]
    v_pk_fma_f32 v[14:15], v[14:15], v[28:29], v[28:29]
    v_rcp_f32 v12, v12
    v_rcp_f32 v13, v13
    v_rcp_f32 v14, v14
    v_rcp_f32 v15, v15
    v_pk_mul_f32 v[124:125], v[124:125], v[12:13]
    v_pk_mul_f32 v[126:127], v[126:127], v[14:15]
    v_cvt_pk_bf16_f32 v146, v124, v125
    v_cvt_pk_bf16_f32 v147, v126, v127
    v_pk_mul_f32 v[12:13], v[128:129], v[128:129]
    v_pk_mul_f32 v[14:15], v[130:131], v[130:131]
    v_pk_fma_f32 v[12:13], v[12:13], v[26:27], v[24:25]
    v_pk_fma_f32 v[14:15], v[14:15], v[26:27], v[24:25]
    v_pk_mul_f32 v[12:13], v[12:13], v[128:129]
    v_pk_mul_f32 v[14:15], v[14:15], v[130:131]
    v_exp_f32 v12, v12
    v_exp_f32 v13, v13
    v_exp_f32 v14, v14
    v_exp_f32 v15, v15
    v_pk_fma_f32 v[12:13], v[12:13], v[28:29], v[28:29]
    v_pk_fma_f32 v[14:15], v[14:15], v[28:29], v[28:29]
    v_rcp_f32 v12, v12
    v_rcp_f32 v13, v13
    v_rcp_f32 v14, v14
    v_rcp_f32 v15, v15
    v_pk_mul_f32 v[128:129], v[128:129], v[12:13]
    v_pk_mul_f32 v[130:131], v[130:131], v[14:15]
    v_cvt_pk_bf16_f32 v148, v128, v129
    v_cvt_pk_bf16_f32 v149, v130, v131
    v_pk_mul_f32 v[12:13], v[132:133], v[132:133]
    v_pk_mul_f32 v[14:15], v[134:135], v[134:135]
    v_pk_fma_f32 v[12:13], v[12:13], v[26:27], v[24:25]
    v_pk_fma_f32 v[14:15], v[14:15], v[26:27], v[24:25]
    v_pk_mul_f32 v[12:13], v[12:13], v[132:133]
    v_pk_mul_f32 v[14:15], v[14:15], v[134:135]
    v_exp_f32 v12, v12
    v_exp_f32 v13, v13
    v_exp_f32 v14, v14
    v_exp_f32 v15, v15
    v_pk_fma_f32 v[12:13], v[12:13], v[28:29], v[28:29]
    v_pk_fma_f32 v[14:15], v[14:15], v[28:29], v[28:29]
    v_rcp_f32 v12, v12
    v_rcp_f32 v13, v13
    v_rcp_f32 v14, v14
    v_rcp_f32 v15, v15
    v_pk_mul_f32 v[132:133], v[132:133], v[12:13]
    v_pk_mul_f32 v[134:135], v[134:135], v[14:15]
    v_cvt_pk_bf16_f32 v150, v132, v133
    v_cvt_pk_bf16_f32 v151, v134, v135
    s_cmp_eq_u64 s[6:7], 0
    s_cbranch_scc1 SK_68
    s_mov_b64 exec, s[6:7]
    v_mov_b32 v144, 0
    v_mov_b32 v145, 0
    v_mov_b32 v146, 0
    v_mov_b32 v147, 0
    v_mov_b32 v148, 0
    v_mov_b32 v149, 0
    v_mov_b32 v150, 0
    v_mov_b32 v151, 0
    s_mov_b64 exec, -1
SK_68:
    s_add_u32 s83, s85, 132096
    s_add_u32 s84, s85, 198144
    buffer_store_dwordx4 v[144:147], v213, s[64:67], s83 offen sc1
    buffer_store_dwordx4 v[148:151], v213, s[64:67], s84 offen sc1
    s_cmp_lg_u32 s72, 0
    s_cbranch_scc1 SK_69
    s_waitcnt vmcnt(4)
    s_mov_b32 s90, 200000
MODE_70:
    v_cmp_ne_u32 vcc, s73, v50
    s_cbranch_vccz MODEOK_71
    buffer_load_dwordx2 v[50:51], v11, s[64:67], 0 offen sc1
    s_waitcnt vmcnt(0)
    s_sub_u32 s90, s90, 1
    s_cmp_lg_u32 s90, 0
    s_cbranch_scc1 MODE_70
MODEOK_71:
    v_cmp_ne_u32 vcc, s101, v51
    s_nop 0
    s_cmp_lg_u64 vcc, 0
    s_cselect_b32 s100, 1, 0
SK_69:
    s_cmp_lg_u32 s72, 0
    s_cbranch_scc1 SK_72
    v_mov_b32 v5, 73728
    v_mov_b32 v3, s100
    ds_write_b32 v5, v3
    s_waitcnt lgkmcnt(0)
SK_72:
    s_mul_i32 s83, s79, 2048
    s_lshl_b32 s84, s80, 7
    s_add_u32 s83, s83, s84
    s_add_u32 s83, s83, 22183936
    s_sub_u32 s86, s83, 131072
    s_waitcnt vmcnt(0)
    s_barrier
    s_cmp_lg_u32 s72, 0
    s_cbranch_scc1 SK_73
    s_mov_b64 exec, 1
    s_cmp_lg_u32 s100, 0
    s_cbranch_scc1 SLOW_74
    buffer_store_dword v2, off, s[64:67], s83
    s_branch STE_75
SLOW_74:
    buffer_store_dword v2, off, s[64:67], s83 sc1
STE_75:
    s_mov_b64 exec, -1
SK_73:
    s_cmp_lg_u32 s72, 1
    s_cbranch_scc1 SK_76
    s_mov_b64 exec, 1
    buffer_store_dword v2, off, s[64:67], s86 sc1
    s_mov_b64 exec, -1
SK_76:
    s_cmp_lg_u32 s72, 0
    s_cbranch_scc1 SK_77
    s_mov_b32 s90, 200000
    s_mov_b64 exec, 0xfffff
POLL_78:
    buffer_load_dword v63, v8, s[64:67], 0 offen sc1
    s_waitcnt vmcnt(0)
    v_cmp_ne_u32 vcc, s73, v63
    s_cbranch_vccz POLLD_79
    s_sub_u32 s90, s90, 1
    s_cmp_lg_u32 s90, 0
    s_cbranch_scc1 POLL_78
POLLD_79:
    s_mov_b64 exec, -1
SK_77:
    s_cmp_eq_u32 s72, 0
    s_cbranch_scc1 SK_80
    s_cmp_lg_u32 s72, 3
    s_cbranch_scc1 SK_80
    s_cmp_eq_u32 s72, 3
    s_cselect_b32 s52, s20, s30
    s_cselect_b32 s53, s21, s31
    s_mov_b32 s54, 1966080
    s_cselect_b32 s54, 819200, s54
    s_mov_b32 s55, 0x20000
    s_cselect_b32 s84, 40, 48
    s_lshl_b32 s85, s2, 1
    s_add_u32 s85, s85, s72
    s_sub_u32 s85, s85, 1
    s_cmp_eq_u32 s72, 3
    s_cselect_b32 s85, s2, s85
    s_mul_i32 s85, s85, s84
    v_add_lshl_u32 v3, v1, s85, 7
    v_mov_b32 v4, 2147483648
    v_cmp_gt_u32 vcc, s84, v1
    s_nop 1
    v_cndmask_b32 v3, v4, v3, vcc
    buffer_load_dword v254, v3, s[52:55], 0 offen
SK_80:
    s_barrier
    s_add_u32 s83, s9, 2097152
    buffer_load_dwordx4 v[184:187], v7, s[64:67], s83 offen sc1
    s_add_u32 s83, s9, 2163200
    buffer_load_dwordx4 v[188:191], v7, s[64:67], s83 offen sc1
    s_add_u32 s83, s9, 2229248
    buffer_load_dwordx4 v[192:195], v7, s[64:67], s83 offen sc1
    s_add_u32 s83, s9, 2295296
    buffer_load_dwordx4 v[196:199], v7, s[64:67], s83 offen sc1
    s_add_u32 s83, s9, 2361344
    buffer_load_dwordx4 v[200:203], v7, s[64:67], s83 offen sc1
    s_add_u32 s83, s9, 2427392
    buffer_load_dwordx4 v[204:207], v7, s[64:67], s83 offen sc1
    s_add_u32 s83, s9, 2493440
    buffer_load_dwordx4 v[208:211], v7, s[64:67], s83 offen sc1
    s_add_u32 s83, s9, 2559488
    buffer_load_dwordx4 v[212:215], v7, s[64:67], s83 offen sc1
    s_add_u32 s83, s9, 2625536
    buffer_load_dwordx4 v[216:219], v7, s[64:67], s83 offen sc1
    s_add_u32 s83, s9, 2691584
    buffer_load_dwordx4 v[88:91], v7, s[64:67], s83 offen sc1
    s_add_u32 s83, s9, 3418112
    buffer_load_dwordx4 v[92:95], v7, s[64:67], s83 offen sc1
    s_add_u32 s83, s9, 3484160
    buffer_load_dwordx4 v[96:99], v7, s[64:67], s83 offen sc1
    v_mov_b32 v5, 73728
    ds_read_b32 v50, v5
    v_add_u32 v32, 114688, v30
    v_add_u32 v33, 114688, v31
    ds_read_b64_tr_b16 v[64:65], v32 offset:0
    ds_read_b64_tr_b16 v[66:67], v32 offset:1024
    ds_read_b64_tr_b16 v[68:69], v33 offset:0
    ds_read_b64_tr_b16 v[70:71], v33 offset:1024
    ds_read_b64_tr_b16 v[72:73], v32 offset:2048
    ds_read_b64_tr_b16 v[74:75], v32 offset:3072
    ds_read_b64_tr_b16 v[76:77], v33 offset:2048
    ds_read_b64_tr_b16 v[78:79], v33 offset:3072
    s_waitcnt vmcnt(11)
    s_waitcnt lgkmcnt(6)
    v_mfma_f32_32x32x16_bf16 v[104:119], v[64:67], v[184:187], 0
    ds_read_b64_tr_b16 v[80:81], v32 offset:4096
    ds_read_b64_tr_b16 v[82:83], v32 offset:5120
    s_waitcnt lgkmcnt(6)
    v_mfma_f32_32x32x16_bf16 v[120:135], v[68:71], v[184:187], 0
    ds_read_b64_tr_b16 v[84:85], v33 offset:4096
    ds_read_b64_tr_b16 v[86:87], v33 offset:5120
    s_add_u32 s83, s9, 3550208
    buffer_load_dwordx4 v[100:103], v7, s[64:67], s83 offen sc1
    s_add_u32 s83, s9, 3616256
    buffer_load_dwordx4 v[136:139], v7, s[64:67], s83 offen sc1
    s_waitcnt vmcnt(12)
    s_waitcnt lgkmcnt(6)
    v_mfma_f32_32x32x16_bf16 v[104:119], v[72:75], v[188:191], v[104:119]
    ds_read_b64_tr_b16 v[64:65], v32 offset:6144
    ds_read_b64_tr_b16 v[66:67], v32 offset:7168
    s_waitcnt lgkmcnt(6)
    v_mfma_f32_32x32x16_bf16 v[120:135], v[76:79], v[188:191], v[120:135]
    ds_read_b64_tr_b16 v[68:69], v33 offset:6144
    ds_read_b64_tr_b16 v[70:71], v33 offset:7168
    s_cmp_lg_u32 s72, s8
    s_cbranch_scc1 SK_81
    buffer_load_dword v11, v62, s[64:67], 0 offen sc1
SK_81:
    s_add_u32 s83, s9, 3682304
    buffer_load_dwordx4 v[140:143], v7, s[64:67], s83 offen sc1
    s_add_u32 s83, s9, 3748352
    buffer_load_dwordx4 v[144:147], v7, s[64:67], s83 offen sc1
    s_waitcnt vmcnt(13)
    s_waitcnt lgkmcnt(6)
    v_mfma_f32_32x32x16_bf16 v[104:119], v[80:83], v[192:195], v[104:119]
    ds_read_b64_tr_b16 v[72:73], v32 offset:8192
    ds_read_b64_tr_b16 v[74:75], v32 offset:9216
    s_waitcnt lgkmcnt(6)
    v_mfma_f32_32x32x16_bf16 v[120:135], v[84:87], v[192:195], v[120:135]
    ds_read_b64_tr_b16 v[76:77], v33 offset:8192
    ds_read_b64_tr_b16 v[78:79], v33 offset:9216
    s_add_u32 s83, s9, 3814400
    buffer_load_dwordx4 v[148:151], v7, s[64:67], s83 offen sc1
    s_add_u32 s83, s9, 3880448
    buffer_load_dwordx4 v[152:155], v7, s[64:67], s83 offen sc1
    s_waitcnt vmcnt(14)
    s_waitcnt lgkmcnt(6)
    v_mfma_f32_32x32x16_bf16 v[104:119], v[64:67], v[196:199], v[104:119]
    ds_read_b64_tr_b16 v[80:81], v32 offset:10240
    ds_read_b64_tr_b16 v[82:83], v32 offset:11264
    s_waitcnt lgkmcnt(6)
    v_mfma_f32_32x32x16_bf16 v[120:135], v[68:71], v[196:199], v[120:135]
    ds_read_b64_tr_b16 v[84:85], v33 offset:10240
    ds_read_b64_tr_b16 v[86:87], v33 offset:11264
    s_add_u32 s83, s9, 3946496
    buffer_load_dwordx4 v[156:159], v7, s[64:67], s83 offen sc1
    s_add_u32 s83, s9, 4012544
    buffer_load_dwordx4 v[160:163], v7, s[64:67], s83 offen sc1
    s_waitcnt vmcnt(15)
    s_waitcnt lgkmcnt(6)
    v_mfma_f32_32x32x16_bf16 v[104:119], v[72:75], v[200:203], v[104:119]
    ds_read_b64_tr_b16 v[64:65], v32 offset:12288
    ds_read_b64_tr_b16 v[66:67], v32 offset:13312
    s_waitcnt lgkmcnt(6)
    v_mfma_f32_32x32x16_bf16 v[120:135], v[76:79], v[200:203], v[120:135]
    ds_read_b64_tr_b16 v[68:69], v33 offset:12288
    ds_read_b64_tr_b16 v[70:71], v33 offset:13312
    s_cmp_lg_u32 s72, s8
    s_cbranch_scc1 SK_82
    s_waitcnt vmcnt(6)
    v_cmp_ne_u32 vcc, s73, v11
    s_cbranch_vccz RFOK_83
    s_mov_b32 s90, 200000
    s_mov_b64 exec, 0x3ff
POLL_84:
    buffer_load_dword v63, v62, s[64:67], 0 offen sc1
    s_waitcnt vmcnt(0)
    v_cmp_ne_u32 vcc, s73, v63
    s_cbranch_vccz POLLD_85
    s_sub_u32 s90, s90, 1
    s_cmp_lg_u32 s90, 0
    s_cbranch_scc1 POLL_84
POLLD_85:
    s_mov_b64 exec, -1
RFOK_83:
SK_82:
    s_add_u32 s83, s10, 2757632
    buffer_load_dwordx4 v[164:167], v7, s[64:67], s83 offen sc1
    s_add_u32 s83, s10, 2823680
    buffer_load_dwordx4 v[168:171], v7, s[64:67], s83 offen sc1
    s_waitcnt vmcnt(16)
    s_waitcnt lgkmcnt(6)
    v_mfma_f32_32x32x16_bf16 v[104:119], v[80:83], v[204:207], v[104:119]
    ds_read_b64_tr_b16 v[72:73], v32 offset:14336
    ds_read_b64_tr_b16 v[74:75], v32 offset:15360
    s_waitcnt lgkmcnt(6)
    v_mfma_f32_32x32x16_bf16 v[120:135], v[84:87], v[204:207], v[120:135]
    ds_read_b64_tr_b16 v[76:77], v33 offset:14336
    ds_read_b64_tr_b16 v[78:79], v33 offset:15360
    s_add_u32 s83, s10, 2889728
    buffer_load_dwordx4 v[172:175], v7, s[64:67], s83 offen sc1
    s_add_u32 s83, s10, 2955776
    buffer_load_dwordx4 v[176:179], v7, s[64:67], s83 offen sc1
    v_add_u32 v32, 131072, v30
    v_add_u32 v33, 131072, v31
    s_waitcnt vmcnt(17)
    s_waitcnt lgkmcnt(6)
    v_mfma_f32_32x32x16_bf16 v[104:119], v[64:67], v[208:211], v[104:119]
    ds_read_b64_tr_b16 v[80:81], v32 offset:0
    ds_read_b64_tr_b16 v[82:83], v32 offset:1024
    s_waitcnt lgkmcnt(6)
    v_mfma_f32_32x32x16_bf16 v[120:135], v[68:71], v[208:211], v[120:135]
    ds_read_b64_tr_b16 v[84:85], v33 offset:0
    ds_read_b64_tr_b16 v[86:87], v33 offset:1024
    s_add_u32 s83, s10, 3021824
    buffer_load_dwordx4 v[184:187], v7, s[64:67], s83 offen sc1
    s_add_u32 s83, s10, 3087872
    buffer_load_dwordx4 v[188:191], v7, s[64:67], s83 offen sc1
    s_waitcnt vmcnt(18)
    s_waitcnt lgkmcnt(6)
    v_mfma_f32_32x32x16_bf16 v[104:119], v[72:75], v[212:215], v[104:119]
    ds_read_b64_tr_b16 v[64:65], v32 offset:2048
    ds_read_b64_tr_b16 v[66:67], v32 offset:3072
    s_waitcnt lgkmcnt(6)
    v_mfma_f32_32x32x16_bf16 v[120:135], v[76:79], v[212:215], v[120:135]
    ds_read_b64_tr_b16 v[68:69], v33 offset:2048
    ds_read_b64_tr_b16 v[70:71], v33 offset:3072
    s_add_u32 s83, s10, 3153920
    buffer_load_dwordx4 v[192:195], v7, s[64:67], s83 offen sc1
    s_add_u32 s83, s10, 3219968
    buffer_load_dwordx4 v[196:199], v7, s[64:67], s83 offen sc1
    s_waitcnt vmcnt(19)
    s_waitcnt lgkmcnt(6)
    v_mfma_f32_32x32x16_bf16 v[104:119], v[80:83], v[216:219], v[104:119]
    ds_read_b64_tr_b16 v[72:73], v32 offset:4096
    ds_read_b64_tr_b16 v[74:75], v32 offset:5120
    s_waitcnt lgkmcnt(6)
    v_mfma_f32_32x32x16_bf16 v[120:135], v[84:87], v[216:219], v[120:135]
    ds_read_b64_tr_b16 v[76:77], v33 offset:4096
    ds_read_b64_tr_b16 v[78:79], v33 offset:5120
    s_add_u32 s83, s10, 3286016
    buffer_load_dwordx4 v[200:203], v7, s[64:67], s83 offen sc1
    s_add_u32 s83, s10, 3352064
    buffer_load_dwordx4 v[204:207], v7, s[64:67], s83 offen sc1
    s_waitcnt vmcnt(20)
    s_waitcnt lgkmcnt(6)
    v_mfma_f32_32x32x16_bf16 v[104:119], v[64:67], v[88:91], v[104:119]
    ds_read_b64_tr_b16 v[80:81], v32 offset:6144
    ds_read_b64_tr_b16 v[82:83], v32 offset:7168
    s_waitcnt lgkmcnt(6)
    v_mfma_f32_32x32x16_bf16 v[120:135], v[68:71], v[88:91], v[120:135]
    ds_read_b64_tr_b16 v[84:85], v33 offset:6144
    ds_read_b64_tr_b16 v[86:87], v33 offset:7168
    s_add_u32 s83, s10, 4078592
    buffer_load_dwordx4 v[208:211], v7, s[64:67], s83 offen sc1
    s_add_u32 s83, s10, 4144640
    buffer_load_dwordx4 v[212:215], v7, s[64:67], s83 offen sc1
    s_waitcnt vmcnt(21)
    s_waitcnt lgkmcnt(6)
    v_mfma_f32_32x32x16_bf16 v[104:119], v[72:75], v[92:95], v[104:119]
    ds_read_b64_tr_b16 v[64:65], v32 offset:8192
    ds_read_b64_tr_b16 v[66:67], v32 offset:9216
    s_waitcnt lgkmcnt(6)
    v_mfma_f32_32x32x16_bf16 v[120:135], v[76:79], v[92:95], v[120:135]
    ds_read_b64_tr_b16 v[68:69], v33 offset:8192
    ds_read_b64_tr_b16 v[70:71], v33 offset:9216
    s_add_u32 s83, s10, 4210688
    buffer_load_dwordx4 v[216:219], v7, s[64:67], s83 offen sc1
    s_add_u32 s83, s10, 4276736
    buffer_load_dwordx4 v[88:91], v7, s[64:67], s83 offen sc1
    s_waitcnt vmcnt(22)
    s_waitcnt lgkmcnt(6)
    v_mfma_f32_32x32x16_bf16 v[104:119], v[80:83], v[96:99], v[104:119]
    ds_read_b64_tr_b16 v[72:73], v32 offset:10240
    ds_read_b64_tr_b16 v[74:75], v32 offset:11264
    s_waitcnt lgkmcnt(6)
    v_mfma_f32_32x32x16_bf16 v[120:135], v[84:87], v[96:99], v[120:135]
    ds_read_b64_tr_b16 v[76:77], v33 offset:10240
    ds_read_b64_tr_b16 v[78:79], v33 offset:11264
    s_add_u32 s83, s10, 4342784
    buffer_load_dwordx4 v[92:95], v7, s[64:67], s83 offen sc1
    s_add_u32 s83, s10, 4408832
    buffer_load_dwordx4 v[96:99], v7, s[64:67], s83 offen sc1
    s_waitcnt vmcnt(23)
    s_waitcnt lgkmcnt(6)
    v_mfma_f32_32x32x16_bf16 v[104:119], v[64:67], v[100:103], v[104:119]
    ds_read_b64_tr_b16 v[80:81], v32 offset:12288
    ds_read_b64_tr_b16 v[82:83], v32 offset:13312
    s_waitcnt lgkmcnt(6)
    v_mfma_f32_32x32x16_bf16 v[120:135], v[68:71], v[100:103], v[120:135]
    ds_read_b64_tr_b16 v[84:85], v33 offset:12288
    ds_read_b64_tr_b16 v[86:87], v33 offset:13312
    s_add_u32 s83, s10, 4474880
    buffer_load_dwordx4 v[100:103], v7, s[64:67], s83 offen sc1
    s_waitcnt vmcnt(23)
    s_waitcnt lgkmcnt(6)
    v_mfma_f32_32x32x16_bf16 v[104:119], v[72:75], v[136:139], v[104:119]
    ds_read_b64_tr_b16 v[64:65], v32 offset:14336
    ds_read_b64_tr_b16 v[66:67], v32 offset:15360
    s_waitcnt lgkmcnt(6)
    v_mfma_f32_32x32x16_bf16 v[120:135], v[76:79], v[136:139], v[120:135]
    ds_read_b64_tr_b16 v[68:69], v33 offset:14336
    ds_read_b64_tr_b16 v[70:71], v33 offset:15360
    s_add_u32 s83, s10, 4540928
    buffer_load_dwordx4 v[136:139], v7, s[64:67], s83 offen sc1
    v_add_u32 v32, 147456, v30
    v_add_u32 v33, 147456, v31
    s_waitcnt vmcnt(23)
    s_waitcnt lgkmcnt(6)
    v_mfma_f32_32x32x16_bf16 v[104:119], v[80:83], v[140:143], v[104:119]
    ds_read_b64_tr_b16 v[72:73], v32 offset:0
    ds_read_b64_tr_b16 v[74:75], v32 offset:1024
    s_waitcnt lgkmcnt(6)
    v_mfma_f32_32x32x16_bf16 v[120:135], v[84:87], v[140:143], v[120:135]
    ds_read_b64_tr_b16 v[76:77], v33 offset:0
    ds_read_b64_tr_b16 v[78:79], v33 offset:1024
    s_add_u32 s83, s10, 4606976
    buffer_load_dwordx4 v[140:143], v7, s[64:67], s83 offen sc1
    s_waitcnt vmcnt(23)
    s_waitcnt lgkmcnt(6)
    v_mfma_f32_32x32x16_bf16 v[104:119], v[64:67], v[144:147], v[104:119]
    ds_read_b64_tr_b16 v[80:81], v32 offset:2048
    ds_read_b64_tr_b16 v[82:83], v32 offset:3072
    s_waitcnt lgkmcnt(6)
    v_mfma_f32_32x32x16_bf16 v[120:135], v[68:71], v[144:147], v[120:135]
    ds_read_b64_tr_b16 v[84:85], v33 offset:2048
    ds_read_b64_tr_b16 v[86:87], v33 offset:3072
    s_add_u32 s83, s10, 4673024
    buffer_load_dwordx4 v[144:147], v7, s[64:67], s83 offen sc1
    s_waitcnt vmcnt(23)
    s_waitcnt lgkmcnt(6)
    v_mfma_f32_32x32x16_bf16 v[104:119], v[72:75], v[148:151], v[104:119]
    ds_read_b64_tr_b16 v[64:65], v32 offset:4096
    ds_read_b64_tr_b16 v[66:67], v32 offset:5120
    s_waitcnt lgkmcnt(6)
    v_mfma_f32_32x32x16_bf16 v[120:135], v[76:79], v[148:151], v[120:135]
    ds_read_b64_tr_b16 v[68:69], v33 offset:4096
    ds_read_b64_tr_b16 v[70:71], v33 offset:5120
    s_barrier
    s_cmp_eq_u32 s72, 0
    s_cbranch_scc1 SK_86
    s_cmp_eq_u32 s72, 3
    s_cbranch_scc1 SK_86
    s_cmp_eq_u32 s72, 3
    s_cselect_b32 s52, s20, s30
    s_cselect_b32 s53, s21, s31
    s_mov_b32 s54, 1966080
    s_cselect_b32 s54, 819200, s54
    s_mov_b32 s55, 0x20000
    s_cselect_b32 s84, 40, 48
    s_lshl_b32 s85, s2, 1
    s_add_u32 s85, s85, s72
    s_sub_u32 s85, s85, 1
    s_cmp_eq_u32 s72, 3
    s_cselect_b32 s85, s2, s85
    s_mul_i32 s85, s85, s84
    v_add_lshl_u32 v3, v1, s85, 7
    v_mov_b32 v4, 2147483648
    v_cmp_gt_u32 vcc, s84, v1
    s_nop 1
    v_cndmask_b32 v3, v4, v3, vcc
    buffer_load_dword v254, v3, s[52:55], 0 offen
SK_86:
    s_waitcnt vmcnt(22)
    s_waitcnt lgkmcnt(6)
    v_mfma_f32_32x32x16_bf16 v[104:119], v[80:83], v[152:155], v[104:119]
    ds_read_b64_tr_b16 v[72:73], v32 offset:6144
    ds_read_b64_tr_b16 v[74:75], v32 offset:7168
    s_waitcnt lgkmcnt(6)
    v_mfma_f32_32x32x16_bf16 v[120:135], v[84:87], v[152:155], v[120:135]
    ds_read_b64_tr_b16 v[76:77], v33 offset:6144
    ds_read_b64_tr_b16 v[78:79], v33 offset:7168
    s_waitcnt vmcnt(21)
    s_waitcnt lgkmcnt(6)
    v_mfma_f32_32x32x16_bf16 v[104:119], v[64:67], v[156:159], v[104:119]
    ds_read_b64_tr_b16 v[80:81], v32 offset:8192
    ds_read_b64_tr_b16 v[82:83], v32 offset:9216
    s_waitcnt lgkmcnt(6)
    v_mfma_f32_32x32x16_bf16 v[120:135], v[68:71], v[156:159], v[120:135]
    ds_read_b64_tr_b16 v[84:85], v33 offset:8192
    ds_read_b64_tr_b16 v[86:87], v33 offset:9216
    s_waitcnt vmcnt(20)
    s_waitcnt lgkmcnt(6)
    v_mfma_f32_32x32x16_bf16 v[104:119], v[72:75], v[160:163], v[104:119]
    ds_read_b64_tr_b16 v[64:65], v32 offset:10240
    ds_read_b64_tr_b16 v[66:67], v32 offset:11264
    s_waitcnt lgkmcnt(6)
    v_mfma_f32_32x32x16_bf16 v[120:135], v[76:79], v[160:163], v[120:135]
    ds_read_b64_tr_b16 v[68:69], v33 offset:10240
    ds_read_b64_tr_b16 v[70:71], v33 offset:11264
    s_waitcnt vmcnt(19)
    s_waitcnt lgkmcnt(6)
    v_mfma_f32_32x32x16_bf16 v[104:119], v[80:83], v[164:167], v[104:119]
    ds_read_b64_tr_b16 v[72:73], v32 offset:12288
    ds_read_b64_tr_b16 v[74:75], v32 offset:13312
    s_waitcnt lgkmcnt(6)
    v_mfma_f32_32x32x16_bf16 v[120:135], v[84:87], v[164:167], v[120:135]
    ds_read_b64_tr_b16 v[76:77], v33 offset:12288
    ds_read_b64_tr_b16 v[78:79], v33 offset:13312
    s_waitcnt vmcnt(18)
    s_waitcnt lgkmcnt(6)
    v_mfma_f32_32x32x16_bf16 v[104:119], v[64:67], v[168:171], v[104:119]
    ds_read_b64_tr_b16 v[80:81], v32 offset:14336
    ds_read_b64_tr_b16 v[82:83], v32 offset:15360
    s_waitcnt lgkmcnt(6)
    v_mfma_f32_32x32x16_bf16 v[120:135], v[68:71], v[168:171], v[120:135]
    ds_read_b64_tr_b16 v[84:85], v33 offset:14336
    ds_read_b64_tr_b16 v[86:87], v33 offset:15360
    v_add_u32 v32, 81920, v30
    v_add_u32 v33, 81920, v31
    s_waitcnt vmcnt(17)
    s_waitcnt lgkmcnt(6)
    v_mfma_f32_32x32x16_bf16 v[104:119], v[72:75], v[172:175], v[104:119]
    ds_read_b64_tr_b16 v[64:65], v32 offset:0
    ds_read_b64_tr_b16 v[66:67], v32 offset:1024
    s_waitcnt lgkmcnt(6)
    v_mfma_f32_32x32x16_bf16 v[120:135], v[76:79], v[172:175], v[120:135]
    ds_read_b64_tr_b16 v[68:69], v33 offset:0
    ds_read_b64_tr_b16 v[70:71], v33 offset:1024
    s_waitcnt vmcnt(16)
    s_waitcnt lgkmcnt(6)
    v_mfma_f32_32x32x16_bf16 v[104:119], v[80:83], v[176:179], v[104:119]
    ds_read_b64_tr_b16 v[72:73], v32 offset:2048
    ds_read_b64_tr_b16 v[74:75], v32 offset:3072
    s_waitcnt lgkmcnt(6)
    v_mfma_f32_32x32x16_bf16 v[120:135], v[84:87], v[176:179], v[120:135]
    ds_read_b64_tr_b16 v[76:77], v33 offset:2048
    ds_read_b64_tr_b16 v[78:79], v33 offset:3072
    s_waitcnt vmcnt(15)
    s_waitcnt lgkmcnt(6)
    v_mfma_f32_32x32x16_bf16 v[104:119], v[64:67], v[184:187], v[104:119]
    ds_read_b64_tr_b16 v[80:81], v32 offset:4096
    ds_read_b64_tr_b16 v[82:83], v32 offset:5120
    s_waitcnt lgkmcnt(6)
    v_mfma_f32_32x32x16_bf16 v[120:135], v[68:71], v[184:187], v[120:135]
    ds_read_b64_tr_b16 v[84:85], v33 offset:4096
    ds_read_b64_tr_b16 v[86:87], v33 offset:5120
    s_waitcnt vmcnt(14)
    s_waitcnt lgkmcnt(6)
    v_mfma_f32_32x32x16_bf16 v[104:119], v[72:75], v[188:191], v[104:119]
    ds_read_b64_tr_b16 v[64:65], v32 offset:6144
    ds_read_b64_tr_b16 v[66:67], v32 offset:7168
    s_waitcnt lgkmcnt(6)
    v_mfma_f32_32x32x16_bf16 v[120:135], v[76:79], v[188:191], v[120:135]
    ds_read_b64_tr_b16 v[68:69], v33 offset:6144
    ds_read_b64_tr_b16 v[70:71], v33 offset:7168
    s_waitcnt vmcnt(13)
    s_waitcnt lgkmcnt(6)
    v_mfma_f32_32x32x16_bf16 v[104:119], v[80:83], v[192:195], v[104:119]
    ds_read_b64_tr_b16 v[72:73], v32 offset:8192
    ds_read_b64_tr_b16 v[74:75], v32 offset:9216
    s_waitcnt lgkmcnt(6)
    v_mfma_f32_32x32x16_bf16 v[120:135], v[84:87], v[192:195], v[120:135]
    ds_read_b64_tr_b16 v[76:77], v33 offset:8192
    ds_read_b64_tr_b16 v[78:79], v33 offset:9216
    s_waitcnt vmcnt(12)
    s_waitcnt lgkmcnt(6)
    v_mfma_f32_32x32x16_bf16 v[104:119], v[64:67], v[196:199], v[104:119]
    ds_read_b64_tr_b16 v[80:81], v32 offset:10240
    ds_read_b64_tr_b16 v[82:83], v32 offset:11264
    s_waitcnt lgkmcnt(6)
    v_mfma_f32_32x32x16_bf16 v[120:135], v[68:71], v[196:199], v[120:135]
    ds_read_b64_tr_b16 v[84:85], v33 offset:10240
    ds_read_b64_tr_b16 v[86:87], v33 offset:11264
    s_waitcnt vmcnt(11)
    s_waitcnt lgkmcnt(6)
    v_mfma_f32_32x32x16_bf16 v[104:119], v[72:75], v[200:203], v[104:119]
    ds_read_b64_tr_b16 v[64:65], v32 offset:12288
    ds_read_b64_tr_b16 v[66:67], v32 offset:13312
    s_waitcnt lgkmcnt(6)
    v_mfma_f32_32x32x16_bf16 v[120:135], v[76:79], v[200:203], v[120:135]
    ds_read_b64_tr_b16 v[68:69], v33 offset:12288
    ds_read_b64_tr_b16 v[70:71], v33 offset:13312
    s_waitcnt vmcnt(10)
    s_waitcnt lgkmcnt(6)
    v_mfma_f32_32x32x16_bf16 v[104:119], v[80:83], v[204:207], v[104:119]
    ds_read_b64_tr_b16 v[72:73], v32 offset:14336
    ds_read_b64_tr_b16 v[74:75], v32 offset:15360
    s_waitcnt lgkmcnt(6)
    v_mfma_f32_32x32x16_bf16 v[120:135], v[84:87], v[204:207], v[120:135]
    ds_read_b64_tr_b16 v[76:77], v33 offset:14336
    ds_read_b64_tr_b16 v[78:79], v33 offset:15360
    v_add_u32 v32, 98304, v30
    v_add_u32 v33, 98304, v31
    s_waitcnt vmcnt(9)
    s_waitcnt lgkmcnt(6)
    v_mfma_f32_32x32x16_bf16 v[104:119], v[64:67], v[208:211], v[104:119]
    ds_read_b64_tr_b16 v[80:81], v32 offset:0
    ds_read_b64_tr_b16 v[82:83], v32 offset:1024
    s_waitcnt lgkmcnt(6)
    v_mfma_f32_32x32x16_bf16 v[120:135], v[68:71], v[208:211], v[120:135]
    ds_read_b64_tr_b16 v[84:85], v33 offset:0
    ds_read_b64_tr_b16 v[86:87], v33 offset:1024
    s_waitcnt vmcnt(8)
    s_waitcnt lgkmcnt(6)
    v_mfma_f32_32x32x16_bf16 v[104:119], v[72:75], v[212:215], v[104:119]
    ds_read_b64_tr_b16 v[64:65], v32 offset:2048
    ds_read_b64_tr_b16 v[66:67], v32 offset:3072
    s_waitcnt lgkmcnt(6)
    v_mfma_f32_32x32x16_bf16 v[120:135], v[76:79], v[212:215], v[120:135]
    ds_read_b64_tr_b16 v[68:69], v33 offset:2048
    ds_read_b64_tr_b16 v[70:71], v33 offset:3072
    s_waitcnt vmcnt(7)
    s_waitcnt lgkmcnt(6)
    v_mfma_f32_32x32x16_bf16 v[104:119], v[80:83], v[216:219], v[104:119]
    ds_read_b64_tr_b16 v[72:73], v32 offset:4096
    ds_read_b64_tr_b16 v[74:75], v32 offset:5120
    s_waitcnt lgkmcnt(6)
    v_mfma_f32_32x32x16_bf16 v[120:135], v[84:87], v[216:219], v[120:135]
    ds_read_b64_tr_b16 v[76:77], v33 offset:4096
    ds_read_b64_tr_b16 v[78:79], v33 offset:5120
    s_waitcnt vmcnt(6)
    s_waitcnt lgkmcnt(6)
    v_mfma_f32_32x32x16_bf16 v[104:119], v[64:67], v[88:91], v[104:119]
    ds_read_b64_tr_b16 v[80:81], v32 offset:6144
    ds_read_b64_tr_b16 v[82:83], v32 offset:7168
    s_waitcnt lgkmcnt(6)
    v_mfma_f32_32x32x16_bf16 v[120:135], v[68:71], v[88:91], v[120:135]
    ds_read_b64_tr_b16 v[84:85], v33 offset:6144
    ds_read_b64_tr_b16 v[86:87], v33 offset:7168
    s_waitcnt vmcnt(5)
    s_waitcnt lgkmcnt(6)
    v_mfma_f32_32x32x16_bf16 v[104:119], v[72:75], v[92:95], v[104:119]
    ds_read_b64_tr_b16 v[64:65], v32 offset:8192
    ds_read_b64_tr_b16 v[66:67], v32 offset:9216
    s_waitcnt lgkmcnt(6)
    v_mfma_f32_32x32x16_bf16 v[120:135], v[76:79], v[92:95], v[120:135]
    ds_read_b64_tr_b16 v[68:69], v33 offset:8192
    ds_read_b64_tr_b16 v[70:71], v33 offset:9216
    s_waitcnt vmcnt(4)
    s_waitcnt lgkmcnt(6)
    v_mfma_f32_32x32x16_bf16 v[104:119], v[80:83], v[96:99], v[104:119]
    ds_read_b64_tr_b16 v[72:73], v32 offset:10240
    ds_read_b64_tr_b16 v[74:75], v32 offset:11264
    s_waitcnt lgkmcnt(6)
    v_mfma_f32_32x32x16_bf16 v[120:135], v[84:87], v[96:99], v[120:135]
    ds_read_b64_tr_b16 v[76:77], v33 offset:10240
    ds_read_b64_tr_b16 v[78:79], v33 offset:11264
    s_waitcnt vmcnt(3)
    s_waitcnt lgkmcnt(6)
    v_mfma_f32_32x32x16_bf16 v[104:119], v[64:67], v[100:103], v[104:119]
    ds_read_b64_tr_b16 v[80:81], v32 offset:12288
    ds_read_b64_tr_b16 v[82:83], v32 offset:13312
    s_waitcnt lgkmcnt(6)
    v_mfma_f32_32x32x16_bf16 v[120:135], v[68:71], v[100:103], v[120:135]
    ds_read_b64_tr_b16 v[84:85], v33 offset:12288
    ds_read_b64_tr_b16 v[86:87], v33 offset:13312
    s_waitcnt vmcnt(2)
    s_waitcnt lgkmcnt(6)
    v_mfma_f32_32x32x16_bf16 v[104:119], v[72:75], v[136:139], v[104:119]
    ds_read_b64_tr_b16 v[64:65], v32 offset:14336
    ds_read_b64_tr_b16 v[66:67], v32 offset:15360
    s_waitcnt lgkmcnt(6)
    v_mfma_f32_32x32x16_bf16 v[120:135], v[76:79], v[136:139], v[120:135]
    ds_read_b64_tr_b16 v[68:69], v33 offset:14336
    ds_read_b64_tr_b16 v[70:71], v33 offset:15360
E2B:
    s_waitcnt vmcnt(1)
    s_waitcnt lgkmcnt(6)
    v_mfma_f32_32x32x16_bf16 v[104:119], v[80:83], v[140:143], v[104:119]
    s_waitcnt lgkmcnt(4)
    v_mfma_f32_32x32x16_bf16 v[120:135], v[84:87], v[140:143], v[120:135]
    s_waitcnt vmcnt(0)
    s_waitcnt lgkmcnt(2)
    v_mfma_f32_32x32x16_bf16 v[104:119], v[64:67], v[144:147], v[104:119]
    s_waitcnt lgkmcnt(0)
    v_mfma_f32_32x32x16_bf16 v[120:135], v[68:71], v[144:147], v[120:135]
    v_readfirstlane_b32 s100, v50
    v_mov_b32 v24, v49
    v_mov_b32 v25, v49
    v_mul_f32 v26, v48, v49
    v_sub_f32 v26, 0, v26
    v_mov_b32 v27, v26
    v_lshlrev_b32 v136, 16, v220
    v_and_b32 v137, 0xffff0000, v220
    v_pk_fma_f32 v[136:137], v[136:137], v[24:25], v[26:27]
    v_lshlrev_b32_e64 v138, 16, v221
    v_and_b32 v139, 0xffff0000, v221
    v_pk_fma_f32 v[138:139], v[138:139], v[24:25], v[26:27]
    v_lshlrev_b32_e64 v140, 16, v222
    v_and_b32 v141, 0xffff0000, v222
    v_pk_fma_f32 v[140:141], v[140:141], v[24:25], v[26:27]
    v_lshlrev_b32_e64 v142, 16, v223
    v_and_b32 v143, 0xffff0000, v223
    v_pk_fma_f32 v[142:143], v[142:143], v[24:25], v[26:27]
    v_lshlrev_b32_e64 v144, 16, v224
    v_and_b32 v145, 0xffff0000, v224
    v_pk_fma_f32 v[144:145], v[144:145], v[24:25], v[26:27]
    v_lshlrev_b32_e64 v146, 16, v225
    v_and_b32 v147, 0xffff0000, v225
    v_pk_fma_f32 v[146:147], v[146:147], v[24:25], v[26:27]
    v_lshlrev_b32_e64 v148, 16, v226
    v_and_b32 v149, 0xffff0000, v226
    v_pk_fma_f32 v[148:149], v[148:149], v[24:25], v[26:27]
    v_lshlrev_b32_e64 v150, 16, v227
    v_and_b32 v151, 0xffff0000, v227
    v_pk_fma_f32 v[150:151], v[150:151], v[24:25], v[26:27]
    v_lshlrev_b32_e64 v152, 16, v228
    v_and_b32 v153, 0xffff0000, v228
    v_pk_fma_f32 v[152:153], v[152:153], v[24:25], v[26:27]
    v_lshlrev_b32_e64 v154, 16, v229
    v_and_b32 v155, 0xffff0000, v229
    v_pk_fma_f32 v[154:155], v[154:155], v[24:25], v[26:27]
    v_lshlrev_b32_e64 v156, 16, v230
    v_and_b32 v157, 0xffff0000, v230
    v_pk_fma_f32 v[156:157], v[156:157], v[24:25], v[26:27]
    v_lshlrev_b32_e64 v158, 16, v231
    v_and_b32 v159, 0xffff0000, v231
    v_pk_fma_f32 v[158:159], v[158:159], v[24:25], v[26:27]
    v_lshlrev_b32_e64 v160, 16, v232
    v_and_b32 v161, 0xffff0000, v232
    v_pk_fma_f32 v[160:161], v[160:161], v[24:25], v[26:27]
    v_lshlrev_b32_e64 v162, 16, v233
    v_and_b32 v163, 0xffff0000, v233
    v_pk_fma_f32 v[162:163], v[162:163], v[24:25], v[26:27]
    v_lshlrev_b32_e64 v164, 16, v234
    v_and_b32 v165, 0xffff0000, v234
    v_pk_fma_f32 v[164:165], v[164:165], v[24:25], v[26:27]
    v_lshlrev_b32_e64 v166, 16, v235
    v_and_b32 v167, 0xffff0000, v235
    v_pk_fma_f32 v[166:167], v[166:167], v[24:25], v[26:27]
    s_mul_i32 s85, s80, 264192
    s_add_u32 s85, s85, 7471104
    v_pk_add_f32 v[136:137], v[136:137], v[104:105]
    v_pk_add_f32 v[138:139], v[138:139], v[106:107]
    v_pk_add_f32 v[140:141], v[140:141], v[108:109]
    v_pk_add_f32 v[142:143], v[142:143], v[110:111]
    v_pk_add_f32 v[144:145], v[144:145], v[112:113]
    v_pk_add_f32 v[146:147], v[146:147], v[114:115]
    v_pk_add_f32 v[148:149], v[148:149], v[116:117]
    v_pk_add_f32 v[150:151], v[150:151], v[118:119]
    v_cvt_pk_bf16_f32 v236, v136, v137
    v_cvt_pk_bf16_f32 v237, v138, v139
    v_cvt_pk_bf16_f32 v238, v140, v141
    v_cvt_pk_bf16_f32 v239, v142, v143
    v_cvt_pk_bf16_f32 v240, v144, v145
    v_cvt_pk_bf16_f32 v241, v146, v147
    v_cvt_pk_bf16_f32 v242, v148, v149
    v_cvt_pk_bf16_f32 v243, v150, v151
    s_add_u32 s83, s85, 0
    s_add_u32 s84, s85, 66048
    buffer_store_dwordx4 v[236:239], v7, s[64:67], s83 offen sc1
    buffer_store_dwordx4 v[240:243], v7, s[64:67], s84 offen sc1
    s_nop 0
    v_pk_add_f32 v[152:153], v[152:153], v[120:121]
    v_pk_add_f32 v[154:155], v[154:155], v[122:123]
    v_pk_add_f32 v[156:157], v[156:157], v[124:125]
    v_pk_add_f32 v[158:159], v[158:159], v[126:127]
    v_pk_add_f32 v[160:161], v[160:161], v[128:129]
    v_pk_add_f32 v[162:163], v[162:163], v[130:131]
    v_pk_add_f32 v[164:165], v[164:165], v[132:133]
    v_pk_add_f32 v[166:167], v[166:167], v[134:135]
    v_cvt_pk_bf16_f32 v244, v152, v153
    v_cvt_pk_bf16_f32 v245, v154, v155
    v_cvt_pk_bf16_f32 v246, v156, v157
    v_cvt_pk_bf16_f32 v247, v158, v159
    v_cvt_pk_bf16_f32 v248, v160, v161
    v_cvt_pk_bf16_f32 v249, v162, v163
    v_cvt_pk_bf16_f32 v250, v164, v165
    v_cvt_pk_bf16_f32 v251, v166, v167
    s_add_u32 s83, s85, 132096
    s_add_u32 s84, s85, 198144
    buffer_store_dwordx4 v[244:247], v7, s[64:67], s83 offen sc1
    buffer_store_dwordx4 v[248:251], v7, s[64:67], s84 offen sc1
    v_pk_add_f32 v[12:13], v[136:137], v[138:139]
    v_pk_mul_f32 v[14:15], v[136:137], v[136:137]
    v_pk_fma_f32 v[14:15], v[138:139], v[138:139], v[14:15]
    v_pk_add_f32 v[12:13], v[12:13], v[140:141]
    v_pk_fma_f32 v[14:15], v[140:141], v[140:141], v[14:15]
    v_pk_add_f32 v[12:13], v[12:13], v[142:143]
    v_pk_fma_f32 v[14:15], v[142:143], v[142:143], v[14:15]
    v_pk_add_f32 v[12:13], v[12:13], v[144:145]
    v_pk_fma_f32 v[14:15], v[144:145], v[144:145], v[14:15]
    v_pk_add_f32 v[12:13], v[12:13], v[146:147]
    v_pk_fma_f32 v[14:15], v[146:147], v[146:147], v[14:15]
    v_pk_add_f32 v[12:13], v[12:13], v[148:149]
    v_pk_fma_f32 v[14:15], v[148:149], v[148:149], v[14:15]
    v_pk_add_f32 v[12:13], v[12:13], v[150:151]
    v_pk_fma_f32 v[14:15], v[150:151], v[150:151], v[14:15]
    v_pk_add_f32 v[12:13], v[12:13], v[152:153]
    v_pk_fma_f32 v[14:15], v[152:153], v[152:153], v[14:15]
    v_pk_add_f32 v[12:13], v[12:13], v[154:155]
    v_pk_fma_f32 v[14:15], v[154:155], v[154:155], v[14:15]
    v_pk_add_f32 v[12:13], v[12:13], v[156:157]
    v_pk_fma_f32 v[14:15], v[156:157], v[156:157], v[14:15]
    v_pk_add_f32 v[12:13], v[12:13], v[158:159]
    v_pk_fma_f32 v[14:15], v[158:159], v[158:159], v[14:15]
    v_pk_add_f32 v[12:13], v[12:13], v[160:161]
    v_pk_fma_f32 v[14:15], v[160:161], v[160:161], v[14:15]
    v_pk_add_f32 v[12:13], v[12:13], v[162:163]
    v_pk_fma_f32 v[14:15], v[162:163], v[162:163], v[14:15]
    v_pk_add_f32 v[12:13], v[12:13], v[164:165]
    v_pk_fma_f32 v[14:15], v[164:165], v[164:165], v[14:15]
    v_pk_add_f32 v[12:13], v[12:13], v[166:167]
    v_pk_fma_f32 v[14:15], v[166:167], v[166:167], v[14:15]
    v_add_f32 v12, v12, v13
    v_add_f32 v13, v14, v15
    v_mov_b32 v14, v12
    v_mov_b32 v15, v13
    s_nop 0
    v_permlane32_swap_b32 v12, v14
    v_permlane32_swap_b32 v13, v15
    v_pk_add_f32 v[12:13], v[12:13], v[14:15]
    v_lshlrev_b32 v3, 3, v6
    s_lshl_b32 s83, s80, 14
    s_add_u32 s83, s83, 196608
    s_mov_b32 exec_hi, 0
    buffer_store_dwordx2 v[12:13], v3, s[64:67], s83 offen sc1
    s_mov_b64 exec, -1
    s_mul_i32 s83, s79, 2048
    s_add_u32 s83, s83, 22085632
    v_lshl_add_u32 v8, v1, 7, s83
    s_mul_i32 s96, s80, 264192
    s_add_u32 s96, s96, 7669248
    v_add_u32 v32, 0, v30
    v_add_u32_e64 v33, 0, v31
    v_add_u32 v34, 16384, v30
    v_add_u32 v35, 16384, v31
    ds_read_b64_tr_b16 v[64:65], v32 offset:0
    ds_read_b64_tr_b16 v[66:67], v32 offset:1024
    ds_read_b64_tr_b16 v[68:69], v33 offset:0
    ds_read_b64_tr_b16 v[70:71], v33 offset:1024
    ds_read_b64_tr_b16 v[72:73], v34 offset:0
    ds_read_b64_tr_b16 v[74:75], v34 offset:1024
    ds_read_b64_tr_b16 v[76:77], v35 offset:0
    ds_read_b64_tr_b16 v[78:79], v35 offset:1024
    s_waitcnt lgkmcnt(6)
    v_mfma_f32_32x32x16_bf16 v[104:119], v[64:67], v[236:239], 0
    ds_read_b64_tr_b16 v[80:81], v32 offset:2048
    ds_read_b64_tr_b16 v[82:83], v32 offset:3072
    s_waitcnt lgkmcnt(6)
    v_mfma_f32_32x32x16_bf16 v[120:135], v[68:71], v[236:239], 0
    ds_read_b64_tr_b16 v[84:85], v33 offset:2048
    ds_read_b64_tr_b16 v[86:87], v33 offset:3072
    s_waitcnt lgkmcnt(6)
    v_mfma_f32_32x32x16_bf16 v[136:151], v[72:75], v[236:239], 0
    ds_read_b64_tr_b16 v[88:89], v34 offset:2048
    ds_read_b64_tr_b16 v[90:91], v34 offset:3072
    s_waitcnt lgkmcnt(6)
    v_mfma_f32_32x32x16_bf16 v[152:167], v[76:79], v[236:239], 0
    ds_read_b64_tr_b16 v[92:93], v35 offset:2048
    ds_read_b64_tr_b16 v[94:95], v35 offset:3072
    s_waitcnt lgkmcnt(6)
    v_mfma_f32_32x32x16_bf16 v[104:119], v[80:83], v[240:243], v[104:119]
    ds_read_b64_tr_b16 v[64:65], v32 offset:4096
    ds_read_b64_tr_b16 v[66:67], v32 offset:5120
    s_waitcnt lgkmcnt(6)
    v_mfma_f32_32x32x16_bf16 v[120:135], v[84:87], v[240:243], v[120:135]
    ds_read_b64_tr_b16 v[68:69], v33 offset:4096
    ds_read_b64_tr_b16 v[70:71], v33 offset:5120
    s_waitcnt lgkmcnt(6)
    v_mfma_f32_32x32x16_bf16 v[136:151], v[88:91], v[240:243], v[136:151]
    ds_read_b64_tr_b16 v[72:73], v34 offset:4096
    ds_read_b64_tr_b16 v[74:75], v34 offset:5120
    s_waitcnt lgkmcnt(6)
    v_mfma_f32_32x32x16_bf16 v[152:167], v[92:95], v[240:243], v[152:167]
    ds_read_b64_tr_b16 v[76:77], v35 offset:4096
    ds_read_b64_tr_b16 v[78:79], v35 offset:5120
    s_waitcnt lgkmcnt(6)
    v_mfma_f32_32x32x16_bf16 v[104:119], v[64:67], v[244:247], v[104:119]
    ds_read_b64_tr_b16 v[80:81], v32 offset:6144
    ds_read_b64_tr_b16 v[82:83], v32 offset:7168
    s_waitcnt lgkmcnt(6)
    v_mfma_f32_32x32x16_bf16 v[120:135], v[68:71], v[244:247], v[120:135]
    ds_read_b64_tr_b16 v[84:85], v33 offset:6144
    ds_read_b64_tr_b16 v[86:87], v33 offset:7168
    s_waitcnt lgkmcnt(6)
    v_mfma_f32_32x32x16_bf16 v[136:151], v[72:75], v[244:247], v[136:151]
    ds_read_b64_tr_b16 v[88:89], v34 offset:6144
    ds_read_b64_tr_b16 v[90:91], v34 offset:7168
    s_waitcnt lgkmcnt(6)
    v_mfma_f32_32x32x16_bf16 v[152:167], v[76:79], v[244:247], v[152:167]
    ds_read_b64_tr_b16 v[92:93], v35 offset:6144
    ds_read_b64_tr_b16 v[94:95], v35 offset:7168
    s_waitcnt lgkmcnt(6)
    v_mfma_f32_32x32x16_bf16 v[104:119], v[80:83], v[248:251], v[104:119]
    ds_read_b64_tr_b16 v[64:65], v32 offset:8192
    ds_read_b64_tr_b16 v[66:67], v32 offset:9216
    s_waitcnt lgkmcnt(6)
    v_mfma_f32_32x32x16_bf16 v[120:135], v[84:87], v[248:251], v[120:135]
    ds_read_b64_tr_b16 v[68:69], v33 offset:8192
    ds_read_b64_tr_b16 v[70:71], v33 offset:9216
    s_waitcnt lgkmcnt(6)
    v_mfma_f32_32x32x16_bf16 v[136:151], v[88:91], v[248:251], v[136:151]
    ds_read_b64_tr_b16 v[72:73], v34 offset:8192
    ds_read_b64_tr_b16 v[74:75], v34 offset:9216
    s_waitcnt lgkmcnt(6)
    v_mfma_f32_32x32x16_bf16 v[152:167], v[92:95], v[248:251], v[152:167]
    ds_read_b64_tr_b16 v[76:77], v35 offset:8192
    ds_read_b64_tr_b16 v[78:79], v35 offset:9216
    s_mul_i32 s83, s79, 2048
    s_lshl_b32 s84, s80, 7
    s_add_u32 s83, s83, s84
    s_add_u32 s83, s83, 22085632
    s_waitcnt vmcnt(0)
    s_barrier
    s_cmp_lg_u32 s72, 0
    s_cbranch_scc1 SK_87
    s_mov_b64 exec, 1
    s_cmp_lg_u32 s100, 0
    s_cbranch_scc1 SLOW_88
    buffer_store_dword v2, off, s[64:67], s83
    s_branch STE_89
SLOW_88:
    buffer_store_dword v2, off, s[64:67], s83 sc1
STE_89:
    s_mov_b64 exec, -1
    s_mov_b32 s90, 200000
    s_mov_b64 exec, 0x3ff
POLL_90:
    buffer_load_dword v63, v8, s[64:67], 0 offen sc1
    s_waitcnt vmcnt(0)
    v_cmp_ne_u32 vcc, s73, v63
    s_cbranch_vccz POLLD_91
    s_sub_u32 s90, s90, 1
    s_cmp_lg_u32 s90, 0
    s_cbranch_scc1 POLL_90
POLLD_91:
    s_mov_b64 exec, -1
SK_87:
    s_cmp_lg_u32 s72, 1
    s_cbranch_scc1 SK_92
    s_getpc_b64 s[14:15]
L_PCREF_93:
    s_sub_u32 s14, s14, L_PCREF_93-L_CODE0
    s_subb_u32 s15, s15, 0
    s_bfe_u32 s84, s2, 0x40003
    s_mul_i32 s84, s84, 5760
    v_lshl_add_u32 v3, v1, 7, s84
    v_min_u32 v3, L_CODE1-L_CODE0-4, v3
    global_load_dword v253, v3, s[14:15]
SK_92:
    s_barrier
    s_add_u32 s96, s96, 66048
    s_cmp_eq_u32 s96, 10113024
    s_cselect_b32 s96, 7471104, s96
    s_mov_b32 s83, s96
    buffer_load_dwordx4 v[184:187], v7, s[64:67], s83 offen sc1
    s_add_u32 s96, s96, 66048
    s_cmp_eq_u32 s96, 10113024
    s_cselect_b32 s96, 7471104, s96
    s_mov_b32 s83, s96
    buffer_load_dwordx4 v[188:191], v7, s[64:67], s83 offen sc1
    s_add_u32 s96, s96, 66048
    s_cmp_eq_u32 s96, 10113024
    s_cselect_b32 s96, 7471104, s96
    s_mov_b32 s83, s96
    buffer_load_dwordx4 v[192:195], v7, s[64:67], s83 offen sc1
    s_add_u32 s96, s96, 66048
    s_cmp_eq_u32 s96, 10113024
    s_cselect_b32 s96, 7471104, s96
    s_mov_b32 s83, s96
    buffer_load_dwordx4 v[196:199], v7, s[64:67], s83 offen sc1
    s_add_u32 s96, s96, 66048
    s_cmp_eq_u32 s96, 10113024
    s_cselect_b32 s96, 7471104, s96
    s_mov_b32 s83, s96
    buffer_load_dwordx4 v[200:203], v7, s[64:67], s83 offen sc1
    s_add_u32 s96, s96, 66048
    s_cmp_eq_u32 s96, 10113024
    s_cselect_b32 s96, 7471104, s96
    s_mov_b32 s83, s96
    buffer_load_dwordx4 v[204:207], v7, s[64:67], s83 offen sc1
    s_add_u32 s96, s96, 66048
    s_cmp_eq_u32 s96, 10113024
    s_cselect_b32 s96, 7471104, s96
    s_mov_b32 s83, s96
    buffer_load_dwordx4 v[208:211], v7, s[64:67], s83 offen sc1
    s_add_u32 s96, s96, 66048
    s_cmp_eq_u32 s96, 10113024
    s_cselect_b32 s96, 7471104, s96
    s_mov_b32 s83, s96
    buffer_load_dwordx4 v[212:215], v7, s[64:67], s83 offen sc1
    s_add_u32 s96, s96, 66048
    s_cmp_eq_u32 s96, 10113024
    s_cselect_b32 s96, 7471104, s96
    s_mov_b32 s83, s96
    buffer_load_dwordx4 v[216:219], v7, s[64:67], s83 offen sc1
    s_add_u32 s96, s96, 66048
    s_cmp_eq_u32 s96, 10113024
    s_cselect_b32 s96, 7471104, s96
    s_mov_b32 s83, s96
    buffer_load_dwordx4 v[36:39], v7, s[64:67], s83 offen sc1
    s_add_u32 s96, s96, 66048
    s_cmp_eq_u32 s96, 10113024
    s_cselect_b32 s96, 7471104, s96
    s_mov_b32 s83, s96
    buffer_load_dwordx4 v[40:43], v7, s[64:67], s83 offen sc1
    s_add_u32 s96, s96, 66048
    s_cmp_eq_u32 s96, 10113024
    s_cselect_b32 s96, 7471104, s96
    s_mov_b32 s83, s96
    buffer_load_dwordx4 v[44:47], v7, s[64:67], s83 offen sc1
    v_and_b32 v5, 31, v1
    v_lshlrev_b32_e64 v5, 3, v5
    v_add_u32 v5, 147456, v5
    ds_read_b64 v[168:169], v5 offset:0
    v_mov_b32 v170, 0
    v_mov_b32 v171, 0
    ds_read_b64 v[172:173], v5 offset:256
    v_mov_b32 v174, 0
    v_mov_b32 v175, 0
    ds_read_b64 v[176:177], v5 offset:512
    v_mov_b32 v178, 0
    v_mov_b32 v179, 0
    ds_read_b64 v[180:181], v5 offset:768
    v_mov_b32 v182, 0
    v_mov_b32 v183, 0
    s_waitcnt vmcnt(11)
    s_waitcnt lgkmcnt(10)
    v_mfma_f32_32x32x16_bf16 v[104:119], v[64:67], v[184:187], v[104:119]
    ds_read_b64_tr_b16 v[80:81], v32 offset:10240
    ds_read_b64_tr_b16 v[82:83], v32 offset:11264
    s_waitcnt lgkmcnt(10)
    v_mfma_f32_32x32x16_bf16 v[120:135], v[68:71], v[184:187], v[120:135]
    ds_read_b64_tr_b16 v[84:85], v33 offset:10240
    ds_read_b64_tr_b16 v[86:87], v33 offset:11264
    s_waitcnt lgkmcnt(10)
    v_mfma_f32_32x32x16_bf16 v[136:151], v[72:75], v[184:187], v[136:151]
    ds_read_b64_tr_b16 v[88:89], v34 offset:10240
    ds_read_b64_tr_b16 v[90:91], v34 offset:11264
    s_waitcnt lgkmcnt(10)
    v_mfma_f32_32x32x16_bf16 v[152:167], v[76:79], v[184:187], v[152:167]
    ds_read_b64_tr_b16 v[92:93], v35 offset:10240
    ds_read_b64_tr_b16 v[94:95], v35 offset:11264
    s_add_u32 s96, s96, 66048
    s_cmp_eq_u32 s96, 10113024
    s_cselect_b32 s96, 7471104, s96
    s_mov_b32 s83, s96
    buffer_load_dwordx4 v[96:99], v7, s[64:67], s83 offen sc1
    s_add_u32 s96, s96, 66048
    s_cmp_eq_u32 s96, 10113024
    s_cselect_b32 s96, 7471104, s96
    s_mov_b32 s83, s96
    buffer_load_dwordx4 v[100:103], v7, s[64:67], s83 offen sc1
    s_waitcnt vmcnt(12)
    s_waitcnt lgkmcnt(6)
    v_mfma_f32_32x32x16_bf16 v[104:119], v[80:83], v[188:191], v[104:119]
    ds_read_b64_tr_b16 v[64:65], v32 offset:12288
    ds_read_b64_tr_b16 v[66:67], v32 offset:13312
    s_waitcnt lgkmcnt(6)
    v_mfma_f32_32x32x16_bf16 v[120:135], v[84:87], v[188:191], v[120:135]
    ds_read_b64_tr_b16 v[68:69], v33 offset:12288
    ds_read_b64_tr_b16 v[70:71], v33 offset:13312
    s_waitcnt lgkmcnt(6)
    v_mfma_f32_32x32x16_bf16 v[136:151], v[88:91], v[188:191], v[136:151]
    ds_read_b64_tr_b16 v[72:73], v34 offset:12288
    ds_read_b64_tr_b16 v[74:75], v34 offset:13312
    s_waitcnt lgkmcnt(6)
    v_mfma_f32_32x32x16_bf16 v[152:167], v[92:95], v[188:191], v[152:167]
    ds_read_b64_tr_b16 v[76:77], v35 offset:12288
    ds_read_b64_tr_b16 v[78:79], v35 offset:13312
    s_add_u32 s96, s96, 66048
    s_cmp_eq_u32 s96, 10113024
    s_cselect_b32 s96, 7471104, s96
    s_mov_b32 s83, s96
    buffer_load_dwordx4 v[52:55], v7, s[64:67], s83 offen sc1
    s_add_u32 s96, s96, 66048
    s_cmp_eq_u32 s96, 10113024
    s_cselect_b32 s96, 7471104, s96
    s_mov_b32 s83, s96
    buffer_load_dwordx4 v[56:59], v7, s[64:67], s83 offen sc1
    s_waitcnt vmcnt(13)
    s_waitcnt lgkmcnt(6)
    v_mfma_f32_32x32x16_bf16 v[104:119], v[64:67], v[192:195], v[104:119]
    ds_read_b64_tr_b16 v[80:81], v32 offset:14336
    ds_read_b64_tr_b16 v[82:83], v32 offset:15360
    s_waitcnt lgkmcnt(6)
    v_mfma_f32_32x32x16_bf16 v[120:135], v[68:71], v[192:195], v[120:135]
    ds_read_b64_tr_b16 v[84:85], v33 offset:14336
    ds_read_b64_tr_b16 v[86:87], v33 offset:15360
    s_waitcnt lgkmcnt(6)
    v_mfma_f32_32x32x16_bf16 v[136:151], v[72:75], v[192:195], v[136:151]
    ds_read_b64_tr_b16 v[88:89], v34 offset:14336
    ds_read_b64_tr_b16 v[90:91], v34 offset:15360
    s_waitcnt lgkmcnt(6)
    v_mfma_f32_32x32x16_bf16 v[152:167], v[76:79], v[192:195], v[152:167]
    ds_read_b64_tr_b16 v[92:93], v35 offset:14336
    ds_read_b64_tr_b16 v[94:95], v35 offset:15360
    s_add_u32 s96, s96, 66048
    s_cmp_eq_u32 s96, 10113024
    s_cselect_b32 s96, 7471104, s96
    s_mov_b32 s83, s96
    buffer_load_dwordx4 v[184:187], v7, s[64:67], s83 offen sc1
    s_add_u32 s96, s96, 66048
    s_cmp_eq_u32 s96, 10113024
    s_cselect_b32 s96, 7471104, s96
    s_mov_b32 s83, s96
    buffer_load_dwordx4 v[188:191], v7, s[64:67], s83 offen sc1
    s_waitcnt lgkmcnt(0)
    v_add_u32 v32, 32768, v30
    v_add_u32 v33, 32768, v31
    v_add_u32 v34, 49152, v30
    v_add_u32 v35, 49152, v31
    s_barrier
    s_waitcnt vmcnt(14)
    v_mfma_f32_32x32x16_bf16 v[104:119], v[80:83], v[196:199], v[104:119]
    ds_read_b64_tr_b16 v[64:65], v32 offset:0
    ds_read_b64_tr_b16 v[66:67], v32 offset:1024
    v_mfma_f32_32x32x16_bf16 v[120:135], v[84:87], v[196:199], v[120:135]
    ds_read_b64_tr_b16 v[68:69], v33 offset:0
    ds_read_b64_tr_b16 v[70:71], v33 offset:1024
    v_mfma_f32_32x32x16_bf16 v[136:151], v[88:91], v[196:199], v[136:151]
    ds_read_b64_tr_b16 v[72:73], v34 offset:0
    ds_read_b64_tr_b16 v[74:75], v34 offset:1024
    v_mfma_f32_32x32x16_bf16 v[152:167], v[92:95], v[196:199], v[152:167]
    ds_read_b64_tr_b16 v[76:77], v35 offset:0
    ds_read_b64_tr_b16 v[78:79], v35 offset:1024
    s_add_u32 s96, s96, 66048
    s_cmp_eq_u32 s96, 10113024
    s_cselect_b32 s96, 7471104, s96
    s_mov_b32 s83, s96
    buffer_load_dwordx4 v[192:195], v7, s[64:67], s83 offen sc1
    s_add_u32 s96, s96, 66048
    s_cmp_eq_u32 s96, 10113024
    s_cselect_b32 s96, 7471104, s96
    s_mov_b32 s83, s96
    buffer_load_dwordx4 v[196:199], v7, s[64:67], s83 offen sc1
    s_waitcnt vmcnt(15)
    s_waitcnt lgkmcnt(6)
    v_mfma_f32_32x32x16_bf16 v[104:119], v[64:67], v[200:203], v[104:119]
    ds_read_b64_tr_b16 v[80:81], v32 offset:2048
    ds_read_b64_tr_b16 v[82:83], v32 offset:3072
    s_waitcnt lgkmcnt(6)
    v_mfma_f32_32x32x16_bf16 v[120:135], v[68:71], v[200:203], v[120:135]
    ds_read_b64_tr_b16 v[84:85], v33 offset:2048
    ds_read_b64_tr_b16 v[86:87], v33 offset:3072
    s_waitcnt lgkmcnt(6)
    v_mfma_f32_32x32x16_bf16 v[136:151], v[72:75], v[200:203], v[136:151]
    ds_read_b64_tr_b16 v[88:89], v34 offset:2048
    ds_read_b64_tr_b16 v[90:91], v34 offset:3072
    s_waitcnt lgkmcnt(6)
    v_mfma_f32_32x32x16_bf16 v[152:167], v[76:79], v[200:203], v[152:167]
    ds_read_b64_tr_b16 v[92:93], v35 offset:2048
    ds_read_b64_tr_b16 v[94:95], v35 offset:3072
    s_add_u32 s96, s96, 66048
    s_cmp_eq_u32 s96, 10113024
    s_cselect_b32 s96, 7471104, s96
    s_mov_b32 s83, s96
    buffer_load_dwordx4 v[200:203], v7, s[64:67], s83 offen sc1
    s_waitcnt vmcnt(15)
    s_waitcnt lgkmcnt(6)
    v_mfma_f32_32x32x16_bf16 v[104:119], v[80:83], v[204:207], v[104:119]
    ds_read_b64_tr_b16 v[64:65], v32 offset:4096
    ds_read_b64_tr_b16 v[66:67], v32 offset:5120
    s_waitcnt lgkmcnt(6)
    v_mfma_f32_32x32x16_bf16 v[120:135], v[84:87], v[204:207], v[120:135]
    ds_read_b64_tr_b16 v[68:69], v33 offset:4096
    ds_read_b64_tr_b16 v[70:71], v33 offset:5120
    s_waitcnt lgkmcnt(6)
    v_mfma_f32_32x32x16_bf16 v[136:151], v[88:91], v[204:207], v[136:151]
    ds_read_b64_tr_b16 v[72:73], v34 offset:4096
    ds_read_b64_tr_b16 v[74:75], v34 offset:5120
    s_waitcnt lgkmcnt(6)
    v_mfma_f32_32x32x16_bf16 v[152:167], v[92:95], v[204:207], v[152:167]
    ds_read_b64_tr_b16 v[76:77], v35 offset:4096
    ds_read_b64_tr_b16 v[78:79], v35 offset:5120
    s_add_u32 s96, s96, 66048
    s_cmp_eq_u32 s96, 10113024
    s_cselect_b32 s96, 7471104, s96
    s_mov_b32 s83, s96
    buffer_load_dwordx4 v[204:207], v7, s[64:67], s83 offen sc1
    s_waitcnt vmcnt(15)
    s_waitcnt lgkmcnt(6)
    v_mfma_f32_32x32x16_bf16 v[104:119], v[64:67], v[208:211], v[104:119]
    ds_read_b64_tr_b16 v[80:81], v32 offset:6144
    ds_read_b64_tr_b16 v[82:83], v32 offset:7168
    s_waitcnt lgkmcnt(6)
    v_mfma_f32_32x32x16_bf16 v[120:135], v[68:71], v[208:211], v[120:135]
    ds_read_b64_tr_b16 v[84:85], v33 offset:6144
    ds_read_b64_tr_b16 v[86:87], v33 offset:7168
    s_waitcnt lgkmcnt(6)
    v_mfma_f32_32x32x16_bf16 v[136:151], v[72:75], v[208:211], v[136:151]
    ds_read_b64_tr_b16 v[88:89], v34 offset:6144
    ds_read_b64_tr_b16 v[90:91], v34 offset:7168
    s_waitcnt lgkmcnt(6)
    v_mfma_f32_32x32x16_bf16 v[152:167], v[76:79], v[208:211], v[152:167]
    ds_read_b64_tr_b16 v[92:93], v35 offset:6144
    ds_read_b64_tr_b16 v[94:95], v35 offset:7168
    s_add_u32 s96, s96, 66048
    s_cmp_eq_u32 s96, 10113024
    s_cselect_b32 s96, 7471104, s96
    s_mov_b32 s83, s96
    buffer_load_dwordx4 v[208:211], v7, s[64:67], s83 offen sc1
    s_waitcnt vmcnt(15)
    s_waitcnt lgkmcnt(6)
    v_mfma_f32_32x32x16_bf16 v[104:119], v[80:83], v[212:215], v[104:119]
    ds_read_b64_tr_b16 v[64:65], v32 offset:8192
    ds_read_b64_tr_b16 v[66:67], v32 offset:9216
    s_waitcnt lgkmcnt(6)
    v_mfma_f32_32x32x16_bf16 v[120:135], v[84:87], v[212:215], v[120:135]
    ds_read_b64_tr_b16 v[68:69], v33 offset:8192
    ds_read_b64_tr_b16 v[70:71], v33 offset:9216
    s_waitcnt lgkmcnt(6)
    v_mfma_f32_32x32x16_bf16 v[136:151], v[88:91], v[212:215], v[136:151]
    ds_read_b64_tr_b16 v[72:73], v34 offset:8192
    ds_read_b64_tr_b16 v[74:75], v34 offset:9216
    s_waitcnt lgkmcnt(6)
    v_mfma_f32_32x32x16_bf16 v[152:167], v[92:95], v[212:215], v[152:167]
    ds_read_b64_tr_b16 v[76:77], v35 offset:8192
    ds_read_b64_tr_b16 v[78:79], v35 offset:9216
    s_add_u32 s96, s96, 66048
    s_cmp_eq_u32 s96, 10113024
    s_cselect_b32 s96, 7471104, s96
    s_mov_b32 s83, s96
    buffer_load_dwordx4 v[212:215], v7, s[64:67], s83 offen sc1
    s_waitcnt vmcnt(15)
    s_waitcnt lgkmcnt(6)
    v_mfma_f32_32x32x16_bf16 v[104:119], v[64:67], v[216:219], v[104:119]
    ds_read_b64_tr_b16 v[80:81], v32 offset:10240
    ds_read_b64_tr_b16 v[82:83], v32 offset:11264
    s_waitcnt lgkmcnt(6)
    v_mfma_f32_32x32x16_bf16 v[120:135], v[68:71], v[216:219], v[120:135]
    ds_read_b64_tr_b16 v[84:85], v33 offset:10240
    ds_read_b64_tr_b16 v[86:87], v33 offset:11264
    s_waitcnt lgkmcnt(6)
    v_mfma_f32_32x32x16_bf16 v[136:151], v[72:75], v[216:219], v[136:151]
    ds_read_b64_tr_b16 v[88:89], v34 offset:10240
    ds_read_b64_tr_b16 v[90:91], v34 offset:11264
    s_waitcnt lgkmcnt(6)
    v_mfma_f32_32x32x16_bf16 v[152:167], v[76:79], v[216:219], v[152:167]
    ds_read_b64_tr_b16 v[92:93], v35 offset:10240
    ds_read_b64_tr_b16 v[94:95], v35 offset:11264
    s_add_u32 s96, s96, 66048
    s_cmp_eq_u32 s96, 10113024
    s_cselect_b32 s96, 7471104, s96
    s_mov_b32 s83, s96
    buffer_load_dwordx4 v[216:219], v7, s[64:67], s83 offen sc1
    s_waitcnt vmcnt(15)
    s_waitcnt lgkmcnt(6)
    v_mfma_f32_32x32x16_bf16 v[104:119], v[80:83], v[36:39], v[104:119]
    ds_read_b64_tr_b16 v[64:65], v32 offset:12288
    ds_read_b64_tr_b16 v[66:67], v32 offset:13312
    s_waitcnt lgkmcnt(6)
    v_mfma_f32_32x32x16_bf16 v[120:135], v[84:87], v[36:39], v[120:135]
    ds_read_b64_tr_b16 v[68:69], v33 offset:12288
    ds_read_b64_tr_b16 v[70:71], v33 offset:13312
    s_waitcnt lgkmcnt(6)
    v_mfma_f32_32x32x16_bf16 v[136:151], v[88:91], v[36:39], v[136:151]
    ds_read_b64_tr_b16 v[72:73], v34 offset:12288
    ds_read_b64_tr_b16 v[74:75], v34 offset:13312
    s_waitcnt lgkmcnt(6)
    v_mfma_f32_32x32x16_bf16 v[152:167], v[92:95], v[36:39], v[152:167]
    ds_read_b64_tr_b16 v[76:77], v35 offset:12288
    ds_read_b64_tr_b16 v[78:79], v35 offset:13312
    s_add_u32 s96, s96, 66048
    s_cmp_eq_u32 s96, 10113024
    s_cselect_b32 s96, 7471104, s96
    s_mov_b32 s83, s96
    buffer_load_dwordx4 v[36:39], v7, s[64:67], s83 offen sc1
    s_waitcnt vmcnt(15)
    s_waitcnt lgkmcnt(6)
    v_mfma_f32_32x32x16_bf16 v[104:119], v[64:67], v[40:43], v[104:119]
    ds_read_b64_tr_b16 v[80:81], v32 offset:14336
    ds_read_b64_tr_b16 v[82:83], v32 offset:15360
    s_waitcnt lgkmcnt(6)
    v_mfma_f32_32x32x16_bf16 v[120:135], v[68:71], v[40:43], v[120:135]
    ds_read_b64_tr_b16 v[84:85], v33 offset:14336
    ds_read_b64_tr_b16 v[86:87], v33 offset:15360
    s_waitcnt lgkmcnt(6)
    v_mfma_f32_32x32x16_bf16 v[136:151], v[72:75], v[40:43], v[136:151]
    ds_read_b64_tr_b16 v[88:89], v34 offset:14336
    ds_read_b64_tr_b16 v[90:91], v34 offset:15360
    s_waitcnt lgkmcnt(6)
    v_mfma_f32_32x32x16_bf16 v[152:167], v[76:79], v[40:43], v[152:167]
    ds_read_b64_tr_b16 v[92:93], v35 offset:14336
    ds_read_b64_tr_b16 v[94:95], v35 offset:15360
    s_add_u32 s96, s96, 66048
    s_cmp_eq_u32 s96, 10113024
    s_cselect_b32 s96, 7471104, s96
    s_mov_b32 s83, s96
    buffer_load_dwordx4 v[40:43], v7, s[64:67], s83 offen sc1
    s_waitcnt lgkmcnt(0)
    v_add_u32 v32, 65536, v30
    v_add_u32 v33, 65536, v31
    v_add_u32 v34, 81920, v30
    v_add_u32 v35, 81920, v31
    s_barrier
    s_waitcnt vmcnt(15)
    v_mfma_f32_32x32x16_bf16 v[104:119], v[80:83], v[44:47], v[104:119]
    ds_read_b64_tr_b16 v[64:65], v32 offset:0
    ds_read_b64_tr_b16 v[66:67], v32 offset:1024
    v_mfma_f32_32x32x16_bf16 v[120:135], v[84:87], v[44:47], v[120:135]
    ds_read_b64_tr_b16 v[68:69], v33 offset:0
    ds_read_b64_tr_b16 v[70:71], v33 offset:1024
    v_mfma_f32_32x32x16_bf16 v[136:151], v[88:91], v[44:47], v[136:151]
    ds_read_b64_tr_b16 v[72:73], v34 offset:0
    ds_read_b64_tr_b16 v[74:75], v34 offset:1024
    v_mfma_f32_32x32x16_bf16 v[152:167], v[92:95], v[44:47], v[152:167]
    ds_read_b64_tr_b16 v[76:77], v35 offset:0
    ds_read_b64_tr_b16 v[78:79], v35 offset:1024
    s_add_u32 s96, s96, 66048
    s_cmp_eq_u32 s96, 10113024
    s_cselect_b32 s96, 7471104, s96
    s_mov_b32 s83, s96
    buffer_load_dwordx4 v[44:47], v7, s[64:67], s83 offen sc1
    s_waitcnt vmcnt(15)
    s_waitcnt lgkmcnt(6)
    v_mfma_f32_32x32x16_bf16 v[104:119], v[64:67], v[96:99], v[104:119]
    ds_read_b64_tr_b16 v[80:81], v32 offset:2048
    ds_read_b64_tr_b16 v[82:83], v32 offset:3072
    s_waitcnt lgkmcnt(6)
    v_mfma_f32_32x32x16_bf16 v[120:135], v[68:71], v[96:99], v[120:135]
    ds_read_b64_tr_b16 v[84:85], v33 offset:2048
    ds_read_b64_tr_b16 v[86:87], v33 offset:3072
    s_waitcnt lgkmcnt(6)
    v_mfma_f32_32x32x16_bf16 v[136:151], v[72:75], v[96:99], v[136:151]
    ds_read_b64_tr_b16 v[88:89], v34 offset:2048
    ds_read_b64_tr_b16 v[90:91], v34 offset:3072
    s_waitcnt lgkmcnt(6)
    v_mfma_f32_32x32x16_bf16 v[152:167], v[76:79], v[96:99], v[152:167]
    ds_read_b64_tr_b16 v[92:93], v35 offset:2048
    ds_read_b64_tr_b16 v[94:95], v35 offset:3072
    s_add_u32 s96, s96, 66048
    s_cmp_eq_u32 s96, 10113024
    s_cselect_b32 s96, 7471104, s96
    s_mov_b32 s83, s96
    buffer_load_dwordx4 v[96:99], v7, s[64:67], s83 offen sc1
    s_waitcnt vmcnt(15)
    s_waitcnt lgkmcnt(6)
    v_mfma_f32_32x32x16_bf16 v[104:119], v[80:83], v[100:103], v[104:119]
    ds_read_b64_tr_b16 v[64:65], v32 offset:4096
    ds_read_b64_tr_b16 v[66:67], v32 offset:5120
    s_waitcnt lgkmcnt(6)
    v_mfma_f32_32x32x16_bf16 v[120:135], v[84:87], v[100:103], v[120:135]
    ds_read_b64_tr_b16 v[68:69], v33 offset:4096
    ds_read_b64_tr_b16 v[70:71], v33 offset:5120
    s_waitcnt lgkmcnt(6)
    v_mfma_f32_32x32x16_bf16 v[136:151], v[88:91], v[100:103], v[136:151]
    ds_read_b64_tr_b16 v[72:73], v34 offset:4096
    ds_read_b64_tr_b16 v[74:75], v34 offset:5120
    s_waitcnt lgkmcnt(6)
    v_mfma_f32_32x32x16_bf16 v[152:167], v[92:95], v[100:103], v[152:167]
    ds_read_b64_tr_b16 v[76:77], v35 offset:4096
    ds_read_b64_tr_b16 v[78:79], v35 offset:5120
    s_add_u32 s96, s96, 66048
    s_cmp_eq_u32 s96, 10113024
    s_cselect_b32 s96, 7471104, s96
    s_mov_b32 s83, s96
    buffer_load_dwordx4 v[100:103], v7, s[64:67], s83 offen sc1
    s_waitcnt vmcnt(15)
    s_waitcnt lgkmcnt(6)
    v_mfma_f32_32x32x16_bf16 v[104:119], v[64:67], v[52:55], v[104:119]
    ds_read_b64_tr_b16 v[80:81], v32 offset:6144
    ds_read_b64_tr_b16 v[82:83], v32 offset:7168
    s_waitcnt lgkmcnt(6)
    v_mfma_f32_32x32x16_bf16 v[120:135], v[68:71], v[52:55], v[120:135]
    ds_read_b64_tr_b16 v[84:85], v33 offset:6144
    ds_read_b64_tr_b16 v[86:87], v33 offset:7168
    s_waitcnt lgkmcnt(6)
    v_mfma_f32_32x32x16_bf16 v[136:151], v[72:75], v[52:55], v[136:151]
    ds_read_b64_tr_b16 v[88:89], v34 offset:6144
    ds_read_b64_tr_b16 v[90:91], v34 offset:7168
    s_waitcnt lgkmcnt(6)
    v_mfma_f32_32x32x16_bf16 v[152:167], v[76:79], v[52:55], v[152:167]
    ds_read_b64_tr_b16 v[92:93], v35 offset:6144
    ds_read_b64_tr_b16 v[94:95], v35 offset:7168
    s_add_u32 s96, s96, 66048
    s_cmp_eq_u32 s96, 10113024
    s_cselect_b32 s96, 7471104, s96
    s_mov_b32 s83, s96
    buffer_load_dwordx4 v[52:55], v7, s[64:67], s83 offen sc1
    v_lshrrev_b32 v3, 5, v1
    v_lshlrev_b32 v3, 14, v3
    v_lshl_add_u32 v3, v6, 3, v3
    s_mov_b32 s83, 196608
    buffer_load_dwordx2 v[12:13], v3, s[64:67], s83 offen sc1
    s_mov_b32 s83, 229376
    buffer_load_dwordx2 v[14:15], v3, s[64:67], s83 offen sc1
    s_mov_b32 s83, 262144
    buffer_load_dwordx2 v[16:17], v3, s[64:67], s83 offen sc1
    s_mov_b32 s83, 294912
    buffer_load_dwordx2 v[18:19], v3, s[64:67], s83 offen sc1
    s_mov_b32 s83, 327680
    buffer_load_dwordx2 v[20:21], v3, s[64:67], s83 offen sc1
    s_waitcnt vmcnt(20)
    s_waitcnt lgkmcnt(6)
    v_mfma_f32_32x32x16_bf16 v[104:119], v[80:83], v[56:59], v[104:119]
    ds_read_b64_tr_b16 v[64:65], v32 offset:8192
    ds_read_b64_tr_b16 v[66:67], v32 offset:9216
    s_waitcnt lgkmcnt(6)
    v_mfma_f32_32x32x16_bf16 v[120:135], v[84:87], v[56:59], v[120:135]
    ds_read_b64_tr_b16 v[68:69], v33 offset:8192
    ds_read_b64_tr_b16 v[70:71], v33 offset:9216
    s_waitcnt lgkmcnt(6)
    v_mfma_f32_32x32x16_bf16 v[136:151], v[88:91], v[56:59], v[136:151]
    ds_read_b64_tr_b16 v[72:73], v34 offset:8192
    ds_read_b64_tr_b16 v[74:75], v34 offset:9216
    s_waitcnt lgkmcnt(6)
    v_mfma_f32_32x32x16_bf16 v[152:167], v[92:95], v[56:59], v[152:167]
    ds_read_b64_tr_b16 v[76:77], v35 offset:8192
    ds_read_b64_tr_b16 v[78:79], v35 offset:9216
    s_add_u32 s96, s96, 66048
    s_cmp_eq_u32 s96, 10113024
    s_cselect_b32 s96, 7471104, s96
    s_mov_b32 s83, s96
    buffer_load_dwordx4 v[56:59], v7, s[64:67], s83 offen sc1
    s_waitcnt vmcnt(20)
    s_waitcnt lgkmcnt(6)
    v_mfma_f32_32x32x16_bf16 v[104:119], v[64:67], v[184:187], v[104:119]
    ds_read_b64_tr_b16 v[80:81], v32 offset:10240
    ds_read_b64_tr_b16 v[82:83], v32 offset:11264
    s_waitcnt lgkmcnt(6)
    v_mfma_f32_32x32x16_bf16 v[120:135], v[68:71], v[184:187], v[120:135]
    ds_read_b64_tr_b16 v[84:85], v33 offset:10240
    ds_read_b64_tr_b16 v[86:87], v33 offset:11264
    s_waitcnt lgkmcnt(6)
    v_mfma_f32_32x32x16_bf16 v[136:151], v[72:75], v[184:187], v[136:151]
    ds_read_b64_tr_b16 v[88:89], v34 offset:10240
    ds_read_b64_tr_b16 v[90:91], v34 offset:11264
    s_waitcnt lgkmcnt(6)
    v_mfma_f32_32x32x16_bf16 v[152:167], v[76:79], v[184:187], v[152:167]
    ds_read_b64_tr_b16 v[92:93], v35 offset:10240
    ds_read_b64_tr_b16 v[94:95], v35 offset:11264
    s_add_u32 s96, s96, 66048
    s_cmp_eq_u32 s96, 10113024
    s_cselect_b32 s96, 7471104, s96
    s_mov_b32 s83, s96
    buffer_load_dwordx4 v[184:187], v7, s[64:67], s83 offen sc1
    s_waitcnt vmcnt(20)
    s_waitcnt lgkmcnt(6)
    v_mfma_f32_32x32x16_bf16 v[104:119], v[80:83], v[188:191], v[104:119]
    ds_read_b64_tr_b16 v[64:65], v32 offset:12288
    ds_read_b64_tr_b16 v[66:67], v32 offset:13312
    s_waitcnt lgkmcnt(6)
    v_mfma_f32_32x32x16_bf16 v[120:135], v[84:87], v[188:191], v[120:135]
    ds_read_b64_tr_b16 v[68:69], v33 offset:12288
    ds_read_b64_tr_b16 v[70:71], v33 offset:13312
    s_waitcnt lgkmcnt(6)
    v_mfma_f32_32x32x16_bf16 v[136:151], v[88:91], v[188:191], v[136:151]
    ds_read_b64_tr_b16 v[72:73], v34 offset:12288
    ds_read_b64_tr_b16 v[74:75], v34 offset:13312
    s_waitcnt lgkmcnt(6)
    v_mfma_f32_32x32x16_bf16 v[152:167], v[92:95], v[188:191], v[152:167]
    ds_read_b64_tr_b16 v[76:77], v35 offset:12288
    ds_read_b64_tr_b16 v[78:79], v35 offset:13312
    s_add_u32 s96, s96, 66048
    s_cmp_eq_u32 s96, 10113024
    s_cselect_b32 s96, 7471104, s96
    s_mov_b32 s83, s96
    buffer_load_dwordx4 v[188:191], v7, s[64:67], s83 offen sc1
    s_waitcnt vmcnt(20)
    s_waitcnt lgkmcnt(6)
    v_mfma_f32_32x32x16_bf16 v[104:119], v[64:67], v[192:195], v[104:119]
    ds_read_b64_tr_b16 v[80:81], v32 offset:14336
    ds_read_b64_tr_b16 v[82:83], v32 offset:15360
    s_waitcnt lgkmcnt(6)
    v_mfma_f32_32x32x16_bf16 v[120:135], v[68:71], v[192:195], v[120:135]
    ds_read_b64_tr_b16 v[84:85], v33 offset:14336
    ds_read_b64_tr_b16 v[86:87], v33 offset:15360
    s_waitcnt lgkmcnt(6)
    v_mfma_f32_32x32x16_bf16 v[136:151], v[72:75], v[192:195], v[136:151]
    ds_read_b64_tr_b16 v[88:89], v34 offset:14336
    ds_read_b64_tr_b16 v[90:91], v34 offset:15360
    s_waitcnt lgkmcnt(6)
    v_mfma_f32_32x32x16_bf16 v[152:167], v[76:79], v[192:195], v[152:167]
    ds_read_b64_tr_b16 v[92:93], v35 offset:14336
    ds_read_b64_tr_b16 v[94:95], v35 offset:15360
    s_add_u32 s96, s96, 66048
    s_cmp_eq_u32 s96, 10113024
    s_cselect_b32 s96, 7471104, s96
    s_mov_b32 s83, s96
    buffer_load_dwordx4 v[192:195], v7, s[64:67], s83 offen sc1
    s_waitcnt lgkmcnt(0)
    v_add_u32 v32, 98304, v30
    v_add_u32 v33, 98304, v31
    v_add_u32 v34, 114688, v30
    v_add_u32 v35, 114688, v31
    s_barrier
    s_waitcnt vmcnt(20)
    v_mfma_f32_32x32x16_bf16 v[104:119], v[80:83], v[196:199], v[104:119]
    ds_read_b64_tr_b16 v[64:65], v32 offset:0
    ds_read_b64_tr_b16 v[66:67], v32 offset:1024
    v_mfma_f32_32x32x16_bf16 v[120:135], v[84:87], v[196:199], v[120:135]
    ds_read_b64_tr_b16 v[68:69], v33 offset:0
    ds_read_b64_tr_b16 v[70:71], v33 offset:1024
    v_mfma_f32_32x32x16_bf16 v[136:151], v[88:91], v[196:199], v[136:151]
    ds_read_b64_tr_b16 v[72:73], v34 offset:0
    ds_read_b64_tr_b16 v[74:75], v34 offset:1024
    v_mfma_f32_32x32x16_bf16 v[152:167], v[92:95], v[196:199], v[152:167]
    ds_read_b64_tr_b16 v[76:77], v35 offset:0
    ds_read_b64_tr_b16 v[78:79], v35 offset:1024
    s_add_u32 s96, s96, 66048
    s_cmp_eq_u32 s96, 10113024
    s_cselect_b32 s96, 7471104, s96
    s_mov_b32 s83, s96
    buffer_load_dwordx4 v[196:199], v7, s[64:67], s83 offen sc1
    s_waitcnt vmcnt(20)
    s_waitcnt lgkmcnt(6)
    v_mfma_f32_32x32x16_bf16 v[104:119], v[64:67], v[200:203], v[104:119]
    ds_read_b64_tr_b16 v[80:81], v32 offset:2048
    ds_read_b64_tr_b16 v[82:83], v32 offset:3072
    s_waitcnt lgkmcnt(6)
    v_mfma_f32_32x32x16_bf16 v[120:135], v[68:71], v[200:203], v[120:135]
    ds_read_b64_tr_b16 v[84:85], v33 offset:2048
    ds_read_b64_tr_b16 v[86:87], v33 offset:3072
    s_waitcnt lgkmcnt(6)
    v_mfma_f32_32x32x16_bf16 v[136:151], v[72:75], v[200:203], v[136:151]
    ds_read_b64_tr_b16 v[88:89], v34 offset:2048
    ds_read_b64_tr_b16 v[90:91], v34 offset:3072
    s_waitcnt lgkmcnt(6)
    v_mfma_f32_32x32x16_bf16 v[152:167], v[76:79], v[200:203], v[152:167]
    ds_read_b64_tr_b16 v[92:93], v35 offset:2048
    ds_read_b64_tr_b16 v[94:95], v35 offset:3072
    s_waitcnt vmcnt(19)
    s_waitcnt lgkmcnt(6)
    v_mfma_f32_32x32x16_bf16 v[104:119], v[80:83], v[204:207], v[104:119]
    ds_read_b64_tr_b16 v[64:65], v32 offset:4096
    ds_read_b64_tr_b16 v[66:67], v32 offset:5120
    s_waitcnt lgkmcnt(6)
    v_mfma_f32_32x32x16_bf16 v[120:135], v[84:87], v[204:207], v[120:135]
    ds_read_b64_tr_b16 v[68:69], v33 offset:4096
    ds_read_b64_tr_b16 v[70:71], v33 offset:5120
    s_waitcnt lgkmcnt(6)
    v_mfma_f32_32x32x16_bf16 v[136:151], v[88:91], v[204:207], v[136:151]
    ds_read_b64_tr_b16 v[72:73], v34 offset:4096
    ds_read_b64_tr_b16 v[74:75], v34 offset:5120
    s_waitcnt lgkmcnt(6)
    v_mfma_f32_32x32x16_bf16 v[152:167], v[92:95], v[204:207], v[152:167]
    ds_read_b64_tr_b16 v[76:77], v35 offset:4096
    ds_read_b64_tr_b16 v[78:79], v35 offset:5120
    s_waitcnt vmcnt(18)
    s_waitcnt lgkmcnt(6)
    v_mfma_f32_32x32x16_bf16 v[104:119], v[64:67], v[208:211], v[104:119]
    ds_read_b64_tr_b16 v[80:81], v32 offset:6144
    ds_read_b64_tr_b16 v[82:83], v32 offset:7168
    s_waitcnt lgkmcnt(6)
    v_mfma_f32_32x32x16_bf16 v[120:135], v[68:71], v[208:211], v[120:135]
    ds_read_b64_tr_b16 v[84:85], v33 offset:6144
    ds_read_b64_tr_b16 v[86:87], v33 offset:7168
    s_waitcnt lgkmcnt(6)
    v_mfma_f32_32x32x16_bf16 v[136:151], v[72:75], v[208:211], v[136:151]
    ds_read_b64_tr_b16 v[88:89], v34 offset:6144
    ds_read_b64_tr_b16 v[90:91], v34 offset:7168
    s_waitcnt lgkmcnt(6)
    v_mfma_f32_32x32x16_bf16 v[152:167], v[76:79], v[208:211], v[152:167]
    ds_read_b64_tr_b16 v[92:93], v35 offset:6144
    ds_read_b64_tr_b16 v[94:95], v35 offset:7168
    s_waitcnt vmcnt(17)
    s_waitcnt lgkmcnt(6)
    v_mfma_f32_32x32x16_bf16 v[104:119], v[80:83], v[212:215], v[104:119]
    ds_read_b64_tr_b16 v[64:65], v32 offset:8192
    ds_read_b64_tr_b16 v[66:67], v32 offset:9216
    s_waitcnt lgkmcnt(6)
    v_mfma_f32_32x32x16_bf16 v[120:135], v[84:87], v[212:215], v[120:135]
    ds_read_b64_tr_b16 v[68:69], v33 offset:8192
    ds_read_b64_tr_b16 v[70:71], v33 offset:9216
    s_waitcnt lgkmcnt(6)
    v_mfma_f32_32x32x16_bf16 v[136:151], v[88:91], v[212:215], v[136:151]
    ds_read_b64_tr_b16 v[72:73], v34 offset:8192
    ds_read_b64_tr_b16 v[74:75], v34 offset:9216
    s_waitcnt lgkmcnt(6)
    v_mfma_f32_32x32x16_bf16 v[152:167], v[92:95], v[212:215], v[152:167]
    ds_read_b64_tr_b16 v[76:77], v35 offset:8192
    ds_read_b64_tr_b16 v[78:79], v35 offset:9216
    s_waitcnt vmcnt(16)
    s_waitcnt lgkmcnt(6)
    v_mfma_f32_32x32x16_bf16 v[104:119], v[64:67], v[216:219], v[104:119]
    ds_read_b64_tr_b16 v[80:81], v32 offset:10240
    ds_read_b64_tr_b16 v[82:83], v32 offset:11264
    s_waitcnt lgkmcnt(6)
    v_mfma_f32_32x32x16_bf16 v[120:135], v[68:71], v[216:219], v[120:135]
    ds_read_b64_tr_b16 v[84:85], v33 offset:10240
    ds_read_b64_tr_b16 v[86:87], v33 offset:11264
    s_waitcnt lgkmcnt(6)
    v_mfma_f32_32x32x16_bf16 v[136:151], v[72:75], v[216:219], v[136:151]
    ds_read_b64_tr_b16 v[88:89], v34 offset:10240
    ds_read_b64_tr_b16 v[90:91], v34 offset:11264
    s_waitcnt lgkmcnt(6)
    v_mfma_f32_32x32x16_bf16 v[152:167], v[76:79], v[216:219], v[152:167]
    ds_read_b64_tr_b16 v[92:93], v35 offset:10240
    ds_read_b64_tr_b16 v[94:95], v35 offset:11264
    s_waitcnt vmcnt(15)
    s_waitcnt lgkmcnt(6)
    v_mfma_f32_32x32x16_bf16 v[104:119], v[80:83], v[36:39], v[104:119]
    ds_read_b64_tr_b16 v[64:65], v32 offset:12288
    ds_read_b64_tr_b16 v[66:67], v32 offset:13312
    s_waitcnt lgkmcnt(6)
    v_mfma_f32_32x32x16_bf16 v[120:135], v[84:87], v[36:39], v[120:135]
    ds_read_b64_tr_b16 v[68:69], v33 offset:12288
    ds_read_b64_tr_b16 v[70:71], v33 offset:13312
    s_waitcnt lgkmcnt(6)
    v_mfma_f32_32x32x16_bf16 v[136:151], v[88:91], v[36:39], v[136:151]
    ds_read_b64_tr_b16 v[72:73], v34 offset:12288
    ds_read_b64_tr_b16 v[74:75], v34 offset:13312
    s_waitcnt lgkmcnt(6)
    v_mfma_f32_32x32x16_bf16 v[152:167], v[92:95], v[36:39], v[152:167]
    ds_read_b64_tr_b16 v[76:77], v35 offset:12288
    ds_read_b64_tr_b16 v[78:79], v35 offset:13312
    s_waitcnt vmcnt(14)
    s_waitcnt lgkmcnt(6)
    v_mfma_f32_32x32x16_bf16 v[104:119], v[64:67], v[40:43], v[104:119]
    ds_read_b64_tr_b16 v[80:81], v32 offset:14336
    ds_read_b64_tr_b16 v[82:83], v32 offset:15360
    s_waitcnt lgkmcnt(6)
    v_mfma_f32_32x32x16_bf16 v[120:135], v[68:71], v[40:43], v[120:135]
    ds_read_b64_tr_b16 v[84:85], v33 offset:14336
    ds_read_b64_tr_b16 v[86:87], v33 offset:15360
    s_waitcnt lgkmcnt(6)
    v_mfma_f32_32x32x16_bf16 v[136:151], v[72:75], v[40:43], v[136:151]
    ds_read_b64_tr_b16 v[88:89], v34 offset:14336
    ds_read_b64_tr_b16 v[90:91], v34 offset:15360
    s_waitcnt lgkmcnt(6)
    v_mfma_f32_32x32x16_bf16 v[152:167], v[76:79], v[40:43], v[152:167]
    ds_read_b64_tr_b16 v[92:93], v35 offset:14336
    ds_read_b64_tr_b16 v[94:95], v35 offset:15360
    s_waitcnt lgkmcnt(0)
    v_add_u32 v32, 131072, v30
    v_add_u32 v33, 131072, v31
    v_add_u32 v34, 147456, v30
    v_add_u32 v35, 147456, v31
    s_barrier
    s_waitcnt vmcnt(13)
    v_mfma_f32_32x32x16_bf16 v[104:119], v[80:83], v[44:47], v[104:119]
    ds_read_b64_tr_b16 v[64:65], v32 offset:0
    ds_read_b64_tr_b16 v[66:67], v32 offset:1024
    v_mfma_f32_32x32x16_bf16 v[120:135], v[84:87], v[44:47], v[120:135]
    ds_read_b64_tr_b16 v[68:69], v33 offset:0
    ds_read_b64_tr_b16 v[70:71], v33 offset:1024
    v_mfma_f32_32x32x16_bf16 v[136:151], v[88:91], v[44:47], v[136:151]
    ds_read_b64_tr_b16 v[72:73], v34 offset:0
    ds_read_b64_tr_b16 v[74:75], v34 offset:1024
    v_mfma_f32_32x32x16_bf16 v[152:167], v[92:95], v[44:47], v[152:167]
    ds_read_b64_tr_b16 v[76:77], v35 offset:0
    ds_read_b64_tr_b16 v[78:79], v35 offset:1024
    s_waitcnt vmcnt(12)
    s_waitcnt lgkmcnt(6)
    v_mfma_f32_32x32x16_bf16 v[104:119], v[64:67], v[96:99], v[104:119]
    ds_read_b64_tr_b16 v[80:81], v32 offset:2048
    ds_read_b64_tr_b16 v[82:83], v32 offset:3072
    s_waitcnt lgkmcnt(6)
    v_mfma_f32_32x32x16_bf16 v[120:135], v[68:71], v[96:99], v[120:135]
    ds_read_b64_tr_b16 v[84:85], v33 offset:2048
    ds_read_b64_tr_b16 v[86:87], v33 offset:3072
    s_waitcnt lgkmcnt(6)
    v_mfma_f32_32x32x16_bf16 v[136:151], v[72:75], v[96:99], v[136:151]
    ds_read_b64_tr_b16 v[88:89], v34 offset:2048
    ds_read_b64_tr_b16 v[90:91], v34 offset:3072
    s_waitcnt lgkmcnt(6)
    v_mfma_f32_32x32x16_bf16 v[152:167], v[76:79], v[96:99], v[152:167]
    ds_read_b64_tr_b16 v[92:93], v35 offset:2048
    ds_read_b64_tr_b16 v[94:95], v35 offset:3072
    s_waitcnt vmcnt(5)
    v_pk_add_f32 v[12:13], v[12:13], v[14:15]
    v_pk_add_f32 v[16:17], v[16:17], v[18:19]
    v_pk_add_f32 v[12:13], v[12:13], v[20:21]
    v_pk_add_f32 v[12:13], v[12:13], v[16:17]
    v_mov_b32 v14, v12
    v_mov_b32 v15, v13
    s_waitcnt lgkmcnt(6)
    v_mfma_f32_32x32x16_bf16 v[104:119], v[80:83], v[100:103], v[104:119]
    ds_read_b64_tr_b16 v[64:65], v32 offset:4096
    ds_read_b64_tr_b16 v[66:67], v32 offset:5120
    s_waitcnt lgkmcnt(6)
    v_mfma_f32_32x32x16_bf16 v[120:135], v[84:87], v[100:103], v[120:135]
    ds_read_b64_tr_b16 v[68:69], v33 offset:4096
    ds_read_b64_tr_b16 v[70:71], v33 offset:5120
    s_waitcnt lgkmcnt(6)
    v_mfma_f32_32x32x16_bf16 v[136:151], v[88:91], v[100:103], v[136:151]
    ds_read_b64_tr_b16 v[72:73], v34 offset:4096
    ds_read_b64_tr_b16 v[74:75], v34 offset:5120
    s_waitcnt lgkmcnt(6)
    v_mfma_f32_32x32x16_bf16 v[152:167], v[92:95], v[100:103], v[152:167]
    ds_read_b64_tr_b16 v[76:77], v35 offset:4096
    ds_read_b64_tr_b16 v[78:79], v35 offset:5120
    v_permlane32_swap_b32 v12, v14
    v_permlane32_swap_b32 v13, v15
    v_pk_add_f32 v[12:13], v[12:13], v[14:15]
    v_mul_f32 v12, 0x3acccccd, v12
    v_mul_f32 v13, 0x3acccccd, v13
    v_fma_f32 v13, -v12, v12, v13
    v_max_f32_e64 v13, 0, v13
    v_add_f32 v13, 0x3727c5ac, v13
    v_rsq_f32 v13, v13
    s_waitcnt lgkmcnt(6)
    v_mfma_f32_32x32x16_bf16 v[104:119], v[64:67], v[52:55], v[104:119]
    ds_read_b64_tr_b16 v[80:81], v32 offset:6144
    ds_read_b64_tr_b16 v[82:83], v32 offset:7168
    s_waitcnt lgkmcnt(6)
    v_mfma_f32_32x32x16_bf16 v[120:135], v[68:71], v[52:55], v[120:135]
    ds_read_b64_tr_b16 v[84:85], v33 offset:6144
    ds_read_b64_tr_b16 v[86:87], v33 offset:7168
    s_waitcnt lgkmcnt(6)
    v_mfma_f32_32x32x16_bf16 v[136:151], v[72:75], v[52:55], v[136:151]
    ds_read_b64_tr_b16 v[88:89], v34 offset:6144
    ds_read_b64_tr_b16 v[90:91], v34 offset:7168
    s_waitcnt lgkmcnt(6)
    v_mfma_f32_32x32x16_bf16 v[152:167], v[76:79], v[52:55], v[152:167]
    ds_read_b64_tr_b16 v[92:93], v35 offset:6144
    ds_read_b64_tr_b16 v[94:95], v35 offset:7168
    v_sub_f32 v3, 0, v12
    v_cmp_gt_u32 vcc, 32, v1
    s_nop 1
    v_cndmask_b32_e64 v3, 0, v3, vcc
    v_cvt_pk_bf16_f32 v16, v3, v3
    v_and_b32 v4, 0xffff0000, v16
    v_sub_f32_e64 v4, v3, v4
    v_cvt_pk_bf16_f32 v17, v4, 0
    v_mov_b32 v18, 0
    v_mov_b32 v19, 0
    s_waitcnt vmcnt(4)
    s_waitcnt lgkmcnt(6)
    v_mfma_f32_32x32x16_bf16 v[104:119], v[80:83], v[56:59], v[104:119]
    ds_read_b64_tr_b16 v[64:65], v32 offset:8192
    ds_read_b64_tr_b16 v[66:67], v32 offset:9216
    s_waitcnt lgkmcnt(6)
    v_mfma_f32_32x32x16_bf16 v[120:135], v[84:87], v[56:59], v[120:135]
    ds_read_b64_tr_b16 v[68:69], v33 offset:8192
    ds_read_b64_tr_b16 v[70:71], v33 offset:9216
    s_waitcnt lgkmcnt(6)
    v_mfma_f32_32x32x16_bf16 v[136:151], v[88:91], v[56:59], v[136:151]
    ds_read_b64_tr_b16 v[72:73], v34 offset:8192
    ds_read_b64_tr_b16 v[74:75], v34 offset:9216
    s_waitcnt lgkmcnt(6)
    v_mfma_f32_32x32x16_bf16 v[152:167], v[92:95], v[56:59], v[152:167]
    ds_read_b64_tr_b16 v[76:77], v35 offset:8192
    ds_read_b64_tr_b16 v[78:79], v35 offset:9216
    v_mul_f32 v24, 0xc0135761, v13
    v_mul_f32 v26, v13, v13
    v_rcp_f32 v28, v13
    v_mul_f32 v26, v26, v24
    v_mul_f32 v26, 0x3d372713, v26
    v_mov_b32 v25, v24
    v_mov_b32 v27, v26
    v_mov_b32 v29, v28
    s_waitcnt vmcnt(3)
    s_waitcnt lgkmcnt(6)
    v_mfma_f32_32x32x16_bf16 v[104:119], v[64:67], v[184:187], v[104:119]
    ds_read_b64_tr_b16 v[80:81], v32 offset:10240
    ds_read_b64_tr_b16 v[82:83], v32 offset:11264
    s_waitcnt lgkmcnt(6)
    v_mfma_f32_32x32x16_bf16 v[120:135], v[68:71], v[184:187], v[120:135]
    ds_read_b64_tr_b16 v[84:85], v33 offset:10240
    ds_read_b64_tr_b16 v[86:87], v33 offset:11264
    s_waitcnt lgkmcnt(6)
    v_mfma_f32_32x32x16_bf16 v[136:151], v[72:75], v[184:187], v[136:151]
    ds_read_b64_tr_b16 v[88:89], v34 offset:10240
    ds_read_b64_tr_b16 v[90:91], v34 offset:11264
    s_waitcnt lgkmcnt(6)
    v_mfma_f32_32x32x16_bf16 v[152:167], v[76:79], v[184:187], v[152:167]
    ds_read_b64_tr_b16 v[92:93], v35 offset:10240
    ds_read_b64_tr_b16 v[94:95], v35 offset:11264
    v_mfma_f32_32x32x16_bf16 v[104:119], v[168:171], v[16:19], v[104:119]
    v_mfma_f32_32x32x16_bf16 v[120:135], v[172:175], v[16:19], v[120:135]
    v_mfma_f32_32x32x16_bf16 v[136:151], v[176:179], v[16:19], v[136:151]
    v_mfma_f32_32x32x16_bf16 v[152:167], v[180:183], v[16:19], v[152:167]
    s_waitcnt vmcnt(2)
    s_waitcnt lgkmcnt(6)
    v_mfma_f32_32x32x16_bf16 v[104:119], v[80:83], v[188:191], v[104:119]
    ds_read_b64_tr_b16 v[64:65], v32 offset:12288
    ds_read_b64_tr_b16 v[66:67], v32 offset:13312
    s_waitcnt lgkmcnt(6)
    v_mfma_f32_32x32x16_bf16 v[120:135], v[84:87], v[188:191], v[120:135]
    ds_read_b64_tr_b16 v[68:69], v33 offset:12288
    ds_read_b64_tr_b16 v[70:71], v33 offset:13312
    s_waitcnt lgkmcnt(6)
    v_mfma_f32_32x32x16_bf16 v[136:151], v[88:91], v[188:191], v[136:151]
    ds_read_b64_tr_b16 v[72:73], v34 offset:12288
    ds_read_b64_tr_b16 v[74:75], v34 offset:13312
    s_waitcnt lgkmcnt(6)
    v_mfma_f32_32x32x16_bf16 v[152:167], v[92:95], v[188:191], v[152:167]
    ds_read_b64_tr_b16 v[76:77], v35 offset:12288
    ds_read_b64_tr_b16 v[78:79], v35 offset:13312
    s_mul_i32 s85, s11, 528384
    s_add_u32 s85, s85, 15532032
    s_lshl_b32 s86, s79, 2
    s_add_u32 s86, s86, s72
    s_mul_i32 s86, s86, 2048
    s_add_u32 s86, s86, 1441792
    s_lshl_b32 s8, s11, 7
    s_add_u32 s8, s8, s86
    s_waitcnt vmcnt(1)
    s_waitcnt lgkmcnt(6)
    v_mfma_f32_32x32x16_bf16 v[104:119], v[64:67], v[192:195], v[104:119]
    ds_read_b64_tr_b16 v[80:81], v32 offset:14336
    ds_read_b64_tr_b16 v[82:83], v32 offset:15360
    s_waitcnt lgkmcnt(6)
    v_mfma_f32_32x32x16_bf16 v[120:135], v[68:71], v[192:195], v[120:135]
    ds_read_b64_tr_b16 v[84:85], v33 offset:14336
    ds_read_b64_tr_b16 v[86:87], v33 offset:15360
    s_waitcnt lgkmcnt(6)
    v_mfma_f32_32x32x16_bf16 v[136:151], v[72:75], v[192:195], v[136:151]
    ds_read_b64_tr_b16 v[88:89], v34 offset:14336
    ds_read_b64_tr_b16 v[90:91], v34 offset:15360
    s_waitcnt lgkmcnt(6)
    v_mfma_f32_32x32x16_bf16 v[152:167], v[76:79], v[192:195], v[152:167]
    ds_read_b64_tr_b16 v[92:93], v35 offset:14336
    ds_read_b64_tr_b16 v[94:95], v35 offset:15360
    s_waitcnt lgkmcnt(0)
E3B:
    s_barrier
    s_waitcnt vmcnt(0)
    v_mfma_f32_32x32x16_bf16 v[104:119], v[80:83], v[196:199], v[104:119]
    v_mfma_f32_32x32x16_bf16 v[120:135], v[84:87], v[196:199], v[120:135]
    v_mfma_f32_32x32x16_bf16 v[136:151], v[88:91], v[196:199], v[136:151]
    v_mfma_f32_32x32x16_bf16 v[152:167], v[92:95], v[196:199], v[152:167]
    s_nop 8
    v_pk_mul_f32 v[12:13], v[104:105], v[104:105]
    v_pk_mul_f32 v[14:15], v[106:107], v[106:107]
    v_pk_fma_f32 v[12:13], v[12:13], v[26:27], v[24:25]
    v_pk_fma_f32 v[14:15], v[14:15], v[26:27], v[24:25]
    v_pk_mul_f32 v[12:13], v[12:13], v[104:105]
    v_pk_mul_f32 v[14:15], v[14:15], v[106:107]
    v_exp_f32 v12, v12
    v_exp_f32 v13, v13
    v_exp_f32 v14, v14
    v_exp_f32 v15, v15
    v_pk_fma_f32 v[12:13], v[12:13], v[28:29], v[28:29]
    v_pk_fma_f32 v[14:15], v[14:15], v[28:29], v[28:29]
    v_rcp_f32 v12, v12
    v_rcp_f32 v13, v13
    v_rcp_f32 v14, v14
    v_rcp_f32 v15, v15
    v_pk_mul_f32 v[104:105], v[104:105], v[12:13]
    v_pk_mul_f32 v[106:107], v[106:107], v[14:15]
    v_cvt_pk_bf16_f32 v184, v104, v105
    v_cvt_pk_bf16_f32 v185, v106, v107
    v_pk_mul_f32 v[12:13], v[108:109], v[108:109]
    v_pk_mul_f32 v[14:15], v[110:111], v[110:111]
    v_pk_fma_f32 v[12:13], v[12:13], v[26:27], v[24:25]
    v_pk_fma_f32 v[14:15], v[14:15], v[26:27], v[24:25]
    v_pk_mul_f32 v[12:13], v[12:13], v[108:109]
    v_pk_mul_f32 v[14:15], v[14:15], v[110:111]
    v_exp_f32 v12, v12
    v_exp_f32 v13, v13
    v_exp_f32 v14, v14
    v_exp_f32 v15, v15
    v_pk_fma_f32 v[12:13], v[12:13], v[28:29], v[28:29]
    v_pk_fma_f32 v[14:15], v[14:15], v[28:29], v[28:29]
    v_rcp_f32 v12, v12
    v_rcp_f32 v13, v13
    v_rcp_f32 v14, v14
    v_rcp_f32 v15, v15
    v_pk_mul_f32 v[108:109], v[108:109], v[12:13]
    v_pk_mul_f32 v[110:111], v[110:111], v[14:15]
    v_cvt_pk_bf16_f32 v186, v108, v109
    v_cvt_pk_bf16_f32 v187, v110, v111
    v_pk_mul_f32 v[12:13], v[112:113], v[112:113]
    v_pk_mul_f32 v[14:15], v[114:115], v[114:115]
    v_pk_fma_f32 v[12:13], v[12:13], v[26:27], v[24:25]
    v_pk_fma_f32 v[14:15], v[14:15], v[26:27], v[24:25]
    v_pk_mul_f32 v[12:13], v[12:13], v[112:113]
    v_pk_mul_f32 v[14:15], v[14:15], v[114:115]
    v_exp_f32 v12, v12
    v_exp_f32 v13, v13
    v_exp_f32 v14, v14
    v_exp_f32 v15, v15
    v_pk_fma_f32 v[12:13], v[12:13], v[28:29], v[28:29]
    v_pk_fma_f32 v[14:15], v[14:15], v[28:29], v[28:29]
    v_rcp_f32 v12, v12
    v_rcp_f32 v13, v13
    v_rcp_f32 v14, v14
    v_rcp_f32 v15, v15
    v_pk_mul_f32 v[112:113], v[112:113], v[12:13]
    v_pk_mul_f32 v[114:115], v[114:115], v[14:15]
    v_cvt_pk_bf16_f32 v188, v112, v113
    v_cvt_pk_bf16_f32 v189, v114, v115
    v_pk_mul_f32 v[12:13], v[116:117], v[116:117]
    v_pk_mul_f32 v[14:15], v[118:119], v[118:119]
    v_pk_fma_f32 v[12:13], v[12:13], v[26:27], v[24:25]
    v_pk_fma_f32 v[14:15], v[14:15], v[26:27], v[24:25]
    v_pk_mul_f32 v[12:13], v[12:13], v[116:117]
    v_pk_mul_f32 v[14:15], v[14:15], v[118:119]
    v_exp_f32 v12, v12
    v_exp_f32 v13, v13
    v_exp_f32 v14, v14
    v_exp_f32 v15, v15
    v_pk_fma_f32 v[12:13], v[12:13], v[28:29], v[28:29]
    v_pk_fma_f32 v[14:15], v[14:15], v[28:29], v[28:29]
    v_rcp_f32 v12, v12
    v_rcp_f32 v13, v13
    v_rcp_f32 v14, v14
    v_rcp_f32 v15, v15
    v_pk_mul_f32 v[116:117], v[116:117], v[12:13]
    v_pk_mul_f32 v[118:119], v[118:119], v[14:15]
    v_cvt_pk_bf16_f32 v190, v116, v117
    v_cvt_pk_bf16_f32 v191, v118, v119
    s_add_u32 s83, s85, 0
    s_add_u32 s84, s85, 66048
    buffer_store_dwordx4 v[184:187], v7, s[64:67], s83 offen sc1
    buffer_store_dwordx4 v[188:191], v7, s[64:67], s84 offen sc1
    s_nop 0
    v_pk_mul_f32 v[12:13], v[120:121], v[120:121]
    v_pk_mul_f32 v[14:15], v[122:123], v[122:123]
    v_pk_fma_f32 v[12:13], v[12:13], v[26:27], v[24:25]
    v_pk_fma_f32 v[14:15], v[14:15], v[26:27], v[24:25]
    v_pk_mul_f32 v[12:13], v[12:13], v[120:121]
    v_pk_mul_f32 v[14:15], v[14:15], v[122:123]
    v_exp_f32 v12, v12
    v_exp_f32 v13, v13
    v_exp_f32 v14, v14
    v_exp_f32 v15, v15
    v_pk_fma_f32 v[12:13], v[12:13], v[28:29], v[28:29]
    v_pk_fma_f32 v[14:15], v[14:15], v[28:29], v[28:29]
    v_rcp_f32 v12, v12
    v_rcp_f32 v13, v13
    v_rcp_f32 v14, v14
    v_rcp_f32 v15, v15
    v_pk_mul_f32 v[120:121], v[120:121], v[12:13]
    v_pk_mul_f32 v[122:123], v[122:123], v[14:15]
    v_cvt_pk_bf16_f32 v192, v120, v121
    v_cvt_pk_bf16_f32 v193, v122, v123
    v_pk_mul_f32 v[12:13], v[124:125], v[124:125]
    v_pk_mul_f32 v[14:15], v[126:127], v[126:127]
    v_pk_fma_f32 v[12:13], v[12:13], v[26:27], v[24:25]
    v_pk_fma_f32 v[14:15], v[14:15], v[26:27], v[24:25]
    v_pk_mul_f32 v[12:13], v[12:13], v[124:125]
    v_pk_mul_f32 v[14:15], v[14:15], v[126:127]
    v_exp_f32 v12, v12
    v_exp_f32 v13, v13
    v_exp_f32 v14, v14
    v_exp_f32 v15, v15
    v_pk_fma_f32 v[12:13], v[12:13], v[28:29], v[28:29]
    v_pk_fma_f32 v[14:15], v[14:15], v[28:29], v[28:29]
    v_rcp_f32 v12, v12
    v_rcp_f32 v13, v13
    v_rcp_f32 v14, v14
    v_rcp_f32 v15, v15
    v_pk_mul_f32 v[124:125], v[124:125], v[12:13]
    v_pk_mul_f32 v[126:127], v[126:127], v[14:15]
    v_cvt_pk_bf16_f32 v194, v124, v125
    v_cvt_pk_bf16_f32 v195, v126, v127
    v_pk_mul_f32 v[12:13], v[128:129], v[128:129]
    v_pk_mul_f32 v[14:15], v[130:131], v[130:131]
    v_pk_fma_f32 v[12:13], v[12:13], v[26:27], v[24:25]
    v_pk_fma_f32 v[14:15], v[14:15], v[26:27], v[24:25]
    v_pk_mul_f32 v[12:13], v[12:13], v[128:129]
    v_pk_mul_f32 v[14:15], v[14:15], v[130:131]
    v_exp_f32 v12, v12
    v_exp_f32 v13, v13
    v_exp_f32 v14, v14
    v_exp_f32 v15, v15
    v_pk_fma_f32 v[12:13], v[12:13], v[28:29], v[28:29]
    v_pk_fma_f32 v[14:15], v[14:15], v[28:29], v[28:29]
    v_rcp_f32 v12, v12
    v_rcp_f32 v13, v13
    v_rcp_f32 v14, v14
    v_rcp_f32 v15, v15
    v_pk_mul_f32 v[128:129], v[128:129], v[12:13]
    v_pk_mul_f32 v[130:131], v[130:131], v[14:15]
    v_cvt_pk_bf16_f32 v196, v128, v129
    v_cvt_pk_bf16_f32 v197, v130, v131
    v_pk_mul_f32 v[12:13], v[132:133], v[132:133]
    v_pk_mul_f32 v[14:15], v[134:135], v[134:135]
    v_pk_fma_f32 v[12:13], v[12:13], v[26:27], v[24:25]
    v_pk_fma_f32 v[14:15], v[14:15], v[26:27], v[24:25]
    v_pk_mul_f32 v[12:13], v[12:13], v[132:133]
    v_pk_mul_f32 v[14:15], v[14:15], v[134:135]
    v_exp_f32 v12, v12
    v_exp_f32 v13, v13
    v_exp_f32 v14, v14
    v_exp_f32 v15, v15
    v_pk_fma_f32 v[12:13], v[12:13], v[28:29], v[28:29]
    v_pk_fma_f32 v[14:15], v[14:15], v[28:29], v[28:29]
    v_rcp_f32 v12, v12
    v_rcp_f32 v13, v13
    v_rcp_f32 v14, v14
    v_rcp_f32 v15, v15
    v_pk_mul_f32 v[132:133], v[132:133], v[12:13]
    v_pk_mul_f32 v[134:135], v[134:135], v[14:15]
    v_cvt_pk_bf16_f32 v198, v132, v133
    v_cvt_pk_bf16_f32 v199, v134, v135
    s_add_u32 s83, s85, 132096
    s_add_u32 s84, s85, 198144
    buffer_store_dwordx4 v[192:195], v7, s[64:67], s83 offen sc1
    buffer_store_dwordx4 v[196:199], v7, s[64:67], s84 offen sc1
    v_pk_mul_f32 v[12:13], v[136:137], v[136:137]
    v_pk_mul_f32 v[14:15], v[138:139], v[138:139]
    v_pk_fma_f32 v[12:13], v[12:13], v[26:27], v[24:25]
    v_pk_fma_f32 v[14:15], v[14:15], v[26:27], v[24:25]
    v_pk_mul_f32 v[12:13], v[12:13], v[136:137]
    v_pk_mul_f32 v[14:15], v[14:15], v[138:139]
    v_exp_f32 v12, v12
    v_exp_f32 v13, v13
    v_exp_f32 v14, v14
    v_exp_f32 v15, v15
    v_pk_fma_f32 v[12:13], v[12:13], v[28:29], v[28:29]
    v_pk_fma_f32 v[14:15], v[14:15], v[28:29], v[28:29]
    v_rcp_f32 v12, v12
    v_rcp_f32 v13, v13
    v_rcp_f32 v14, v14
    v_rcp_f32 v15, v15
    v_pk_mul_f32 v[136:137], v[136:137], v[12:13]
    v_pk_mul_f32 v[138:139], v[138:139], v[14:15]
    v_cvt_pk_bf16_f32 v200, v136, v137
    v_cvt_pk_bf16_f32 v201, v138, v139
    v_pk_mul_f32 v[12:13], v[140:141], v[140:141]
    v_pk_mul_f32 v[14:15], v[142:143], v[142:143]
    v_pk_fma_f32 v[12:13], v[12:13], v[26:27], v[24:25]
    v_pk_fma_f32 v[14:15], v[14:15], v[26:27], v[24:25]
    v_pk_mul_f32 v[12:13], v[12:13], v[140:141]
    v_pk_mul_f32 v[14:15], v[14:15], v[142:143]
    v_exp_f32 v12, v12
    v_exp_f32 v13, v13
    v_exp_f32 v14, v14
    v_exp_f32 v15, v15
    v_pk_fma_f32 v[12:13], v[12:13], v[28:29], v[28:29]
    v_pk_fma_f32 v[14:15], v[14:15], v[28:29], v[28:29]
    v_rcp_f32 v12, v12
    v_rcp_f32 v13, v13
    v_rcp_f32 v14, v14
    v_rcp_f32 v15, v15
    v_pk_mul_f32 v[140:141], v[140:141], v[12:13]
    v_pk_mul_f32 v[142:143], v[142:143], v[14:15]
    v_cvt_pk_bf16_f32 v202, v140, v141
    v_cvt_pk_bf16_f32 v203, v142, v143
    v_pk_mul_f32 v[12:13], v[144:145], v[144:145]
    v_pk_mul_f32 v[14:15], v[146:147], v[146:147]
    v_pk_fma_f32 v[12:13], v[12:13], v[26:27], v[24:25]
    v_pk_fma_f32 v[14:15], v[14:15], v[26:27], v[24:25]
    v_pk_mul_f32 v[12:13], v[12:13], v[144:145]
    v_pk_mul_f32 v[14:15], v[14:15], v[146:147]
    v_exp_f32 v12, v12
    v_exp_f32 v13, v13
    v_exp_f32 v14, v14
    v_exp_f32 v15, v15
    v_pk_fma_f32 v[12:13], v[12:13], v[28:29], v[28:29]
    v_pk_fma_f32 v[14:15], v[14:15], v[28:29], v[28:29]
    v_rcp_f32 v12, v12
    v_rcp_f32 v13, v13
    v_rcp_f32 v14, v14
    v_rcp_f32 v15, v15
    v_pk_mul_f32 v[144:145], v[144:145], v[12:13]
    v_pk_mul_f32 v[146:147], v[146:147], v[14:15]
    v_cvt_pk_bf16_f32 v204, v144, v145
    v_cvt_pk_bf16_f32 v205, v146, v147
    v_pk_mul_f32 v[12:13], v[148:149], v[148:149]
    v_pk_mul_f32 v[14:15], v[150:151], v[150:151]
    v_pk_fma_f32 v[12:13], v[12:13], v[26:27], v[24:25]
    v_pk_fma_f32 v[14:15], v[14:15], v[26:27], v[24:25]
    v_pk_mul_f32 v[12:13], v[12:13], v[148:149]
    v_pk_mul_f32 v[14:15], v[14:15], v[150:151]
    v_exp_f32 v12, v12
    v_exp_f32 v13, v13
    v_exp_f32 v14, v14
    v_exp_f32 v15, v15
    v_pk_fma_f32 v[12:13], v[12:13], v[28:29], v[28:29]
    v_pk_fma_f32 v[14:15], v[14:15], v[28:29], v[28:29]
    v_rcp_f32 v12, v12
    v_rcp_f32 v13, v13
    v_rcp_f32 v14, v14
    v_rcp_f32 v15, v15
    v_pk_mul_f32 v[148:149], v[148:149], v[12:13]
    v_pk_mul_f32 v[150:151], v[150:151], v[14:15]
    v_cvt_pk_bf16_f32 v206, v148, v149
    v_cvt_pk_bf16_f32 v207, v150, v151
    s_add_u32 s83, s85, 264192
    s_add_u32 s84, s85, 330240
    buffer_store_dwordx4 v[200:203], v7, s[64:67], s83 offen sc1
    buffer_store_dwordx4 v[204:207], v7, s[64:67], s84 offen sc1
    v_pk_mul_f32 v[12:13], v[152:153], v[152:153]
    v_pk_mul_f32 v[14:15], v[154:155], v[154:155]
    v_pk_fma_f32 v[12:13], v[12:13], v[26:27], v[24:25]
    v_pk_fma_f32 v[14:15], v[14:15], v[26:27], v[24:25]
    v_pk_mul_f32 v[12:13], v[12:13], v[152:153]
    v_pk_mul_f32 v[14:15], v[14:15], v[154:155]
    v_exp_f32 v12, v12
    v_exp_f32 v13, v13
    v_exp_f32 v14, v14
    v_exp_f32 v15, v15
    v_pk_fma_f32 v[12:13], v[12:13], v[28:29], v[28:29]
    v_pk_fma_f32 v[14:15], v[14:15], v[28:29], v[28:29]
    v_rcp_f32 v12, v12
    v_rcp_f32 v13, v13
    v_rcp_f32 v14, v14
    v_rcp_f32 v15, v15
    v_pk_mul_f32 v[152:153], v[152:153], v[12:13]
    v_pk_mul_f32 v[154:155], v[154:155], v[14:15]
    v_cvt_pk_bf16_f32 v208, v152, v153
    v_cvt_pk_bf16_f32 v209, v154, v155
    v_pk_mul_f32 v[12:13], v[156:157], v[156:157]
    v_pk_mul_f32 v[14:15], v[158:159], v[158:159]
    v_pk_fma_f32 v[12:13], v[12:13], v[26:27], v[24:25]
    v_pk_fma_f32 v[14:15], v[14:15], v[26:27], v[24:25]
    v_pk_mul_f32 v[12:13], v[12:13], v[156:157]
    v_pk_mul_f32 v[14:15], v[14:15], v[158:159]
    v_exp_f32 v12, v12
    v_exp_f32 v13, v13
    v_exp_f32 v14, v14
    v_exp_f32 v15, v15
    v_pk_fma_f32 v[12:13], v[12:13], v[28:29], v[28:29]
    v_pk_fma_f32 v[14:15], v[14:15], v[28:29], v[28:29]
    v_rcp_f32 v12, v12
    v_rcp_f32 v13, v13
    v_rcp_f32 v14, v14
    v_rcp_f32 v15, v15
    v_pk_mul_f32 v[156:157], v[156:157], v[12:13]
    v_pk_mul_f32 v[158:159], v[158:159], v[14:15]
    v_cvt_pk_bf16_f32 v210, v156, v157
    v_cvt_pk_bf16_f32 v211, v158, v159
    v_pk_mul_f32 v[12:13], v[160:161], v[160:161]
    v_pk_mul_f32 v[14:15], v[162:163], v[162:163]
    v_pk_fma_f32 v[12:13], v[12:13], v[26:27], v[24:25]
    v_pk_fma_f32 v[14:15], v[14:15], v[26:27], v[24:25]
    v_pk_mul_f32 v[12:13], v[12:13], v[160:161]
    v_pk_mul_f32 v[14:15], v[14:15], v[162:163]
    v_exp_f32 v12, v12
    v_exp_f32 v13, v13
    v_exp_f32 v14, v14
    v_exp_f32 v15, v15
    v_pk_fma_f32 v[12:13], v[12:13], v[28:29], v[28:29]
    v_pk_fma_f32 v[14:15], v[14:15], v[28:29], v[28:29]
    v_rcp_f32 v12, v12
    v_rcp_f32 v13, v13
    v_rcp_f32 v14, v14
    v_rcp_f32 v15, v15
    v_pk_mul_f32 v[160:161], v[160:161], v[12:13]
    v_pk_mul_f32 v[162:163], v[162:163], v[14:15]
    v_cvt_pk_bf16_f32 v212, v160, v161
    v_cvt_pk_bf16_f32 v213, v162, v163
    v_pk_mul_f32 v[12:13], v[164:165], v[164:165]
    v_pk_mul_f32 v[14:15], v[166:167], v[166:167]
    v_pk_fma_f32 v[12:13], v[12:13], v[26:27], v[24:25]
    v_pk_fma_f32 v[14:15], v[14:15], v[26:27], v[24:25]
    v_pk_mul_f32 v[12:13], v[12:13], v[164:165]
    v_pk_mul_f32 v[14:15], v[14:15], v[166:167]
    v_exp_f32 v12, v12
    v_exp_f32 v13, v13
    v_exp_f32 v14, v14
    v_exp_f32 v15, v15
    v_pk_fma_f32 v[12:13], v[12:13], v[28:29], v[28:29]
    v_pk_fma_f32 v[14:15], v[14:15], v[28:29], v[28:29]
    v_rcp_f32 v12, v12
    v_rcp_f32 v13, v13
    v_rcp_f32 v14, v14
    v_rcp_f32 v15, v15
    v_pk_mul_f32 v[164:165], v[164:165], v[12:13]
    v_pk_mul_f32 v[166:167], v[166:167], v[14:15]
    v_cvt_pk_bf16_f32 v214, v164, v165
    v_cvt_pk_bf16_f32 v215, v166, v167
    s_add_u32 s83, s85, 396288
    s_add_u32 s84, s85, 462336
    buffer_store_dwordx4 v[208:211], v7, s[64:67], s83 offen sc1
    buffer_store_dwordx4 v[212:215], v7, s[64:67], s84 offen sc1
    v_min_u32_e64 v3, 9, v1
    v_lshl_add_u32 v8, v3, 7, s86
    v_and_b32_e64 v3, 1, v1
    v_lshl_add_u32 v62, v3, 7, s86
    v_add_u32 v62, 1280, v62
    s_mul_i32 s96, s80, 528384
    s_add_u32 s96, s96, 15532032
    s_mov_b32 s92, 0
    v_add_u32 v32, 0, v30
    v_add_u32_e64 v33, 0, v31
    ds_read_b64_tr_b16 v[64:65], v32 offset:0
    ds_read_b64_tr_b16 v[66:67], v32 offset:1024
    ds_read_b64_tr_b16 v[68:69], v33 offset:0
    ds_read_b64_tr_b16 v[70:71], v33 offset:1024
    ds_read_b64_tr_b16 v[72:73], v32 offset:2048
    ds_read_b64_tr_b16 v[74:75], v32 offset:3072
    ds_read_b64_tr_b16 v[76:77], v33 offset:2048
    ds_read_b64_tr_b16 v[78:79], v33 offset:3072
    s_waitcnt lgkmcnt(6)
    v_mfma_f32_32x32x16_bf16 v[104:119], v[64:67], v[184:187], 0
    ds_read_b64_tr_b16 v[80:81], v32 offset:4096
    ds_read_b64_tr_b16 v[82:83], v32 offset:5120
    s_waitcnt lgkmcnt(6)
    v_mfma_f32_32x32x16_bf16 v[120:135], v[68:71], v[184:187], 0
    ds_read_b64_tr_b16 v[84:85], v33 offset:4096
    ds_read_b64_tr_b16 v[86:87], v33 offset:5120
    s_waitcnt lgkmcnt(6)
    v_mfma_f32_32x32x16_bf16 v[104:119], v[72:75], v[188:191], v[104:119]
    ds_read_b64_tr_b16 v[64:65], v32 offset:6144
    ds_read_b64_tr_b16 v[66:67], v32 offset:7168
    s_waitcnt lgkmcnt(6)
    v_mfma_f32_32x32x16_bf16 v[120:135], v[76:79], v[188:191], v[120:135]
    ds_read_b64_tr_b16 v[68:69], v33 offset:6144
    ds_read_b64_tr_b16 v[70:71], v33 offset:7168
    s_waitcnt lgkmcnt(6)
    v_mfma_f32_32x32x16_bf16 v[104:119], v[80:83], v[192:195], v[104:119]
    ds_read_b64_tr_b16 v[72:73], v32 offset:8192
    ds_read_b64_tr_b16 v[74:75], v32 offset:9216
    s_waitcnt lgkmcnt(6)
    v_mfma_f32_32x32x16_bf16 v[120:135], v[84:87], v[192:195], v[120:135]
    ds_read_b64_tr_b16 v[76:77], v33 offset:8192
    ds_read_b64_tr_b16 v[78:79], v33 offset:9216
    s_waitcnt lgkmcnt(6)
    v_mfma_f32_32x32x16_bf16 v[104:119], v[64:67], v[196:199], v[104:119]
    ds_read_b64_tr_b16 v[80:81], v32 offset:10240
    ds_read_b64_tr_b16 v[82:83], v32 offset:11264
    s_waitcnt lgkmcnt(6)
    v_mfma_f32_32x32x16_bf16 v[120:135], v[68:71], v[196:199], v[120:135]
    ds_read_b64_tr_b16 v[84:85], v33 offset:10240
    ds_read_b64_tr_b16 v[86:87], v33 offset:11264
    s_waitcnt lgkmcnt(6)
    v_mfma_f32_32x32x16_bf16 v[104:119], v[72:75], v[200:203], v[104:119]
    ds_read_b64_tr_b16 v[64:65], v32 offset:12288
    ds_read_b64_tr_b16 v[66:67], v32 offset:13312
    s_waitcnt lgkmcnt(6)
    v_mfma_f32_32x32x16_bf16 v[120:135], v[76:79], v[200:203], v[120:135]
    ds_read_b64_tr_b16 v[68:69], v33 offset:12288
    ds_read_b64_tr_b16 v[70:71], v33 offset:13312
    s_waitcnt lgkmcnt(6)
    v_mfma_f32_32x32x16_bf16 v[104:119], v[80:83], v[204:207], v[104:119]
    ds_read_b64_tr_b16 v[72:73], v32 offset:14336
    ds_read_b64_tr_b16 v[74:75], v32 offset:15360
    s_waitcnt lgkmcnt(6)
    v_mfma_f32_32x32x16_bf16 v[120:135], v[84:87], v[204:207], v[120:135]
    ds_read_b64_tr_b16 v[76:77], v33 offset:14336
    ds_read_b64_tr_b16 v[78:79], v33 offset:15360
    s_waitcnt vmcnt(0)
    s_mov_b64 exec, 1
    s_cmp_lg_u32 s100, 0
    s_cbranch_scc1 SLOW_94
    buffer_store_dword v2, off, s[64:67], s8
    s_branch STE_95
SLOW_94:
    buffer_store_dword v2, off, s[64:67], s8 sc1
STE_95:
    s_mov_b64 exec, -1
    v_add_u32 v32, 16384, v30
    v_add_u32 v33, 16384, v31
    s_waitcnt lgkmcnt(6)
    v_mfma_f32_32x32x16_bf16 v[104:119], v[64:67], v[208:211], v[104:119]
    ds_read_b64_tr_b16 v[80:81], v32 offset:0
    ds_read_b64_tr_b16 v[82:83], v32 offset:1024
    s_waitcnt lgkmcnt(6)
    v_mfma_f32_32x32x16_bf16 v[120:135], v[68:71], v[208:211], v[120:135]
    ds_read_b64_tr_b16 v[84:85], v33 offset:0
    ds_read_b64_tr_b16 v[86:87], v33 offset:1024
    s_waitcnt lgkmcnt(6)
    v_mfma_f32_32x32x16_bf16 v[104:119], v[72:75], v[212:215], v[104:119]
    ds_read_b64_tr_b16 v[64:65], v32 offset:2048
    ds_read_b64_tr_b16 v[66:67], v32 offset:3072
    s_waitcnt lgkmcnt(6)
    v_mfma_f32_32x32x16_bf16 v[120:135], v[76:79], v[212:215], v[120:135]
    ds_read_b64_tr_b16 v[68:69], v33 offset:2048
    ds_read_b64_tr_b16 v[70:71], v33 offset:3072
    s_mov_b32 s90, 200000
    s_mov_b64 exec, 0x3ff
POLL_96:
    buffer_load_dword v63, v8, s[64:67], 0 offen sc1
    s_waitcnt vmcnt(0)
    v_cmp_ne_u32 vcc, s73, v63
    s_cbranch_vccz POLLD_97
    s_sub_u32 s90, s90, 1
    s_cmp_lg_u32 s90, 0
    s_cbranch_scc1 POLL_96
POLLD_97:
    s_mov_b64 exec, -1
    s_add_u32 s96, s96, 528384
    s_cmp_eq_u32 s96, 20815872
    s_cselect_b32 s96, 15532032, s96
    s_add_u32 s83, s96, 0
    buffer_load_dwordx4 v[216:219], v7, s[64:67], s83 offen sc1
    s_add_u32 s83, s96, 66048
    buffer_load_dwordx4 v[88:91], v7, s[64:67], s83 offen sc1
    s_add_u32 s83, s96, 132096
    buffer_load_dwordx4 v[92:95], v7, s[64:67], s83 offen sc1
    s_add_u32 s83, s96, 198144
    buffer_load_dwordx4 v[96:99], v7, s[64:67], s83 offen sc1
    s_add_u32 s83, s96, 264192
    buffer_load_dwordx4 v[100:103], v7, s[64:67], s83 offen sc1
    s_add_u32 s83, s96, 330240
    buffer_load_dwordx4 v[136:139], v7, s[64:67], s83 offen sc1
    s_add_u32 s83, s96, 396288
    buffer_load_dwordx4 v[140:143], v7, s[64:67], s83 offen sc1
    s_add_u32 s83, s96, 462336
    buffer_load_dwordx4 v[144:147], v7, s[64:67], s83 offen sc1
    s_add_u32 s96, s96, 528384
    s_cmp_eq_u32 s96, 20815872
    s_cselect_b32 s96, 15532032, s96
    s_add_u32 s83, s96, 0
    buffer_load_dwordx4 v[148:151], v7, s[64:67], s83 offen sc1
    s_add_u32 s83, s96, 66048
    buffer_load_dwordx4 v[152:155], v7, s[64:67], s83 offen sc1
    s_add_u32 s83, s96, 132096
    buffer_load_dwordx4 v[156:159], v7, s[64:67], s83 offen sc1
    s_add_u32 s83, s96, 198144
    buffer_load_dwordx4 v[160:163], v7, s[64:67], s83 offen sc1
    s_waitcnt vmcnt(11)
    s_waitcnt lgkmcnt(6)
    v_mfma_f32_32x32x16_bf16 v[104:119], v[80:83], v[216:219], v[104:119]
    ds_read_b64_tr_b16 v[72:73], v32 offset:4096
    ds_read_b64_tr_b16 v[74:75], v32 offset:5120
    s_waitcnt lgkmcnt(6)
    v_mfma_f32_32x32x16_bf16 v[120:135], v[84:87], v[216:219], v[120:135]
    ds_read_b64_tr_b16 v[76:77], v33 offset:4096
    ds_read_b64_tr_b16 v[78:79], v33 offset:5120
    s_add_u32 s83, s96, 264192
    buffer_load_dwordx4 v[164:167], v7, s[64:67], s83 offen sc1
    s_add_u32 s83, s96, 330240
    buffer_load_dwordx4 v[36:39], v7, s[64:67], s83 offen sc1
    s_waitcnt vmcnt(12)
    s_waitcnt lgkmcnt(6)
    v_mfma_f32_32x32x16_bf16 v[104:119], v[64:67], v[88:91], v[104:119]
    ds_read_b64_tr_b16 v[80:81], v32 offset:6144
    ds_read_b64_tr_b16 v[82:83], v32 offset:7168
    s_waitcnt lgkmcnt(6)
    v_mfma_f32_32x32x16_bf16 v[120:135], v[68:71], v[88:91], v[120:135]
    ds_read_b64_tr_b16 v[84:85], v33 offset:6144
    ds_read_b64_tr_b16 v[86:87], v33 offset:7168
    s_add_u32 s83, s96, 396288
    buffer_load_dwordx4 v[40:43], v7, s[64:67], s83 offen sc1
    s_add_u32 s83, s96, 462336
    buffer_load_dwordx4 v[44:47], v7, s[64:67], s83 offen sc1
    s_waitcnt vmcnt(13)
    s_waitcnt lgkmcnt(6)
    v_mfma_f32_32x32x16_bf16 v[104:119], v[72:75], v[92:95], v[104:119]
    ds_read_b64_tr_b16 v[64:65], v32 offset:8192
    ds_read_b64_tr_b16 v[66:67], v32 offset:9216
    s_waitcnt lgkmcnt(6)
    v_mfma_f32_32x32x16_bf16 v[120:135], v[76:79], v[92:95], v[120:135]
    ds_read_b64_tr_b16 v[68:69], v33 offset:8192
    ds_read_b64_tr_b16 v[70:71], v33 offset:9216
    s_add_u32 s96, s96, 528384
    s_cmp_eq_u32 s96, 20815872
    s_cselect_b32 s96, 15532032, s96
    s_add_u32 s83, s96, 0
    buffer_load_dwordx4 v[184:187], v7, s[64:67], s83 offen sc1
    s_add_u32 s83, s96, 66048
    buffer_load_dwordx4 v[188:191], v7, s[64:67], s83 offen sc1
    s_waitcnt vmcnt(14)
    s_waitcnt lgkmcnt(6)
    v_mfma_f32_32x32x16_bf16 v[104:119], v[80:83], v[96:99], v[104:119]
    ds_read_b64_tr_b16 v[72:73], v32 offset:10240
    ds_read_b64_tr_b16 v[74:75], v32 offset:11264
    s_waitcnt lgkmcnt(6)
    v_mfma_f32_32x32x16_bf16 v[120:135], v[84:87], v[96:99], v[120:135]
    ds_read_b64_tr_b16 v[76:77], v33 offset:10240
    ds_read_b64_tr_b16 v[78:79], v33 offset:11264
    s_add_u32 s83, s96, 132096
    buffer_load_dwordx4 v[192:195], v7, s[64:67], s83 offen sc1
    s_add_u32 s83, s96, 198144
    buffer_load_dwordx4 v[196:199], v7, s[64:67], s83 offen sc1
    s_waitcnt vmcnt(15)
    s_waitcnt lgkmcnt(6)
    v_mfma_f32_32x32x16_bf16 v[104:119], v[64:67], v[100:103], v[104:119]
    ds_read_b64_tr_b16 v[80:81], v32 offset:12288
    ds_read_b64_tr_b16 v[82:83], v32 offset:13312
    s_waitcnt lgkmcnt(6)
    v_mfma_f32_32x32x16_bf16 v[120:135], v[68:71], v[100:103], v[120:135]
    ds_read_b64_tr_b16 v[84:85], v33 offset:12288
    ds_read_b64_tr_b16 v[86:87], v33 offset:13312
    s_add_u32 s83, s96, 264192
    buffer_load_dwordx4 v[200:203], v7, s[64:67], s83 offen sc1
    s_add_u32 s83, s96, 330240
    buffer_load_dwordx4 v[204:207], v7, s[64:67], s83 offen sc1
    s_waitcnt vmcnt(16)
    s_waitcnt lgkmcnt(6)
    v_mfma_f32_32x32x16_bf16 v[104:119], v[72:75], v[136:139], v[104:119]
    ds_read_b64_tr_b16 v[64:65], v32 offset:14336
    ds_read_b64_tr_b16 v[66:67], v32 offset:15360
    s_waitcnt lgkmcnt(6)
    v_mfma_f32_32x32x16_bf16 v[120:135], v[76:79], v[136:139], v[120:135]
    ds_read_b64_tr_b16 v[68:69], v33 offset:14336
    ds_read_b64_tr_b16 v[70:71], v33 offset:15360
    s_add_u32 s83, s96, 396288
    buffer_load_dwordx4 v[208:211], v7, s[64:67], s83 offen sc1
    s_add_u32 s83, s96, 462336
    buffer_load_dwordx4 v[212:215], v7, s[64:67], s83 offen sc1
    s_waitcnt lgkmcnt(0)
    v_add_u32 v32, 32768, v30
    v_add_u32 v33, 32768, v31
    s_barrier
    s_waitcnt vmcnt(17)
    v_mfma_f32_32x32x16_bf16 v[104:119], v[80:83], v[140:143], v[104:119]
    ds_read_b64_tr_b16 v[72:73], v32 offset:0
    ds_read_b64_tr_b16 v[74:75], v32 offset:1024
    v_mfma_f32_32x32x16_bf16 v[120:135], v[84:87], v[140:143], v[120:135]
    ds_read_b64_tr_b16 v[76:77], v33 offset:0
    ds_read_b64_tr_b16 v[78:79], v33 offset:1024
    s_add_u32 s96, s96, 528384
    s_cmp_eq_u32 s96, 20815872
    s_cselect_b32 s96, 15532032, s96
    s_add_u32 s83, s96, 0
    buffer_load_dwordx4 v[216:219], v7, s[64:67], s83 offen sc1
    s_add_u32 s83, s96, 66048
    buffer_load_dwordx4 v[88:91], v7, s[64:67], s83 offen sc1
    s_waitcnt vmcnt(18)
    v_mfma_f32_32x32x16_bf16 v[104:119], v[64:67], v[144:147], v[104:119]
    ds_read_b64_tr_b16 v[80:81], v32 offset:2048
    ds_read_b64_tr_b16 v[82:83], v32 offset:3072
    v_mfma_f32_32x32x16_bf16 v[120:135], v[68:71], v[144:147], v[120:135]
    ds_read_b64_tr_b16 v[84:85], v33 offset:2048
    ds_read_b64_tr_b16 v[86:87], v33 offset:3072
    s_add_u32 s83, s96, 132096
    buffer_load_dwordx4 v[92:95], v7, s[64:67], s83 offen sc1
    s_add_u32 s83, s96, 198144
    buffer_load_dwordx4 v[96:99], v7, s[64:67], s83 offen sc1
    s_waitcnt vmcnt(19)
    s_waitcnt lgkmcnt(6)
    v_mfma_f32_32x32x16_bf16 v[104:119], v[72:75], v[148:151], v[104:119]
    ds_read_b64_tr_b16 v[64:65], v32 offset:4096
    ds_read_b64_tr_b16 v[66:67], v32 offset:5120
    s_waitcnt lgkmcnt(6)
    v_mfma_f32_32x32x16_bf16 v[120:135], v[76:79], v[148:151], v[120:135]
    ds_read_b64_tr_b16 v[68:69], v33 offset:4096
    ds_read_b64_tr_b16 v[70:71], v33 offset:5120
    s_add_u32 s83, s96, 264192
    buffer_load_dwordx4 v[100:103], v7, s[64:67], s83 offen sc1
    s_add_u32 s83, s96, 330240
    buffer_load_dwordx4 v[136:139], v7, s[64:67], s83 offen sc1
    s_waitcnt vmcnt(20)
    s_waitcnt lgkmcnt(6)
    v_mfma_f32_32x32x16_bf16 v[104:119], v[80:83], v[152:155], v[104:119]
    ds_read_b64_tr_b16 v[72:73], v32 offset:6144
    ds_read_b64_tr_b16 v[74:75], v32 offset:7168
    s_waitcnt lgkmcnt(6)
    v_mfma_f32_32x32x16_bf16 v[120:135], v[84:87], v[152:155], v[120:135]
    ds_read_b64_tr_b16 v[76:77], v33 offset:6144
    ds_read_b64_tr_b16 v[78:79], v33 offset:7168
    s_add_u32 s83, s96, 396288
    buffer_load_dwordx4 v[140:143], v7, s[64:67], s83 offen sc1
    s_add_u32 s83, s96, 462336
    buffer_load_dwordx4 v[144:147], v7, s[64:67], s83 offen sc1
    s_waitcnt vmcnt(21)
    s_waitcnt lgkmcnt(6)
    v_mfma_f32_32x32x16_bf16 v[104:119], v[64:67], v[156:159], v[104:119]
    ds_read_b64_tr_b16 v[80:81], v32 offset:8192
    ds_read_b64_tr_b16 v[82:83], v32 offset:9216
    s_waitcnt lgkmcnt(6)
    v_mfma_f32_32x32x16_bf16 v[120:135], v[68:71], v[156:159], v[120:135]
    ds_read_b64_tr_b16 v[84:85], v33 offset:8192
    ds_read_b64_tr_b16 v[86:87], v33 offset:9216
    s_add_u32 s96, s96, 528384
    s_cmp_eq_u32 s96, 20815872
    s_cselect_b32 s96, 15532032, s96
    s_add_u32 s83, s96, 0
    buffer_load_dwordx4 v[148:151], v7, s[64:67], s83 offen sc1
    s_add_u32 s83, s96, 66048
    buffer_load_dwordx4 v[152:155], v7, s[64:67], s83 offen sc1
    s_waitcnt vmcnt(22)
    s_waitcnt lgkmcnt(6)
    v_mfma_f32_32x32x16_bf16 v[104:119], v[72:75], v[160:163], v[104:119]
    ds_read_b64_tr_b16 v[64:65], v32 offset:10240
    ds_read_b64_tr_b16 v[66:67], v32 offset:11264
    s_waitcnt lgkmcnt(6)
    v_mfma_f32_32x32x16_bf16 v[120:135], v[76:79], v[160:163], v[120:135]
    ds_read_b64_tr_b16 v[68:69], v33 offset:10240
    ds_read_b64_tr_b16 v[70:71], v33 offset:11264
    s_add_u32 s83, s96, 132096
    buffer_load_dwordx4 v[156:159], v7, s[64:67], s83 offen sc1
    s_add_u32 s83, s96, 198144
    buffer_load_dwordx4 v[160:163], v7, s[64:67], s83 offen sc1
    s_waitcnt vmcnt(23)
    s_waitcnt lgkmcnt(6)
    v_mfma_f32_32x32x16_bf16 v[104:119], v[80:83], v[164:167], v[104:119]
    ds_read_b64_tr_b16 v[72:73], v32 offset:12288
    ds_read_b64_tr_b16 v[74:75], v32 offset:13312
    s_waitcnt lgkmcnt(6)
    v_mfma_f32_32x32x16_bf16 v[120:135], v[84:87], v[164:167], v[120:135]
    ds_read_b64_tr_b16 v[76:77], v33 offset:12288
    ds_read_b64_tr_b16 v[78:79], v33 offset:13312
    s_add_u32 s83, s96, 264192
    buffer_load_dwordx4 v[164:167], v7, s[64:67], s83 offen sc1
    s_waitcnt vmcnt(23)
    s_waitcnt lgkmcnt(6)
    v_mfma_f32_32x32x16_bf16 v[104:119], v[64:67], v[36:39], v[104:119]
    ds_read_b64_tr_b16 v[80:81], v32 offset:14336
    ds_read_b64_tr_b16 v[82:83], v32 offset:15360
    s_waitcnt lgkmcnt(6)
    v_mfma_f32_32x32x16_bf16 v[120:135], v[68:71], v[36:39], v[120:135]
    ds_read_b64_tr_b16 v[84:85], v33 offset:14336
    ds_read_b64_tr_b16 v[86:87], v33 offset:15360
    s_add_u32 s83, s96, 330240
    buffer_load_dwordx4 v[36:39], v7, s[64:67], s83 offen sc1
    v_add_u32 v32, 49152, v30
    v_add_u32 v33, 49152, v31
    s_waitcnt vmcnt(23)
    s_waitcnt lgkmcnt(6)
    v_mfma_f32_32x32x16_bf16 v[104:119], v[72:75], v[40:43], v[104:119]
    ds_read_b64_tr_b16 v[64:65], v32 offset:0
    ds_read_b64_tr_b16 v[66:67], v32 offset:1024
    s_waitcnt lgkmcnt(6)
    v_mfma_f32_32x32x16_bf16 v[120:135], v[76:79], v[40:43], v[120:135]
    ds_read_b64_tr_b16 v[68:69], v33 offset:0
    ds_read_b64_tr_b16 v[70:71], v33 offset:1024
    s_add_u32 s83, s96, 396288
    buffer_load_dwordx4 v[40:43], v7, s[64:67], s83 offen sc1
    s_waitcnt vmcnt(23)
    s_waitcnt lgkmcnt(6)
    v_mfma_f32_32x32x16_bf16 v[104:119], v[80:83], v[44:47], v[104:119]
    ds_read_b64_tr_b16 v[72:73], v32 offset:2048
    ds_read_b64_tr_b16 v[74:75], v32 offset:3072
    s_waitcnt lgkmcnt(6)
    v_mfma_f32_32x32x16_bf16 v[120:135], v[84:87], v[44:47], v[120:135]
    ds_read_b64_tr_b16 v[76:77], v33 offset:2048
    ds_read_b64_tr_b16 v[78:79], v33 offset:3072
    s_add_u32 s83, s96, 462336
    buffer_load_dwordx4 v[44:47], v7, s[64:67], s83 offen sc1
    s_waitcnt vmcnt(23)
    s_waitcnt lgkmcnt(6)
    v_mfma_f32_32x32x16_bf16 v[104:119], v[64:67], v[184:187], v[104:119]
    ds_read_b64_tr_b16 v[80:81], v32 offset:4096
    ds_read_b64_tr_b16 v[82:83], v32 offset:5120
    s_waitcnt lgkmcnt(6)
    v_mfma_f32_32x32x16_bf16 v[120:135], v[68:71], v[184:187], v[120:135]
    ds_read_b64_tr_b16 v[84:85], v33 offset:4096
    ds_read_b64_tr_b16 v[86:87], v33 offset:5120
    s_add_u32 s96, s96, 528384
    s_cmp_eq_u32 s96, 20815872
    s_cselect_b32 s96, 15532032, s96
    s_add_u32 s83, s96, 0
    buffer_load_dwordx4 v[184:187], v7, s[64:67], s83 offen sc1
    s_waitcnt vmcnt(23)
    s_waitcnt lgkmcnt(6)
    v_mfma_f32_32x32x16_bf16 v[104:119], v[72:75], v[188:191], v[104:119]
    ds_read_b64_tr_b16 v[64:65], v32 offset:6144
    ds_read_b64_tr_b16 v[66:67], v32 offset:7168
    s_waitcnt lgkmcnt(6)
    v_mfma_f32_32x32x16_bf16 v[120:135], v[76:79], v[188:191], v[120:135]
    ds_read_b64_tr_b16 v[68:69], v33 offset:6144
    ds_read_b64_tr_b16 v[70:71], v33 offset:7168
    s_add_u32 s83, s96, 66048
    buffer_load_dwordx4 v[188:191], v7, s[64:67], s83 offen sc1
    s_waitcnt vmcnt(23)
    s_waitcnt lgkmcnt(6)
    v_mfma_f32_32x32x16_bf16 v[104:119], v[80:83], v[192:195], v[104:119]
    ds_read_b64_tr_b16 v[72:73], v32 offset:8192
    ds_read_b64_tr_b16 v[74:75], v32 offset:9216
    s_waitcnt lgkmcnt(6)
    v_mfma_f32_32x32x16_bf16 v[120:135], v[84:87], v[192:195], v[120:135]
    ds_read_b64_tr_b16 v[76:77], v33 offset:8192
    ds_read_b64_tr_b16 v[78:79], v33 offset:9216
    s_add_u32 s83, s96, 132096
    buffer_load_dwordx4 v[192:195], v7, s[64:67], s83 offen sc1
    s_waitcnt vmcnt(23)
    s_waitcnt lgkmcnt(6)
    v_mfma_f32_32x32x16_bf16 v[104:119], v[64:67], v[196:199], v[104:119]
    ds_read_b64_tr_b16 v[80:81], v32 offset:10240
    ds_read_b64_tr_b16 v[82:83], v32 offset:11264
    s_waitcnt lgkmcnt(6)
    v_mfma_f32_32x32x16_bf16 v[120:135], v[68:71], v[196:199], v[120:135]
    ds_read_b64_tr_b16 v[84:85], v33 offset:10240
    ds_read_b64_tr_b16 v[86:87], v33 offset:11264
    s_add_u32 s83, s96, 198144
    buffer_load_dwordx4 v[196:199], v7, s[64:67], s83 offen sc1
    s_waitcnt vmcnt(23)
    s_waitcnt lgkmcnt(6)
    v_mfma_f32_32x32x16_bf16 v[104:119], v[72:75], v[200:203], v[104:119]
    ds_read_b64_tr_b16 v[64:65], v32 offset:12288
    ds_read_b64_tr_b16 v[66:67], v32 offset:13312
    s_waitcnt lgkmcnt(6)
    v_mfma_f32_32x32x16_bf16 v[120:135], v[76:79], v[200:203], v[120:135]
    ds_read_b64_tr_b16 v[68:69], v33 offset:12288
    ds_read_b64_tr_b16 v[70:71], v33 offset:13312
    s_add_u32 s83, s96, 264192
    buffer_load_dwordx4 v[200:203], v7, s[64:67], s83 offen sc1
    s_waitcnt vmcnt(23)
    s_waitcnt lgkmcnt(6)
    v_mfma_f32_32x32x16_bf16 v[104:119], v[80:83], v[204:207], v[104:119]
    ds_read_b64_tr_b16 v[72:73], v32 offset:14336
    ds_read_b64_tr_b16 v[74:75], v32 offset:15360
    s_waitcnt lgkmcnt(6)
    v_mfma_f32_32x32x16_bf16 v[120:135], v[84:87], v[204:207], v[120:135]
    ds_read_b64_tr_b16 v[76:77], v33 offset:14336
    ds_read_b64_tr_b16 v[78:79], v33 offset:15360
    s_add_u32 s83, s96, 330240
    buffer_load_dwordx4 v[204:207], v7, s[64:67], s83 offen sc1
    v_add_u32 v32, 65536, v30
    v_add_u32 v33, 65536, v31
    s_waitcnt vmcnt(23)
    s_waitcnt lgkmcnt(6)
    v_mfma_f32_32x32x16_bf16 v[104:119], v[64:67], v[208:211], v[104:119]
    ds_read_b64_tr_b16 v[80:81], v32 offset:0
    ds_read_b64_tr_b16 v[82:83], v32 offset:1024
    s_waitcnt lgkmcnt(6)
    v_mfma_f32_32x32x16_bf16 v[120:135], v[68:71], v[208:211], v[120:135]
    ds_read_b64_tr_b16 v[84:85], v33 offset:0
    ds_read_b64_tr_b16 v[86:87], v33 offset:1024
    s_add_u32 s83, s96, 396288
    buffer_load_dwordx4 v[208:211], v7, s[64:67], s83 offen sc1
    s_waitcnt vmcnt(23)
    s_waitcnt lgkmcnt(6)
    v_mfma_f32_32x32x16_bf16 v[104:119], v[72:75], v[212:215], v[104:119]
    ds_read_b64_tr_b16 v[64:65], v32 offset:2048
    ds_read_b64_tr_b16 v[66:67], v32 offset:3072
    s_waitcnt lgkmcnt(6)
    v_mfma_f32_32x32x16_bf16 v[120:135], v[76:79], v[212:215], v[120:135]
    ds_read_b64_tr_b16 v[68:69], v33 offset:2048
    ds_read_b64_tr_b16 v[70:71], v33 offset:3072
    s_add_u32 s83, s96, 462336
    buffer_load_dwordx4 v[212:215], v7, s[64:67], s83 offen sc1
    s_waitcnt vmcnt(23)
    s_waitcnt lgkmcnt(6)
    v_mfma_f32_32x32x16_bf16 v[104:119], v[80:83], v[216:219], v[104:119]
    ds_read_b64_tr_b16 v[72:73], v32 offset:4096
    ds_read_b64_tr_b16 v[74:75], v32 offset:5120
    s_waitcnt lgkmcnt(6)
    v_mfma_f32_32x32x16_bf16 v[120:135], v[84:87], v[216:219], v[120:135]
    ds_read_b64_tr_b16 v[76:77], v33 offset:4096
    ds_read_b64_tr_b16 v[78:79], v33 offset:5120
    s_add_u32 s96, s96, 528384
    s_cmp_eq_u32 s96, 20815872
    s_cselect_b32 s96, 15532032, s96
    s_add_u32 s83, s96, 0
    buffer_load_dwordx4 v[216:219], v7, s[64:67], s83 offen sc1
    s_waitcnt vmcnt(23)
    s_waitcnt lgkmcnt(6)
    v_mfma_f32_32x32x16_bf16 v[104:119], v[64:67], v[88:91], v[104:119]
    ds_read_b64_tr_b16 v[80:81], v32 offset:6144
    ds_read_b64_tr_b16 v[82:83], v32 offset:7168
    s_waitcnt lgkmcnt(6)
    v_mfma_f32_32x32x16_bf16 v[120:135], v[68:71], v[88:91], v[120:135]
    ds_read_b64_tr_b16 v[84:85], v33 offset:6144
    ds_read_b64_tr_b16 v[86:87], v33 offset:7168
    s_add_u32 s83, s96, 66048
    buffer_load_dwordx4 v[88:91], v7, s[64:67], s83 offen sc1
    s_waitcnt vmcnt(23)
    s_waitcnt lgkmcnt(6)
    v_mfma_f32_32x32x16_bf16 v[104:119], v[72:75], v[92:95], v[104:119]
    ds_read_b64_tr_b16 v[64:65], v32 offset:8192
    ds_read_b64_tr_b16 v[66:67], v32 offset:9216
    s_waitcnt lgkmcnt(6)
    v_mfma_f32_32x32x16_bf16 v[120:135], v[76:79], v[92:95], v[120:135]
    ds_read_b64_tr_b16 v[68:69], v33 offset:8192
    ds_read_b64_tr_b16 v[70:71], v33 offset:9216
    s_add_u32 s83, s96, 132096
    buffer_load_dwordx4 v[92:95], v7, s[64:67], s83 offen sc1
    s_waitcnt vmcnt(23)
    s_waitcnt lgkmcnt(6)
    v_mfma_f32_32x32x16_bf16 v[104:119], v[80:83], v[96:99], v[104:119]
    ds_read_b64_tr_b16 v[72:73], v32 offset:10240
    ds_read_b64_tr_b16 v[74:75], v32 offset:11264
    s_waitcnt lgkmcnt(6)
    v_mfma_f32_32x32x16_bf16 v[120:135], v[84:87], v[96:99], v[120:135]
    ds_read_b64_tr_b16 v[76:77], v33 offset:10240
    ds_read_b64_tr_b16 v[78:79], v33 offset:11264
    s_add_u32 s83, s96, 198144
    buffer_load_dwordx4 v[96:99], v7, s[64:67], s83 offen sc1
    s_waitcnt vmcnt(23)
    s_waitcnt lgkmcnt(6)
    v_mfma_f32_32x32x16_bf16 v[104:119], v[64:67], v[100:103], v[104:119]
    ds_read_b64_tr_b16 v[80:81], v32 offset:12288
    ds_read_b64_tr_b16 v[82:83], v32 offset:13312
    s_waitcnt lgkmcnt(6)
    v_mfma_f32_32x32x16_bf16 v[120:135], v[68:71], v[100:103], v[120:135]
    ds_read_b64_tr_b16 v[84:85], v33 offset:12288
    ds_read_b64_tr_b16 v[86:87], v33 offset:13312
    buffer_load_dword v10, v62, s[64:67], 0 offen sc1
    s_add_u32 s83, s96, 264192
    buffer_load_dwordx4 v[100:103], v7, s[64:67], s83 offen sc1
    s_waitcnt vmcnt(24)
    s_waitcnt lgkmcnt(6)
    v_mfma_f32_32x32x16_bf16 v[104:119], v[72:75], v[136:139], v[104:119]
    ds_read_b64_tr_b16 v[64:65], v32 offset:14336
    ds_read_b64_tr_b16 v[66:67], v32 offset:15360
    s_waitcnt lgkmcnt(6)
    v_mfma_f32_32x32x16_bf16 v[120:135], v[76:79], v[136:139], v[120:135]
    ds_read_b64_tr_b16 v[68:69], v33 offset:14336
    ds_read_b64_tr_b16 v[70:71], v33 offset:15360
    s_add_u32 s83, s96, 330240
    buffer_load_dwordx4 v[136:139], v7, s[64:67], s83 offen sc1
    v_add_u32 v32, 81920, v30
    v_add_u32 v33, 81920, v31
    s_waitcnt vmcnt(24)
    s_waitcnt lgkmcnt(6)
    v_mfma_f32_32x32x16_bf16 v[104:119], v[80:83], v[140:143], v[104:119]
    ds_read_b64_tr_b16 v[72:73], v32 offset:0
    ds_read_b64_tr_b16 v[74:75], v32 offset:1024
    s_waitcnt lgkmcnt(6)
    v_mfma_f32_32x32x16_bf16 v[120:135], v[84:87], v[140:143], v[120:135]
    ds_read_b64_tr_b16 v[76:77], v33 offset:0
    ds_read_b64_tr_b16 v[78:79], v33 offset:1024
    s_add_u32 s83, s96, 396288
    buffer_load_dwordx4 v[140:143], v7, s[64:67], s83 offen sc1
    s_waitcnt vmcnt(24)
    s_waitcnt lgkmcnt(6)
    v_mfma_f32_32x32x16_bf16 v[104:119], v[64:67], v[144:147], v[104:119]
    ds_read_b64_tr_b16 v[80:81], v32 offset:2048
    ds_read_b64_tr_b16 v[82:83], v32 offset:3072
    s_waitcnt lgkmcnt(6)
    v_mfma_f32_32x32x16_bf16 v[120:135], v[68:71], v[144:147], v[120:135]
    ds_read_b64_tr_b16 v[84:85], v33 offset:2048
    ds_read_b64_tr_b16 v[86:87], v33 offset:3072
    s_add_u32 s83, s96, 462336
    buffer_load_dwordx4 v[144:147], v7, s[64:67], s83 offen sc1
    s_waitcnt vmcnt(24)
    s_waitcnt lgkmcnt(6)
    v_mfma_f32_32x32x16_bf16 v[104:119], v[72:75], v[148:151], v[104:119]
    ds_read_b64_tr_b16 v[64:65], v32 offset:4096
    ds_read_b64_tr_b16 v[66:67], v32 offset:5120
    s_waitcnt lgkmcnt(6)
    v_mfma_f32_32x32x16_bf16 v[120:135], v[76:79], v[148:151], v[120:135]
    ds_read_b64_tr_b16 v[68:69], v33 offset:4096
    ds_read_b64_tr_b16 v[70:71], v33 offset:5120
    s_add_u32 s96, s96, 528384
    s_cmp_eq_u32 s96, 20815872
    s_cselect_b32 s96, 15532032, s96
    s_add_u32 s83, s96, 0
    buffer_load_dwordx4 v[148:151], v7, s[64:67], s83 offen sc1
    s_waitcnt vmcnt(24)
    s_waitcnt lgkmcnt(6)
    v_mfma_f32_32x32x16_bf16 v[104:119], v[80:83], v[152:155], v[104:119]
    ds_read_b64_tr_b16 v[72:73], v32 offset:6144
    ds_read_b64_tr_b16 v[74:75], v32 offset:7168
    s_waitcnt lgkmcnt(6)
    v_mfma_f32_32x32x16_bf16 v[120:135], v[84:87], v[152:155], v[120:135]
    ds_read_b64_tr_b16 v[76:77], v33 offset:6144
    ds_read_b64_tr_b16 v[78:79], v33 offset:7168
    s_add_u32 s83, s96, 66048
    buffer_load_dwordx4 v[152:155], v7, s[64:67], s83 offen sc1
    s_waitcnt vmcnt(24)
    s_waitcnt lgkmcnt(6)
    v_mfma_f32_32x32x16_bf16 v[104:119], v[64:67], v[156:159], v[104:119]
    ds_read_b64_tr_b16 v[80:81], v32 offset:8192
    ds_read_b64_tr_b16 v[82:83], v32 offset:9216
    s_waitcnt lgkmcnt(6)
    v_mfma_f32_32x32x16_bf16 v[120:135], v[68:71], v[156:159], v[120:135]
    ds_read_b64_tr_b16 v[84:85], v33 offset:8192
    ds_read_b64_tr_b16 v[86:87], v33 offset:9216
    s_add_u32 s83, s96, 132096
    buffer_load_dwordx4 v[156:159], v7, s[64:67], s83 offen sc1
    s_waitcnt vmcnt(24)
    s_waitcnt lgkmcnt(6)
    v_mfma_f32_32x32x16_bf16 v[104:119], v[72:75], v[160:163], v[104:119]
    ds_read_b64_tr_b16 v[64:65], v32 offset:10240
    ds_read_b64_tr_b16 v[66:67], v32 offset:11264
    s_waitcnt lgkmcnt(6)
    v_mfma_f32_32x32x16_bf16 v[120:135], v[76:79], v[160:163], v[120:135]
    ds_read_b64_tr_b16 v[68:69], v33 offset:10240
    ds_read_b64_tr_b16 v[70:71], v33 offset:11264
    s_add_u32 s83, s96, 198144
    buffer_load_dwordx4 v[160:163], v7, s[64:67], s83 offen sc1
    s_waitcnt vmcnt(24)
    s_waitcnt lgkmcnt(6)
    v_mfma_f32_32x32x16_bf16 v[104:119], v[80:83], v[164:167], v[104:119]
    ds_read_b64_tr_b16 v[72:73], v32 offset:12288
    ds_read_b64_tr_b16 v[74:75], v32 offset:13312
    s_waitcnt lgkmcnt(6)
    v_mfma_f32_32x32x16_bf16 v[120:135], v[84:87], v[164:167], v[120:135]
    ds_read_b64_tr_b16 v[76:77], v33 offset:12288
    ds_read_b64_tr_b16 v[78:79], v33 offset:13312
    s_add_u32 s83, s96, 264192
    buffer_load_dwordx4 v[164:167], v7, s[64:67], s83 offen sc1
    s_waitcnt vmcnt(24)
    s_waitcnt lgkmcnt(6)
    v_mfma_f32_32x32x16_bf16 v[104:119], v[64:67], v[36:39], v[104:119]
    ds_read_b64_tr_b16 v[80:81], v32 offset:14336
    ds_read_b64_tr_b16 v[82:83], v32 offset:15360
    s_waitcnt lgkmcnt(6)
    v_mfma_f32_32x32x16_bf16 v[120:135], v[68:71], v[36:39], v[120:135]
    ds_read_b64_tr_b16 v[84:85], v33 offset:14336
    ds_read_b64_tr_b16 v[86:87], v33 offset:15360
    s_add_u32 s83, s96, 330240
    buffer_load_dwordx4 v[36:39], v7, s[64:67], s83 offen sc1
    v_add_u32 v32, 98304, v30
    v_add_u32 v33, 98304, v31
    s_waitcnt vmcnt(24)
    s_waitcnt lgkmcnt(6)
    v_mfma_f32_32x32x16_bf16 v[104:119], v[72:75], v[40:43], v[104:119]
    ds_read_b64_tr_b16 v[64:65], v32 offset:0
    ds_read_b64_tr_b16 v[66:67], v32 offset:1024
    s_waitcnt lgkmcnt(6)
    v_mfma_f32_32x32x16_bf16 v[120:135], v[76:79], v[40:43], v[120:135]
    ds_read_b64_tr_b16 v[68:69], v33 offset:0
    ds_read_b64_tr_b16 v[70:71], v33 offset:1024
    s_add_u32 s83, s96, 396288
    buffer_load_dwordx4 v[40:43], v7, s[64:67], s83 offen sc1
    s_waitcnt vmcnt(24)
    s_waitcnt lgkmcnt(6)
    v_mfma_f32_32x32x16_bf16 v[104:119], v[80:83], v[44:47], v[104:119]
    ds_read_b64_tr_b16 v[72:73], v32 offset:2048
    ds_read_b64_tr_b16 v[74:75], v32 offset:3072
    s_waitcnt lgkmcnt(6)
    v_mfma_f32_32x32x16_bf16 v[120:135], v[84:87], v[44:47], v[120:135]
    ds_read_b64_tr_b16 v[76:77], v33 offset:2048
    ds_read_b64_tr_b16 v[78:79], v33 offset:3072
    s_add_u32 s83, s96, 462336
    buffer_load_dwordx4 v[44:47], v7, s[64:67], s83 offen sc1
    s_waitcnt vmcnt(24)
    s_waitcnt lgkmcnt(6)
    v_mfma_f32_32x32x16_bf16 v[104:119], v[64:67], v[184:187], v[104:119]
    ds_read_b64_tr_b16 v[80:81], v32 offset:4096
    ds_read_b64_tr_b16 v[82:83], v32 offset:5120
    s_waitcnt lgkmcnt(6)
    v_mfma_f32_32x32x16_bf16 v[120:135], v[68:71], v[184:187], v[120:135]
    ds_read_b64_tr_b16 v[84:85], v33 offset:4096
    ds_read_b64_tr_b16 v[86:87], v33 offset:5120
    s_add_u32 s96, s96, 528384
    s_cmp_eq_u32 s96, 20815872
    s_cselect_b32 s96, 15532032, s96
    s_add_u32 s83, s96, 0
    buffer_load_dwordx4 v[184:187], v7, s[64:67], s83 offen sc1
    s_waitcnt vmcnt(24)
    s_waitcnt lgkmcnt(6)
    v_mfma_f32_32x32x16_bf16 v[104:119], v[72:75], v[188:191], v[104:119]
    ds_read_b64_tr_b16 v[64:65], v32 offset:6144
    ds_read_b64_tr_b16 v[66:67], v32 offset:7168
    s_waitcnt lgkmcnt(6)
    v_mfma_f32_32x32x16_bf16 v[120:135], v[76:79], v[188:191], v[120:135]
    ds_read_b64_tr_b16 v[68:69], v33 offset:6144
    ds_read_b64_tr_b16 v[70:71], v33 offset:7168
    s_add_u32 s83, s96, 66048
    buffer_load_dwordx4 v[188:191], v7, s[64:67], s83 offen sc1
    s_waitcnt vmcnt(24)
    s_waitcnt lgkmcnt(6)
    v_mfma_f32_32x32x16_bf16 v[104:119], v[80:83], v[192:195], v[104:119]
    ds_read_b64_tr_b16 v[72:73], v32 offset:8192
    ds_read_b64_tr_b16 v[74:75], v32 offset:9216
    s_waitcnt lgkmcnt(6)
    v_mfma_f32_32x32x16_bf16 v[120:135], v[84:87], v[192:195], v[120:135]
    ds_read_b64_tr_b16 v[76:77], v33 offset:8192
    ds_read_b64_tr_b16 v[78:79], v33 offset:9216
    s_add_u32 s83, s96, 132096
    buffer_load_dwordx4 v[192:195], v7, s[64:67], s83 offen sc1
    s_waitcnt vmcnt(24)
    s_waitcnt lgkmcnt(6)
    v_mfma_f32_32x32x16_bf16 v[104:119], v[64:67], v[196:199], v[104:119]
    ds_read_b64_tr_b16 v[80:81], v32 offset:10240
    ds_read_b64_tr_b16 v[82:83], v32 offset:11264
    s_waitcnt lgkmcnt(6)
    v_mfma_f32_32x32x16_bf16 v[120:135], v[68:71], v[196:199], v[120:135]
    ds_read_b64_tr_b16 v[84:85], v33 offset:10240
    ds_read_b64_tr_b16 v[86:87], v33 offset:11264
    s_add_u32 s83, s96, 198144
    buffer_load_dwordx4 v[196:199], v7, s[64:67], s83 offen sc1
    s_waitcnt vmcnt(24)
    s_waitcnt lgkmcnt(6)
    v_mfma_f32_32x32x16_bf16 v[104:119], v[72:75], v[200:203], v[104:119]
    ds_read_b64_tr_b16 v[64:65], v32 offset:12288
    ds_read_b64_tr_b16 v[66:67], v32 offset:13312
    s_waitcnt lgkmcnt(6)
    v_mfma_f32_32x32x16_bf16 v[120:135], v[76:79], v[200:203], v[120:135]
    ds_read_b64_tr_b16 v[68:69], v33 offset:12288
    ds_read_b64_tr_b16 v[70:71], v33 offset:13312
    s_add_u32 s83, s96, 264192
    buffer_load_dwordx4 v[200:203], v7, s[64:67], s83 offen sc1
    s_waitcnt vmcnt(24)
    s_waitcnt lgkmcnt(6)
    v_mfma_f32_32x32x16_bf16 v[104:119], v[80:83], v[204:207], v[104:119]
    ds_read_b64_tr_b16 v[72:73], v32 offset:14336
    ds_read_b64_tr_b16 v[74:75], v32 offset:15360
    s_waitcnt lgkmcnt(6)
    v_mfma_f32_32x32x16_bf16 v[120:135], v[84:87], v[204:207], v[120:135]
    ds_read_b64_tr_b16 v[76:77], v33 offset:14336
    ds_read_b64_tr_b16 v[78:79], v33 offset:15360
    s_add_u32 s83, s96, 330240
    buffer_load_dwordx4 v[204:207], v7, s[64:67], s83 offen sc1
    v_add_u32 v32, 114688, v30
    v_add_u32 v33, 114688, v31
    s_waitcnt vmcnt(24)
    s_waitcnt lgkmcnt(6)
    v_mfma_f32_32x32x16_bf16 v[104:119], v[64:67], v[208:211], v[104:119]
    ds_read_b64_tr_b16 v[80:81], v32 offset:0
    ds_read_b64_tr_b16 v[82:83], v32 offset:1024
    s_waitcnt lgkmcnt(6)
    v_mfma_f32_32x32x16_bf16 v[120:135], v[68:71], v[208:211], v[120:135]
    ds_read_b64_tr_b16 v[84:85], v33 offset:0
    ds_read_b64_tr_b16 v[86:87], v33 offset:1024
    s_add_u32 s83, s96, 396288
    buffer_load_dwordx4 v[208:211], v7, s[64:67], s83 offen sc1
    s_waitcnt vmcnt(24)
    s_waitcnt lgkmcnt(6)
    v_mfma_f32_32x32x16_bf16 v[104:119], v[72:75], v[212:215], v[104:119]
    ds_read_b64_tr_b16 v[64:65], v32 offset:2048
    ds_read_b64_tr_b16 v[66:67], v32 offset:3072
    s_waitcnt lgkmcnt(6)
    v_mfma_f32_32x32x16_bf16 v[120:135], v[76:79], v[212:215], v[120:135]
    ds_read_b64_tr_b16 v[68:69], v33 offset:2048
    ds_read_b64_tr_b16 v[70:71], v33 offset:3072
    s_add_u32 s83, s96, 462336
    buffer_load_dwordx4 v[212:215], v7, s[64:67], s83 offen sc1
    s_waitcnt vmcnt(24)
    s_waitcnt lgkmcnt(6)
    v_mfma_f32_32x32x16_bf16 v[104:119], v[80:83], v[216:219], v[104:119]
    ds_read_b64_tr_b16 v[72:73], v32 offset:4096
    ds_read_b64_tr_b16 v[74:75], v32 offset:5120
    s_waitcnt lgkmcnt(6)
    v_mfma_f32_32x32x16_bf16 v[120:135], v[84:87], v[216:219], v[120:135]
    ds_read_b64_tr_b16 v[76:77], v33 offset:4096
    ds_read_b64_tr_b16 v[78:79], v33 offset:5120
    s_waitcnt vmcnt(20)
    v_cmp_ne_u32 vcc, s73, v10
    s_cbranch_vccz FOK_98
    s_mov_b32 s90, 200000
    s_mov_b64 exec, 0x3
POLL_99:
    buffer_load_dword v63, v62, s[64:67], 0 offen sc1
    s_waitcnt vmcnt(0)
    v_cmp_ne_u32 vcc, s73, v63
    s_cbranch_vccz POLLD_100
    s_sub_u32 s90, s90, 1
    s_cmp_lg_u32 s90, 0
    s_cbranch_scc1 POLL_99
POLLD_100:
    s_mov_b64 exec, -1
FOK_98:
    s_mov_b32 s83, 20815872
    buffer_load_dwordx4 v[216:219], v7, s[64:67], s83 offen sc1
    s_waitcnt lgkmcnt(6)
    v_mfma_f32_32x32x16_bf16 v[104:119], v[64:67], v[88:91], v[104:119]
    ds_read_b64_tr_b16 v[80:81], v32 offset:6144
    ds_read_b64_tr_b16 v[82:83], v32 offset:7168
    s_waitcnt lgkmcnt(6)
    v_mfma_f32_32x32x16_bf16 v[120:135], v[68:71], v[88:91], v[120:135]
    ds_read_b64_tr_b16 v[84:85], v33 offset:6144
    ds_read_b64_tr_b16 v[86:87], v33 offset:7168
    s_mov_b32 s83, 20881920
    buffer_load_dwordx4 v[88:91], v7, s[64:67], s83 offen sc1
    s_waitcnt lgkmcnt(6)
    v_mfma_f32_32x32x16_bf16 v[104:119], v[72:75], v[92:95], v[104:119]
    ds_read_b64_tr_b16 v[64:65], v32 offset:8192
    ds_read_b64_tr_b16 v[66:67], v32 offset:9216
    s_waitcnt lgkmcnt(6)
    v_mfma_f32_32x32x16_bf16 v[120:135], v[76:79], v[92:95], v[120:135]
    ds_read_b64_tr_b16 v[68:69], v33 offset:8192
    ds_read_b64_tr_b16 v[70:71], v33 offset:9216
    s_mov_b32 s83, 20947968
    buffer_load_dwordx4 v[92:95], v7, s[64:67], s83 offen sc1
    s_waitcnt lgkmcnt(6)
    v_mfma_f32_32x32x16_bf16 v[104:119], v[80:83], v[96:99], v[104:119]
    ds_read_b64_tr_b16 v[72:73], v32 offset:10240
    ds_read_b64_tr_b16 v[74:75], v32 offset:11264
    s_waitcnt lgkmcnt(6)
    v_mfma_f32_32x32x16_bf16 v[120:135], v[84:87], v[96:99], v[120:135]
    ds_read_b64_tr_b16 v[76:77], v33 offset:10240
    ds_read_b64_tr_b16 v[78:79], v33 offset:11264
    s_mov_b32 s83, 21014016
    buffer_load_dwordx4 v[96:99], v7, s[64:67], s83 offen sc1
    s_waitcnt vmcnt(23)
    s_waitcnt lgkmcnt(6)
    v_mfma_f32_32x32x16_bf16 v[104:119], v[64:67], v[100:103], v[104:119]
    ds_read_b64_tr_b16 v[80:81], v32 offset:12288
    ds_read_b64_tr_b16 v[82:83], v32 offset:13312
    s_waitcnt lgkmcnt(6)
    v_mfma_f32_32x32x16_bf16 v[120:135], v[68:71], v[100:103], v[120:135]
    ds_read_b64_tr_b16 v[84:85], v33 offset:12288
    ds_read_b64_tr_b16 v[86:87], v33 offset:13312
    s_mov_b32 s83, 21080064
    buffer_load_dwordx4 v[100:103], v7, s[64:67], s83 offen sc1
    s_waitcnt vmcnt(23)
    s_waitcnt lgkmcnt(6)
    v_mfma_f32_32x32x16_bf16 v[104:119], v[72:75], v[136:139], v[104:119]
    ds_read_b64_tr_b16 v[64:65], v32 offset:14336
    ds_read_b64_tr_b16 v[66:67], v32 offset:15360
    s_waitcnt lgkmcnt(6)
    v_mfma_f32_32x32x16_bf16 v[120:135], v[76:79], v[136:139], v[120:135]
    ds_read_b64_tr_b16 v[68:69], v33 offset:14336
    ds_read_b64_tr_b16 v[70:71], v33 offset:15360
    s_mov_b32 s83, 21146112
    buffer_load_dwordx4 v[136:139], v7, s[64:67], s83 offen sc1
    v_add_u32 v32, 131072, v30
    v_add_u32 v33, 131072, v31
    s_waitcnt vmcnt(23)
    s_waitcnt lgkmcnt(6)
    v_mfma_f32_32x32x16_bf16 v[104:119], v[80:83], v[140:143], v[104:119]
    ds_read_b64_tr_b16 v[72:73], v32 offset:0
    ds_read_b64_tr_b16 v[74:75], v32 offset:1024
    s_waitcnt lgkmcnt(6)
    v_mfma_f32_32x32x16_bf16 v[120:135], v[84:87], v[140:143], v[120:135]
    ds_read_b64_tr_b16 v[76:77], v33 offset:0
    ds_read_b64_tr_b16 v[78:79], v33 offset:1024
    s_mov_b32 s83, 21212160
    buffer_load_dwordx4 v[140:143], v7, s[64:67], s83 offen sc1
    s_waitcnt vmcnt(23)
    s_waitcnt lgkmcnt(6)
    v_mfma_f32_32x32x16_bf16 v[104:119], v[64:67], v[144:147], v[104:119]
    ds_read_b64_tr_b16 v[80:81], v32 offset:2048
    ds_read_b64_tr_b16 v[82:83], v32 offset:3072
    s_waitcnt lgkmcnt(6)
    v_mfma_f32_32x32x16_bf16 v[120:135], v[68:71], v[144:147], v[120:135]
    ds_read_b64_tr_b16 v[84:85], v33 offset:2048
    ds_read_b64_tr_b16 v[86:87], v33 offset:3072
    s_mov_b32 s83, 21278208
    buffer_load_dwordx4 v[144:147], v7, s[64:67], s83 offen sc1
    s_waitcnt vmcnt(23)
    s_waitcnt lgkmcnt(6)
    v_mfma_f32_32x32x16_bf16 v[104:119], v[72:75], v[148:151], v[104:119]
    ds_read_b64_tr_b16 v[64:65], v32 offset:4096
    ds_read_b64_tr_b16 v[66:67], v32 offset:5120
    s_waitcnt lgkmcnt(6)
    v_mfma_f32_32x32x16_bf16 v[120:135], v[76:79], v[148:151], v[120:135]
    ds_read_b64_tr_b16 v[68:69], v33 offset:4096
    ds_read_b64_tr_b16 v[70:71], v33 offset:5120
    s_mov_b32 s83, 21344256
    buffer_load_dwordx4 v[148:151], v7, s[64:67], s83 offen sc1
    s_waitcnt vmcnt(23)
    s_waitcnt lgkmcnt(6)
    v_mfma_f32_32x32x16_bf16 v[104:119], v[80:83], v[152:155], v[104:119]
    ds_read_b64_tr_b16 v[72:73], v32 offset:6144
    ds_read_b64_tr_b16 v[74:75], v32 offset:7168
    s_waitcnt lgkmcnt(6)
    v_mfma_f32_32x32x16_bf16 v[120:135], v[84:87], v[152:155], v[120:135]
    ds_read_b64_tr_b16 v[76:77], v33 offset:6144
    ds_read_b64_tr_b16 v[78:79], v33 offset:7168
    s_mov_b32 s83, 21410304
    buffer_load_dwordx4 v[152:155], v7, s[64:67], s83 offen sc1
    s_waitcnt vmcnt(23)
    s_waitcnt lgkmcnt(6)
    v_mfma_f32_32x32x16_bf16 v[104:119], v[64:67], v[156:159], v[104:119]
    ds_read_b64_tr_b16 v[80:81], v32 offset:8192
    ds_read_b64_tr_b16 v[82:83], v32 offset:9216
    s_waitcnt lgkmcnt(6)
    v_mfma_f32_32x32x16_bf16 v[120:135], v[68:71], v[156:159], v[120:135]
    ds_read_b64_tr_b16 v[84:85], v33 offset:8192
    ds_read_b64_tr_b16 v[86:87], v33 offset:9216
    s_mov_b32 s83, 21476352
    buffer_load_dwordx4 v[156:159], v7, s[64:67], s83 offen sc1
    s_waitcnt vmcnt(23)
    s_waitcnt lgkmcnt(6)
    v_mfma_f32_32x32x16_bf16 v[104:119], v[72:75], v[160:163], v[104:119]
    ds_read_b64_tr_b16 v[64:65], v32 offset:10240
    ds_read_b64_tr_b16 v[66:67], v32 offset:11264
    s_waitcnt lgkmcnt(6)
    v_mfma_f32_32x32x16_bf16 v[120:135], v[76:79], v[160:163], v[120:135]
    ds_read_b64_tr_b16 v[68:69], v33 offset:10240
    ds_read_b64_tr_b16 v[70:71], v33 offset:11264
    s_mov_b32 s83, 21542400
    buffer_load_dwordx4 v[160:163], v7, s[64:67], s83 offen sc1
    s_waitcnt vmcnt(23)
    s_waitcnt lgkmcnt(6)
    v_mfma_f32_32x32x16_bf16 v[104:119], v[80:83], v[164:167], v[104:119]
    ds_read_b64_tr_b16 v[72:73], v32 offset:12288
    ds_read_b64_tr_b16 v[74:75], v32 offset:13312
    s_waitcnt lgkmcnt(6)
    v_mfma_f32_32x32x16_bf16 v[120:135], v[84:87], v[164:167], v[120:135]
    ds_read_b64_tr_b16 v[76:77], v33 offset:12288
    ds_read_b64_tr_b16 v[78:79], v33 offset:13312
    s_mov_b32 s83, 21608448
    buffer_load_dwordx4 v[164:167], v7, s[64:67], s83 offen sc1
    s_waitcnt vmcnt(23)
    s_waitcnt lgkmcnt(6)
    v_mfma_f32_32x32x16_bf16 v[104:119], v[64:67], v[36:39], v[104:119]
    ds_read_b64_tr_b16 v[80:81], v32 offset:14336
    ds_read_b64_tr_b16 v[82:83], v32 offset:15360
    s_waitcnt lgkmcnt(6)
    v_mfma_f32_32x32x16_bf16 v[120:135], v[68:71], v[36:39], v[120:135]
    ds_read_b64_tr_b16 v[84:85], v33 offset:14336
    ds_read_b64_tr_b16 v[86:87], v33 offset:15360
    s_mov_b32 s83, 21674496
    buffer_load_dwordx4 v[36:39], v7, s[64:67], s83 offen sc1
    v_add_u32 v32, 147456, v30
    v_add_u32 v33, 147456, v31
    s_waitcnt vmcnt(23)
    s_waitcnt lgkmcnt(6)
    v_mfma_f32_32x32x16_bf16 v[104:119], v[72:75], v[40:43], v[104:119]
    ds_read_b64_tr_b16 v[64:65], v32 offset:0
    ds_read_b64_tr_b16 v[66:67], v32 offset:1024
    s_waitcnt lgkmcnt(6)
    v_mfma_f32_32x32x16_bf16 v[120:135], v[76:79], v[40:43], v[120:135]
    ds_read_b64_tr_b16 v[68:69], v33 offset:0
    ds_read_b64_tr_b16 v[70:71], v33 offset:1024
    s_mov_b32 s83, 21740544
    buffer_load_dwordx4 v[40:43], v7, s[64:67], s83 offen sc1
    s_waitcnt vmcnt(23)
    s_waitcnt lgkmcnt(6)
    v_mfma_f32_32x32x16_bf16 v[104:119], v[80:83], v[44:47], v[104:119]
    ds_read_b64_tr_b16 v[72:73], v32 offset:2048
    ds_read_b64_tr_b16 v[74:75], v32 offset:3072
    s_waitcnt lgkmcnt(6)
    v_mfma_f32_32x32x16_bf16 v[120:135], v[84:87], v[44:47], v[120:135]
    ds_read_b64_tr_b16 v[76:77], v33 offset:2048
    ds_read_b64_tr_b16 v[78:79], v33 offset:3072
    s_mov_b32 s83, 21806592
    buffer_load_dwordx4 v[44:47], v7, s[64:67], s83 offen sc1
    s_waitcnt vmcnt(23)
    s_waitcnt lgkmcnt(6)
    v_mfma_f32_32x32x16_bf16 v[104:119], v[64:67], v[184:187], v[104:119]
    ds_read_b64_tr_b16 v[80:81], v32 offset:4096
    ds_read_b64_tr_b16 v[82:83], v32 offset:5120
    s_waitcnt lgkmcnt(6)
    v_mfma_f32_32x32x16_bf16 v[120:135], v[68:71], v[184:187], v[120:135]
    ds_read_b64_tr_b16 v[84:85], v33 offset:4096
    ds_read_b64_tr_b16 v[86:87], v33 offset:5120
    s_waitcnt vmcnt(22)
    s_waitcnt lgkmcnt(6)
    v_mfma_f32_32x32x16_bf16 v[104:119], v[72:75], v[188:191], v[104:119]
    ds_read_b64_tr_b16 v[64:65], v32 offset:6144
    ds_read_b64_tr_b16 v[66:67], v32 offset:7168
    s_waitcnt lgkmcnt(6)
    v_mfma_f32_32x32x16_bf16 v[120:135], v[76:79], v[188:191], v[120:135]
    ds_read_b64_tr_b16 v[68:69], v33 offset:6144
    ds_read_b64_tr_b16 v[70:71], v33 offset:7168
    s_waitcnt vmcnt(21)
    s_waitcnt lgkmcnt(6)
    v_mfma_f32_32x32x16_bf16 v[104:119], v[80:83], v[192:195], v[104:119]
    ds_read_b64_tr_b16 v[72:73], v32 offset:8192
    ds_read_b64_tr_b16 v[74:75], v32 offset:9216
    s_waitcnt lgkmcnt(6)
    v_mfma_f32_32x32x16_bf16 v[120:135], v[84:87], v[192:195], v[120:135]
    ds_read_b64_tr_b16 v[76:77], v33 offset:8192
    ds_read_b64_tr_b16 v[78:79], v33 offset:9216
    s_waitcnt vmcnt(20)
    s_waitcnt lgkmcnt(6)
    v_mfma_f32_32x32x16_bf16 v[104:119], v[64:67], v[196:199], v[104:119]
    ds_read_b64_tr_b16 v[80:81], v32 offset:10240
    ds_read_b64_tr_b16 v[82:83], v32 offset:11264
    s_waitcnt lgkmcnt(6)
    v_mfma_f32_32x32x16_bf16 v[120:135], v[68:71], v[196:199], v[120:135]
    ds_read_b64_tr_b16 v[84:85], v33 offset:10240
    ds_read_b64_tr_b16 v[86:87], v33 offset:11264
    s_waitcnt vmcnt(19)
    s_waitcnt lgkmcnt(6)
    v_mfma_f32_32x32x16_bf16 v[104:119], v[72:75], v[200:203], v[104:119]
    ds_read_b64_tr_b16 v[64:65], v32 offset:12288
    ds_read_b64_tr_b16 v[66:67], v32 offset:13312
    s_waitcnt lgkmcnt(6)
    v_mfma_f32_32x32x16_bf16 v[120:135], v[76:79], v[200:203], v[120:135]
    ds_read_b64_tr_b16 v[68:69], v33 offset:12288
    ds_read_b64_tr_b16 v[70:71], v33 offset:13312
    s_lshr_b32 s85, s80, 1
    s_cmp_eq_u32 s80, 9
    s_cselect_b32 s85, 5, s85
    s_lshl_b32 s83, s79, 2
    s_add_u32 s83, s83, s72
    s_mul_i32 s86, s83, 2048
    s_lshl_b32 s84, s85, 7
    s_add_u32 s86, s86, s84
    s_add_u32 s86, s86, 22282240
    v_mov_b32_e64 v8, s86
    buffer_load_dword v10, v8, s[64:67], 0 offen sc1
    s_waitcnt vmcnt(19)
    s_waitcnt lgkmcnt(6)
    v_mfma_f32_32x32x16_bf16 v[104:119], v[80:83], v[204:207], v[104:119]
    ds_read_b64_tr_b16 v[72:73], v32 offset:14336
    ds_read_b64_tr_b16 v[74:75], v32 offset:15360
    s_waitcnt lgkmcnt(6)
    v_mfma_f32_32x32x16_bf16 v[120:135], v[84:87], v[204:207], v[120:135]
    ds_read_b64_tr_b16 v[76:77], v33 offset:14336
    ds_read_b64_tr_b16 v[78:79], v33 offset:15360
    s_waitcnt lgkmcnt(0)
    v_add_u32 v32, 0, v30
    v_add_u32 v33, 0, v31
    s_barrier
    s_waitcnt vmcnt(18)
    v_mfma_f32_32x32x16_bf16 v[104:119], v[64:67], v[208:211], v[104:119]
    ds_read_b64_tr_b16 v[80:81], v32 offset:0
    ds_read_b64_tr_b16 v[82:83], v32 offset:1024
    v_mfma_f32_32x32x16_bf16 v[120:135], v[68:71], v[208:211], v[120:135]
    ds_read_b64_tr_b16 v[84:85], v33 offset:0
    ds_read_b64_tr_b16 v[86:87], v33 offset:1024
    s_waitcnt vmcnt(17)
    v_mfma_f32_32x32x16_bf16 v[104:119], v[72:75], v[212:215], v[104:119]
    ds_read_b64_tr_b16 v[64:65], v32 offset:2048
    ds_read_b64_tr_b16 v[66:67], v32 offset:3072
    v_mfma_f32_32x32x16_bf16 v[120:135], v[76:79], v[212:215], v[120:135]
    ds_read_b64_tr_b16 v[68:69], v33 offset:2048
    ds_read_b64_tr_b16 v[70:71], v33 offset:3072
    s_waitcnt vmcnt(16)
    s_waitcnt lgkmcnt(6)
    v_mfma_f32_32x32x16_bf16 v[104:119], v[80:83], v[216:219], v[104:119]
    ds_read_b64_tr_b16 v[72:73], v32 offset:4096
    ds_read_b64_tr_b16 v[74:75], v32 offset:5120
    s_waitcnt lgkmcnt(6)
    v_mfma_f32_32x32x16_bf16 v[120:135], v[84:87], v[216:219], v[120:135]
    ds_read_b64_tr_b16 v[76:77], v33 offset:4096
    ds_read_b64_tr_b16 v[78:79], v33 offset:5120
    s_waitcnt vmcnt(15)
    s_waitcnt lgkmcnt(6)
    v_mfma_f32_32x32x16_bf16 v[104:119], v[64:67], v[88:91], v[104:119]
    ds_read_b64_tr_b16 v[80:81], v32 offset:6144
    ds_read_b64_tr_b16 v[82:83], v32 offset:7168
    s_waitcnt lgkmcnt(6)
    v_mfma_f32_32x32x16_bf16 v[120:135], v[68:71], v[88:91], v[120:135]
    ds_read_b64_tr_b16 v[84:85], v33 offset:6144
    ds_read_b64_tr_b16 v[86:87], v33 offset:7168
    s_waitcnt vmcnt(14)
    s_waitcnt lgkmcnt(6)
    v_mfma_f32_32x32x16_bf16 v[104:119], v[72:75], v[92:95], v[104:119]
    ds_read_b64_tr_b16 v[64:65], v32 offset:8192
    ds_read_b64_tr_b16 v[66:67], v32 offset:9216
    s_waitcnt lgkmcnt(6)
    v_mfma_f32_32x32x16_bf16 v[120:135], v[76:79], v[92:95], v[120:135]
    ds_read_b64_tr_b16 v[68:69], v33 offset:8192
    ds_read_b64_tr_b16 v[70:71], v33 offset:9216
    s_waitcnt vmcnt(13)
    s_waitcnt lgkmcnt(6)
    v_mfma_f32_32x32x16_bf16 v[104:119], v[80:83], v[96:99], v[104:119]
    ds_read_b64_tr_b16 v[72:73], v32 offset:10240
    ds_read_b64_tr_b16 v[74:75], v32 offset:11264
    s_waitcnt lgkmcnt(6)
    v_mfma_f32_32x32x16_bf16 v[120:135], v[84:87], v[96:99], v[120:135]
    ds_read_b64_tr_b16 v[76:77], v33 offset:10240
    ds_read_b64_tr_b16 v[78:79], v33 offset:11264
    s_waitcnt vmcnt(12)
    s_waitcnt lgkmcnt(6)
    v_mfma_f32_32x32x16_bf16 v[104:119], v[64:67], v[100:103], v[104:119]
    ds_read_b64_tr_b16 v[80:81], v32 offset:12288
    ds_read_b64_tr_b16 v[82:83], v32 offset:13312
    s_waitcnt lgkmcnt(6)
    v_mfma_f32_32x32x16_bf16 v[120:135], v[68:71], v[100:103], v[120:135]
    ds_read_b64_tr_b16 v[84:85], v33 offset:12288
    ds_read_b64_tr_b16 v[86:87], v33 offset:13312
    s_waitcnt vmcnt(11)
    s_waitcnt lgkmcnt(6)
    v_mfma_f32_32x32x16_bf16 v[104:119], v[72:75], v[136:139], v[104:119]
    ds_read_b64_tr_b16 v[64:65], v32 offset:14336
    ds_read_b64_tr_b16 v[66:67], v32 offset:15360
    s_waitcnt lgkmcnt(6)
    v_mfma_f32_32x32x16_bf16 v[120:135], v[76:79], v[136:139], v[120:135]
    ds_read_b64_tr_b16 v[68:69], v33 offset:14336
    ds_read_b64_tr_b16 v[70:71], v33 offset:15360
    v_add_u32 v32, 16384, v30
    v_add_u32 v33, 16384, v31
    s_waitcnt vmcnt(10)
    s_waitcnt lgkmcnt(6)
    v_mfma_f32_32x32x16_bf16 v[104:119], v[80:83], v[140:143], v[104:119]
    ds_read_b64_tr_b16 v[72:73], v32 offset:0
    ds_read_b64_tr_b16 v[74:75], v32 offset:1024
    s_waitcnt lgkmcnt(6)
    v_mfma_f32_32x32x16_bf16 v[120:135], v[84:87], v[140:143], v[120:135]
    ds_read_b64_tr_b16 v[76:77], v33 offset:0
    ds_read_b64_tr_b16 v[78:79], v33 offset:1024
    s_waitcnt vmcnt(0)
    v_cmp_ne_u32 vcc, s73, v10
    s_cbranch_vccnz S_LATE
    s_mov_b32 s92, 1
    s_mul_i32 s85, s80, 264192
    s_add_u32 s85, s85, 12845056
    s_add_u32 s83, s85, 0
    buffer_load_dwordx4 v[168:171], v7, s[64:67], s83 offen sc1
    s_add_u32 s83, s85, 66048
    buffer_load_dwordx4 v[172:175], v7, s[64:67], s83 offen sc1
    s_add_u32 s83, s85, 132096
    buffer_load_dwordx4 v[176:179], v7, s[64:67], s83 offen sc1
    s_add_u32 s83, s85, 198144
    buffer_load_dwordx4 v[180:183], v7, s[64:67], s83 offen sc1
S_LATE:
    s_waitcnt lgkmcnt(6)
    v_mfma_f32_32x32x16_bf16 v[104:119], v[64:67], v[144:147], v[104:119]
    ds_read_b64_tr_b16 v[80:81], v32 offset:2048
    ds_read_b64_tr_b16 v[82:83], v32 offset:3072
    s_waitcnt lgkmcnt(6)
    v_mfma_f32_32x32x16_bf16 v[120:135], v[68:71], v[144:147], v[120:135]
    ds_read_b64_tr_b16 v[84:85], v33 offset:2048
    ds_read_b64_tr_b16 v[86:87], v33 offset:3072
    s_waitcnt lgkmcnt(6)
    v_mfma_f32_32x32x16_bf16 v[104:119], v[72:75], v[148:151], v[104:119]
    ds_read_b64_tr_b16 v[64:65], v32 offset:4096
    ds_read_b64_tr_b16 v[66:67], v32 offset:5120
    s_waitcnt lgkmcnt(6)
    v_mfma_f32_32x32x16_bf16 v[120:135], v[76:79], v[148:151], v[120:135]
    ds_read_b64_tr_b16 v[68:69], v33 offset:4096
    ds_read_b64_tr_b16 v[70:71], v33 offset:5120
    s_waitcnt lgkmcnt(6)
    v_mfma_f32_32x32x16_bf16 v[104:119], v[80:83], v[152:155], v[104:119]
    ds_read_b64_tr_b16 v[72:73], v32 offset:6144
    ds_read_b64_tr_b16 v[74:75], v32 offset:7168
    s_waitcnt lgkmcnt(6)
    v_mfma_f32_32x32x16_bf16 v[120:135], v[84:87], v[152:155], v[120:135]
    ds_read_b64_tr_b16 v[76:77], v33 offset:6144
    ds_read_b64_tr_b16 v[78:79], v33 offset:7168
    s_waitcnt lgkmcnt(6)
    v_mfma_f32_32x32x16_bf16 v[104:119], v[64:67], v[156:159], v[104:119]
    ds_read_b64_tr_b16 v[80:81], v32 offset:8192
    ds_read_b64_tr_b16 v[82:83], v32 offset:9216
    s_waitcnt lgkmcnt(6)
    v_mfma_f32_32x32x16_bf16 v[120:135], v[68:71], v[156:159], v[120:135]
    ds_read_b64_tr_b16 v[84:85], v33 offset:8192
    ds_read_b64_tr_b16 v[86:87], v33 offset:9216
    s_waitcnt lgkmcnt(6)
    v_mfma_f32_32x32x16_bf16 v[104:119], v[72:75], v[160:163], v[104:119]
    ds_read_b64_tr_b16 v[64:65], v32 offset:10240
    ds_read_b64_tr_b16 v[66:67], v32 offset:11264
    s_waitcnt lgkmcnt(6)
    v_mfma_f32_32x32x16_bf16 v[120:135], v[76:79], v[160:163], v[120:135]
    ds_read_b64_tr_b16 v[68:69], v33 offset:10240
    ds_read_b64_tr_b16 v[70:71], v33 offset:11264
    s_waitcnt lgkmcnt(6)
    v_mfma_f32_32x32x16_bf16 v[104:119], v[80:83], v[164:167], v[104:119]
    ds_read_b64_tr_b16 v[72:73], v32 offset:12288
    ds_read_b64_tr_b16 v[74:75], v32 offset:13312
    s_waitcnt lgkmcnt(6)
    v_mfma_f32_32x32x16_bf16 v[120:135], v[84:87], v[164:167], v[120:135]
    ds_read_b64_tr_b16 v[76:77], v33 offset:12288
    ds_read_b64_tr_b16 v[78:79], v33 offset:13312
    s_waitcnt lgkmcnt(6)
    v_mfma_f32_32x32x16_bf16 v[104:119], v[64:67], v[36:39], v[104:119]
    ds_read_b64_tr_b16 v[80:81], v32 offset:14336
    ds_read_b64_tr_b16 v[82:83], v32 offset:15360
    s_waitcnt lgkmcnt(6)
    v_mfma_f32_32x32x16_bf16 v[120:135], v[68:71], v[36:39], v[120:135]
    ds_read_b64_tr_b16 v[84:85], v33 offset:14336
    ds_read_b64_tr_b16 v[86:87], v33 offset:15360
E4B:
    s_waitcnt lgkmcnt(6)
    v_mfma_f32_32x32x16_bf16 v[104:119], v[72:75], v[40:43], v[104:119]
    s_waitcnt lgkmcnt(4)
    v_mfma_f32_32x32x16_bf16 v[120:135], v[76:79], v[40:43], v[120:135]
    s_waitcnt lgkmcnt(2)
    v_mfma_f32_32x32x16_bf16 v[104:119], v[80:83], v[44:47], v[104:119]
    s_waitcnt lgkmcnt(0)
    v_mfma_f32_32x32x16_bf16 v[120:135], v[84:87], v[44:47], v[120:135]
    s_cmp_eq_u32 s92, 1
    s_cbranch_scc1 SK_101
    s_mov_b32 s90, 200000
    s_mov_b64 exec, 0x1
POLL_102:
    buffer_load_dword v63, v8, s[64:67], 0 offen sc1
    s_waitcnt vmcnt(0)
    v_cmp_ne_u32 vcc, s73, v63
    s_cbranch_vccz POLLD_103
    s_sub_u32 s90, s90, 1
    s_cmp_lg_u32 s90, 0
    s_cbranch_scc1 POLL_102
POLLD_103:
    s_mov_b64 exec, -1
    s_mul_i32 s85, s80, 264192
    s_add_u32 s85, s85, 12845056
    s_add_u32 s83, s85, 0
    buffer_load_dwordx4 v[168:171], v7, s[64:67], s83 offen sc1
    s_add_u32 s83, s85, 66048
    buffer_load_dwordx4 v[172:175], v7, s[64:67], s83 offen sc1
    s_add_u32 s83, s85, 132096
    buffer_load_dwordx4 v[176:179], v7, s[64:67], s83 offen sc1
    s_add_u32 s83, s85, 198144
    buffer_load_dwordx4 v[180:183], v7, s[64:67], s83 offen sc1
SK_101:
    v_mov_b32 v24, 0xbfb8aa3b
    v_mov_b32 v25, 0xbfb8aa3b
    v_lshlrev_b32_e64 v188, 16, v236
    v_and_b32 v189, 0xffff0000, v236
    v_lshlrev_b32_e64 v190, 16, v237
    v_and_b32 v191, 0xffff0000, v237
    s_nop 1
    v_pk_add_f32 v[104:105], v[104:105], v[188:189]
    v_pk_add_f32 v[106:107], v[106:107], v[190:191]
    v_pk_mul_f32 v[12:13], v[104:105], v[24:25]
    v_pk_mul_f32 v[14:15], v[106:107], v[24:25]
    v_exp_f32 v12, v12
    v_exp_f32 v13, v13
    v_exp_f32 v14, v14
    v_exp_f32_e64 v15, v15
    v_pk_add_f32 v[12:13], v[12:13], 1.0 op_sel_hi:[1,0]
    v_pk_add_f32 v[14:15], v[14:15], 1.0 op_sel_hi:[1,0]
    v_rcp_f32 v12, v12
    v_rcp_f32 v13, v13
    v_rcp_f32 v14, v14
    v_rcp_f32 v15, v15
    v_pk_mul_f32 v[104:105], v[104:105], v[12:13]
    v_pk_mul_f32 v[106:107], v[106:107], v[14:15]
    v_lshlrev_b32_e64 v188, 16, v238
    v_and_b32 v189, 0xffff0000, v238
    v_lshlrev_b32_e64 v190, 16, v239
    v_and_b32 v191, 0xffff0000, v239
    v_pk_add_f32 v[108:109], v[108:109], v[188:189]
    v_pk_add_f32 v[110:111], v[110:111], v[190:191]
    v_pk_mul_f32 v[12:13], v[108:109], v[24:25]
    v_pk_mul_f32 v[14:15], v[110:111], v[24:25]
    v_exp_f32 v12, v12
    v_exp_f32 v13, v13
    v_exp_f32 v14, v14
    v_exp_f32 v15, v15
    v_pk_add_f32 v[12:13], v[12:13], 1.0 op_sel_hi:[1,0]
    v_pk_add_f32 v[14:15], v[14:15], 1.0 op_sel_hi:[1,0]
    v_rcp_f32 v12, v12
    v_rcp_f32 v13, v13
    v_rcp_f32 v14, v14
    v_rcp_f32 v15, v15
    v_pk_mul_f32 v[108:109], v[108:109], v[12:13]
    v_pk_mul_f32 v[110:111], v[110:111], v[14:15]
    v_lshlrev_b32_e64 v188, 16, v240
    v_and_b32 v189, 0xffff0000, v240
    v_lshlrev_b32_e64 v190, 16, v241
    v_and_b32 v191, 0xffff0000, v241
    v_pk_add_f32 v[112:113], v[112:113], v[188:189]
    v_pk_add_f32 v[114:115], v[114:115], v[190:191]
    v_pk_mul_f32 v[12:13], v[112:113], v[24:25]
    v_pk_mul_f32 v[14:15], v[114:115], v[24:25]
    v_exp_f32 v12, v12
    v_exp_f32 v13, v13
    v_exp_f32 v14, v14
    v_exp_f32 v15, v15
    v_pk_add_f32 v[12:13], v[12:13], 1.0 op_sel_hi:[1,0]
    v_pk_add_f32 v[14:15], v[14:15], 1.0 op_sel_hi:[1,0]
    v_rcp_f32 v12, v12
    v_rcp_f32 v13, v13
    v_rcp_f32 v14, v14
    v_rcp_f32 v15, v15
    v_pk_mul_f32 v[112:113], v[112:113], v[12:13]
    v_pk_mul_f32 v[114:115], v[114:115], v[14:15]
    v_lshlrev_b32_e64 v188, 16, v242
    v_and_b32 v189, 0xffff0000, v242
    v_lshlrev_b32_e64 v190, 16, v243
    v_and_b32 v191, 0xffff0000, v243
    v_pk_add_f32 v[116:117], v[116:117], v[188:189]
    v_pk_add_f32 v[118:119], v[118:119], v[190:191]
    v_pk_mul_f32 v[12:13], v[116:117], v[24:25]
    v_pk_mul_f32 v[14:15], v[118:119], v[24:25]
    v_exp_f32 v12, v12
    v_exp_f32 v13, v13
    v_exp_f32 v14, v14
    v_exp_f32 v15, v15
    v_pk_add_f32 v[12:13], v[12:13], 1.0 op_sel_hi:[1,0]
    v_pk_add_f32 v[14:15], v[14:15], 1.0 op_sel_hi:[1,0]
    v_rcp_f32 v12, v12
    v_rcp_f32 v13, v13
    v_rcp_f32 v14, v14
    v_rcp_f32 v15, v15
    v_pk_mul_f32 v[116:117], v[116:117], v[12:13]
    v_pk_mul_f32 v[118:119], v[118:119], v[14:15]
    v_lshlrev_b32_e64 v188, 16, v244
    v_and_b32 v189, 0xffff0000, v244
    v_lshlrev_b32_e64 v190, 16, v245
    v_and_b32 v191, 0xffff0000, v245
    v_pk_add_f32 v[120:121], v[120:121], v[188:189]
    v_pk_add_f32 v[122:123], v[122:123], v[190:191]
    v_pk_mul_f32 v[12:13], v[120:121], v[24:25]
    v_pk_mul_f32 v[14:15], v[122:123], v[24:25]
    v_exp_f32 v12, v12
    v_exp_f32 v13, v13
    v_exp_f32 v14, v14
    v_exp_f32 v15, v15
    v_pk_add_f32 v[12:13], v[12:13], 1.0 op_sel_hi:[1,0]
    v_pk_add_f32 v[14:15], v[14:15], 1.0 op_sel_hi:[1,0]
    v_rcp_f32 v12, v12
    v_rcp_f32 v13, v13
    v_rcp_f32 v14, v14
    v_rcp_f32 v15, v15
    v_pk_mul_f32 v[120:121], v[120:121], v[12:13]
    v_pk_mul_f32 v[122:123], v[122:123], v[14:15]
    v_lshlrev_b32_e64 v188, 16, v246
    v_and_b32 v189, 0xffff0000, v246
    v_lshlrev_b32_e64 v190, 16, v247
    v_and_b32 v191, 0xffff0000, v247
    v_pk_add_f32 v[124:125], v[124:125], v[188:189]
    v_pk_add_f32 v[126:127], v[126:127], v[190:191]
    v_pk_mul_f32 v[12:13], v[124:125], v[24:25]
    v_pk_mul_f32 v[14:15], v[126:127], v[24:25]
    v_exp_f32 v12, v12
    v_exp_f32 v13, v13
    v_exp_f32 v14, v14
    v_exp_f32 v15, v15
    v_pk_add_f32 v[12:13], v[12:13], 1.0 op_sel_hi:[1,0]
    v_pk_add_f32 v[14:15], v[14:15], 1.0 op_sel_hi:[1,0]
    v_rcp_f32 v12, v12
    v_rcp_f32 v13, v13
    v_rcp_f32 v14, v14
    v_rcp_f32 v15, v15
    v_pk_mul_f32 v[124:125], v[124:125], v[12:13]
    v_pk_mul_f32 v[126:127], v[126:127], v[14:15]
    v_lshlrev_b32_e64 v188, 16, v248
    v_and_b32 v189, 0xffff0000, v248
    v_lshlrev_b32_e64 v190, 16, v249
    v_and_b32 v191, 0xffff0000, v249
    v_pk_add_f32 v[128:129], v[128:129], v[188:189]
    v_pk_add_f32 v[130:131], v[130:131], v[190:191]
    v_pk_mul_f32 v[12:13], v[128:129], v[24:25]
    v_pk_mul_f32 v[14:15], v[130:131], v[24:25]
    v_exp_f32 v12, v12
    v_exp_f32 v13, v13
    v_exp_f32 v14, v14
    v_exp_f32 v15, v15
    v_pk_add_f32 v[12:13], v[12:13], 1.0 op_sel_hi:[1,0]
    v_pk_add_f32 v[14:15], v[14:15], 1.0 op_sel_hi:[1,0]
    v_rcp_f32 v12, v12
    v_rcp_f32 v13, v13
    v_rcp_f32 v14, v14
    v_rcp_f32 v15, v15
    v_pk_mul_f32 v[128:129], v[128:129], v[12:13]
    v_pk_mul_f32 v[130:131], v[130:131], v[14:15]
    v_lshlrev_b32_e64 v188, 16, v250
    v_and_b32 v189, 0xffff0000, v250
    v_lshlrev_b32_e64 v190, 16, v251
    v_and_b32 v191, 0xffff0000, v251
    v_pk_add_f32 v[132:133], v[132:133], v[188:189]
    v_pk_add_f32 v[134:135], v[134:135], v[190:191]
    v_pk_mul_f32 v[12:13], v[132:133], v[24:25]
    v_pk_mul_f32 v[14:15], v[134:135], v[24:25]
    v_exp_f32 v12, v12
    v_exp_f32 v13, v13
    v_exp_f32 v14, v14
    v_exp_f32 v15, v15
    v_pk_add_f32 v[12:13], v[12:13], 1.0 op_sel_hi:[1,0]
    v_pk_add_f32 v[14:15], v[14:15], 1.0 op_sel_hi:[1,0]
    v_rcp_f32 v12, v12
    v_rcp_f32 v13, v13
    v_rcp_f32 v14, v14
    v_rcp_f32 v15, v15
    v_pk_mul_f32 v[132:133], v[132:133], v[12:13]
    v_pk_mul_f32 v[134:135], v[134:135], v[14:15]
    s_waitcnt vmcnt(0)
    v_lshlrev_b32 v184, 16, v168
    v_and_b32 v185, 0xffff0000, v168
    v_lshlrev_b32_e64 v186, 16, v169
    v_and_b32 v187, 0xffff0000, v169
    v_lshlrev_b32_e64 v16, 16, v220
    v_and_b32 v17, 0xffff0000, v220
    v_lshlrev_b32_e64 v18, 16, v221
    v_and_b32 v19, 0xffff0000, v221
    v_pk_fma_f32 v[104:105], v[104:105], v[184:185], v[16:17]
    v_pk_fma_f32 v[106:107], v[106:107], v[186:187], v[18:19]
    v_cvt_pk_bf16_f32 v236, v104, v105
    v_cvt_pk_bf16_f32 v237, v106, v107
    v_lshlrev_b32_e64 v184, 16, v170
    v_and_b32 v185, 0xffff0000, v170
    v_lshlrev_b32_e64 v186, 16, v171
    v_and_b32 v187, 0xffff0000, v171
    v_lshlrev_b32_e64 v16, 16, v222
    v_and_b32 v17, 0xffff0000, v222
    v_lshlrev_b32_e64 v18, 16, v223
    v_and_b32 v19, 0xffff0000, v223
    v_pk_fma_f32 v[108:109], v[108:109], v[184:185], v[16:17]
    v_pk_fma_f32 v[110:111], v[110:111], v[186:187], v[18:19]
    v_cvt_pk_bf16_f32 v238, v108, v109
    v_cvt_pk_bf16_f32 v239, v110, v111
    s_nop 0
    v_permlane32_swap_b32 v236, v238
    v_permlane32_swap_b32 v237, v239
    buffer_store_dwordx4 v[236:239], v9, s[60:63], 0 offen offset:0
    v_lshlrev_b32 v184, 16, v172
    v_and_b32 v185, 0xffff0000, v172
    v_lshlrev_b32_e64 v186, 16, v173
    v_and_b32 v187, 0xffff0000, v173
    v_lshlrev_b32_e64 v16, 16, v224
    v_and_b32 v17, 0xffff0000, v224
    v_lshlrev_b32_e64 v18, 16, v225
    v_and_b32 v19, 0xffff0000, v225
    v_pk_fma_f32 v[112:113], v[112:113], v[184:185], v[16:17]
    v_pk_fma_f32 v[114:115], v[114:115], v[186:187], v[18:19]
    v_cvt_pk_bf16_f32 v240, v112, v113
    v_cvt_pk_bf16_f32 v241, v114, v115
    v_lshlrev_b32_e64 v184, 16, v174
    v_and_b32 v185, 0xffff0000, v174
    v_lshlrev_b32_e64 v186, 16, v175
    v_and_b32 v187, 0xffff0000, v175
    v_lshlrev_b32_e64 v16, 16, v226
    v_and_b32 v17, 0xffff0000, v226
    v_lshlrev_b32_e64 v18, 16, v227
    v_and_b32 v19, 0xffff0000, v227
    v_pk_fma_f32 v[116:117], v[116:117], v[184:185], v[16:17]
    v_pk_fma_f32 v[118:119], v[118:119], v[186:187], v[18:19]
    v_cvt_pk_bf16_f32 v242, v116, v117
    v_cvt_pk_bf16_f32 v243, v118, v119
    s_nop 0
    v_permlane32_swap_b32 v240, v242
    v_permlane32_swap_b32 v241, v243
    buffer_store_dwordx4 v[240:243], v9, s[60:63], 0 offen offset:32
    v_lshlrev_b32 v184, 16, v176
    v_and_b32 v185, 0xffff0000, v176
    v_lshlrev_b32_e64 v186, 16, v177
    v_and_b32 v187, 0xffff0000, v177
    v_lshlrev_b32_e64 v16, 16, v228
    v_and_b32 v17, 0xffff0000, v228
    v_lshlrev_b32_e64 v18, 16, v229
    v_and_b32 v19, 0xffff0000, v229
    v_pk_fma_f32 v[120:121], v[120:121], v[184:185], v[16:17]
    v_pk_fma_f32 v[122:123], v[122:123], v[186:187], v[18:19]
    v_cvt_pk_bf16_f32 v244, v120, v121
    v_cvt_pk_bf16_f32 v245, v122, v123
    v_lshlrev_b32_e64 v184, 16, v178
    v_and_b32 v185, 0xffff0000, v178
    v_lshlrev_b32_e64 v186, 16, v179
    v_and_b32 v187, 0xffff0000, v179
    v_lshlrev_b32_e64 v16, 16, v230
    v_and_b32 v17, 0xffff0000, v230
    v_lshlrev_b32_e64 v18, 16, v231
    v_and_b32 v19, 0xffff0000, v231
    v_pk_fma_f32 v[124:125], v[124:125], v[184:185], v[16:17]
    v_pk_fma_f32 v[126:127], v[126:127], v[186:187], v[18:19]
    v_cvt_pk_bf16_f32 v246, v124, v125
    v_cvt_pk_bf16_f32 v247, v126, v127
    s_nop 0
    v_permlane32_swap_b32 v244, v246
    v_permlane32_swap_b32 v245, v247
    buffer_store_dwordx4 v[244:247], v9, s[60:63], 0 offen offset:64
    v_lshlrev_b32 v184, 16, v180
    v_and_b32 v185, 0xffff0000, v180
    v_lshlrev_b32_e64 v186, 16, v181
    v_and_b32 v187, 0xffff0000, v181
    v_lshlrev_b32_e64 v16, 16, v232
    v_and_b32 v17, 0xffff0000, v232
    v_lshlrev_b32_e64 v18, 16, v233
    v_and_b32 v19, 0xffff0000, v233
    v_pk_fma_f32 v[128:129], v[128:129], v[184:185], v[16:17]
    v_pk_fma_f32 v[130:131], v[130:131], v[186:187], v[18:19]
    v_cvt_pk_bf16_f32 v248, v128, v129
    v_cvt_pk_bf16_f32 v249, v130, v131
    v_lshlrev_b32_e64 v184, 16, v182
    v_and_b32 v185, 0xffff0000, v182
    v_lshlrev_b32_e64 v186, 16, v183
    v_and_b32 v187, 0xffff0000, v183
    v_lshlrev_b32_e64 v16, 16, v234
    v_and_b32 v17, 0xffff0000, v234
    v_lshlrev_b32_e64 v18, 16, v235
    v_and_b32 v19, 0xffff0000, v235
    v_pk_fma_f32 v[132:133], v[132:133], v[184:185], v[16:17]
    v_pk_fma_f32 v[134:135], v[134:135], v[186:187], v[18:19]
    v_cvt_pk_bf16_f32 v250, v132, v133
    v_cvt_pk_bf16_f32 v251, v134, v135
    s_nop 0
    v_permlane32_swap_b32 v248, v250
    v_permlane32_swap_b32 v249, v251
    buffer_store_dwordx4 v[248:251], v9, s[60:63], 0 offen offset:96
    s_endpgm
C_A:
    s_waitcnt lgkmcnt(0)
    v_add_u32 v46, 0, v44
    v_add_u32 v40, 0, v36
    v_add_u32 v41, 0, v37
    v_add_u32 v42, 0, v38
    v_add_u32 v43, 0, v39
    s_barrier
    ds_read_b128 v[232:235], v40 offset:0
    ds_read_b128 v[236:239], v40 offset:4096
    ds_read_b64_tr_b16 v[212:213], v46 offset:0
    ds_read_b64_tr_b16 v[214:215], v46 offset:1280
    ds_read_b64_tr_b16 v[216:217], v46 offset:64
    ds_read_b64_tr_b16 v[218:219], v46 offset:1344
    ds_read_b64_tr_b16 v[220:221], v46 offset:128
    ds_read_b64_tr_b16 v[222:223], v46 offset:1408
    ds_read_b64_tr_b16 v[224:225], v46 offset:192
    ds_read_b64_tr_b16 v[226:227], v46 offset:1472
    ds_read_b64_tr_b16 v[228:229], v46 offset:256
    ds_read_b64_tr_b16 v[230:231], v46 offset:1536
    s_waitcnt lgkmcnt(10)
    s_waitcnt lgkmcnt(8)
    v_mfma_f32_32x32x16_bf16 v[52:67], v[212:215], v[232:235], 0
    ds_read_b128 v[28:31], v41 offset:0
    ds_read_b128 v[32:35], v41 offset:4096
    v_mfma_f32_32x32x16_bf16 v[132:147], v[212:215], v[236:239], 0
    ds_read_b64_tr_b16 v[8:9], v46 offset:5120
    s_waitcnt lgkmcnt(9)
    v_mfma_f32_32x32x16_bf16 v[68:83], v[216:219], v[232:235], 0
    ds_read_b64_tr_b16 v[10:11], v46 offset:6400
    v_mfma_f32_32x32x16_bf16 v[148:163], v[216:219], v[236:239], 0
    ds_read_b64_tr_b16 v[12:13], v46 offset:5184
    s_waitcnt lgkmcnt(9)
    v_mfma_f32_32x32x16_bf16 v[84:99], v[220:223], v[232:235], 0
    ds_read_b64_tr_b16 v[14:15], v46 offset:6464
    v_mfma_f32_32x32x16_bf16 v[164:179], v[220:223], v[236:239], 0
    ds_read_b64_tr_b16 v[16:17], v46 offset:5248
    ds_read_b64_tr_b16 v[18:19], v46 offset:6528
    s_waitcnt lgkmcnt(10)
    v_mfma_f32_32x32x16_bf16 v[100:115], v[224:227], v[232:235], 0
    ds_read_b64_tr_b16 v[20:21], v46 offset:5312
    v_mfma_f32_32x32x16_bf16 v[180:195], v[224:227], v[236:239], 0
    ds_read_b64_tr_b16 v[22:23], v46 offset:6592
    s_waitcnt lgkmcnt(10)
    v_mfma_f32_32x32x16_bf16 v[116:131], v[228:231], v[232:235], 0
    ds_read_b64_tr_b16 v[24:25], v46 offset:5376
    v_mfma_f32_32x32x16_bf16 v[196:211], v[228:231], v[236:239], 0
    ds_read_b64_tr_b16 v[26:27], v46 offset:6656
    s_waitcnt lgkmcnt(10)
    s_waitcnt lgkmcnt(8)
    v_mfma_f32_32x32x16_bf16 v[52:67], v[8:11], v[28:31], v[52:67]
    ds_read_b128 v[232:235], v42 offset:0
    ds_read_b128 v[236:239], v42 offset:4096
    v_mfma_f32_32x32x16_bf16 v[132:147], v[8:11], v[32:35], v[132:147]
    ds_read_b64_tr_b16 v[212:213], v46 offset:10240
    s_waitcnt lgkmcnt(9)
    v_mfma_f32_32x32x16_bf16 v[68:83], v[12:15], v[28:31], v[68:83]
    ds_read_b64_tr_b16 v[214:215], v46 offset:11520
    v_mfma_f32_32x32x16_bf16 v[148:163], v[12:15], v[32:35], v[148:163]
    ds_read_b64_tr_b16 v[216:217], v46 offset:10304
    s_waitcnt lgkmcnt(9)
    v_mfma_f32_32x32x16_bf16 v[84:99], v[16:19], v[28:31], v[84:99]
    ds_read_b64_tr_b16 v[218:219], v46 offset:11584
    v_mfma_f32_32x32x16_bf16 v[164:179], v[16:19], v[32:35], v[164:179]
    ds_read_b64_tr_b16 v[220:221], v46 offset:10368
    ds_read_b64_tr_b16 v[222:223], v46 offset:11648
    s_waitcnt lgkmcnt(10)
    v_mfma_f32_32x32x16_bf16 v[100:115], v[20:23], v[28:31], v[100:115]
    ds_read_b64_tr_b16 v[224:225], v46 offset:10432
    v_mfma_f32_32x32x16_bf16 v[180:195], v[20:23], v[32:35], v[180:195]
    ds_read_b64_tr_b16 v[226:227], v46 offset:11712
    s_waitcnt lgkmcnt(10)
    v_mfma_f32_32x32x16_bf16 v[116:131], v[24:27], v[28:31], v[116:131]
    ds_read_b64_tr_b16 v[228:229], v46 offset:10496
    v_mfma_f32_32x32x16_bf16 v[196:211], v[24:27], v[32:35], v[196:211]
    ds_read_b64_tr_b16 v[230:231], v46 offset:11776
    s_waitcnt lgkmcnt(10)
    s_waitcnt lgkmcnt(8)
    v_mfma_f32_32x32x16_bf16 v[52:67], v[212:215], v[232:235], v[52:67]
    ds_read_b128 v[28:31], v43 offset:0
    ds_read_b128 v[32:35], v43 offset:4096
    v_mfma_f32_32x32x16_bf16 v[132:147], v[212:215], v[236:239], v[132:147]
    ds_read_b64_tr_b16 v[8:9], v46 offset:15360
    s_waitcnt lgkmcnt(9)
    v_mfma_f32_32x32x16_bf16 v[68:83], v[216:219], v[232:235], v[68:83]
    ds_read_b64_tr_b16 v[10:11], v46 offset:16640
    v_mfma_f32_32x32x16_bf16 v[148:163], v[216:219], v[236:239], v[148:163]
    ds_read_b64_tr_b16 v[12:13], v46 offset:15424
    s_waitcnt lgkmcnt(9)
    v_mfma_f32_32x32x16_bf16 v[84:99], v[220:223], v[232:235], v[84:99]
    ds_read_b64_tr_b16 v[14:15], v46 offset:16704
    v_mfma_f32_32x32x16_bf16 v[164:179], v[220:223], v[236:239], v[164:179]
    ds_read_b64_tr_b16 v[16:17], v46 offset:15488
    ds_read_b64_tr_b16 v[18:19], v46 offset:16768
    s_waitcnt lgkmcnt(10)
    v_mfma_f32_32x32x16_bf16 v[100:115], v[224:227], v[232:235], v[100:115]
    ds_read_b64_tr_b16 v[20:21], v46 offset:15552
    v_mfma_f32_32x32x16_bf16 v[180:195], v[224:227], v[236:239], v[180:195]
    ds_read_b64_tr_b16 v[22:23], v46 offset:16832
    s_waitcnt lgkmcnt(10)
    v_mfma_f32_32x32x16_bf16 v[116:131], v[228:231], v[232:235], v[116:131]
    ds_read_b64_tr_b16 v[24:25], v46 offset:15616
    v_mfma_f32_32x32x16_bf16 v[196:211], v[228:231], v[236:239], v[196:211]
    ds_read_b64_tr_b16 v[26:27], v46 offset:16896
    s_waitcnt lgkmcnt(0)
    v_add_u32 v46, 53248, v44
    v_add_u32 v40, 53248, v36
    v_add_u32 v41, 53248, v37
    v_add_u32 v42, 53248, v38
    v_add_u32 v43, 53248, v39
    s_barrier
    v_mfma_f32_32x32x16_bf16 v[52:67], v[8:11], v[28:31], v[52:67]
    ds_read_b128 v[232:235], v40 offset:0
    ds_read_b128 v[236:239], v40 offset:4096
    v_mfma_f32_32x32x16_bf16 v[132:147], v[8:11], v[32:35], v[132:147]
    ds_read_b64_tr_b16 v[212:213], v46 offset:0
    v_mfma_f32_32x32x16_bf16 v[68:83], v[12:15], v[28:31], v[68:83]
    ds_read_b64_tr_b16 v[214:215], v46 offset:1280
    v_mfma_f32_32x32x16_bf16 v[148:163], v[12:15], v[32:35], v[148:163]
    ds_read_b64_tr_b16 v[216:217], v46 offset:64
    v_mfma_f32_32x32x16_bf16 v[84:99], v[16:19], v[28:31], v[84:99]
    ds_read_b64_tr_b16 v[218:219], v46 offset:1344
    v_mfma_f32_32x32x16_bf16 v[164:179], v[16:19], v[32:35], v[164:179]
    ds_read_b64_tr_b16 v[220:221], v46 offset:128
    ds_read_b64_tr_b16 v[222:223], v46 offset:1408
    v_mfma_f32_32x32x16_bf16 v[100:115], v[20:23], v[28:31], v[100:115]
    ds_read_b64_tr_b16 v[224:225], v46 offset:192
    v_mfma_f32_32x32x16_bf16 v[180:195], v[20:23], v[32:35], v[180:195]
    ds_read_b64_tr_b16 v[226:227], v46 offset:1472
    v_mfma_f32_32x32x16_bf16 v[116:131], v[24:27], v[28:31], v[116:131]
    ds_read_b64_tr_b16 v[228:229], v46 offset:256
    v_mfma_f32_32x32x16_bf16 v[196:211], v[24:27], v[32:35], v[196:211]
    ds_read_b64_tr_b16 v[230:231], v46 offset:1536
    s_waitcnt lgkmcnt(10)
    s_waitcnt lgkmcnt(8)
    v_mfma_f32_32x32x16_bf16 v[52:67], v[212:215], v[232:235], v[52:67]
    ds_read_b128 v[28:31], v41 offset:0
    ds_read_b128 v[32:35], v41 offset:4096
    v_mfma_f32_32x32x16_bf16 v[132:147], v[212:215], v[236:239], v[132:147]
    ds_read_b64_tr_b16 v[8:9], v46 offset:5120
    s_waitcnt lgkmcnt(9)
    v_mfma_f32_32x32x16_bf16 v[68:83], v[216:219], v[232:235], v[68:83]
    ds_read_b64_tr_b16 v[10:11], v46 offset:6400
    v_mfma_f32_32x32x16_bf16 v[148:163], v[216:219], v[236:239], v[148:163]
    ds_read_b64_tr_b16 v[12:13], v46 offset:5184
    s_waitcnt lgkmcnt(9)
    v_mfma_f32_32x32x16_bf16 v[84:99], v[220:223], v[232:235], v[84:99]
    ds_read_b64_tr_b16 v[14:15], v46 offset:6464
    v_mfma_f32_32x32x16_bf16 v[164:179], v[220:223], v[236:239], v[164:179]
    ds_read_b64_tr_b16 v[16:17], v46 offset:5248
    ds_read_b64_tr_b16 v[18:19], v46 offset:6528
    s_waitcnt lgkmcnt(10)
    v_mfma_f32_32x32x16_bf16 v[100:115], v[224:227], v[232:235], v[100:115]
    ds_read_b64_tr_b16 v[20:21], v46 offset:5312
    v_mfma_f32_32x32x16_bf16 v[180:195], v[224:227], v[236:239], v[180:195]
    ds_read_b64_tr_b16 v[22:23], v46 offset:6592
    s_waitcnt lgkmcnt(10)
    v_mfma_f32_32x32x16_bf16 v[116:131], v[228:231], v[232:235], v[116:131]
    ds_read_b64_tr_b16 v[24:25], v46 offset:5376
    v_mfma_f32_32x32x16_bf16 v[196:211], v[228:231], v[236:239], v[196:211]
    ds_read_b64_tr_b16 v[26:27], v46 offset:6656
    s_waitcnt lgkmcnt(10)
    s_waitcnt lgkmcnt(8)
    v_mfma_f32_32x32x16_bf16 v[52:67], v[8:11], v[28:31], v[52:67]
    ds_read_b128 v[232:235], v42 offset:0
    ds_read_b128 v[236:239], v42 offset:4096
    v_mfma_f32_32x32x16_bf16 v[132:147], v[8:11], v[32:35], v[132:147]
    ds_read_b64_tr_b16 v[212:213], v46 offset:10240
    s_waitcnt lgkmcnt(9)
    v_mfma_f32_32x32x16_bf16 v[68:83], v[12:15], v[28:31], v[68:83]
    ds_read_b64_tr_b16 v[214:215], v46 offset:11520
    v_mfma_f32_32x32x16_bf16 v[148:163], v[12:15], v[32:35], v[148:163]
    ds_read_b64_tr_b16 v[216:217], v46 offset:10304
    s_waitcnt lgkmcnt(9)
    v_mfma_f32_32x32x16_bf16 v[84:99], v[16:19], v[28:31], v[84:99]
    ds_read_b64_tr_b16 v[218:219], v46 offset:11584
    v_mfma_f32_32x32x16_bf16 v[164:179], v[16:19], v[32:35], v[164:179]
    ds_read_b64_tr_b16 v[220:221], v46 offset:10368
    ds_read_b64_tr_b16 v[222:223], v46 offset:11648
    s_waitcnt lgkmcnt(10)
    v_mfma_f32_32x32x16_bf16 v[100:115], v[20:23], v[28:31], v[100:115]
    ds_read_b64_tr_b16 v[224:225], v46 offset:10432
    v_mfma_f32_32x32x16_bf16 v[180:195], v[20:23], v[32:35], v[180:195]
    ds_read_b64_tr_b16 v[226:227], v46 offset:11712
    s_waitcnt lgkmcnt(10)
    v_mfma_f32_32x32x16_bf16 v[116:131], v[24:27], v[28:31], v[116:131]
    ds_read_b64_tr_b16 v[228:229], v46 offset:10496
    v_mfma_f32_32x32x16_bf16 v[196:211], v[24:27], v[32:35], v[196:211]
    ds_read_b64_tr_b16 v[230:231], v46 offset:11776
    s_waitcnt lgkmcnt(10)
    s_waitcnt lgkmcnt(8)
    v_mfma_f32_32x32x16_bf16 v[52:67], v[212:215], v[232:235], v[52:67]
    ds_read_b128 v[28:31], v43 offset:0
    ds_read_b128 v[32:35], v43 offset:4096
    v_mfma_f32_32x32x16_bf16 v[132:147], v[212:215], v[236:239], v[132:147]
    ds_read_b64_tr_b16 v[8:9], v46 offset:15360
    s_waitcnt lgkmcnt(9)
    v_mfma_f32_32x32x16_bf16 v[68:83], v[216:219], v[232:235], v[68:83]
    ds_read_b64_tr_b16 v[10:11], v46 offset:16640
    v_mfma_f32_32x32x16_bf16 v[148:163], v[216:219], v[236:239], v[148:163]
    ds_read_b64_tr_b16 v[12:13], v46 offset:15424
    s_waitcnt lgkmcnt(9)
    v_mfma_f32_32x32x16_bf16 v[84:99], v[220:223], v[232:235], v[84:99]
    ds_read_b64_tr_b16 v[14:15], v46 offset:16704
    v_mfma_f32_32x32x16_bf16 v[164:179], v[220:223], v[236:239], v[164:179]
    ds_read_b64_tr_b16 v[16:17], v46 offset:15488
    ds_read_b64_tr_b16 v[18:19], v46 offset:16768
    s_waitcnt lgkmcnt(10)
    v_mfma_f32_32x32x16_bf16 v[100:115], v[224:227], v[232:235], v[100:115]
    ds_read_b64_tr_b16 v[20:21], v46 offset:15552
    v_mfma_f32_32x32x16_bf16 v[180:195], v[224:227], v[236:239], v[180:195]
    ds_read_b64_tr_b16 v[22:23], v46 offset:16832
    s_waitcnt lgkmcnt(10)
    v_mfma_f32_32x32x16_bf16 v[116:131], v[228:231], v[232:235], v[116:131]
    ds_read_b64_tr_b16 v[24:25], v46 offset:15616
    v_mfma_f32_32x32x16_bf16 v[196:211], v[228:231], v[236:239], v[196:211]
    ds_read_b64_tr_b16 v[26:27], v46 offset:16896
    s_waitcnt lgkmcnt(0)
    v_add_u32 v46, 106496, v44
    v_add_u32 v40, 106496, v36
    v_add_u32 v41, 106496, v37
    v_add_u32 v42, 106496, v38
    v_add_u32 v43, 106496, v39
    s_barrier
    v_mfma_f32_32x32x16_bf16 v[52:67], v[8:11], v[28:31], v[52:67]
    ds_read_b128 v[232:235], v40 offset:0
    ds_read_b128 v[236:239], v40 offset:4096
    v_mfma_f32_32x32x16_bf16 v[132:147], v[8:11], v[32:35], v[132:147]
    ds_read_b64_tr_b16 v[212:213], v46 offset:0
    v_mfma_f32_32x32x16_bf16 v[68:83], v[12:15], v[28:31], v[68:83]
    ds_read_b64_tr_b16 v[214:215], v46 offset:1280
    v_mfma_f32_32x32x16_bf16 v[148:163], v[12:15], v[32:35], v[148:163]
    ds_read_b64_tr_b16 v[216:217], v46 offset:64
    v_mfma_f32_32x32x16_bf16 v[84:99], v[16:19], v[28:31], v[84:99]
    ds_read_b64_tr_b16 v[218:219], v46 offset:1344
    v_mfma_f32_32x32x16_bf16 v[164:179], v[16:19], v[32:35], v[164:179]
    ds_read_b64_tr_b16 v[220:221], v46 offset:128
    ds_read_b64_tr_b16 v[222:223], v46 offset:1408
    v_mfma_f32_32x32x16_bf16 v[100:115], v[20:23], v[28:31], v[100:115]
    ds_read_b64_tr_b16 v[224:225], v46 offset:192
    v_mfma_f32_32x32x16_bf16 v[180:195], v[20:23], v[32:35], v[180:195]
    ds_read_b64_tr_b16 v[226:227], v46 offset:1472
    v_mfma_f32_32x32x16_bf16 v[116:131], v[24:27], v[28:31], v[116:131]
    ds_read_b64_tr_b16 v[228:229], v46 offset:256
    v_mfma_f32_32x32x16_bf16 v[196:211], v[24:27], v[32:35], v[196:211]
    ds_read_b64_tr_b16 v[230:231], v46 offset:1536
    s_waitcnt lgkmcnt(10)
    s_waitcnt lgkmcnt(8)
    v_mfma_f32_32x32x16_bf16 v[52:67], v[212:215], v[232:235], v[52:67]
    ds_read_b128 v[28:31], v41 offset:0
    ds_read_b128 v[32:35], v41 offset:4096
    v_mfma_f32_32x32x16_bf16 v[132:147], v[212:215], v[236:239], v[132:147]
    ds_read_b64_tr_b16 v[8:9], v46 offset:5120
    s_waitcnt lgkmcnt(9)
    v_mfma_f32_32x32x16_bf16 v[68:83], v[216:219], v[232:235], v[68:83]
    ds_read_b64_tr_b16 v[10:11], v46 offset:6400
    v_mfma_f32_32x32x16_bf16 v[148:163], v[216:219], v[236:239], v[148:163]
    ds_read_b64_tr_b16 v[12:13], v46 offset:5184
    s_waitcnt lgkmcnt(9)
    v_mfma_f32_32x32x16_bf16 v[84:99], v[220:223], v[232:235], v[84:99]
    ds_read_b64_tr_b16 v[14:15], v46 offset:6464
    v_mfma_f32_32x32x16_bf16 v[164:179], v[220:223], v[236:239], v[164:179]
    ds_read_b64_tr_b16 v[16:17], v46 offset:5248
    ds_read_b64_tr_b16 v[18:19], v46 offset:6528
    s_waitcnt lgkmcnt(10)
    v_mfma_f32_32x32x16_bf16 v[100:115], v[224:227], v[232:235], v[100:115]
    ds_read_b64_tr_b16 v[20:21], v46 offset:5312
    v_mfma_f32_32x32x16_bf16 v[180:195], v[224:227], v[236:239], v[180:195]
    ds_read_b64_tr_b16 v[22:23], v46 offset:6592
    s_waitcnt lgkmcnt(10)
    v_mfma_f32_32x32x16_bf16 v[116:131], v[228:231], v[232:235], v[116:131]
    ds_read_b64_tr_b16 v[24:25], v46 offset:5376
    v_mfma_f32_32x32x16_bf16 v[196:211], v[228:231], v[236:239], v[196:211]
    ds_read_b64_tr_b16 v[26:27], v46 offset:6656
    s_waitcnt lgkmcnt(10)
    s_waitcnt lgkmcnt(8)
    v_mfma_f32_32x32x16_bf16 v[52:67], v[8:11], v[28:31], v[52:67]
    ds_read_b128 v[232:235], v42 offset:0
    ds_read_b128 v[236:239], v42 offset:4096
    v_mfma_f32_32x32x16_bf16 v[132:147], v[8:11], v[32:35], v[132:147]
    ds_read_b64_tr_b16 v[212:213], v46 offset:10240
    s_waitcnt lgkmcnt(9)
    v_mfma_f32_32x32x16_bf16 v[68:83], v[12:15], v[28:31], v[68:83]
    ds_read_b64_tr_b16 v[214:215], v46 offset:11520
    v_mfma_f32_32x32x16_bf16 v[148:163], v[12:15], v[32:35], v[148:163]
    ds_read_b64_tr_b16 v[216:217], v46 offset:10304
    s_waitcnt lgkmcnt(9)
    v_mfma_f32_32x32x16_bf16 v[84:99], v[16:19], v[28:31], v[84:99]
    ds_read_b64_tr_b16 v[218:219], v46 offset:11584
    v_mfma_f32_32x32x16_bf16 v[164:179], v[16:19], v[32:35], v[164:179]
    ds_read_b64_tr_b16 v[220:221], v46 offset:10368
    ds_read_b64_tr_b16 v[222:223], v46 offset:11648
    s_waitcnt lgkmcnt(10)
    v_mfma_f32_32x32x16_bf16 v[100:115], v[20:23], v[28:31], v[100:115]
    ds_read_b64_tr_b16 v[224:225], v46 offset:10432
    v_mfma_f32_32x32x16_bf16 v[180:195], v[20:23], v[32:35], v[180:195]
    ds_read_b64_tr_b16 v[226:227], v46 offset:11712
    s_waitcnt lgkmcnt(10)
    v_mfma_f32_32x32x16_bf16 v[116:131], v[24:27], v[28:31], v[116:131]
    ds_read_b64_tr_b16 v[228:229], v46 offset:10496
    v_mfma_f32_32x32x16_bf16 v[196:211], v[24:27], v[32:35], v[196:211]
    ds_read_b64_tr_b16 v[230:231], v46 offset:11776
    s_waitcnt lgkmcnt(10)
    s_waitcnt lgkmcnt(8)
    v_mfma_f32_32x32x16_bf16 v[52:67], v[212:215], v[232:235], v[52:67]
    ds_read_b128 v[28:31], v43 offset:0
    ds_read_b128 v[32:35], v43 offset:4096
    v_mfma_f32_32x32x16_bf16 v[132:147], v[212:215], v[236:239], v[132:147]
    ds_read_b64_tr_b16 v[8:9], v46 offset:15360
    s_waitcnt lgkmcnt(9)
    v_mfma_f32_32x32x16_bf16 v[68:83], v[216:219], v[232:235], v[68:83]
    ds_read_b64_tr_b16 v[10:11], v46 offset:16640
    v_mfma_f32_32x32x16_bf16 v[148:163], v[216:219], v[236:239], v[148:163]
    ds_read_b64_tr_b16 v[12:13], v46 offset:15424
    s_waitcnt lgkmcnt(9)
    v_mfma_f32_32x32x16_bf16 v[84:99], v[220:223], v[232:235], v[84:99]
    ds_read_b64_tr_b16 v[14:15], v46 offset:16704
    v_mfma_f32_32x32x16_bf16 v[164:179], v[220:223], v[236:239], v[164:179]
    ds_read_b64_tr_b16 v[16:17], v46 offset:15488
    ds_read_b64_tr_b16 v[18:19], v46 offset:16768
    s_waitcnt lgkmcnt(10)
    v_mfma_f32_32x32x16_bf16 v[100:115], v[224:227], v[232:235], v[100:115]
    ds_read_b64_tr_b16 v[20:21], v46 offset:15552
    v_mfma_f32_32x32x16_bf16 v[180:195], v[224:227], v[236:239], v[180:195]
    ds_read_b64_tr_b16 v[22:23], v46 offset:16832
    s_waitcnt lgkmcnt(10)
    v_mfma_f32_32x32x16_bf16 v[116:131], v[228:231], v[232:235], v[116:131]
    ds_read_b64_tr_b16 v[24:25], v46 offset:15616
    v_mfma_f32_32x32x16_bf16 v[196:211], v[228:231], v[236:239], v[196:211]
    ds_read_b64_tr_b16 v[26:27], v46 offset:16896
    s_waitcnt lgkmcnt(0)
    v_add_u32 v46, 0, v44
    v_add_u32 v40, 0, v36
    v_add_u32 v41, 0, v37
    v_add_u32 v42, 0, v38
    v_add_u32 v43, 0, v39
    s_barrier
    v_mfma_f32_32x32x16_bf16 v[52:67], v[8:11], v[28:31], v[52:67]
    ds_read_b128 v[232:235], v40 offset:0
    ds_read_b128 v[236:239], v40 offset:4096
    v_mfma_f32_32x32x16_bf16 v[132:147], v[8:11], v[32:35], v[132:147]
    ds_read_b64_tr_b16 v[212:213], v46 offset:0
    v_mfma_f32_32x32x16_bf16 v[68:83], v[12:15], v[28:31], v[68:83]
    ds_read_b64_tr_b16 v[214:215], v46 offset:1280
    v_mfma_f32_32x32x16_bf16 v[148:163], v[12:15], v[32:35], v[148:163]
    ds_read_b64_tr_b16 v[216:217], v46 offset:64
    v_mfma_f32_32x32x16_bf16 v[84:99], v[16:19], v[28:31], v[84:99]
    ds_read_b64_tr_b16 v[218:219], v46 offset:1344
    v_mfma_f32_32x32x16_bf16 v[164:179], v[16:19], v[32:35], v[164:179]
    ds_read_b64_tr_b16 v[220:221], v46 offset:128
    ds_read_b64_tr_b16 v[222:223], v46 offset:1408
    v_mfma_f32_32x32x16_bf16 v[100:115], v[20:23], v[28:31], v[100:115]
    ds_read_b64_tr_b16 v[224:225], v46 offset:192
    v_mfma_f32_32x32x16_bf16 v[180:195], v[20:23], v[32:35], v[180:195]
    ds_read_b64_tr_b16 v[226:227], v46 offset:1472
    v_mfma_f32_32x32x16_bf16 v[116:131], v[24:27], v[28:31], v[116:131]
    ds_read_b64_tr_b16 v[228:229], v46 offset:256
    v_mfma_f32_32x32x16_bf16 v[196:211], v[24:27], v[32:35], v[196:211]
    ds_read_b64_tr_b16 v[230:231], v46 offset:1536
    s_waitcnt lgkmcnt(10)
    s_waitcnt lgkmcnt(8)
    v_mfma_f32_32x32x16_bf16 v[52:67], v[212:215], v[232:235], v[52:67]
    ds_read_b128 v[28:31], v41 offset:0
    ds_read_b128 v[32:35], v41 offset:4096
    v_mfma_f32_32x32x16_bf16 v[132:147], v[212:215], v[236:239], v[132:147]
    ds_read_b64_tr_b16 v[8:9], v46 offset:5120
    s_waitcnt lgkmcnt(9)
    v_mfma_f32_32x32x16_bf16 v[68:83], v[216:219], v[232:235], v[68:83]
    ds_read_b64_tr_b16 v[10:11], v46 offset:6400
    v_mfma_f32_32x32x16_bf16 v[148:163], v[216:219], v[236:239], v[148:163]
    ds_read_b64_tr_b16 v[12:13], v46 offset:5184
    s_waitcnt lgkmcnt(9)
    v_mfma_f32_32x32x16_bf16 v[84:99], v[220:223], v[232:235], v[84:99]
    ds_read_b64_tr_b16 v[14:15], v46 offset:6464
    v_mfma_f32_32x32x16_bf16 v[164:179], v[220:223], v[236:239], v[164:179]
    ds_read_b64_tr_b16 v[16:17], v46 offset:5248
    ds_read_b64_tr_b16 v[18:19], v46 offset:6528
    s_waitcnt lgkmcnt(10)
    v_mfma_f32_32x32x16_bf16 v[100:115], v[224:227], v[232:235], v[100:115]
    ds_read_b64_tr_b16 v[20:21], v46 offset:5312
    v_mfma_f32_32x32x16_bf16 v[180:195], v[224:227], v[236:239], v[180:195]
    ds_read_b64_tr_b16 v[22:23], v46 offset:6592
    s_waitcnt lgkmcnt(10)
    v_mfma_f32_32x32x16_bf16 v[116:131], v[228:231], v[232:235], v[116:131]
    ds_read_b64_tr_b16 v[24:25], v46 offset:5376
    v_mfma_f32_32x32x16_bf16 v[196:211], v[228:231], v[236:239], v[196:211]
    ds_read_b64_tr_b16 v[26:27], v46 offset:6656
    s_waitcnt lgkmcnt(10)
    s_waitcnt lgkmcnt(8)
    v_mfma_f32_32x32x16_bf16 v[52:67], v[8:11], v[28:31], v[52:67]
    ds_read_b128 v[232:235], v42 offset:0
    ds_read_b128 v[236:239], v42 offset:4096
    v_mfma_f32_32x32x16_bf16 v[132:147], v[8:11], v[32:35], v[132:147]
    ds_read_b64_tr_b16 v[212:213], v46 offset:10240
    s_waitcnt lgkmcnt(9)
    v_mfma_f32_32x32x16_bf16 v[68:83], v[12:15], v[28:31], v[68:83]
    ds_read_b64_tr_b16 v[214:215], v46 offset:11520
    v_mfma_f32_32x32x16_bf16 v[148:163], v[12:15], v[32:35], v[148:163]
    ds_read_b64_tr_b16 v[216:217], v46 offset:10304
    s_waitcnt lgkmcnt(9)
    v_mfma_f32_32x32x16_bf16 v[84:99], v[16:19], v[28:31], v[84:99]
    ds_read_b64_tr_b16 v[218:219], v46 offset:11584
    v_mfma_f32_32x32x16_bf16 v[164:179], v[16:19], v[32:35], v[164:179]
    ds_read_b64_tr_b16 v[220:221], v46 offset:10368
    ds_read_b64_tr_b16 v[222:223], v46 offset:11648
    s_waitcnt lgkmcnt(10)
    v_mfma_f32_32x32x16_bf16 v[100:115], v[20:23], v[28:31], v[100:115]
    ds_read_b64_tr_b16 v[224:225], v46 offset:10432
    v_mfma_f32_32x32x16_bf16 v[180:195], v[20:23], v[32:35], v[180:195]
    ds_read_b64_tr_b16 v[226:227], v46 offset:11712
    s_waitcnt lgkmcnt(10)
    v_mfma_f32_32x32x16_bf16 v[116:131], v[24:27], v[28:31], v[116:131]
    ds_read_b64_tr_b16 v[228:229], v46 offset:10496
    v_mfma_f32_32x32x16_bf16 v[196:211], v[24:27], v[32:35], v[196:211]
    ds_read_b64_tr_b16 v[230:231], v46 offset:11776
    s_waitcnt lgkmcnt(10)
    s_waitcnt lgkmcnt(8)
    v_mfma_f32_32x32x16_bf16 v[52:67], v[212:215], v[232:235], v[52:67]
    ds_read_b128 v[28:31], v43 offset:0
    ds_read_b128 v[32:35], v43 offset:4096
    v_mfma_f32_32x32x16_bf16 v[132:147], v[212:215], v[236:239], v[132:147]
    ds_read_b64_tr_b16 v[8:9], v46 offset:15360
    s_waitcnt lgkmcnt(9)
    v_mfma_f32_32x32x16_bf16 v[68:83], v[216:219], v[232:235], v[68:83]
    ds_read_b64_tr_b16 v[10:11], v46 offset:16640
    v_mfma_f32_32x32x16_bf16 v[148:163], v[216:219], v[236:239], v[148:163]
    ds_read_b64_tr_b16 v[12:13], v46 offset:15424
    s_waitcnt lgkmcnt(9)
    v_mfma_f32_32x32x16_bf16 v[84:99], v[220:223], v[232:235], v[84:99]
    ds_read_b64_tr_b16 v[14:15], v46 offset:16704
    v_mfma_f32_32x32x16_bf16 v[164:179], v[220:223], v[236:239], v[164:179]
    ds_read_b64_tr_b16 v[16:17], v46 offset:15488
    ds_read_b64_tr_b16 v[18:19], v46 offset:16768
    s_waitcnt lgkmcnt(10)
    v_mfma_f32_32x32x16_bf16 v[100:115], v[224:227], v[232:235], v[100:115]
    ds_read_b64_tr_b16 v[20:21], v46 offset:15552
    v_mfma_f32_32x32x16_bf16 v[180:195], v[224:227], v[236:239], v[180:195]
    ds_read_b64_tr_b16 v[22:23], v46 offset:16832
    s_waitcnt lgkmcnt(10)
    v_mfma_f32_32x32x16_bf16 v[116:131], v[228:231], v[232:235], v[116:131]
    ds_read_b64_tr_b16 v[24:25], v46 offset:15616
    v_mfma_f32_32x32x16_bf16 v[196:211], v[228:231], v[236:239], v[196:211]
    ds_read_b64_tr_b16 v[26:27], v46 offset:16896
    s_waitcnt lgkmcnt(0)
    v_add_u32 v46, 53248, v44
    v_add_u32 v40, 53248, v36
    v_add_u32 v41, 53248, v37
    v_add_u32 v42, 53248, v38
    v_add_u32 v43, 53248, v39
    s_barrier
    v_mfma_f32_32x32x16_bf16 v[52:67], v[8:11], v[28:31], v[52:67]
    ds_read_b128 v[232:235], v40 offset:0
    ds_read_b128 v[236:239], v40 offset:4096
    v_mfma_f32_32x32x16_bf16 v[132:147], v[8:11], v[32:35], v[132:147]
    ds_read_b64_tr_b16 v[212:213], v46 offset:0
    v_mfma_f32_32x32x16_bf16 v[68:83], v[12:15], v[28:31], v[68:83]
    ds_read_b64_tr_b16 v[214:215], v46 offset:1280
    v_mfma_f32_32x32x16_bf16 v[148:163], v[12:15], v[32:35], v[148:163]
    ds_read_b64_tr_b16 v[216:217], v46 offset:64
    v_mfma_f32_32x32x16_bf16 v[84:99], v[16:19], v[28:31], v[84:99]
    ds_read_b64_tr_b16 v[218:219], v46 offset:1344
    v_mfma_f32_32x32x16_bf16 v[164:179], v[16:19], v[32:35], v[164:179]
    ds_read_b64_tr_b16 v[220:221], v46 offset:128
    ds_read_b64_tr_b16 v[222:223], v46 offset:1408
    v_mfma_f32_32x32x16_bf16 v[100:115], v[20:23], v[28:31], v[100:115]
    ds_read_b64_tr_b16 v[224:225], v46 offset:192
    v_mfma_f32_32x32x16_bf16 v[180:195], v[20:23], v[32:35], v[180:195]
    ds_read_b64_tr_b16 v[226:227], v46 offset:1472
    v_mfma_f32_32x32x16_bf16 v[116:131], v[24:27], v[28:31], v[116:131]
    ds_read_b64_tr_b16 v[228:229], v46 offset:256
    v_mfma_f32_32x32x16_bf16 v[196:211], v[24:27], v[32:35], v[196:211]
    ds_read_b64_tr_b16 v[230:231], v46 offset:1536
    s_waitcnt lgkmcnt(10)
    s_waitcnt lgkmcnt(8)
    v_mfma_f32_32x32x16_bf16 v[52:67], v[212:215], v[232:235], v[52:67]
    ds_read_b128 v[28:31], v41 offset:0
    ds_read_b128 v[32:35], v41 offset:4096
    v_mfma_f32_32x32x16_bf16 v[132:147], v[212:215], v[236:239], v[132:147]
    ds_read_b64_tr_b16 v[8:9], v46 offset:5120
    s_waitcnt lgkmcnt(9)
    v_mfma_f32_32x32x16_bf16 v[68:83], v[216:219], v[232:235], v[68:83]
    ds_read_b64_tr_b16 v[10:11], v46 offset:6400
    v_mfma_f32_32x32x16_bf16 v[148:163], v[216:219], v[236:239], v[148:163]
    ds_read_b64_tr_b16 v[12:13], v46 offset:5184
    s_waitcnt lgkmcnt(9)
    v_mfma_f32_32x32x16_bf16 v[84:99], v[220:223], v[232:235], v[84:99]
    ds_read_b64_tr_b16 v[14:15], v46 offset:6464
    v_mfma_f32_32x32x16_bf16 v[164:179], v[220:223], v[236:239], v[164:179]
    ds_read_b64_tr_b16 v[16:17], v46 offset:5248
    ds_read_b64_tr_b16 v[18:19], v46 offset:6528
    s_waitcnt lgkmcnt(10)
    v_mfma_f32_32x32x16_bf16 v[100:115], v[224:227], v[232:235], v[100:115]
    ds_read_b64_tr_b16 v[20:21], v46 offset:5312
    v_mfma_f32_32x32x16_bf16 v[180:195], v[224:227], v[236:239], v[180:195]
    ds_read_b64_tr_b16 v[22:23], v46 offset:6592
    s_waitcnt lgkmcnt(10)
    v_mfma_f32_32x32x16_bf16 v[116:131], v[228:231], v[232:235], v[116:131]
    ds_read_b64_tr_b16 v[24:25], v46 offset:5376
    v_mfma_f32_32x32x16_bf16 v[196:211], v[228:231], v[236:239], v[196:211]
    ds_read_b64_tr_b16 v[26:27], v46 offset:6656
    s_waitcnt lgkmcnt(10)
    s_waitcnt lgkmcnt(8)
    v_mfma_f32_32x32x16_bf16 v[52:67], v[8:11], v[28:31], v[52:67]
    ds_read_b128 v[232:235], v42 offset:0
    ds_read_b128 v[236:239], v42 offset:4096
    v_mfma_f32_32x32x16_bf16 v[132:147], v[8:11], v[32:35], v[132:147]
    ds_read_b64_tr_b16 v[212:213], v46 offset:10240
    s_waitcnt lgkmcnt(9)
    v_mfma_f32_32x32x16_bf16 v[68:83], v[12:15], v[28:31], v[68:83]
    ds_read_b64_tr_b16 v[214:215], v46 offset:11520
    v_mfma_f32_32x32x16_bf16 v[148:163], v[12:15], v[32:35], v[148:163]
    ds_read_b64_tr_b16 v[216:217], v46 offset:10304
    s_waitcnt lgkmcnt(9)
    v_mfma_f32_32x32x16_bf16 v[84:99], v[16:19], v[28:31], v[84:99]
    ds_read_b64_tr_b16 v[218:219], v46 offset:11584
    v_mfma_f32_32x32x16_bf16 v[164:179], v[16:19], v[32:35], v[164:179]
    ds_read_b64_tr_b16 v[220:221], v46 offset:10368
    ds_read_b64_tr_b16 v[222:223], v46 offset:11648
    s_waitcnt lgkmcnt(10)
    v_mfma_f32_32x32x16_bf16 v[100:115], v[20:23], v[28:31], v[100:115]
    ds_read_b64_tr_b16 v[224:225], v46 offset:10432
    v_mfma_f32_32x32x16_bf16 v[180:195], v[20:23], v[32:35], v[180:195]
    ds_read_b64_tr_b16 v[226:227], v46 offset:11712
    s_waitcnt lgkmcnt(10)
    v_mfma_f32_32x32x16_bf16 v[116:131], v[24:27], v[28:31], v[116:131]
    ds_read_b64_tr_b16 v[228:229], v46 offset:10496
    v_mfma_f32_32x32x16_bf16 v[196:211], v[24:27], v[32:35], v[196:211]
    ds_read_b64_tr_b16 v[230:231], v46 offset:11776
    s_waitcnt lgkmcnt(10)
    s_waitcnt lgkmcnt(8)
    v_mfma_f32_32x32x16_bf16 v[52:67], v[212:215], v[232:235], v[52:67]
    ds_read_b128 v[28:31], v43 offset:0
    ds_read_b128 v[32:35], v43 offset:4096
    v_mfma_f32_32x32x16_bf16 v[132:147], v[212:215], v[236:239], v[132:147]
    ds_read_b64_tr_b16 v[8:9], v46 offset:15360
    s_waitcnt lgkmcnt(9)
    v_mfma_f32_32x32x16_bf16 v[68:83], v[216:219], v[232:235], v[68:83]
    ds_read_b64_tr_b16 v[10:11], v46 offset:16640
    v_mfma_f32_32x32x16_bf16 v[148:163], v[216:219], v[236:239], v[148:163]
    ds_read_b64_tr_b16 v[12:13], v46 offset:15424
    s_waitcnt lgkmcnt(9)
    v_mfma_f32_32x32x16_bf16 v[84:99], v[220:223], v[232:235], v[84:99]
    ds_read_b64_tr_b16 v[14:15], v46 offset:16704
    v_mfma_f32_32x32x16_bf16 v[164:179], v[220:223], v[236:239], v[164:179]
    ds_read_b64_tr_b16 v[16:17], v46 offset:15488
    ds_read_b64_tr_b16 v[18:19], v46 offset:16768
    s_waitcnt lgkmcnt(10)
    v_mfma_f32_32x32x16_bf16 v[100:115], v[224:227], v[232:235], v[100:115]
    ds_read_b64_tr_b16 v[20:21], v46 offset:15552
    v_mfma_f32_32x32x16_bf16 v[180:195], v[224:227], v[236:239], v[180:195]
    ds_read_b64_tr_b16 v[22:23], v46 offset:16832
    s_waitcnt lgkmcnt(10)
    v_mfma_f32_32x32x16_bf16 v[116:131], v[228:231], v[232:235], v[116:131]
    ds_read_b64_tr_b16 v[24:25], v46 offset:15616
    v_mfma_f32_32x32x16_bf16 v[196:211], v[228:231], v[236:239], v[196:211]
    ds_read_b64_tr_b16 v[26:27], v46 offset:16896
    s_waitcnt lgkmcnt(0)
    v_add_u32 v46, 106496, v44
    v_add_u32 v40, 106496, v36
    v_add_u32 v41, 106496, v37
    v_add_u32 v42, 106496, v38
    v_add_u32 v43, 106496, v39
    s_barrier
    v_mfma_f32_32x32x16_bf16 v[52:67], v[8:11], v[28:31], v[52:67]
    ds_read_b128 v[232:235], v40 offset:0
    ds_read_b128 v[236:239], v40 offset:4096
    v_mfma_f32_32x32x16_bf16 v[132:147], v[8:11], v[32:35], v[132:147]
    ds_read_b64_tr_b16 v[212:213], v46 offset:0
    v_mfma_f32_32x32x16_bf16 v[68:83], v[12:15], v[28:31], v[68:83]
    ds_read_b64_tr_b16 v[214:215], v46 offset:1280
    v_mfma_f32_32x32x16_bf16 v[148:163], v[12:15], v[32:35], v[148:163]
    ds_read_b64_tr_b16 v[216:217], v46 offset:64
    v_mfma_f32_32x32x16_bf16 v[84:99], v[16:19], v[28:31], v[84:99]
    ds_read_b64_tr_b16 v[218:219], v46 offset:1344
    v_mfma_f32_32x32x16_bf16 v[164:179], v[16:19], v[32:35], v[164:179]
    ds_read_b64_tr_b16 v[220:221], v46 offset:128
    ds_read_b64_tr_b16 v[222:223], v46 offset:1408
    v_mfma_f32_32x32x16_bf16 v[100:115], v[20:23], v[28:31], v[100:115]
    ds_read_b64_tr_b16 v[224:225], v46 offset:192
    v_mfma_f32_32x32x16_bf16 v[180:195], v[20:23], v[32:35], v[180:195]
    ds_read_b64_tr_b16 v[226:227], v46 offset:1472
    v_mfma_f32_32x32x16_bf16 v[116:131], v[24:27], v[28:31], v[116:131]
    ds_read_b64_tr_b16 v[228:229], v46 offset:256
    v_mfma_f32_32x32x16_bf16 v[196:211], v[24:27], v[32:35], v[196:211]
    ds_read_b64_tr_b16 v[230:231], v46 offset:1536
    s_waitcnt lgkmcnt(10)
    s_waitcnt lgkmcnt(8)
    v_mfma_f32_32x32x16_bf16 v[52:67], v[212:215], v[232:235], v[52:67]
    ds_read_b128 v[28:31], v41 offset:0
    ds_read_b128 v[32:35], v41 offset:4096
    v_mfma_f32_32x32x16_bf16 v[132:147], v[212:215], v[236:239], v[132:147]
    ds_read_b64_tr_b16 v[8:9], v46 offset:5120
    s_waitcnt lgkmcnt(9)
    v_mfma_f32_32x32x16_bf16 v[68:83], v[216:219], v[232:235], v[68:83]
    ds_read_b64_tr_b16 v[10:11], v46 offset:6400
    v_mfma_f32_32x32x16_bf16 v[148:163], v[216:219], v[236:239], v[148:163]
    ds_read_b64_tr_b16 v[12:13], v46 offset:5184
    s_waitcnt lgkmcnt(9)
    v_mfma_f32_32x32x16_bf16 v[84:99], v[220:223], v[232:235], v[84:99]
    ds_read_b64_tr_b16 v[14:15], v46 offset:6464
    v_mfma_f32_32x32x16_bf16 v[164:179], v[220:223], v[236:239], v[164:179]
    ds_read_b64_tr_b16 v[16:17], v46 offset:5248
    ds_read_b64_tr_b16 v[18:19], v46 offset:6528
    s_waitcnt lgkmcnt(10)
    v_mfma_f32_32x32x16_bf16 v[100:115], v[224:227], v[232:235], v[100:115]
    ds_read_b64_tr_b16 v[20:21], v46 offset:5312
    v_mfma_f32_32x32x16_bf16 v[180:195], v[224:227], v[236:239], v[180:195]
    ds_read_b64_tr_b16 v[22:23], v46 offset:6592
    s_waitcnt lgkmcnt(10)
    v_mfma_f32_32x32x16_bf16 v[116:131], v[228:231], v[232:235], v[116:131]
    ds_read_b64_tr_b16 v[24:25], v46 offset:5376
    v_mfma_f32_32x32x16_bf16 v[196:211], v[228:231], v[236:239], v[196:211]
    ds_read_b64_tr_b16 v[26:27], v46 offset:6656
    s_waitcnt lgkmcnt(10)
    s_waitcnt lgkmcnt(8)
    v_mfma_f32_32x32x16_bf16 v[52:67], v[8:11], v[28:31], v[52:67]
    ds_read_b128 v[232:235], v42 offset:0
    ds_read_b128 v[236:239], v42 offset:4096
    v_mfma_f32_32x32x16_bf16 v[132:147], v[8:11], v[32:35], v[132:147]
    ds_read_b64_tr_b16 v[212:213], v46 offset:10240
    s_waitcnt lgkmcnt(9)
    v_mfma_f32_32x32x16_bf16 v[68:83], v[12:15], v[28:31], v[68:83]
    ds_read_b64_tr_b16 v[214:215], v46 offset:11520
    v_mfma_f32_32x32x16_bf16 v[148:163], v[12:15], v[32:35], v[148:163]
    ds_read_b64_tr_b16 v[216:217], v46 offset:10304
    s_waitcnt lgkmcnt(9)
    v_mfma_f32_32x32x16_bf16 v[84:99], v[16:19], v[28:31], v[84:99]
    ds_read_b64_tr_b16 v[218:219], v46 offset:11584
    v_mfma_f32_32x32x16_bf16 v[164:179], v[16:19], v[32:35], v[164:179]
    ds_read_b64_tr_b16 v[220:221], v46 offset:10368
    ds_read_b64_tr_b16 v[222:223], v46 offset:11648
    s_waitcnt lgkmcnt(10)
    v_mfma_f32_32x32x16_bf16 v[100:115], v[20:23], v[28:31], v[100:115]
    ds_read_b64_tr_b16 v[224:225], v46 offset:10432
    v_mfma_f32_32x32x16_bf16 v[180:195], v[20:23], v[32:35], v[180:195]
    ds_read_b64_tr_b16 v[226:227], v46 offset:11712
    s_waitcnt lgkmcnt(10)
    v_mfma_f32_32x32x16_bf16 v[116:131], v[24:27], v[28:31], v[116:131]
    ds_read_b64_tr_b16 v[228:229], v46 offset:10496
    v_mfma_f32_32x32x16_bf16 v[196:211], v[24:27], v[32:35], v[196:211]
    ds_read_b64_tr_b16 v[230:231], v46 offset:11776
    s_waitcnt lgkmcnt(10)
    s_waitcnt lgkmcnt(8)
    v_mfma_f32_32x32x16_bf16 v[52:67], v[212:215], v[232:235], v[52:67]
    ds_read_b128 v[28:31], v43 offset:0
    ds_read_b128 v[32:35], v43 offset:4096
    v_mfma_f32_32x32x16_bf16 v[132:147], v[212:215], v[236:239], v[132:147]
    ds_read_b64_tr_b16 v[8:9], v46 offset:15360
    s_waitcnt lgkmcnt(9)
    v_mfma_f32_32x32x16_bf16 v[68:83], v[216:219], v[232:235], v[68:83]
    ds_read_b64_tr_b16 v[10:11], v46 offset:16640
    v_mfma_f32_32x32x16_bf16 v[148:163], v[216:219], v[236:239], v[148:163]
    ds_read_b64_tr_b16 v[12:13], v46 offset:15424
    s_waitcnt lgkmcnt(9)
    v_mfma_f32_32x32x16_bf16 v[84:99], v[220:223], v[232:235], v[84:99]
    ds_read_b64_tr_b16 v[14:15], v46 offset:16704
    v_mfma_f32_32x32x16_bf16 v[164:179], v[220:223], v[236:239], v[164:179]
    ds_read_b64_tr_b16 v[16:17], v46 offset:15488
    ds_read_b64_tr_b16 v[18:19], v46 offset:16768
    s_waitcnt lgkmcnt(10)
    v_mfma_f32_32x32x16_bf16 v[100:115], v[224:227], v[232:235], v[100:115]
    ds_read_b64_tr_b16 v[20:21], v46 offset:15552
    v_mfma_f32_32x32x16_bf16 v[180:195], v[224:227], v[236:239], v[180:195]
    ds_read_b64_tr_b16 v[22:23], v46 offset:16832
    s_waitcnt lgkmcnt(10)
    v_mfma_f32_32x32x16_bf16 v[116:131], v[228:231], v[232:235], v[116:131]
    ds_read_b64_tr_b16 v[24:25], v46 offset:15616
    v_mfma_f32_32x32x16_bf16 v[196:211], v[228:231], v[236:239], v[196:211]
    ds_read_b64_tr_b16 v[26:27], v46 offset:16896
    s_waitcnt lgkmcnt(0)
    v_add_u32 v46, 0, v44
    v_add_u32 v40, 0, v36
    v_add_u32 v41, 0, v37
    v_add_u32 v42, 0, v38
    v_add_u32 v43, 0, v39
    s_barrier
    v_mfma_f32_32x32x16_bf16 v[52:67], v[8:11], v[28:31], v[52:67]
    ds_read_b128 v[232:235], v40 offset:0
    ds_read_b128 v[236:239], v40 offset:4096
    v_mfma_f32_32x32x16_bf16 v[132:147], v[8:11], v[32:35], v[132:147]
    ds_read_b64_tr_b16 v[212:213], v46 offset:0
    v_mfma_f32_32x32x16_bf16 v[68:83], v[12:15], v[28:31], v[68:83]
    ds_read_b64_tr_b16 v[214:215], v46 offset:1280
    v_mfma_f32_32x32x16_bf16 v[148:163], v[12:15], v[32:35], v[148:163]
    ds_read_b64_tr_b16 v[216:217], v46 offset:64
    v_mfma_f32_32x32x16_bf16 v[84:99], v[16:19], v[28:31], v[84:99]
    ds_read_b64_tr_b16 v[218:219], v46 offset:1344
    v_mfma_f32_32x32x16_bf16 v[164:179], v[16:19], v[32:35], v[164:179]
    ds_read_b64_tr_b16 v[220:221], v46 offset:128
    ds_read_b64_tr_b16 v[222:223], v46 offset:1408
    v_mfma_f32_32x32x16_bf16 v[100:115], v[20:23], v[28:31], v[100:115]
    ds_read_b64_tr_b16 v[224:225], v46 offset:192
    v_mfma_f32_32x32x16_bf16 v[180:195], v[20:23], v[32:35], v[180:195]
    ds_read_b64_tr_b16 v[226:227], v46 offset:1472
    v_mfma_f32_32x32x16_bf16 v[116:131], v[24:27], v[28:31], v[116:131]
    ds_read_b64_tr_b16 v[228:229], v46 offset:256
    v_mfma_f32_32x32x16_bf16 v[196:211], v[24:27], v[32:35], v[196:211]
    ds_read_b64_tr_b16 v[230:231], v46 offset:1536
    s_waitcnt lgkmcnt(10)
    s_waitcnt lgkmcnt(8)
    v_mfma_f32_32x32x16_bf16 v[52:67], v[212:215], v[232:235], v[52:67]
    ds_read_b128 v[28:31], v41 offset:0
    ds_read_b128 v[32:35], v41 offset:4096
    v_mfma_f32_32x32x16_bf16 v[132:147], v[212:215], v[236:239], v[132:147]
    ds_read_b64_tr_b16 v[8:9], v46 offset:5120
    s_waitcnt lgkmcnt(9)
    v_mfma_f32_32x32x16_bf16 v[68:83], v[216:219], v[232:235], v[68:83]
    ds_read_b64_tr_b16 v[10:11], v46 offset:6400
    v_mfma_f32_32x32x16_bf16 v[148:163], v[216:219], v[236:239], v[148:163]
    ds_read_b64_tr_b16 v[12:13], v46 offset:5184
    s_waitcnt lgkmcnt(9)
    v_mfma_f32_32x32x16_bf16 v[84:99], v[220:223], v[232:235], v[84:99]
    ds_read_b64_tr_b16 v[14:15], v46 offset:6464
    v_mfma_f32_32x32x16_bf16 v[164:179], v[220:223], v[236:239], v[164:179]
    ds_read_b64_tr_b16 v[16:17], v46 offset:5248
    ds_read_b64_tr_b16 v[18:19], v46 offset:6528
    s_waitcnt lgkmcnt(10)
    v_mfma_f32_32x32x16_bf16 v[100:115], v[224:227], v[232:235], v[100:115]
    ds_read_b64_tr_b16 v[20:21], v46 offset:5312
    v_mfma_f32_32x32x16_bf16 v[180:195], v[224:227], v[236:239], v[180:195]
    ds_read_b64_tr_b16 v[22:23], v46 offset:6592
    s_waitcnt lgkmcnt(10)
    v_mfma_f32_32x32x16_bf16 v[116:131], v[228:231], v[232:235], v[116:131]
    ds_read_b64_tr_b16 v[24:25], v46 offset:5376
    v_mfma_f32_32x32x16_bf16 v[196:211], v[228:231], v[236:239], v[196:211]
    ds_read_b64_tr_b16 v[26:27], v46 offset:6656
    s_waitcnt lgkmcnt(10)
    s_waitcnt lgkmcnt(8)
    v_mfma_f32_32x32x16_bf16 v[52:67], v[8:11], v[28:31], v[52:67]
    ds_read_b128 v[232:235], v42 offset:0
    ds_read_b128 v[236:239], v42 offset:4096
    v_mfma_f32_32x32x16_bf16 v[132:147], v[8:11], v[32:35], v[132:147]
    ds_read_b64_tr_b16 v[212:213], v46 offset:10240
    s_waitcnt lgkmcnt(9)
    v_mfma_f32_32x32x16_bf16 v[68:83], v[12:15], v[28:31], v[68:83]
    ds_read_b64_tr_b16 v[214:215], v46 offset:11520
    v_mfma_f32_32x32x16_bf16 v[148:163], v[12:15], v[32:35], v[148:163]
    ds_read_b64_tr_b16 v[216:217], v46 offset:10304
    s_waitcnt lgkmcnt(9)
    v_mfma_f32_32x32x16_bf16 v[84:99], v[16:19], v[28:31], v[84:99]
    ds_read_b64_tr_b16 v[218:219], v46 offset:11584
    v_mfma_f32_32x32x16_bf16 v[164:179], v[16:19], v[32:35], v[164:179]
    ds_read_b64_tr_b16 v[220:221], v46 offset:10368
    ds_read_b64_tr_b16 v[222:223], v46 offset:11648
    s_waitcnt lgkmcnt(10)
    v_mfma_f32_32x32x16_bf16 v[100:115], v[20:23], v[28:31], v[100:115]
    ds_read_b64_tr_b16 v[224:225], v46 offset:10432
    v_mfma_f32_32x32x16_bf16 v[180:195], v[20:23], v[32:35], v[180:195]
    ds_read_b64_tr_b16 v[226:227], v46 offset:11712
    s_waitcnt lgkmcnt(10)
    v_mfma_f32_32x32x16_bf16 v[116:131], v[24:27], v[28:31], v[116:131]
    ds_read_b64_tr_b16 v[228:229], v46 offset:10496
    v_mfma_f32_32x32x16_bf16 v[196:211], v[24:27], v[32:35], v[196:211]
    ds_read_b64_tr_b16 v[230:231], v46 offset:11776
    s_waitcnt lgkmcnt(10)
    s_waitcnt lgkmcnt(8)
    v_mfma_f32_32x32x16_bf16 v[52:67], v[212:215], v[232:235], v[52:67]
    ds_read_b128 v[28:31], v43 offset:0
    ds_read_b128 v[32:35], v43 offset:4096
    v_mfma_f32_32x32x16_bf16 v[132:147], v[212:215], v[236:239], v[132:147]
    ds_read_b64_tr_b16 v[8:9], v46 offset:15360
    s_waitcnt lgkmcnt(9)
    v_mfma_f32_32x32x16_bf16 v[68:83], v[216:219], v[232:235], v[68:83]
    ds_read_b64_tr_b16 v[10:11], v46 offset:16640
    v_mfma_f32_32x32x16_bf16 v[148:163], v[216:219], v[236:239], v[148:163]
    ds_read_b64_tr_b16 v[12:13], v46 offset:15424
    s_waitcnt lgkmcnt(9)
    v_mfma_f32_32x32x16_bf16 v[84:99], v[220:223], v[232:235], v[84:99]
    ds_read_b64_tr_b16 v[14:15], v46 offset:16704
    v_mfma_f32_32x32x16_bf16 v[164:179], v[220:223], v[236:239], v[164:179]
    ds_read_b64_tr_b16 v[16:17], v46 offset:15488
    ds_read_b64_tr_b16 v[18:19], v46 offset:16768
    s_waitcnt lgkmcnt(10)
    v_mfma_f32_32x32x16_bf16 v[100:115], v[224:227], v[232:235], v[100:115]
    ds_read_b64_tr_b16 v[20:21], v46 offset:15552
    v_mfma_f32_32x32x16_bf16 v[180:195], v[224:227], v[236:239], v[180:195]
    ds_read_b64_tr_b16 v[22:23], v46 offset:16832
    s_waitcnt lgkmcnt(10)
    v_mfma_f32_32x32x16_bf16 v[116:131], v[228:231], v[232:235], v[116:131]
    ds_read_b64_tr_b16 v[24:25], v46 offset:15616
    v_mfma_f32_32x32x16_bf16 v[196:211], v[228:231], v[236:239], v[196:211]
    ds_read_b64_tr_b16 v[26:27], v46 offset:16896
    s_waitcnt lgkmcnt(0)
    v_add_u32 v46, 53248, v44
    v_add_u32 v40, 53248, v36
    v_add_u32 v41, 53248, v37
    v_add_u32 v42, 53248, v38
    v_add_u32 v43, 53248, v39
    s_barrier
    v_mfma_f32_32x32x16_bf16 v[52:67], v[8:11], v[28:31], v[52:67]
    ds_read_b128 v[232:235], v40 offset:0
    ds_read_b128 v[236:239], v40 offset:4096
    v_mfma_f32_32x32x16_bf16 v[132:147], v[8:11], v[32:35], v[132:147]
    ds_read_b64_tr_b16 v[212:213], v46 offset:0
    v_mfma_f32_32x32x16_bf16 v[68:83], v[12:15], v[28:31], v[68:83]
    ds_read_b64_tr_b16 v[214:215], v46 offset:1280
    v_mfma_f32_32x32x16_bf16 v[148:163], v[12:15], v[32:35], v[148:163]
    ds_read_b64_tr_b16 v[216:217], v46 offset:64
    v_mfma_f32_32x32x16_bf16 v[84:99], v[16:19], v[28:31], v[84:99]
    ds_read_b64_tr_b16 v[218:219], v46 offset:1344
    v_mfma_f32_32x32x16_bf16 v[164:179], v[16:19], v[32:35], v[164:179]
    ds_read_b64_tr_b16 v[220:221], v46 offset:128
    ds_read_b64_tr_b16 v[222:223], v46 offset:1408
    v_mfma_f32_32x32x16_bf16 v[100:115], v[20:23], v[28:31], v[100:115]
    ds_read_b64_tr_b16 v[224:225], v46 offset:192
    v_mfma_f32_32x32x16_bf16 v[180:195], v[20:23], v[32:35], v[180:195]
    ds_read_b64_tr_b16 v[226:227], v46 offset:1472
    v_mfma_f32_32x32x16_bf16 v[116:131], v[24:27], v[28:31], v[116:131]
    ds_read_b64_tr_b16 v[228:229], v46 offset:256
    v_mfma_f32_32x32x16_bf16 v[196:211], v[24:27], v[32:35], v[196:211]
    ds_read_b64_tr_b16 v[230:231], v46 offset:1536
    v_and_b32 v5, 31, v1
    v_lshlrev_b32_e64 v5, 3, v5
    v_add_u32 v5, 159744, v5
    s_lshl_b32 s83, s72, 9
    v_add_u32 v3, s83, v5
    ds_read_b64 v[48:49], v3 offset:2048
    ds_read_b64 v[50:51], v3 offset:2304
    s_waitcnt lgkmcnt(12)
    s_waitcnt lgkmcnt(10)
    v_mfma_f32_32x32x16_bf16 v[52:67], v[212:215], v[232:235], v[52:67]
    ds_read_b128 v[28:31], v41 offset:0
    ds_read_b128 v[32:35], v41 offset:4096
    v_mfma_f32_32x32x16_bf16 v[132:147], v[212:215], v[236:239], v[132:147]
    ds_read_b64_tr_b16 v[8:9], v46 offset:5120
    s_waitcnt lgkmcnt(11)
    v_mfma_f32_32x32x16_bf16 v[68:83], v[216:219], v[232:235], v[68:83]
    ds_read_b64_tr_b16 v[10:11], v46 offset:6400
    v_mfma_f32_32x32x16_bf16 v[148:163], v[216:219], v[236:239], v[148:163]
    ds_read_b64_tr_b16 v[12:13], v46 offset:5184
    s_waitcnt lgkmcnt(11)
    v_mfma_f32_32x32x16_bf16 v[84:99], v[220:223], v[232:235], v[84:99]
    ds_read_b64_tr_b16 v[14:15], v46 offset:6464
    v_mfma_f32_32x32x16_bf16 v[164:179], v[220:223], v[236:239], v[164:179]
    ds_read_b64_tr_b16 v[16:17], v46 offset:5248
    ds_read_b64_tr_b16 v[18:19], v46 offset:6528
    s_waitcnt lgkmcnt(12)
    v_mfma_f32_32x32x16_bf16 v[100:115], v[224:227], v[232:235], v[100:115]
    ds_read_b64_tr_b16 v[20:21], v46 offset:5312
    v_mfma_f32_32x32x16_bf16 v[180:195], v[224:227], v[236:239], v[180:195]
    ds_read_b64_tr_b16 v[22:23], v46 offset:6592
    s_waitcnt lgkmcnt(12)
    v_mfma_f32_32x32x16_bf16 v[116:131], v[228:231], v[232:235], v[116:131]
    ds_read_b64_tr_b16 v[24:25], v46 offset:5376
    v_mfma_f32_32x32x16_bf16 v[196:211], v[228:231], v[236:239], v[196:211]
    ds_read_b64_tr_b16 v[26:27], v46 offset:6656
    s_waitcnt lgkmcnt(10)
    s_waitcnt lgkmcnt(8)
    v_mfma_f32_32x32x16_bf16 v[52:67], v[8:11], v[28:31], v[52:67]
    ds_read_b128 v[232:235], v42 offset:0
    ds_read_b128 v[236:239], v42 offset:4096
    v_mfma_f32_32x32x16_bf16 v[132:147], v[8:11], v[32:35], v[132:147]
    ds_read_b64_tr_b16 v[212:213], v46 offset:10240
    s_waitcnt lgkmcnt(9)
    v_mfma_f32_32x32x16_bf16 v[68:83], v[12:15], v[28:31], v[68:83]
    ds_read_b64_tr_b16 v[214:215], v46 offset:11520
    v_mfma_f32_32x32x16_bf16 v[148:163], v[12:15], v[32:35], v[148:163]
    ds_read_b64_tr_b16 v[216:217], v46 offset:10304
    s_waitcnt lgkmcnt(9)
    v_mfma_f32_32x32x16_bf16 v[84:99], v[16:19], v[28:31], v[84:99]
    ds_read_b64_tr_b16 v[218:219], v46 offset:11584
    v_mfma_f32_32x32x16_bf16 v[164:179], v[16:19], v[32:35], v[164:179]
    ds_read_b64_tr_b16 v[220:221], v46 offset:10368
    ds_read_b64_tr_b16 v[222:223], v46 offset:11648
    s_waitcnt lgkmcnt(10)
    v_mfma_f32_32x32x16_bf16 v[100:115], v[20:23], v[28:31], v[100:115]
    ds_read_b64_tr_b16 v[224:225], v46 offset:10432
    v_mfma_f32_32x32x16_bf16 v[180:195], v[20:23], v[32:35], v[180:195]
    ds_read_b64_tr_b16 v[226:227], v46 offset:11712
    s_waitcnt lgkmcnt(10)
    v_mfma_f32_32x32x16_bf16 v[116:131], v[24:27], v[28:31], v[116:131]
    ds_read_b64_tr_b16 v[228:229], v46 offset:10496
    v_mfma_f32_32x32x16_bf16 v[196:211], v[24:27], v[32:35], v[196:211]
    ds_read_b64_tr_b16 v[230:231], v46 offset:11776
    s_waitcnt lgkmcnt(10)
    s_waitcnt lgkmcnt(8)
    v_mfma_f32_32x32x16_bf16 v[52:67], v[212:215], v[232:235], v[52:67]
    ds_read_b128 v[28:31], v43 offset:0
    ds_read_b128 v[32:35], v43 offset:4096
    v_mfma_f32_32x32x16_bf16 v[132:147], v[212:215], v[236:239], v[132:147]
    ds_read_b64_tr_b16 v[8:9], v46 offset:15360
    s_waitcnt lgkmcnt(9)
    v_mfma_f32_32x32x16_bf16 v[68:83], v[216:219], v[232:235], v[68:83]
    ds_read_b64_tr_b16 v[10:11], v46 offset:16640
    v_mfma_f32_32x32x16_bf16 v[148:163], v[216:219], v[236:239], v[148:163]
    ds_read_b64_tr_b16 v[12:13], v46 offset:15424
    s_waitcnt lgkmcnt(9)
    v_mfma_f32_32x32x16_bf16 v[84:99], v[220:223], v[232:235], v[84:99]
    ds_read_b64_tr_b16 v[14:15], v46 offset:16704
    v_mfma_f32_32x32x16_bf16 v[164:179], v[220:223], v[236:239], v[164:179]
    ds_read_b64_tr_b16 v[16:17], v46 offset:15488
    ds_read_b64_tr_b16 v[18:19], v46 offset:16768
    s_waitcnt lgkmcnt(10)
    v_mfma_f32_32x32x16_bf16 v[100:115], v[224:227], v[232:235], v[100:115]
    ds_read_b64_tr_b16 v[20:21], v46 offset:15552
    v_mfma_f32_32x32x16_bf16 v[180:195], v[224:227], v[236:239], v[180:195]
    ds_read_b64_tr_b16 v[22:23], v46 offset:16832
    s_waitcnt lgkmcnt(10)
    v_mfma_f32_32x32x16_bf16 v[116:131], v[228:231], v[232:235], v[116:131]
    ds_read_b64_tr_b16 v[24:25], v46 offset:15616
    v_mfma_f32_32x32x16_bf16 v[196:211], v[228:231], v[236:239], v[196:211]
    ds_read_b64_tr_b16 v[26:27], v46 offset:16896
    s_waitcnt lgkmcnt(0)
    v_add_u32 v46, 106496, v44
    v_add_u32 v40, 106496, v36
    v_add_u32 v41, 106496, v37
    v_add_u32 v42, 106496, v38
    v_add_u32 v43, 106496, v39
    s_barrier
    v_mfma_f32_32x32x16_bf16 v[52:67], v[8:11], v[28:31], v[52:67]
    ds_read_b128 v[232:235], v40 offset:0
    ds_read_b128 v[236:239], v40 offset:4096
    v_mfma_f32_32x32x16_bf16 v[132:147], v[8:11], v[32:35], v[132:147]
    ds_read_b64_tr_b16 v[212:213], v46 offset:0
    v_mfma_f32_32x32x16_bf16 v[68:83], v[12:15], v[28:31], v[68:83]
    ds_read_b64_tr_b16 v[214:215], v46 offset:1280
    v_mfma_f32_32x32x16_bf16 v[148:163], v[12:15], v[32:35], v[148:163]
    ds_read_b64_tr_b16 v[216:217], v46 offset:64
    v_mfma_f32_32x32x16_bf16 v[84:99], v[16:19], v[28:31], v[84:99]
    ds_read_b64_tr_b16 v[218:219], v46 offset:1344
    v_mfma_f32_32x32x16_bf16 v[164:179], v[16:19], v[32:35], v[164:179]
    ds_read_b64_tr_b16 v[220:221], v46 offset:128
    ds_read_b64_tr_b16 v[222:223], v46 offset:1408
    v_mfma_f32_32x32x16_bf16 v[100:115], v[20:23], v[28:31], v[100:115]
    ds_read_b64_tr_b16 v[224:225], v46 offset:192
    v_mfma_f32_32x32x16_bf16 v[180:195], v[20:23], v[32:35], v[180:195]
    ds_read_b64_tr_b16 v[226:227], v46 offset:1472
    v_mfma_f32_32x32x16_bf16 v[116:131], v[24:27], v[28:31], v[116:131]
    ds_read_b64_tr_b16 v[228:229], v46 offset:256
    v_mfma_f32_32x32x16_bf16 v[196:211], v[24:27], v[32:35], v[196:211]
    ds_read_b64_tr_b16 v[230:231], v46 offset:1536
    v_sub_f32 v3, 0, v48
    v_cmp_gt_u32 vcc, 32, v1
    s_nop 1
    v_cndmask_b32 v3, 0, v3, vcc
    v_cvt_pk_bf16_f32 v240, v3, v3
    v_and_b32 v4, 0xffff0000, v240
    v_sub_f32_e64 v4, v3, v4
    v_cvt_pk_bf16_f32 v241, v4, 0
    v_mov_b32 v242, 0
    v_mov_b32 v243, 0
    s_waitcnt lgkmcnt(10)
    s_waitcnt lgkmcnt(8)
    v_mfma_f32_32x32x16_bf16 v[52:67], v[212:215], v[232:235], v[52:67]
    ds_read_b128 v[28:31], v41 offset:0
    ds_read_b128 v[32:35], v41 offset:4096
    v_mfma_f32_32x32x16_bf16 v[132:147], v[212:215], v[236:239], v[132:147]
    ds_read_b64_tr_b16 v[8:9], v46 offset:5120
    s_waitcnt lgkmcnt(9)
    v_mfma_f32_32x32x16_bf16 v[68:83], v[216:219], v[232:235], v[68:83]
    ds_read_b64_tr_b16 v[10:11], v46 offset:6400
    v_mfma_f32_32x32x16_bf16 v[148:163], v[216:219], v[236:239], v[148:163]
    ds_read_b64_tr_b16 v[12:13], v46 offset:5184
    s_waitcnt lgkmcnt(9)
    v_mfma_f32_32x32x16_bf16 v[84:99], v[220:223], v[232:235], v[84:99]
    ds_read_b64_tr_b16 v[14:15], v46 offset:6464
    v_mfma_f32_32x32x16_bf16 v[164:179], v[220:223], v[236:239], v[164:179]
    ds_read_b64_tr_b16 v[16:17], v46 offset:5248
    ds_read_b64_tr_b16 v[18:19], v46 offset:6528
    s_waitcnt lgkmcnt(10)
    v_mfma_f32_32x32x16_bf16 v[100:115], v[224:227], v[232:235], v[100:115]
    ds_read_b64_tr_b16 v[20:21], v46 offset:5312
    v_mfma_f32_32x32x16_bf16 v[180:195], v[224:227], v[236:239], v[180:195]
    ds_read_b64_tr_b16 v[22:23], v46 offset:6592
    s_waitcnt lgkmcnt(10)
    v_mfma_f32_32x32x16_bf16 v[116:131], v[228:231], v[232:235], v[116:131]
    ds_read_b64_tr_b16 v[24:25], v46 offset:5376
    v_mfma_f32_32x32x16_bf16 v[196:211], v[228:231], v[236:239], v[196:211]
    ds_read_b64_tr_b16 v[26:27], v46 offset:6656
    v_and_b32_e64 v252, 31, v1
    v_lshl_add_u32 v252, v252, 3, s74
    v_lshlrev_b32_e64 v252, 7, v252
    v_add_u32 v252, 22020096, v252
    buffer_load_dwordx2 v[250:251], v252, s[64:67], 0 offen sc1
SK_104:
    v_sub_f32 v3, 0, v50
    v_cmp_gt_u32 vcc, 32, v1
    s_nop 1
    v_cndmask_b32 v3, 0, v3, vcc
    v_cvt_pk_bf16_f32 v244, v3, v3
    v_and_b32 v4, 0xffff0000, v244
    v_sub_f32_e64 v4, v3, v4
    v_cvt_pk_bf16_f32 v245, v4, 0
    v_mov_b32 v246, 0
    v_mov_b32 v247, 0
    s_waitcnt lgkmcnt(10)
    s_waitcnt lgkmcnt(8)
    v_mfma_f32_32x32x16_bf16 v[52:67], v[8:11], v[28:31], v[52:67]
    ds_read_b128 v[232:235], v42 offset:0
    ds_read_b128 v[236:239], v42 offset:4096
    v_mfma_f32_32x32x16_bf16 v[132:147], v[8:11], v[32:35], v[132:147]
    ds_read_b64_tr_b16 v[212:213], v46 offset:10240
    s_waitcnt lgkmcnt(9)
    v_mfma_f32_32x32x16_bf16 v[68:83], v[12:15], v[28:31], v[68:83]
    ds_read_b64_tr_b16 v[214:215], v46 offset:11520
    v_mfma_f32_32x32x16_bf16 v[148:163], v[12:15], v[32:35], v[148:163]
    ds_read_b64_tr_b16 v[216:217], v46 offset:10304
    s_waitcnt lgkmcnt(9)
    v_mfma_f32_32x32x16_bf16 v[84:99], v[16:19], v[28:31], v[84:99]
    ds_read_b64_tr_b16 v[218:219], v46 offset:11584
    v_mfma_f32_32x32x16_bf16 v[164:179], v[16:19], v[32:35], v[164:179]
    ds_read_b64_tr_b16 v[220:221], v46 offset:10368
    ds_read_b64_tr_b16 v[222:223], v46 offset:11648
    s_waitcnt lgkmcnt(10)
    v_mfma_f32_32x32x16_bf16 v[100:115], v[20:23], v[28:31], v[100:115]
    ds_read_b64_tr_b16 v[224:225], v46 offset:10432
    v_mfma_f32_32x32x16_bf16 v[180:195], v[20:23], v[32:35], v[180:195]
    ds_read_b64_tr_b16 v[226:227], v46 offset:11712
    s_waitcnt lgkmcnt(10)
    v_mfma_f32_32x32x16_bf16 v[116:131], v[24:27], v[28:31], v[116:131]
    ds_read_b64_tr_b16 v[228:229], v46 offset:10496
    v_mfma_f32_32x32x16_bf16 v[196:211], v[24:27], v[32:35], v[196:211]
    ds_read_b64_tr_b16 v[230:231], v46 offset:11776
    s_waitcnt lgkmcnt(10)
    s_waitcnt lgkmcnt(8)
    v_mfma_f32_32x32x16_bf16 v[52:67], v[212:215], v[232:235], v[52:67]
    ds_read_b128 v[28:31], v43 offset:0
    ds_read_b128 v[32:35], v43 offset:4096
    v_mfma_f32_32x32x16_bf16 v[132:147], v[212:215], v[236:239], v[132:147]
    ds_read_b64_tr_b16 v[8:9], v46 offset:15360
    s_waitcnt lgkmcnt(9)
    v_mfma_f32_32x32x16_bf16 v[68:83], v[216:219], v[232:235], v[68:83]
    ds_read_b64_tr_b16 v[10:11], v46 offset:16640
    v_mfma_f32_32x32x16_bf16 v[148:163], v[216:219], v[236:239], v[148:163]
    ds_read_b64_tr_b16 v[12:13], v46 offset:15424
    s_waitcnt lgkmcnt(9)
    v_mfma_f32_32x32x16_bf16 v[84:99], v[220:223], v[232:235], v[84:99]
    ds_read_b64_tr_b16 v[14:15], v46 offset:16704
    v_mfma_f32_32x32x16_bf16 v[164:179], v[220:223], v[236:239], v[164:179]
    ds_read_b64_tr_b16 v[16:17], v46 offset:15488
    ds_read_b64_tr_b16 v[18:19], v46 offset:16768
    s_waitcnt lgkmcnt(10)
    v_mfma_f32_32x32x16_bf16 v[100:115], v[224:227], v[232:235], v[100:115]
    ds_read_b64_tr_b16 v[20:21], v46 offset:15552
    v_mfma_f32_32x32x16_bf16 v[180:195], v[224:227], v[236:239], v[180:195]
    ds_read_b64_tr_b16 v[22:23], v46 offset:16832
    s_waitcnt lgkmcnt(10)
    v_mfma_f32_32x32x16_bf16 v[116:131], v[228:231], v[232:235], v[116:131]
    ds_read_b64_tr_b16 v[24:25], v46 offset:15616
    v_mfma_f32_32x32x16_bf16 v[196:211], v[228:231], v[236:239], v[196:211]
    ds_read_b64_tr_b16 v[26:27], v46 offset:16896
    s_waitcnt lgkmcnt(0)
    v_add_u32 v46, 0, v44
    v_add_u32 v40, 0, v36
    v_add_u32 v41, 0, v37
    v_add_u32 v42, 0, v38
    v_add_u32 v43, 0, v39
    s_barrier
    v_mfma_f32_32x32x16_bf16 v[52:67], v[8:11], v[28:31], v[52:67]
    ds_read_b128 v[232:235], v40 offset:0
    ds_read_b128 v[236:239], v40 offset:4096
    v_mfma_f32_32x32x16_bf16 v[132:147], v[8:11], v[32:35], v[132:147]
    ds_read_b64_tr_b16 v[212:213], v46 offset:0
    v_mfma_f32_32x32x16_bf16 v[68:83], v[12:15], v[28:31], v[68:83]
    ds_read_b64_tr_b16 v[214:215], v46 offset:1280
    v_mfma_f32_32x32x16_bf16 v[148:163], v[12:15], v[32:35], v[148:163]
    ds_read_b64_tr_b16 v[216:217], v46 offset:64
    v_mfma_f32_32x32x16_bf16 v[84:99], v[16:19], v[28:31], v[84:99]
    ds_read_b64_tr_b16 v[218:219], v46 offset:1344
    v_mfma_f32_32x32x16_bf16 v[164:179], v[16:19], v[32:35], v[164:179]
    ds_read_b64_tr_b16 v[220:221], v46 offset:128
    ds_read_b64_tr_b16 v[222:223], v46 offset:1408
    v_mfma_f32_32x32x16_bf16 v[100:115], v[20:23], v[28:31], v[100:115]
    ds_read_b64_tr_b16 v[224:225], v46 offset:192
    v_mfma_f32_32x32x16_bf16 v[180:195], v[20:23], v[32:35], v[180:195]
    ds_read_b64_tr_b16 v[226:227], v46 offset:1472
    v_mfma_f32_32x32x16_bf16 v[116:131], v[24:27], v[28:31], v[116:131]
    ds_read_b64_tr_b16 v[228:229], v46 offset:256
    v_mfma_f32_32x32x16_bf16 v[196:211], v[24:27], v[32:35], v[196:211]
    ds_read_b64_tr_b16 v[230:231], v46 offset:1536
    s_waitcnt lgkmcnt(10)
    s_waitcnt lgkmcnt(8)
    v_mfma_f32_32x32x16_bf16 v[52:67], v[212:215], v[232:235], v[52:67]
    ds_read_b128 v[28:31], v41 offset:0
    ds_read_b128 v[32:35], v41 offset:4096
    v_mfma_f32_32x32x16_bf16 v[132:147], v[212:215], v[236:239], v[132:147]
    ds_read_b64_tr_b16 v[8:9], v46 offset:5120
    s_waitcnt lgkmcnt(9)
    v_mfma_f32_32x32x16_bf16 v[68:83], v[216:219], v[232:235], v[68:83]
    ds_read_b64_tr_b16 v[10:11], v46 offset:6400
    v_mfma_f32_32x32x16_bf16 v[148:163], v[216:219], v[236:239], v[148:163]
    ds_read_b64_tr_b16 v[12:13], v46 offset:5184
    s_waitcnt lgkmcnt(9)
    v_mfma_f32_32x32x16_bf16 v[84:99], v[220:223], v[232:235], v[84:99]
    ds_read_b64_tr_b16 v[14:15], v46 offset:6464
    v_mfma_f32_32x32x16_bf16 v[164:179], v[220:223], v[236:239], v[164:179]
    ds_read_b64_tr_b16 v[16:17], v46 offset:5248
    ds_read_b64_tr_b16 v[18:19], v46 offset:6528
    s_waitcnt lgkmcnt(10)
    v_mfma_f32_32x32x16_bf16 v[100:115], v[224:227], v[232:235], v[100:115]
    ds_read_b64_tr_b16 v[20:21], v46 offset:5312
    v_mfma_f32_32x32x16_bf16 v[180:195], v[224:227], v[236:239], v[180:195]
    ds_read_b64_tr_b16 v[22:23], v46 offset:6592
    s_waitcnt lgkmcnt(10)
    v_mfma_f32_32x32x16_bf16 v[116:131], v[228:231], v[232:235], v[116:131]
    ds_read_b64_tr_b16 v[24:25], v46 offset:5376
    v_mfma_f32_32x32x16_bf16 v[196:211], v[228:231], v[236:239], v[196:211]
    ds_read_b64_tr_b16 v[26:27], v46 offset:6656
    s_waitcnt lgkmcnt(10)
    s_waitcnt lgkmcnt(8)
    v_mfma_f32_32x32x16_bf16 v[52:67], v[8:11], v[28:31], v[52:67]
    ds_read_b128 v[232:235], v42 offset:0
    ds_read_b128 v[236:239], v42 offset:4096
    v_mfma_f32_32x32x16_bf16 v[132:147], v[8:11], v[32:35], v[132:147]
    ds_read_b64_tr_b16 v[212:213], v46 offset:10240
    s_waitcnt lgkmcnt(9)
    v_mfma_f32_32x32x16_bf16 v[68:83], v[12:15], v[28:31], v[68:83]
    ds_read_b64_tr_b16 v[214:215], v46 offset:11520
    v_mfma_f32_32x32x16_bf16 v[148:163], v[12:15], v[32:35], v[148:163]
    ds_read_b64_tr_b16 v[216:217], v46 offset:10304
    s_waitcnt lgkmcnt(9)
    v_mfma_f32_32x32x16_bf16 v[84:99], v[16:19], v[28:31], v[84:99]
    ds_read_b64_tr_b16 v[218:219], v46 offset:11584
    v_mfma_f32_32x32x16_bf16 v[164:179], v[16:19], v[32:35], v[164:179]
    ds_read_b64_tr_b16 v[220:221], v46 offset:10368
    ds_read_b64_tr_b16 v[222:223], v46 offset:11648
    s_waitcnt lgkmcnt(10)
    v_mfma_f32_32x32x16_bf16 v[100:115], v[20:23], v[28:31], v[100:115]
    ds_read_b64_tr_b16 v[224:225], v46 offset:10432
    v_mfma_f32_32x32x16_bf16 v[180:195], v[20:23], v[32:35], v[180:195]
    ds_read_b64_tr_b16 v[226:227], v46 offset:11712
    s_waitcnt lgkmcnt(10)
    v_mfma_f32_32x32x16_bf16 v[116:131], v[24:27], v[28:31], v[116:131]
    ds_read_b64_tr_b16 v[228:229], v46 offset:10496
    v_mfma_f32_32x32x16_bf16 v[196:211], v[24:27], v[32:35], v[196:211]
    ds_read_b64_tr_b16 v[230:231], v46 offset:11776
    s_waitcnt lgkmcnt(10)
    s_waitcnt lgkmcnt(8)
    v_mfma_f32_32x32x16_bf16 v[52:67], v[212:215], v[232:235], v[52:67]
    ds_read_b128 v[28:31], v43 offset:0
    ds_read_b128 v[32:35], v43 offset:4096
    v_mfma_f32_32x32x16_bf16 v[132:147], v[212:215], v[236:239], v[132:147]
    ds_read_b64_tr_b16 v[8:9], v46 offset:15360
    s_waitcnt lgkmcnt(9)
    v_mfma_f32_32x32x16_bf16 v[68:83], v[216:219], v[232:235], v[68:83]
    ds_read_b64_tr_b16 v[10:11], v46 offset:16640
    v_mfma_f32_32x32x16_bf16 v[148:163], v[216:219], v[236:239], v[148:163]
    ds_read_b64_tr_b16 v[12:13], v46 offset:15424
    s_waitcnt lgkmcnt(9)
    v_mfma_f32_32x32x16_bf16 v[84:99], v[220:223], v[232:235], v[84:99]
    ds_read_b64_tr_b16 v[14:15], v46 offset:16704
    v_mfma_f32_32x32x16_bf16 v[164:179], v[220:223], v[236:239], v[164:179]
    ds_read_b64_tr_b16 v[16:17], v46 offset:15488
    ds_read_b64_tr_b16 v[18:19], v46 offset:16768
    s_waitcnt lgkmcnt(10)
    v_mfma_f32_32x32x16_bf16 v[100:115], v[224:227], v[232:235], v[100:115]
    ds_read_b64_tr_b16 v[20:21], v46 offset:15552
    v_mfma_f32_32x32x16_bf16 v[180:195], v[224:227], v[236:239], v[180:195]
    ds_read_b64_tr_b16 v[22:23], v46 offset:16832
    s_waitcnt lgkmcnt(10)
    v_mfma_f32_32x32x16_bf16 v[116:131], v[228:231], v[232:235], v[116:131]
    ds_read_b64_tr_b16 v[24:25], v46 offset:15616
    v_mfma_f32_32x32x16_bf16 v[196:211], v[228:231], v[236:239], v[196:211]
    ds_read_b64_tr_b16 v[26:27], v46 offset:16896
    s_waitcnt lgkmcnt(0)
E1A:
    s_barrier
    ds_read_b64 v[212:213], v5 offset:0
    v_mov_b32 v214, 0
    v_mov_b32_e64 v215, 0
    ds_read_b64 v[216:217], v5 offset:256
    v_mov_b32 v218, 0
    v_mov_b32 v219, 0
    ds_read_b64 v[220:221], v5 offset:512
    v_mov_b32 v222, 0
    v_mov_b32 v223, 0
    ds_read_b64 v[224:225], v5 offset:768
    v_mov_b32 v226, 0
    v_mov_b32 v227, 0
    ds_read_b64 v[228:229], v5 offset:1024
    v_mov_b32 v230, 0
    v_mov_b32 v231, 0
    v_mfma_f32_32x32x16_bf16 v[52:67], v[8:11], v[28:31], v[52:67]
    v_mfma_f32_32x32x16_bf16 v[132:147], v[8:11], v[32:35], v[132:147]
    v_mfma_f32_32x32x16_bf16 v[68:83], v[12:15], v[28:31], v[68:83]
    v_mfma_f32_32x32x16_bf16 v[148:163], v[12:15], v[32:35], v[148:163]
    v_mfma_f32_32x32x16_bf16 v[84:99], v[16:19], v[28:31], v[84:99]
    v_mfma_f32_32x32x16_bf16 v[164:179], v[16:19], v[32:35], v[164:179]
    v_mfma_f32_32x32x16_bf16 v[100:115], v[20:23], v[28:31], v[100:115]
    v_mfma_f32_32x32x16_bf16 v[180:195], v[20:23], v[32:35], v[180:195]
    v_mfma_f32_32x32x16_bf16 v[116:131], v[24:27], v[28:31], v[116:131]
    v_mfma_f32_32x32x16_bf16 v[196:211], v[24:27], v[32:35], v[196:211]
    s_waitcnt lgkmcnt(0)
    v_mfma_f32_32x32x16_bf16 v[52:67], v[212:215], v[240:243], v[52:67]
    v_mfma_f32_32x32x16_bf16 v[68:83], v[216:219], v[240:243], v[68:83]
    v_mfma_f32_32x32x16_bf16 v[84:99], v[220:223], v[240:243], v[84:99]
    v_mfma_f32_32x32x16_bf16 v[100:115], v[224:227], v[240:243], v[100:115]
    v_mfma_f32_32x32x16_bf16 v[116:131], v[228:231], v[240:243], v[116:131]
    v_mfma_f32_32x32x16_bf16 v[132:147], v[212:215], v[244:247], v[132:147]
    v_mfma_f32_32x32x16_bf16 v[148:163], v[216:219], v[244:247], v[148:163]
    v_mfma_f32_32x32x16_bf16 v[164:179], v[220:223], v[244:247], v[164:179]
    v_mfma_f32_32x32x16_bf16 v[180:195], v[224:227], v[244:247], v[180:195]
    v_mfma_f32_32x32x16_bf16 v[196:211], v[228:231], v[244:247], v[196:211]
    v_mov_b32 v32, 0x358637bd
    v_mov_b32 v33, 0x358637bd
    s_cmp_lt_u32 s75, 8
    s_cbranch_scc1 G1_KV
    s_lshl_b32 s83, s81, 8
    s_lshl_b32 s84, s72, 6
    s_add_u32 s83, s83, s84
    v_and_b32 v5, 31, v1
    v_add_u32 v5, s83, v5
    v_lshrrev_b32_e64 v3, 5, v1
    v_mul_u32_u24 v3, 33024, v3
    v_lshl_add_u32 v34, v5, 4, v3
    v_add_u32 v35, 512, v34
    s_sub_u32 s85, s75, 8
    s_mul_i32 s85, s85, 660480
    s_add_u32 s85, s85, 4784128
    v_mov_b32 v28, v49
    v_mov_b32_e64 v29, v49
    v_mul_f32 v30, 0x3fb8aa3b, v49
    v_mul_f32 v31, 0x3fb8aa3b, v49
    v_pk_mul_f32 v[24:25], v[52:53], v[30:31]
    v_pk_mul_f32 v[26:27], v[54:55], v[30:31]
    v_exp_f32 v24, v24 clamp
    v_exp_f32 v25, v25 clamp
    v_exp_f32 v26, v26 clamp
    v_exp_f32 v27, v27 clamp
    v_max_f32 v52, 0, v52
    v_max_f32 v53, 0, v53
    v_max_f32 v54, 0, v54
    v_max_f32 v55, 0, v55
    v_pk_add_f32 v[24:25], v[24:25], v[32:33]
    v_pk_add_f32 v[26:27], v[26:27], v[32:33]
    v_pk_fma_f32 v[52:53], v[52:53], v[28:29], v[24:25]
    v_pk_fma_f32 v[54:55], v[54:55], v[28:29], v[26:27]
    v_cvt_pk_bf16_f32 v8, v52, v53
    v_cvt_pk_bf16_f32 v9, v54, v55
    v_pk_mul_f32 v[24:25], v[56:57], v[30:31]
    v_pk_mul_f32 v[26:27], v[58:59], v[30:31]
    v_exp_f32 v24, v24 clamp
    v_exp_f32 v25, v25 clamp
    v_exp_f32 v26, v26 clamp
    v_exp_f32 v27, v27 clamp
    v_max_f32 v56, 0, v56
    v_max_f32 v57, 0, v57
    v_max_f32 v58, 0, v58
    v_max_f32 v59, 0, v59
    v_pk_add_f32 v[24:25], v[24:25], v[32:33]
    v_pk_add_f32 v[26:27], v[26:27], v[32:33]
    v_pk_fma_f32 v[56:57], v[56:57], v[28:29], v[24:25]
    v_pk_fma_f32 v[58:59], v[58:59], v[28:29], v[26:27]
    v_cvt_pk_bf16_f32 v10, v56, v57
    v_cvt_pk_bf16_f32 v11, v58, v59
    v_pk_mul_f32 v[24:25], v[60:61], v[30:31]
    v_pk_mul_f32 v[26:27], v[62:63], v[30:31]
    v_exp_f32 v24, v24 clamp
    v_exp_f32 v25, v25 clamp
    v_exp_f32 v26, v26 clamp
    v_exp_f32 v27, v27 clamp
    v_max_f32 v60, 0, v60
    v_max_f32 v61, 0, v61
    v_max_f32 v62, 0, v62
    v_max_f32 v63, 0, v63
    v_pk_add_f32 v[24:25], v[24:25], v[32:33]
    v_pk_add_f32 v[26:27], v[26:27], v[32:33]
    v_pk_fma_f32 v[60:61], v[60:61], v[28:29], v[24:25]
    v_pk_fma_f32 v[62:63], v[62:63], v[28:29], v[26:27]
    v_cvt_pk_bf16_f32 v12, v60, v61
    v_cvt_pk_bf16_f32 v13, v62, v63
    v_pk_mul_f32 v[24:25], v[64:65], v[30:31]
    v_pk_mul_f32 v[26:27], v[66:67], v[30:31]
    v_exp_f32 v24, v24 clamp
    v_exp_f32 v25, v25 clamp
    v_exp_f32 v26, v26 clamp
    v_exp_f32 v27, v27 clamp
    v_max_f32 v64, 0, v64
    v_max_f32 v65, 0, v65
    v_max_f32 v66, 0, v66
    v_max_f32 v67, 0, v67
    v_pk_add_f32 v[24:25], v[24:25], v[32:33]
    v_pk_add_f32 v[26:27], v[26:27], v[32:33]
    v_pk_fma_f32 v[64:65], v[64:65], v[28:29], v[24:25]
    v_pk_fma_f32 v[66:67], v[66:67], v[28:29], v[26:27]
    v_cvt_pk_bf16_f32 v14, v64, v65
    v_cvt_pk_bf16_f32 v15, v66, v67
    s_add_u32 s83, s85, 0
    s_add_u32 s84, s85, 66048
    buffer_store_dwordx4 v[8:11], v34, s[64:67], s83 offen sc1
    buffer_store_dwordx4 v[12:15], v34, s[64:67], s84 offen sc1
    s_nop 0
    v_pk_mul_f32 v[24:25], v[68:69], v[30:31]
    v_pk_mul_f32 v[26:27], v[70:71], v[30:31]
    v_exp_f32 v24, v24 clamp
    v_exp_f32 v25, v25 clamp
    v_exp_f32 v26, v26 clamp
    v_exp_f32 v27, v27 clamp
    v_max_f32 v68, 0, v68
    v_max_f32 v69, 0, v69
    v_max_f32 v70, 0, v70
    v_max_f32 v71, 0, v71
    v_pk_add_f32 v[24:25], v[24:25], v[32:33]
    v_pk_add_f32 v[26:27], v[26:27], v[32:33]
    v_pk_fma_f32 v[68:69], v[68:69], v[28:29], v[24:25]
    v_pk_fma_f32 v[70:71], v[70:71], v[28:29], v[26:27]
    v_cvt_pk_bf16_f32 v16, v68, v69
    v_cvt_pk_bf16_f32 v17, v70, v71
    v_pk_mul_f32 v[24:25], v[72:73], v[30:31]
    v_pk_mul_f32 v[26:27], v[74:75], v[30:31]
    v_exp_f32 v24, v24 clamp
    v_exp_f32 v25, v25 clamp
    v_exp_f32 v26, v26 clamp
    v_exp_f32 v27, v27 clamp
    v_max_f32 v72, 0, v72
    v_max_f32 v73, 0, v73
    v_max_f32 v74, 0, v74
    v_max_f32 v75, 0, v75
    v_pk_add_f32 v[24:25], v[24:25], v[32:33]
    v_pk_add_f32 v[26:27], v[26:27], v[32:33]
    v_pk_fma_f32 v[72:73], v[72:73], v[28:29], v[24:25]
    v_pk_fma_f32 v[74:75], v[74:75], v[28:29], v[26:27]
    v_cvt_pk_bf16_f32 v18, v72, v73
    v_cvt_pk_bf16_f32 v19, v74, v75
    v_pk_mul_f32 v[24:25], v[76:77], v[30:31]
    v_pk_mul_f32 v[26:27], v[78:79], v[30:31]
    v_exp_f32 v24, v24 clamp
    v_exp_f32 v25, v25 clamp
    v_exp_f32 v26, v26 clamp
    v_exp_f32 v27, v27 clamp
    v_max_f32 v76, 0, v76
    v_max_f32 v77, 0, v77
    v_max_f32 v78, 0, v78
    v_max_f32 v79, 0, v79
    v_pk_add_f32 v[24:25], v[24:25], v[32:33]
    v_pk_add_f32 v[26:27], v[26:27], v[32:33]
    v_pk_fma_f32 v[76:77], v[76:77], v[28:29], v[24:25]
    v_pk_fma_f32 v[78:79], v[78:79], v[28:29], v[26:27]
    v_cvt_pk_bf16_f32 v20, v76, v77
    v_cvt_pk_bf16_f32 v21, v78, v79
    v_pk_mul_f32 v[24:25], v[80:81], v[30:31]
    v_pk_mul_f32 v[26:27], v[82:83], v[30:31]
    v_exp_f32 v24, v24 clamp
    v_exp_f32 v25, v25 clamp
    v_exp_f32 v26, v26 clamp
    v_exp_f32 v27, v27 clamp
    v_max_f32 v80, 0, v80
    v_max_f32 v81, 0, v81
    v_max_f32 v82, 0, v82
    v_max_f32 v83, 0, v83
    v_pk_add_f32 v[24:25], v[24:25], v[32:33]
    v_pk_add_f32 v[26:27], v[26:27], v[32:33]
    v_pk_fma_f32 v[80:81], v[80:81], v[28:29], v[24:25]
    v_pk_fma_f32 v[82:83], v[82:83], v[28:29], v[26:27]
    v_cvt_pk_bf16_f32 v22, v80, v81
    v_cvt_pk_bf16_f32 v23, v82, v83
    s_add_u32 s83, s85, 132096
    s_add_u32 s84, s85, 198144
    buffer_store_dwordx4 v[16:19], v34, s[64:67], s83 offen sc1
    buffer_store_dwordx4 v[20:23], v34, s[64:67], s84 offen sc1
    v_pk_mul_f32 v[24:25], v[84:85], v[30:31]
    v_pk_mul_f32 v[26:27], v[86:87], v[30:31]
    v_exp_f32 v24, v24 clamp
    v_exp_f32 v25, v25 clamp
    v_exp_f32 v26, v26 clamp
    v_exp_f32 v27, v27 clamp
    v_max_f32 v84, 0, v84
    v_max_f32 v85, 0, v85
    v_max_f32 v86, 0, v86
    v_max_f32 v87, 0, v87
    v_pk_add_f32 v[24:25], v[24:25], v[32:33]
    v_pk_add_f32 v[26:27], v[26:27], v[32:33]
    v_pk_fma_f32 v[84:85], v[84:85], v[28:29], v[24:25]
    v_pk_fma_f32 v[86:87], v[86:87], v[28:29], v[26:27]
    v_cvt_pk_bf16_f32 v8, v84, v85
    v_cvt_pk_bf16_f32 v9, v86, v87
    v_pk_mul_f32 v[24:25], v[88:89], v[30:31]
    v_pk_mul_f32 v[26:27], v[90:91], v[30:31]
    v_exp_f32 v24, v24 clamp
    v_exp_f32 v25, v25 clamp
    v_exp_f32 v26, v26 clamp
    v_exp_f32 v27, v27 clamp
    v_max_f32 v88, 0, v88
    v_max_f32 v89, 0, v89
    v_max_f32 v90, 0, v90
    v_max_f32 v91, 0, v91
    v_pk_add_f32 v[24:25], v[24:25], v[32:33]
    v_pk_add_f32 v[26:27], v[26:27], v[32:33]
    v_pk_fma_f32 v[88:89], v[88:89], v[28:29], v[24:25]
    v_pk_fma_f32 v[90:91], v[90:91], v[28:29], v[26:27]
    v_cvt_pk_bf16_f32 v10, v88, v89
    v_cvt_pk_bf16_f32 v11, v90, v91
    v_pk_mul_f32 v[24:25], v[92:93], v[30:31]
    v_pk_mul_f32 v[26:27], v[94:95], v[30:31]
    v_exp_f32 v24, v24 clamp
    v_exp_f32 v25, v25 clamp
    v_exp_f32 v26, v26 clamp
    v_exp_f32 v27, v27 clamp
    v_max_f32 v92, 0, v92
    v_max_f32 v93, 0, v93
    v_max_f32 v94, 0, v94
    v_max_f32 v95, 0, v95
    v_pk_add_f32 v[24:25], v[24:25], v[32:33]
    v_pk_add_f32 v[26:27], v[26:27], v[32:33]
    v_pk_fma_f32 v[92:93], v[92:93], v[28:29], v[24:25]
    v_pk_fma_f32 v[94:95], v[94:95], v[28:29], v[26:27]
    v_cvt_pk_bf16_f32 v12, v92, v93
    v_cvt_pk_bf16_f32 v13, v94, v95
    v_pk_mul_f32 v[24:25], v[96:97], v[30:31]
    v_pk_mul_f32 v[26:27], v[98:99], v[30:31]
    v_exp_f32 v24, v24 clamp
    v_exp_f32 v25, v25 clamp
    v_exp_f32 v26, v26 clamp
    v_exp_f32 v27, v27 clamp
    v_max_f32 v96, 0, v96
    v_max_f32 v97, 0, v97
    v_max_f32 v98, 0, v98
    v_max_f32 v99, 0, v99
    v_pk_add_f32 v[24:25], v[24:25], v[32:33]
    v_pk_add_f32 v[26:27], v[26:27], v[32:33]
    v_pk_fma_f32 v[96:97], v[96:97], v[28:29], v[24:25]
    v_pk_fma_f32 v[98:99], v[98:99], v[28:29], v[26:27]
    v_cvt_pk_bf16_f32 v14, v96, v97
    v_cvt_pk_bf16_f32 v15, v98, v99
    s_add_u32 s83, s85, 264192
    s_add_u32 s84, s85, 330240
    buffer_store_dwordx4 v[8:11], v34, s[64:67], s83 offen sc1
    buffer_store_dwordx4 v[12:15], v34, s[64:67], s84 offen sc1
    v_pk_mul_f32 v[24:25], v[100:101], v[30:31]
    v_pk_mul_f32 v[26:27], v[102:103], v[30:31]
    v_exp_f32 v24, v24 clamp
    v_exp_f32 v25, v25 clamp
    v_exp_f32 v26, v26 clamp
    v_exp_f32 v27, v27 clamp
    v_max_f32 v100, 0, v100
    v_max_f32 v101, 0, v101
    v_max_f32 v102, 0, v102
    v_max_f32 v103, 0, v103
    v_pk_add_f32 v[24:25], v[24:25], v[32:33]
    v_pk_add_f32 v[26:27], v[26:27], v[32:33]
    v_pk_fma_f32 v[100:101], v[100:101], v[28:29], v[24:25]
    v_pk_fma_f32 v[102:103], v[102:103], v[28:29], v[26:27]
    v_cvt_pk_bf16_f32 v16, v100, v101
    v_cvt_pk_bf16_f32 v17, v102, v103
    v_pk_mul_f32 v[24:25], v[104:105], v[30:31]
    v_pk_mul_f32 v[26:27], v[106:107], v[30:31]
    v_exp_f32 v24, v24 clamp
    v_exp_f32 v25, v25 clamp
    v_exp_f32 v26, v26 clamp
    v_exp_f32 v27, v27 clamp
    v_max_f32 v104, 0, v104
    v_max_f32 v105, 0, v105
    v_max_f32 v106, 0, v106
    v_max_f32 v107, 0, v107
    v_pk_add_f32 v[24:25], v[24:25], v[32:33]
    v_pk_add_f32 v[26:27], v[26:27], v[32:33]
    v_pk_fma_f32 v[104:105], v[104:105], v[28:29], v[24:25]
    v_pk_fma_f32 v[106:107], v[106:107], v[28:29], v[26:27]
    v_cvt_pk_bf16_f32 v18, v104, v105
    v_cvt_pk_bf16_f32 v19, v106, v107
    v_pk_mul_f32 v[24:25], v[108:109], v[30:31]
    v_pk_mul_f32 v[26:27], v[110:111], v[30:31]
    v_exp_f32 v24, v24 clamp
    v_exp_f32 v25, v25 clamp
    v_exp_f32 v26, v26 clamp
    v_exp_f32 v27, v27 clamp
    v_max_f32 v108, 0, v108
    v_max_f32 v109, 0, v109
    v_max_f32 v110, 0, v110
    v_max_f32 v111, 0, v111
    v_pk_add_f32 v[24:25], v[24:25], v[32:33]
    v_pk_add_f32 v[26:27], v[26:27], v[32:33]
    v_pk_fma_f32 v[108:109], v[108:109], v[28:29], v[24:25]
    v_pk_fma_f32 v[110:111], v[110:111], v[28:29], v[26:27]
    v_cvt_pk_bf16_f32 v20, v108, v109
    v_cvt_pk_bf16_f32 v21, v110, v111
    v_pk_mul_f32 v[24:25], v[112:113], v[30:31]
    v_pk_mul_f32 v[26:27], v[114:115], v[30:31]
    v_exp_f32 v24, v24 clamp
    v_exp_f32 v25, v25 clamp
    v_exp_f32 v26, v26 clamp
    v_exp_f32 v27, v27 clamp
    v_max_f32 v112, 0, v112
    v_max_f32 v113, 0, v113
    v_max_f32 v114, 0, v114
    v_max_f32 v115, 0, v115
    v_pk_add_f32 v[24:25], v[24:25], v[32:33]
    v_pk_add_f32 v[26:27], v[26:27], v[32:33]
    v_pk_fma_f32 v[112:113], v[112:113], v[28:29], v[24:25]
    v_pk_fma_f32 v[114:115], v[114:115], v[28:29], v[26:27]
    v_cvt_pk_bf16_f32 v22, v112, v113
    v_cvt_pk_bf16_f32 v23, v114, v115
    s_add_u32 s83, s85, 396288
    s_add_u32 s84, s85, 462336
    buffer_store_dwordx4 v[16:19], v34, s[64:67], s83 offen sc1
    buffer_store_dwordx4 v[20:23], v34, s[64:67], s84 offen sc1
    v_pk_mul_f32 v[24:25], v[116:117], v[30:31]
    v_pk_mul_f32 v[26:27], v[118:119], v[30:31]
    v_exp_f32 v24, v24 clamp
    v_exp_f32 v25, v25 clamp
    v_exp_f32 v26, v26 clamp
    v_exp_f32 v27, v27 clamp
    v_max_f32 v116, 0, v116
    v_max_f32 v117, 0, v117
    v_max_f32 v118, 0, v118
    v_max_f32 v119, 0, v119
    v_pk_add_f32 v[24:25], v[24:25], v[32:33]
    v_pk_add_f32 v[26:27], v[26:27], v[32:33]
    v_pk_fma_f32 v[116:117], v[116:117], v[28:29], v[24:25]
    v_pk_fma_f32 v[118:119], v[118:119], v[28:29], v[26:27]
    v_cvt_pk_bf16_f32 v8, v116, v117
    v_cvt_pk_bf16_f32 v9, v118, v119
    v_pk_mul_f32 v[24:25], v[120:121], v[30:31]
    v_pk_mul_f32 v[26:27], v[122:123], v[30:31]
    v_exp_f32 v24, v24 clamp
    v_exp_f32 v25, v25 clamp
    v_exp_f32 v26, v26 clamp
    v_exp_f32 v27, v27 clamp
    v_max_f32 v120, 0, v120
    v_max_f32 v121, 0, v121
    v_max_f32 v122, 0, v122
    v_max_f32 v123, 0, v123
    v_pk_add_f32 v[24:25], v[24:25], v[32:33]
    v_pk_add_f32 v[26:27], v[26:27], v[32:33]
    v_pk_fma_f32 v[120:121], v[120:121], v[28:29], v[24:25]
    v_pk_fma_f32 v[122:123], v[122:123], v[28:29], v[26:27]
    v_cvt_pk_bf16_f32 v10, v120, v121
    v_cvt_pk_bf16_f32 v11, v122, v123
    v_pk_mul_f32 v[24:25], v[124:125], v[30:31]
    v_pk_mul_f32 v[26:27], v[126:127], v[30:31]
    v_exp_f32 v24, v24 clamp
    v_exp_f32 v25, v25 clamp
    v_exp_f32 v26, v26 clamp
    v_exp_f32 v27, v27 clamp
    v_max_f32 v124, 0, v124
    v_max_f32 v125, 0, v125
    v_max_f32 v126, 0, v126
    v_max_f32 v127, 0, v127
    v_pk_add_f32 v[24:25], v[24:25], v[32:33]
    v_pk_add_f32 v[26:27], v[26:27], v[32:33]
    v_pk_fma_f32 v[124:125], v[124:125], v[28:29], v[24:25]
    v_pk_fma_f32 v[126:127], v[126:127], v[28:29], v[26:27]
    v_cvt_pk_bf16_f32 v12, v124, v125
    v_cvt_pk_bf16_f32 v13, v126, v127
    v_pk_mul_f32 v[24:25], v[128:129], v[30:31]
    v_pk_mul_f32 v[26:27], v[130:131], v[30:31]
    v_exp_f32 v24, v24 clamp
    v_exp_f32 v25, v25 clamp
    v_exp_f32 v26, v26 clamp
    v_exp_f32 v27, v27 clamp
    v_max_f32 v128, 0, v128
    v_max_f32 v129, 0, v129
    v_max_f32 v130, 0, v130
    v_max_f32 v131, 0, v131
    v_pk_add_f32 v[24:25], v[24:25], v[32:33]
    v_pk_add_f32 v[26:27], v[26:27], v[32:33]
    v_pk_fma_f32 v[128:129], v[128:129], v[28:29], v[24:25]
    v_pk_fma_f32 v[130:131], v[130:131], v[28:29], v[26:27]
    v_cvt_pk_bf16_f32 v14, v128, v129
    v_cvt_pk_bf16_f32 v15, v130, v131
    s_add_u32 s83, s85, 528384
    s_add_u32 s84, s85, 594432
    buffer_store_dwordx4 v[8:11], v34, s[64:67], s83 offen sc1
    buffer_store_dwordx4 v[12:15], v34, s[64:67], s84 offen sc1
    v_mov_b32 v28, v51
    v_mov_b32 v29, v51
    v_mul_f32 v30, 0x3fb8aa3b, v51
    v_mul_f32 v31, 0x3fb8aa3b, v51
    v_pk_mul_f32 v[24:25], v[132:133], v[30:31]
    v_pk_mul_f32 v[26:27], v[134:135], v[30:31]
    v_exp_f32 v24, v24 clamp
    v_exp_f32 v25, v25 clamp
    v_exp_f32 v26, v26 clamp
    v_exp_f32 v27, v27 clamp
    v_max_f32 v132, 0, v132
    v_max_f32 v133, 0, v133
    v_max_f32 v134, 0, v134
    v_max_f32 v135, 0, v135
    v_pk_add_f32 v[24:25], v[24:25], v[32:33]
    v_pk_add_f32 v[26:27], v[26:27], v[32:33]
    v_pk_fma_f32 v[132:133], v[132:133], v[28:29], v[24:25]
    v_pk_fma_f32 v[134:135], v[134:135], v[28:29], v[26:27]
    v_cvt_pk_bf16_f32 v16, v132, v133
    v_cvt_pk_bf16_f32 v17, v134, v135
    v_pk_mul_f32 v[24:25], v[136:137], v[30:31]
    v_pk_mul_f32 v[26:27], v[138:139], v[30:31]
    v_exp_f32 v24, v24 clamp
    v_exp_f32 v25, v25 clamp
    v_exp_f32 v26, v26 clamp
    v_exp_f32 v27, v27 clamp
    v_max_f32 v136, 0, v136
    v_max_f32 v137, 0, v137
    v_max_f32 v138, 0, v138
    v_max_f32 v139, 0, v139
    v_pk_add_f32 v[24:25], v[24:25], v[32:33]
    v_pk_add_f32 v[26:27], v[26:27], v[32:33]
    v_pk_fma_f32 v[136:137], v[136:137], v[28:29], v[24:25]
    v_pk_fma_f32 v[138:139], v[138:139], v[28:29], v[26:27]
    v_cvt_pk_bf16_f32 v18, v136, v137
    v_cvt_pk_bf16_f32 v19, v138, v139
    v_pk_mul_f32 v[24:25], v[140:141], v[30:31]
    v_pk_mul_f32 v[26:27], v[142:143], v[30:31]
    v_exp_f32 v24, v24 clamp
    v_exp_f32 v25, v25 clamp
    v_exp_f32 v26, v26 clamp
    v_exp_f32 v27, v27 clamp
    v_max_f32 v140, 0, v140
    v_max_f32 v141, 0, v141
    v_max_f32 v142, 0, v142
    v_max_f32 v143, 0, v143
    v_pk_add_f32 v[24:25], v[24:25], v[32:33]
    v_pk_add_f32 v[26:27], v[26:27], v[32:33]
    v_pk_fma_f32 v[140:141], v[140:141], v[28:29], v[24:25]
    v_pk_fma_f32 v[142:143], v[142:143], v[28:29], v[26:27]
    v_cvt_pk_bf16_f32 v20, v140, v141
    v_cvt_pk_bf16_f32 v21, v142, v143
    v_pk_mul_f32 v[24:25], v[144:145], v[30:31]
    v_pk_mul_f32 v[26:27], v[146:147], v[30:31]
    v_exp_f32 v24, v24 clamp
    v_exp_f32 v25, v25 clamp
    v_exp_f32 v26, v26 clamp
    v_exp_f32 v27, v27 clamp
    v_max_f32 v144, 0, v144
    v_max_f32 v145, 0, v145
    v_max_f32 v146, 0, v146
    v_max_f32 v147, 0, v147
    v_pk_add_f32 v[24:25], v[24:25], v[32:33]
    v_pk_add_f32 v[26:27], v[26:27], v[32:33]
    v_pk_fma_f32 v[144:145], v[144:145], v[28:29], v[24:25]
    v_pk_fma_f32 v[146:147], v[146:147], v[28:29], v[26:27]
    v_cvt_pk_bf16_f32 v22, v144, v145
    v_cvt_pk_bf16_f32 v23, v146, v147
    s_add_u32 s83, s85, 0
    s_add_u32 s84, s85, 66048
    buffer_store_dwordx4 v[16:19], v35, s[64:67], s83 offen sc1
    buffer_store_dwordx4 v[20:23], v35, s[64:67], s84 offen sc1
    s_nop 0
    v_pk_mul_f32 v[24:25], v[148:149], v[30:31]
    v_pk_mul_f32 v[26:27], v[150:151], v[30:31]
    v_exp_f32 v24, v24 clamp
    v_exp_f32 v25, v25 clamp
    v_exp_f32 v26, v26 clamp
    v_exp_f32 v27, v27 clamp
    v_max_f32 v148, 0, v148
    v_max_f32 v149, 0, v149
    v_max_f32 v150, 0, v150
    v_max_f32 v151, 0, v151
    v_pk_add_f32 v[24:25], v[24:25], v[32:33]
    v_pk_add_f32 v[26:27], v[26:27], v[32:33]
    v_pk_fma_f32 v[148:149], v[148:149], v[28:29], v[24:25]
    v_pk_fma_f32 v[150:151], v[150:151], v[28:29], v[26:27]
    v_cvt_pk_bf16_f32 v8, v148, v149
    v_cvt_pk_bf16_f32 v9, v150, v151
    v_pk_mul_f32 v[24:25], v[152:153], v[30:31]
    v_pk_mul_f32 v[26:27], v[154:155], v[30:31]
    v_exp_f32 v24, v24 clamp
    v_exp_f32 v25, v25 clamp
    v_exp_f32 v26, v26 clamp
    v_exp_f32 v27, v27 clamp
    v_max_f32 v152, 0, v152
    v_max_f32 v153, 0, v153
    v_max_f32 v154, 0, v154
    v_max_f32 v155, 0, v155
    v_pk_add_f32 v[24:25], v[24:25], v[32:33]
    v_pk_add_f32 v[26:27], v[26:27], v[32:33]
    v_pk_fma_f32 v[152:153], v[152:153], v[28:29], v[24:25]
    v_pk_fma_f32 v[154:155], v[154:155], v[28:29], v[26:27]
    v_cvt_pk_bf16_f32 v10, v152, v153
    v_cvt_pk_bf16_f32 v11, v154, v155
    v_pk_mul_f32 v[24:25], v[156:157], v[30:31]
    v_pk_mul_f32 v[26:27], v[158:159], v[30:31]
    v_exp_f32 v24, v24 clamp
    v_exp_f32 v25, v25 clamp
    v_exp_f32 v26, v26 clamp
    v_exp_f32 v27, v27 clamp
    v_max_f32 v156, 0, v156
    v_max_f32 v157, 0, v157
    v_max_f32 v158, 0, v158
    v_max_f32 v159, 0, v159
    v_pk_add_f32 v[24:25], v[24:25], v[32:33]
    v_pk_add_f32 v[26:27], v[26:27], v[32:33]
    v_pk_fma_f32 v[156:157], v[156:157], v[28:29], v[24:25]
    v_pk_fma_f32 v[158:159], v[158:159], v[28:29], v[26:27]
    v_cvt_pk_bf16_f32 v12, v156, v157
    v_cvt_pk_bf16_f32 v13, v158, v159
    v_pk_mul_f32 v[24:25], v[160:161], v[30:31]
    v_pk_mul_f32 v[26:27], v[162:163], v[30:31]
    v_exp_f32 v24, v24 clamp
    v_exp_f32 v25, v25 clamp
    v_exp_f32 v26, v26 clamp
    v_exp_f32 v27, v27 clamp
    v_max_f32 v160, 0, v160
    v_max_f32 v161, 0, v161
    v_max_f32 v162, 0, v162
    v_max_f32 v163, 0, v163
    v_pk_add_f32 v[24:25], v[24:25], v[32:33]
    v_pk_add_f32 v[26:27], v[26:27], v[32:33]
    v_pk_fma_f32 v[160:161], v[160:161], v[28:29], v[24:25]
    v_pk_fma_f32 v[162:163], v[162:163], v[28:29], v[26:27]
    v_cvt_pk_bf16_f32 v14, v160, v161
    v_cvt_pk_bf16_f32 v15, v162, v163
    s_add_u32 s83, s85, 132096
    s_add_u32 s84, s85, 198144
    buffer_store_dwordx4 v[8:11], v35, s[64:67], s83 offen sc1
    buffer_store_dwordx4 v[12:15], v35, s[64:67], s84 offen sc1
    v_pk_mul_f32 v[24:25], v[164:165], v[30:31]
    v_pk_mul_f32 v[26:27], v[166:167], v[30:31]
    v_exp_f32 v24, v24 clamp
    v_exp_f32 v25, v25 clamp
    v_exp_f32 v26, v26 clamp
    v_exp_f32 v27, v27 clamp
    v_max_f32 v164, 0, v164
    v_max_f32 v165, 0, v165
    v_max_f32 v166, 0, v166
    v_max_f32 v167, 0, v167
    v_pk_add_f32 v[24:25], v[24:25], v[32:33]
    v_pk_add_f32 v[26:27], v[26:27], v[32:33]
    v_pk_fma_f32 v[164:165], v[164:165], v[28:29], v[24:25]
    v_pk_fma_f32 v[166:167], v[166:167], v[28:29], v[26:27]
    v_cvt_pk_bf16_f32 v16, v164, v165
    v_cvt_pk_bf16_f32 v17, v166, v167
    v_pk_mul_f32 v[24:25], v[168:169], v[30:31]
    v_pk_mul_f32 v[26:27], v[170:171], v[30:31]
    v_exp_f32 v24, v24 clamp
    v_exp_f32 v25, v25 clamp
    v_exp_f32 v26, v26 clamp
    v_exp_f32 v27, v27 clamp
    v_max_f32 v168, 0, v168
    v_max_f32 v169, 0, v169
    v_max_f32 v170, 0, v170
    v_max_f32 v171, 0, v171
    v_pk_add_f32 v[24:25], v[24:25], v[32:33]
    v_pk_add_f32 v[26:27], v[26:27], v[32:33]
    v_pk_fma_f32 v[168:169], v[168:169], v[28:29], v[24:25]
    v_pk_fma_f32 v[170:171], v[170:171], v[28:29], v[26:27]
    v_cvt_pk_bf16_f32 v18, v168, v169
    v_cvt_pk_bf16_f32 v19, v170, v171
    v_pk_mul_f32 v[24:25], v[172:173], v[30:31]
    v_pk_mul_f32 v[26:27], v[174:175], v[30:31]
    v_exp_f32 v24, v24 clamp
    v_exp_f32 v25, v25 clamp
    v_exp_f32 v26, v26 clamp
    v_exp_f32 v27, v27 clamp
    v_max_f32 v172, 0, v172
    v_max_f32 v173, 0, v173
    v_max_f32 v174, 0, v174
    v_max_f32 v175, 0, v175
    v_pk_add_f32 v[24:25], v[24:25], v[32:33]
    v_pk_add_f32 v[26:27], v[26:27], v[32:33]
    v_pk_fma_f32 v[172:173], v[172:173], v[28:29], v[24:25]
    v_pk_fma_f32 v[174:175], v[174:175], v[28:29], v[26:27]
    v_cvt_pk_bf16_f32 v20, v172, v173
    v_cvt_pk_bf16_f32 v21, v174, v175
    v_pk_mul_f32 v[24:25], v[176:177], v[30:31]
    v_pk_mul_f32 v[26:27], v[178:179], v[30:31]
    v_exp_f32 v24, v24 clamp
    v_exp_f32 v25, v25 clamp
    v_exp_f32 v26, v26 clamp
    v_exp_f32 v27, v27 clamp
    v_max_f32 v176, 0, v176
    v_max_f32 v177, 0, v177
    v_max_f32 v178, 0, v178
    v_max_f32 v179, 0, v179
    v_pk_add_f32 v[24:25], v[24:25], v[32:33]
    v_pk_add_f32 v[26:27], v[26:27], v[32:33]
    v_pk_fma_f32 v[176:177], v[176:177], v[28:29], v[24:25]
    v_pk_fma_f32 v[178:179], v[178:179], v[28:29], v[26:27]
    v_cvt_pk_bf16_f32 v22, v176, v177
    v_cvt_pk_bf16_f32 v23, v178, v179
    s_add_u32 s83, s85, 264192
    s_add_u32 s84, s85, 330240
    buffer_store_dwordx4 v[16:19], v35, s[64:67], s83 offen sc1
    buffer_store_dwordx4 v[20:23], v35, s[64:67], s84 offen sc1
    v_pk_mul_f32 v[24:25], v[180:181], v[30:31]
    v_pk_mul_f32 v[26:27], v[182:183], v[30:31]
    v_exp_f32 v24, v24 clamp
    v_exp_f32 v25, v25 clamp
    v_exp_f32 v26, v26 clamp
    v_exp_f32 v27, v27 clamp
    v_max_f32 v180, 0, v180
    v_max_f32 v181, 0, v181
    v_max_f32 v182, 0, v182
    v_max_f32 v183, 0, v183
    v_pk_add_f32 v[24:25], v[24:25], v[32:33]
    v_pk_add_f32 v[26:27], v[26:27], v[32:33]
    v_pk_fma_f32 v[180:181], v[180:181], v[28:29], v[24:25]
    v_pk_fma_f32 v[182:183], v[182:183], v[28:29], v[26:27]
    v_cvt_pk_bf16_f32 v8, v180, v181
    v_cvt_pk_bf16_f32 v9, v182, v183
    v_pk_mul_f32 v[24:25], v[184:185], v[30:31]
    v_pk_mul_f32 v[26:27], v[186:187], v[30:31]
    v_exp_f32 v24, v24 clamp
    v_exp_f32 v25, v25 clamp
    v_exp_f32 v26, v26 clamp
    v_exp_f32 v27, v27 clamp
    v_max_f32 v184, 0, v184
    v_max_f32 v185, 0, v185
    v_max_f32 v186, 0, v186
    v_max_f32 v187, 0, v187
    v_pk_add_f32 v[24:25], v[24:25], v[32:33]
    v_pk_add_f32 v[26:27], v[26:27], v[32:33]
    v_pk_fma_f32 v[184:185], v[184:185], v[28:29], v[24:25]
    v_pk_fma_f32 v[186:187], v[186:187], v[28:29], v[26:27]
    v_cvt_pk_bf16_f32 v10, v184, v185
    v_cvt_pk_bf16_f32 v11, v186, v187
    v_pk_mul_f32 v[24:25], v[188:189], v[30:31]
    v_pk_mul_f32 v[26:27], v[190:191], v[30:31]
    v_exp_f32 v24, v24 clamp
    v_exp_f32 v25, v25 clamp
    v_exp_f32 v26, v26 clamp
    v_exp_f32 v27, v27 clamp
    v_max_f32 v188, 0, v188
    v_max_f32 v189, 0, v189
    v_max_f32 v190, 0, v190
    v_max_f32 v191, 0, v191
    v_pk_add_f32 v[24:25], v[24:25], v[32:33]
    v_pk_add_f32 v[26:27], v[26:27], v[32:33]
    v_pk_fma_f32 v[188:189], v[188:189], v[28:29], v[24:25]
    v_pk_fma_f32 v[190:191], v[190:191], v[28:29], v[26:27]
    v_cvt_pk_bf16_f32 v12, v188, v189
    v_cvt_pk_bf16_f32 v13, v190, v191
    v_pk_mul_f32 v[24:25], v[192:193], v[30:31]
    v_pk_mul_f32 v[26:27], v[194:195], v[30:31]
    v_exp_f32 v24, v24 clamp
    v_exp_f32 v25, v25 clamp
    v_exp_f32 v26, v26 clamp
    v_exp_f32 v27, v27 clamp
    v_max_f32 v192, 0, v192
    v_max_f32 v193, 0, v193
    v_max_f32 v194, 0, v194
    v_max_f32 v195, 0, v195
    v_pk_add_f32 v[24:25], v[24:25], v[32:33]
    v_pk_add_f32 v[26:27], v[26:27], v[32:33]
    v_pk_fma_f32 v[192:193], v[192:193], v[28:29], v[24:25]
    v_pk_fma_f32 v[194:195], v[194:195], v[28:29], v[26:27]
    v_cvt_pk_bf16_f32 v14, v192, v193
    v_cvt_pk_bf16_f32 v15, v194, v195
    s_add_u32 s83, s85, 396288
    s_add_u32 s84, s85, 462336
    buffer_store_dwordx4 v[8:11], v35, s[64:67], s83 offen sc1
    buffer_store_dwordx4 v[12:15], v35, s[64:67], s84 offen sc1
    v_pk_mul_f32 v[24:25], v[196:197], v[30:31]
    v_pk_mul_f32 v[26:27], v[198:199], v[30:31]
    v_exp_f32 v24, v24 clamp
    v_exp_f32 v25, v25 clamp
    v_exp_f32 v26, v26 clamp
    v_exp_f32 v27, v27 clamp
    v_max_f32 v196, 0, v196
    v_max_f32 v197, 0, v197
    v_max_f32 v198, 0, v198
    v_max_f32 v199, 0, v199
    v_pk_add_f32 v[24:25], v[24:25], v[32:33]
    v_pk_add_f32 v[26:27], v[26:27], v[32:33]
    v_pk_fma_f32 v[196:197], v[196:197], v[28:29], v[24:25]
    v_pk_fma_f32 v[198:199], v[198:199], v[28:29], v[26:27]
    v_cvt_pk_bf16_f32 v16, v196, v197
    v_cvt_pk_bf16_f32 v17, v198, v199
    v_pk_mul_f32 v[24:25], v[200:201], v[30:31]
    v_pk_mul_f32 v[26:27], v[202:203], v[30:31]
    v_exp_f32 v24, v24 clamp
    v_exp_f32 v25, v25 clamp
    v_exp_f32 v26, v26 clamp
    v_exp_f32 v27, v27 clamp
    v_max_f32 v200, 0, v200
    v_max_f32 v201, 0, v201
    v_max_f32 v202, 0, v202
    v_max_f32 v203, 0, v203
    v_pk_add_f32 v[24:25], v[24:25], v[32:33]
    v_pk_add_f32 v[26:27], v[26:27], v[32:33]
    v_pk_fma_f32 v[200:201], v[200:201], v[28:29], v[24:25]
    v_pk_fma_f32 v[202:203], v[202:203], v[28:29], v[26:27]
    v_cvt_pk_bf16_f32 v18, v200, v201
    v_cvt_pk_bf16_f32 v19, v202, v203
    v_pk_mul_f32 v[24:25], v[204:205], v[30:31]
    v_pk_mul_f32 v[26:27], v[206:207], v[30:31]
    v_exp_f32 v24, v24 clamp
    v_exp_f32 v25, v25 clamp
    v_exp_f32 v26, v26 clamp
    v_exp_f32 v27, v27 clamp
    v_max_f32 v204, 0, v204
    v_max_f32 v205, 0, v205
    v_max_f32 v206, 0, v206
    v_max_f32 v207, 0, v207
    v_pk_add_f32 v[24:25], v[24:25], v[32:33]
    v_pk_add_f32 v[26:27], v[26:27], v[32:33]
    v_pk_fma_f32 v[204:205], v[204:205], v[28:29], v[24:25]
    v_pk_fma_f32 v[206:207], v[206:207], v[28:29], v[26:27]
    v_cvt_pk_bf16_f32 v20, v204, v205
    v_cvt_pk_bf16_f32 v21, v206, v207
    v_pk_mul_f32 v[24:25], v[208:209], v[30:31]
    v_pk_mul_f32 v[26:27], v[210:211], v[30:31]
    v_exp_f32 v24, v24 clamp
    v_exp_f32 v25, v25 clamp
    v_exp_f32 v26, v26 clamp
    v_exp_f32 v27, v27 clamp
    v_max_f32 v208, 0, v208
    v_max_f32 v209, 0, v209
    v_max_f32 v210, 0, v210
    v_max_f32 v211, 0, v211
    v_pk_add_f32 v[24:25], v[24:25], v[32:33]
    v_pk_add_f32 v[26:27], v[26:27], v[32:33]
    v_pk_fma_f32 v[208:209], v[208:209], v[28:29], v[24:25]
    v_pk_fma_f32 v[210:211], v[210:211], v[28:29], v[26:27]
    v_cvt_pk_bf16_f32 v22, v208, v209
    v_cvt_pk_bf16_f32 v23, v210, v211
    s_add_u32 s83, s85, 528384
    s_add_u32 s84, s85, 594432
    buffer_store_dwordx4 v[16:19], v35, s[64:67], s83 offen sc1
    buffer_store_dwordx4 v[20:23], v35, s[64:67], s84 offen sc1
    s_branch G1_DONE
G1_KV:
    v_and_b32 v3, 31, v1
    s_lshl_b32 s83, s72, 6
    v_add_u32 v3, s83, v3
    v_mul_u32_u24 v3, 328, v3
    v_lshrrev_b32_e64 v4, 5, v1
    v_lshl_add_u32 v34, v4, 3, v3
    v_mov_b32 v28, v49
    v_mov_b32 v29, v49
    v_mul_f32 v30, 0x3fb8aa3b, v49
    v_mul_f32 v31, 0x3fb8aa3b, v49
    v_pk_mul_f32 v[24:25], v[52:53], v[30:31]
    v_pk_mul_f32 v[26:27], v[54:55], v[30:31]
    v_exp_f32 v24, v24 clamp
    v_exp_f32 v25, v25 clamp
    v_exp_f32 v26, v26 clamp
    v_exp_f32 v27, v27 clamp
    v_max_f32 v52, 0, v52
    v_max_f32 v53, 0, v53
    v_max_f32 v54, 0, v54
    v_max_f32 v55, 0, v55
    v_pk_add_f32 v[24:25], v[24:25], v[32:33]
    v_pk_add_f32 v[26:27], v[26:27], v[32:33]
    v_pk_fma_f32 v[52:53], v[52:53], v[28:29], v[24:25]
    v_pk_fma_f32 v[54:55], v[54:55], v[28:29], v[26:27]
    v_cvt_pk_bf16_f32 v8, v52, v53
    v_cvt_pk_bf16_f32 v9, v54, v55
    ds_write_b64 v34, v[8:9] offset:0
    v_pk_mul_f32 v[24:25], v[56:57], v[30:31]
    v_pk_mul_f32 v[26:27], v[58:59], v[30:31]
    v_exp_f32 v24, v24 clamp
    v_exp_f32 v25, v25 clamp
    v_exp_f32 v26, v26 clamp
    v_exp_f32 v27, v27 clamp
    v_max_f32 v56, 0, v56
    v_max_f32 v57, 0, v57
    v_max_f32 v58, 0, v58
    v_max_f32 v59, 0, v59
    v_pk_add_f32 v[24:25], v[24:25], v[32:33]
    v_pk_add_f32 v[26:27], v[26:27], v[32:33]
    v_pk_fma_f32 v[56:57], v[56:57], v[28:29], v[24:25]
    v_pk_fma_f32 v[58:59], v[58:59], v[28:29], v[26:27]
    v_cvt_pk_bf16_f32 v10, v56, v57
    v_cvt_pk_bf16_f32 v11, v58, v59
    ds_write_b64 v34, v[10:11] offset:16
    v_pk_mul_f32 v[24:25], v[60:61], v[30:31]
    v_pk_mul_f32 v[26:27], v[62:63], v[30:31]
    v_exp_f32 v24, v24 clamp
    v_exp_f32 v25, v25 clamp
    v_exp_f32 v26, v26 clamp
    v_exp_f32 v27, v27 clamp
    v_max_f32 v60, 0, v60
    v_max_f32 v61, 0, v61
    v_max_f32 v62, 0, v62
    v_max_f32 v63, 0, v63
    v_pk_add_f32 v[24:25], v[24:25], v[32:33]
    v_pk_add_f32 v[26:27], v[26:27], v[32:33]
    v_pk_fma_f32 v[60:61], v[60:61], v[28:29], v[24:25]
    v_pk_fma_f32 v[62:63], v[62:63], v[28:29], v[26:27]
    v_cvt_pk_bf16_f32 v12, v60, v61
    v_cvt_pk_bf16_f32 v13, v62, v63
    ds_write_b64 v34, v[12:13] offset:32
    v_pk_mul_f32 v[24:25], v[64:65], v[30:31]
    v_pk_mul_f32 v[26:27], v[66:67], v[30:31]
    v_exp_f32 v24, v24 clamp
    v_exp_f32 v25, v25 clamp
    v_exp_f32 v26, v26 clamp
    v_exp_f32 v27, v27 clamp
    v_max_f32 v64, 0, v64
    v_max_f32 v65, 0, v65
    v_max_f32 v66, 0, v66
    v_max_f32 v67, 0, v67
    v_pk_add_f32 v[24:25], v[24:25], v[32:33]
    v_pk_add_f32 v[26:27], v[26:27], v[32:33]
    v_pk_fma_f32 v[64:65], v[64:65], v[28:29], v[24:25]
    v_pk_fma_f32 v[66:67], v[66:67], v[28:29], v[26:27]
    v_cvt_pk_bf16_f32 v14, v64, v65
    v_cvt_pk_bf16_f32 v15, v66, v67
    ds_write_b64 v34, v[14:15] offset:48
    v_pk_mul_f32 v[24:25], v[68:69], v[30:31]
    v_pk_mul_f32 v[26:27], v[70:71], v[30:31]
    v_exp_f32 v24, v24 clamp
    v_exp_f32 v25, v25 clamp
    v_exp_f32 v26, v26 clamp
    v_exp_f32 v27, v27 clamp
    v_max_f32 v68, 0, v68
    v_max_f32 v69, 0, v69
    v_max_f32 v70, 0, v70
    v_max_f32 v71, 0, v71
    v_pk_add_f32 v[24:25], v[24:25], v[32:33]
    v_pk_add_f32 v[26:27], v[26:27], v[32:33]
    v_pk_fma_f32 v[68:69], v[68:69], v[28:29], v[24:25]
    v_pk_fma_f32 v[70:71], v[70:71], v[28:29], v[26:27]
    v_cvt_pk_bf16_f32 v16, v68, v69
    v_cvt_pk_bf16_f32 v17, v70, v71
    ds_write_b64 v34, v[16:17] offset:64
    v_pk_mul_f32 v[24:25], v[72:73], v[30:31]
    v_pk_mul_f32 v[26:27], v[74:75], v[30:31]
    v_exp_f32 v24, v24 clamp
    v_exp_f32 v25, v25 clamp
    v_exp_f32 v26, v26 clamp
    v_exp_f32 v27, v27 clamp
    v_max_f32 v72, 0, v72
    v_max_f32 v73, 0, v73
    v_max_f32 v74, 0, v74
    v_max_f32 v75, 0, v75
    v_pk_add_f32 v[24:25], v[24:25], v[32:33]
    v_pk_add_f32 v[26:27], v[26:27], v[32:33]
    v_pk_fma_f32 v[72:73], v[72:73], v[28:29], v[24:25]
    v_pk_fma_f32 v[74:75], v[74:75], v[28:29], v[26:27]
    v_cvt_pk_bf16_f32 v18, v72, v73
    v_cvt_pk_bf16_f32 v19, v74, v75
    ds_write_b64 v34, v[18:19] offset:80
    v_pk_mul_f32 v[24:25], v[76:77], v[30:31]
    v_pk_mul_f32 v[26:27], v[78:79], v[30:31]
    v_exp_f32 v24, v24 clamp
    v_exp_f32 v25, v25 clamp
    v_exp_f32 v26, v26 clamp
    v_exp_f32 v27, v27 clamp
    v_max_f32 v76, 0, v76
    v_max_f32 v77, 0, v77
    v_max_f32 v78, 0, v78
    v_max_f32 v79, 0, v79
    v_pk_add_f32 v[24:25], v[24:25], v[32:33]
    v_pk_add_f32 v[26:27], v[26:27], v[32:33]
    v_pk_fma_f32 v[76:77], v[76:77], v[28:29], v[24:25]
    v_pk_fma_f32 v[78:79], v[78:79], v[28:29], v[26:27]
    v_cvt_pk_bf16_f32 v20, v76, v77
    v_cvt_pk_bf16_f32 v21, v78, v79
    ds_write_b64 v34, v[20:21] offset:96
    v_pk_mul_f32 v[24:25], v[80:81], v[30:31]
    v_pk_mul_f32 v[26:27], v[82:83], v[30:31]
    v_exp_f32 v24, v24 clamp
    v_exp_f32 v25, v25 clamp
    v_exp_f32 v26, v26 clamp
    v_exp_f32 v27, v27 clamp
    v_max_f32 v80, 0, v80
    v_max_f32 v81, 0, v81
    v_max_f32 v82, 0, v82
    v_max_f32 v83, 0, v83
    v_pk_add_f32 v[24:25], v[24:25], v[32:33]
    v_pk_add_f32 v[26:27], v[26:27], v[32:33]
    v_pk_fma_f32 v[80:81], v[80:81], v[28:29], v[24:25]
    v_pk_fma_f32 v[82:83], v[82:83], v[28:29], v[26:27]
    v_cvt_pk_bf16_f32 v22, v80, v81
    v_cvt_pk_bf16_f32 v23, v82, v83
    ds_write_b64 v34, v[22:23] offset:112
    v_pk_mul_f32 v[24:25], v[84:85], v[30:31]
    v_pk_mul_f32 v[26:27], v[86:87], v[30:31]
    v_exp_f32 v24, v24 clamp
    v_exp_f32 v25, v25 clamp
    v_exp_f32 v26, v26 clamp
    v_exp_f32 v27, v27 clamp
    v_max_f32 v84, 0, v84
    v_max_f32 v85, 0, v85
    v_max_f32 v86, 0, v86
    v_max_f32 v87, 0, v87
    v_pk_add_f32 v[24:25], v[24:25], v[32:33]
    v_pk_add_f32 v[26:27], v[26:27], v[32:33]
    v_pk_fma_f32 v[84:85], v[84:85], v[28:29], v[24:25]
    v_pk_fma_f32 v[86:87], v[86:87], v[28:29], v[26:27]
    v_cvt_pk_bf16_f32 v8, v84, v85
    v_cvt_pk_bf16_f32 v9, v86, v87
    ds_write_b64 v34, v[8:9] offset:128
    v_pk_mul_f32 v[24:25], v[88:89], v[30:31]
    v_pk_mul_f32 v[26:27], v[90:91], v[30:31]
    v_exp_f32 v24, v24 clamp
    v_exp_f32 v25, v25 clamp
    v_exp_f32 v26, v26 clamp
    v_exp_f32 v27, v27 clamp
    v_max_f32 v88, 0, v88
    v_max_f32 v89, 0, v89
    v_max_f32 v90, 0, v90
    v_max_f32 v91, 0, v91
    v_pk_add_f32 v[24:25], v[24:25], v[32:33]
    v_pk_add_f32 v[26:27], v[26:27], v[32:33]
    v_pk_fma_f32 v[88:89], v[88:89], v[28:29], v[24:25]
    v_pk_fma_f32 v[90:91], v[90:91], v[28:29], v[26:27]
    v_cvt_pk_bf16_f32 v10, v88, v89
    v_cvt_pk_bf16_f32 v11, v90, v91
    ds_write_b64 v34, v[10:11] offset:144
    v_pk_mul_f32 v[92:93], v[92:93], v[28:29]
    v_pk_mul_f32 v[94:95], v[94:95], v[28:29]
    v_cvt_pk_bf16_f32 v12, v92, v93
    v_cvt_pk_bf16_f32 v13, v94, v95
    ds_write_b64 v34, v[12:13] offset:160
    v_pk_mul_f32 v[96:97], v[96:97], v[28:29]
    v_pk_mul_f32 v[98:99], v[98:99], v[28:29]
    v_cvt_pk_bf16_f32 v14, v96, v97
    v_cvt_pk_bf16_f32 v15, v98, v99
    ds_write_b64 v34, v[14:15] offset:176
    v_pk_mul_f32 v[100:101], v[100:101], v[28:29]
    v_pk_mul_f32 v[102:103], v[102:103], v[28:29]
    v_cvt_pk_bf16_f32 v16, v100, v101
    v_cvt_pk_bf16_f32 v17, v102, v103
    ds_write_b64 v34, v[16:17] offset:192
    v_pk_mul_f32 v[104:105], v[104:105], v[28:29]
    v_pk_mul_f32 v[106:107], v[106:107], v[28:29]
    v_cvt_pk_bf16_f32 v18, v104, v105
    v_cvt_pk_bf16_f32 v19, v106, v107
    ds_write_b64 v34, v[18:19] offset:208
    v_pk_mul_f32 v[108:109], v[108:109], v[28:29]
    v_pk_mul_f32 v[110:111], v[110:111], v[28:29]
    v_cvt_pk_bf16_f32 v20, v108, v109
    v_cvt_pk_bf16_f32 v21, v110, v111
    ds_write_b64 v34, v[20:21] offset:224
    v_pk_mul_f32 v[112:113], v[112:113], v[28:29]
    v_pk_mul_f32 v[114:115], v[114:115], v[28:29]
    v_cvt_pk_bf16_f32 v22, v112, v113
    v_cvt_pk_bf16_f32 v23, v114, v115
    ds_write_b64 v34, v[22:23] offset:240
    v_pk_mul_f32 v[116:117], v[116:117], v[28:29]
    v_pk_mul_f32 v[118:119], v[118:119], v[28:29]
    v_cvt_pk_bf16_f32 v8, v116, v117
    v_cvt_pk_bf16_f32 v9, v118, v119
    ds_write_b64 v34, v[8:9] offset:256
    v_pk_mul_f32 v[120:121], v[120:121], v[28:29]
    v_pk_mul_f32 v[122:123], v[122:123], v[28:29]
    v_cvt_pk_bf16_f32 v10, v120, v121
    v_cvt_pk_bf16_f32 v11, v122, v123
    ds_write_b64 v34, v[10:11] offset:272
    v_pk_mul_f32 v[124:125], v[124:125], v[28:29]
    v_pk_mul_f32 v[126:127], v[126:127], v[28:29]
    v_cvt_pk_bf16_f32 v12, v124, v125
    v_cvt_pk_bf16_f32 v13, v126, v127
    ds_write_b64 v34, v[12:13] offset:288
    v_pk_mul_f32 v[128:129], v[128:129], v[28:29]
    v_pk_mul_f32 v[130:131], v[130:131], v[28:29]
    v_cvt_pk_bf16_f32 v14, v128, v129
    v_cvt_pk_bf16_f32 v15, v130, v131
    ds_write_b64 v34, v[14:15] offset:304
    v_mov_b32 v28, v51
    v_mov_b32 v29, v51
    v_mul_f32 v30, 0x3fb8aa3b, v51
    v_mul_f32 v31, 0x3fb8aa3b, v51
    v_pk_mul_f32 v[24:25], v[132:133], v[30:31]
    v_pk_mul_f32 v[26:27], v[134:135], v[30:31]
    v_exp_f32 v24, v24 clamp
    v_exp_f32 v25, v25 clamp
    v_exp_f32 v26, v26 clamp
    v_exp_f32 v27, v27 clamp
    v_max_f32 v132, 0, v132
    v_max_f32 v133, 0, v133
    v_max_f32 v134, 0, v134
    v_max_f32 v135, 0, v135
    v_pk_add_f32 v[24:25], v[24:25], v[32:33]
    v_pk_add_f32 v[26:27], v[26:27], v[32:33]
    v_pk_fma_f32 v[132:133], v[132:133], v[28:29], v[24:25]
    v_pk_fma_f32 v[134:135], v[134:135], v[28:29], v[26:27]
    v_cvt_pk_bf16_f32 v16, v132, v133
    v_cvt_pk_bf16_f32 v17, v134, v135
    ds_write_b64 v34, v[16:17] offset:10496
    v_pk_mul_f32 v[24:25], v[136:137], v[30:31]
    v_pk_mul_f32 v[26:27], v[138:139], v[30:31]
    v_exp_f32 v24, v24 clamp
    v_exp_f32 v25, v25 clamp
    v_exp_f32 v26, v26 clamp
    v_exp_f32 v27, v27 clamp
    v_max_f32 v136, 0, v136
    v_max_f32 v137, 0, v137
    v_max_f32 v138, 0, v138
    v_max_f32 v139, 0, v139
    v_pk_add_f32 v[24:25], v[24:25], v[32:33]
    v_pk_add_f32 v[26:27], v[26:27], v[32:33]
    v_pk_fma_f32 v[136:137], v[136:137], v[28:29], v[24:25]
    v_pk_fma_f32 v[138:139], v[138:139], v[28:29], v[26:27]
    v_cvt_pk_bf16_f32 v18, v136, v137
    v_cvt_pk_bf16_f32 v19, v138, v139
    ds_write_b64 v34, v[18:19] offset:10512
    v_pk_mul_f32 v[24:25], v[140:141], v[30:31]
    v_pk_mul_f32 v[26:27], v[142:143], v[30:31]
    v_exp_f32 v24, v24 clamp
    v_exp_f32 v25, v25 clamp
    v_exp_f32 v26, v26 clamp
    v_exp_f32 v27, v27 clamp
    v_max_f32 v140, 0, v140
    v_max_f32 v141, 0, v141
    v_max_f32 v142, 0, v142
    v_max_f32 v143, 0, v143
    v_pk_add_f32 v[24:25], v[24:25], v[32:33]
    v_pk_add_f32 v[26:27], v[26:27], v[32:33]
    v_pk_fma_f32 v[140:141], v[140:141], v[28:29], v[24:25]
    v_pk_fma_f32 v[142:143], v[142:143], v[28:29], v[26:27]
    v_cvt_pk_bf16_f32 v20, v140, v141
    v_cvt_pk_bf16_f32 v21, v142, v143
    ds_write_b64 v34, v[20:21] offset:10528
    v_pk_mul_f32 v[24:25], v[144:145], v[30:31]
    v_pk_mul_f32 v[26:27], v[146:147], v[30:31]
    v_exp_f32 v24, v24 clamp
    v_exp_f32 v25, v25 clamp
    v_exp_f32 v26, v26 clamp
    v_exp_f32 v27, v27 clamp
    v_max_f32 v144, 0, v144
    v_max_f32 v145, 0, v145
    v_max_f32 v146, 0, v146
    v_max_f32 v147, 0, v147
    v_pk_add_f32 v[24:25], v[24:25], v[32:33]
    v_pk_add_f32 v[26:27], v[26:27], v[32:33]
    v_pk_fma_f32 v[144:145], v[144:145], v[28:29], v[24:25]
    v_pk_fma_f32 v[146:147], v[146:147], v[28:29], v[26:27]
    v_cvt_pk_bf16_f32 v22, v144, v145
    v_cvt_pk_bf16_f32 v23, v146, v147
    ds_write_b64 v34, v[22:23] offset:10544
    v_pk_mul_f32 v[24:25], v[148:149], v[30:31]
    v_pk_mul_f32 v[26:27], v[150:151], v[30:31]
    v_exp_f32 v24, v24 clamp
    v_exp_f32 v25, v25 clamp
    v_exp_f32 v26, v26 clamp
    v_exp_f32 v27, v27 clamp
    v_max_f32 v148, 0, v148
    v_max_f32 v149, 0, v149
    v_max_f32 v150, 0, v150
    v_max_f32 v151, 0, v151
    v_pk_add_f32 v[24:25], v[24:25], v[32:33]
    v_pk_add_f32 v[26:27], v[26:27], v[32:33]
    v_pk_fma_f32 v[148:149], v[148:149], v[28:29], v[24:25]
    v_pk_fma_f32 v[150:151], v[150:151], v[28:29], v[26:27]
    v_cvt_pk_bf16_f32 v8, v148, v149
    v_cvt_pk_bf16_f32 v9, v150, v151
    ds_write_b64 v34, v[8:9] offset:10560
    v_pk_mul_f32 v[24:25], v[152:153], v[30:31]
    v_pk_mul_f32 v[26:27], v[154:155], v[30:31]
    v_exp_f32 v24, v24 clamp
    v_exp_f32 v25, v25 clamp
    v_exp_f32 v26, v26 clamp
    v_exp_f32 v27, v27 clamp
    v_max_f32 v152, 0, v152
    v_max_f32 v153, 0, v153
    v_max_f32 v154, 0, v154
    v_max_f32 v155, 0, v155
    v_pk_add_f32 v[24:25], v[24:25], v[32:33]
    v_pk_add_f32 v[26:27], v[26:27], v[32:33]
    v_pk_fma_f32 v[152:153], v[152:153], v[28:29], v[24:25]
    v_pk_fma_f32 v[154:155], v[154:155], v[28:29], v[26:27]
    v_cvt_pk_bf16_f32 v10, v152, v153
    v_cvt_pk_bf16_f32 v11, v154, v155
    ds_write_b64 v34, v[10:11] offset:10576
    v_pk_mul_f32 v[24:25], v[156:157], v[30:31]
    v_pk_mul_f32 v[26:27], v[158:159], v[30:31]
    v_exp_f32 v24, v24 clamp
    v_exp_f32 v25, v25 clamp
    v_exp_f32 v26, v26 clamp
    v_exp_f32 v27, v27 clamp
    v_max_f32 v156, 0, v156
    v_max_f32 v157, 0, v157
    v_max_f32 v158, 0, v158
    v_max_f32 v159, 0, v159
    v_pk_add_f32 v[24:25], v[24:25], v[32:33]
    v_pk_add_f32 v[26:27], v[26:27], v[32:33]
    v_pk_fma_f32 v[156:157], v[156:157], v[28:29], v[24:25]
    v_pk_fma_f32 v[158:159], v[158:159], v[28:29], v[26:27]
    v_cvt_pk_bf16_f32 v12, v156, v157
    v_cvt_pk_bf16_f32 v13, v158, v159
    ds_write_b64 v34, v[12:13] offset:10592
    v_pk_mul_f32 v[24:25], v[160:161], v[30:31]
    v_pk_mul_f32 v[26:27], v[162:163], v[30:31]
    v_exp_f32 v24, v24 clamp
    v_exp_f32 v25, v25 clamp
    v_exp_f32 v26, v26 clamp
    v_exp_f32 v27, v27 clamp
    v_max_f32 v160, 0, v160
    v_max_f32 v161, 0, v161
    v_max_f32 v162, 0, v162
    v_max_f32 v163, 0, v163
    v_pk_add_f32 v[24:25], v[24:25], v[32:33]
    v_pk_add_f32 v[26:27], v[26:27], v[32:33]
    v_pk_fma_f32 v[160:161], v[160:161], v[28:29], v[24:25]
    v_pk_fma_f32 v[162:163], v[162:163], v[28:29], v[26:27]
    v_cvt_pk_bf16_f32 v14, v160, v161
    v_cvt_pk_bf16_f32 v15, v162, v163
    ds_write_b64 v34, v[14:15] offset:10608
    v_pk_mul_f32 v[24:25], v[164:165], v[30:31]
    v_pk_mul_f32 v[26:27], v[166:167], v[30:31]
    v_exp_f32 v24, v24 clamp
    v_exp_f32 v25, v25 clamp
    v_exp_f32 v26, v26 clamp
    v_exp_f32 v27, v27 clamp
    v_max_f32 v164, 0, v164
    v_max_f32 v165, 0, v165
    v_max_f32 v166, 0, v166
    v_max_f32 v167, 0, v167
    v_pk_add_f32 v[24:25], v[24:25], v[32:33]
    v_pk_add_f32 v[26:27], v[26:27], v[32:33]
    v_pk_fma_f32 v[164:165], v[164:165], v[28:29], v[24:25]
    v_pk_fma_f32 v[166:167], v[166:167], v[28:29], v[26:27]
    v_cvt_pk_bf16_f32 v16, v164, v165
    v_cvt_pk_bf16_f32 v17, v166, v167
    ds_write_b64 v34, v[16:17] offset:10624
    v_pk_mul_f32 v[24:25], v[168:169], v[30:31]
    v_pk_mul_f32 v[26:27], v[170:171], v[30:31]
    v_exp_f32 v24, v24 clamp
    v_exp_f32 v25, v25 clamp
    v_exp_f32 v26, v26 clamp
    v_exp_f32 v27, v27 clamp
    v_max_f32 v168, 0, v168
    v_max_f32 v169, 0, v169
    v_max_f32 v170, 0, v170
    v_max_f32 v171, 0, v171
    v_pk_add_f32 v[24:25], v[24:25], v[32:33]
    v_pk_add_f32 v[26:27], v[26:27], v[32:33]
    v_pk_fma_f32 v[168:169], v[168:169], v[28:29], v[24:25]
    v_pk_fma_f32 v[170:171], v[170:171], v[28:29], v[26:27]
    v_cvt_pk_bf16_f32 v18, v168, v169
    v_cvt_pk_bf16_f32 v19, v170, v171
    ds_write_b64 v34, v[18:19] offset:10640
    v_pk_mul_f32 v[172:173], v[172:173], v[28:29]
    v_pk_mul_f32 v[174:175], v[174:175], v[28:29]
    v_cvt_pk_bf16_f32 v20, v172, v173
    v_cvt_pk_bf16_f32 v21, v174, v175
    ds_write_b64 v34, v[20:21] offset:10656
    v_pk_mul_f32 v[176:177], v[176:177], v[28:29]
    v_pk_mul_f32 v[178:179], v[178:179], v[28:29]
    v_cvt_pk_bf16_f32 v22, v176, v177
    v_cvt_pk_bf16_f32 v23, v178, v179
    ds_write_b64 v34, v[22:23] offset:10672
    v_pk_mul_f32 v[180:181], v[180:181], v[28:29]
    v_pk_mul_f32 v[182:183], v[182:183], v[28:29]
    v_cvt_pk_bf16_f32 v8, v180, v181
    v_cvt_pk_bf16_f32 v9, v182, v183
    ds_write_b64 v34, v[8:9] offset:10688
    v_pk_mul_f32 v[184:185], v[184:185], v[28:29]
    v_pk_mul_f32 v[186:187], v[186:187], v[28:29]
    v_cvt_pk_bf16_f32 v10, v184, v185
    v_cvt_pk_bf16_f32 v11, v186, v187
    ds_write_b64 v34, v[10:11] offset:10704
    v_pk_mul_f32 v[188:189], v[188:189], v[28:29]
    v_pk_mul_f32 v[190:191], v[190:191], v[28:29]
    v_cvt_pk_bf16_f32 v12, v188, v189
    v_cvt_pk_bf16_f32 v13, v190, v191
    ds_write_b64 v34, v[12:13] offset:10720
    v_pk_mul_f32 v[192:193], v[192:193], v[28:29]
    v_pk_mul_f32 v[194:195], v[194:195], v[28:29]
    v_cvt_pk_bf16_f32 v14, v192, v193
    v_cvt_pk_bf16_f32 v15, v194, v195
    ds_write_b64 v34, v[14:15] offset:10736
    v_pk_mul_f32 v[196:197], v[196:197], v[28:29]
    v_pk_mul_f32 v[198:199], v[198:199], v[28:29]
    v_cvt_pk_bf16_f32 v16, v196, v197
    v_cvt_pk_bf16_f32 v17, v198, v199
    ds_write_b64 v34, v[16:17] offset:10752
    v_pk_mul_f32 v[200:201], v[200:201], v[28:29]
    v_pk_mul_f32 v[202:203], v[202:203], v[28:29]
    v_cvt_pk_bf16_f32 v18, v200, v201
    v_cvt_pk_bf16_f32 v19, v202, v203
    ds_write_b64 v34, v[18:19] offset:10768
    v_pk_mul_f32 v[204:205], v[204:205], v[28:29]
    v_pk_mul_f32 v[206:207], v[206:207], v[28:29]
    v_cvt_pk_bf16_f32 v20, v204, v205
    v_cvt_pk_bf16_f32 v21, v206, v207
    ds_write_b64 v34, v[20:21] offset:10784
    v_pk_mul_f32 v[208:209], v[208:209], v[28:29]
    v_pk_mul_f32 v[210:211], v[210:211], v[28:29]
    v_cvt_pk_bf16_f32 v22, v208, v209
    v_cvt_pk_bf16_f32 v23, v210, v211
    ds_write_b64 v34, v[22:23] offset:10800
    v_mov_b32 v8, 0x3f803f80
    v_mov_b32 v9, 0x3f803f80
    s_lshl_b32 s83, s72, 6
    v_add_u32 v3, s83, v1
    v_mul_u32_u24 v3, 328, v3
    ds_write_b64 v3, v[8:9] offset:320
    s_lshr_b32 s85, s72, 1
    s_add_u32 s86, s72, 1
    s_lshr_b32 s86, s86, 1
    s_add_u32 s86, s86, 2
    s_sub_u32 s96, s72, 1
    s_cmp_eq_u32 s72, 0
    s_cselect_b32 s96, 2, s96
    v_lshrrev_b32 v3, 5, v1
    v_bfe_u32 v4, v1, 2, 2
    v_lshl_add_u32 v3, v3, 3, v4
    v_mul_u32_u24 v3, 328, v3
    v_bfe_u32 v4, v1, 4, 1
    v_lshl_add_u32 v3, v4, 5, v3
    v_and_b32_e64 v4, 3, v1
    v_lshl_add_u32 v5, v4, 3, v3
    s_lshl_b32 s83, s85, 6
    v_add_u32 v212, s83, v5
    s_lshl_b32 s83, s86, 6
    v_add_u32 v214, s83, v5
    s_lshl_b32 s83, s96, 6
    v_add_u32 v216, s83, v5
    v_add_u32 v218, 256, v5
    s_cmp_eq_u32 s72, 0
    s_cbranch_scc1 SK_105
    v_lshrrev_b32_e64 v3, 5, v1
    v_bfe_u32 v4, v1, 2, 2
    v_lshl_add_u32 v3, v3, 3, v4
    v_mul_u32_u24 v3, 328, v3
    v_add_u32 v218, 320, v3
SK_105:
    v_add_u32 v213, 41984, v212
    v_add_u32 v215, 41984, v214
    v_add_u32 v217, 41984, v216
    v_add_u32 v219, 41984, v218
    s_waitcnt lgkmcnt(0)
    s_barrier
    ds_read_b64_tr_b16 v[84:85], v212 offset:0
    ds_read_b64_tr_b16 v[86:87], v212 offset:1312
    ds_read_b64_tr_b16 v[88:89], v214 offset:0
    ds_read_b64_tr_b16 v[90:91], v214 offset:1312
    ds_read_b64_tr_b16 v[92:93], v216 offset:0
    ds_read_b64_tr_b16 v[94:95], v216 offset:1312
    ds_read_b64_tr_b16 v[96:97], v218 offset:0
    ds_read_b64_tr_b16 v[98:99], v218 offset:1312
    ds_read_b64_tr_b16 v[100:101], v212 offset:5248
    ds_read_b64_tr_b16 v[102:103], v212 offset:6560
    ds_read_b64_tr_b16 v[104:105], v214 offset:5248
    ds_read_b64_tr_b16 v[106:107], v214 offset:6560
    ds_read_b64_tr_b16 v[108:109], v216 offset:5248
    ds_read_b64_tr_b16 v[110:111], v216 offset:6560
    ds_read_b64_tr_b16 v[112:113], v218 offset:5248
    ds_read_b64_tr_b16 v[114:115], v218 offset:6560
    ds_read_b64_tr_b16 v[116:117], v212 offset:10496
    ds_read_b64_tr_b16 v[118:119], v212 offset:11808
    ds_read_b64_tr_b16 v[120:121], v214 offset:10496
    ds_read_b64_tr_b16 v[122:123], v214 offset:11808
    ds_read_b64_tr_b16 v[124:125], v216 offset:10496
    ds_read_b64_tr_b16 v[126:127], v216 offset:11808
    ds_read_b64_tr_b16 v[128:129], v218 offset:10496
    ds_read_b64_tr_b16 v[130:131], v218 offset:11808
    s_waitcnt lgkmcnt(15)
    v_mfma_f32_32x32x16_bf16 v[52:67], v[84:87], v[88:91], 0
    v_mov_b32 v5, 93184
    s_lshl_b32 s83, s86, 5
    s_sub_u32 s83, s83, 80
    v_and_b32 v220, 31, v1
    v_add_u32 v220, s83, v220
    ds_read_b64_tr_b16 v[132:133], v212 offset:15744
    ds_read_b64_tr_b16 v[134:135], v212 offset:17056
    ds_read_b64_tr_b16 v[136:137], v214 offset:15744
    ds_read_b64_tr_b16 v[138:139], v214 offset:17056
    v_mfma_f32_32x32x16_bf16 v[68:83], v[92:95], v[96:99], 0
    v_and_b32 v220, 0xffff, v220
    v_mul_u32_u24 v221, 3277, v220
    v_lshrrev_b32 v221, 16, v221
    v_sub_u32 v220, v220, v221
    v_mul_u32_u24 v220, 80, v220
    ds_read_b64_tr_b16 v[140:141], v216 offset:15744
    ds_read_b64_tr_b16 v[142:143], v216 offset:17056
    ds_read_b64_tr_b16 v[144:145], v218 offset:15744
    ds_read_b64_tr_b16 v[146:147], v218 offset:17056
    s_waitcnt lgkmcnt(15)
    v_mfma_f32_32x32x16_bf16 v[52:67], v[100:103], v[104:107], v[52:67]
    v_add_u32 v220, 84992, v220
    s_lshl_b32 s83, s85, 5
    s_add_u32 s83, s83, 0
    v_lshrrev_b32 v222, 5, v1
    v_lshl_add_u32 v222, v222, 2, s83
    ds_read_b64_tr_b16 v[84:85], v212 offset:20992
    ds_read_b64_tr_b16 v[86:87], v212 offset:22304
    ds_read_b64_tr_b16 v[88:89], v214 offset:20992
    ds_read_b64_tr_b16 v[90:91], v214 offset:22304
    v_mfma_f32_32x32x16_bf16 v[68:83], v[108:111], v[112:115], v[68:83]
    v_mul_u32_u24 v223, 3277, v222
    v_lshrrev_b32 v223, 16, v223
    v_cmp_eq_u32 vcc, v223, v221
    v_lshl_add_u32 v222, v222, 2, v220
    s_nop 0
    v_cndmask_b32 v232, v5, v222, vcc
    ds_read_b64_tr_b16 v[92:93], v216 offset:20992
    ds_read_b64_tr_b16 v[94:95], v216 offset:22304
    ds_read_b64_tr_b16 v[96:97], v218 offset:20992
    ds_read_b64_tr_b16 v[98:99], v218 offset:22304
    s_waitcnt lgkmcnt(15)
    v_mfma_f32_32x32x16_bf16 v[52:67], v[116:119], v[120:123], v[52:67]
    s_lshl_b32 s83, s85, 5
    s_add_u32 s83, s83, 8
    v_lshrrev_b32 v222, 5, v1
    v_lshl_add_u32 v222, v222, 2, s83
    v_mul_u32_u24 v223, 3277, v222
    ds_read_b64_tr_b16 v[100:101], v212 offset:26240
    ds_read_b64_tr_b16 v[102:103], v212 offset:27552
    ds_read_b64_tr_b16 v[104:105], v214 offset:26240
    ds_read_b64_tr_b16 v[106:107], v214 offset:27552
    v_mfma_f32_32x32x16_bf16 v[68:83], v[124:127], v[128:131], v[68:83]
    v_lshrrev_b32 v223, 16, v223
    v_cmp_eq_u32 vcc, v223, v221
    v_lshl_add_u32 v222, v222, 2, v220
    s_nop 0
    v_cndmask_b32 v233, v5, v222, vcc
    s_lshl_b32 s83, s85, 5
    ds_read_b64_tr_b16 v[108:109], v216 offset:26240
    ds_read_b64_tr_b16 v[110:111], v216 offset:27552
    ds_read_b64_tr_b16 v[112:113], v218 offset:26240
    ds_read_b64_tr_b16 v[114:115], v218 offset:27552
    s_waitcnt lgkmcnt(15)
    v_mfma_f32_32x32x16_bf16 v[52:67], v[132:135], v[136:139], v[52:67]
    s_add_u32 s83, s83, 16
    v_lshrrev_b32 v222, 5, v1
    v_lshl_add_u32 v222, v222, 2, s83
    v_mul_u32_u24 v223, 3277, v222
    v_lshrrev_b32_e64 v223, 16, v223
    ds_read_b64_tr_b16 v[116:117], v212 offset:31488
    ds_read_b64_tr_b16 v[118:119], v212 offset:32800
    ds_read_b64_tr_b16 v[120:121], v214 offset:31488
    ds_read_b64_tr_b16 v[122:123], v214 offset:32800
    v_mfma_f32_32x32x16_bf16 v[68:83], v[140:143], v[144:147], v[68:83]
    v_cmp_eq_u32 vcc, v223, v221
    v_lshl_add_u32 v222, v222, 2, v220
    s_nop 0
    v_cndmask_b32 v234, v5, v222, vcc
    s_lshl_b32 s83, s85, 5
    s_add_u32 s83, s83, 24
    ds_read_b64_tr_b16 v[124:125], v216 offset:31488
    ds_read_b64_tr_b16 v[126:127], v216 offset:32800
    ds_read_b64_tr_b16 v[128:129], v218 offset:31488
    ds_read_b64_tr_b16 v[130:131], v218 offset:32800
    s_waitcnt lgkmcnt(15)
    v_mfma_f32_32x32x16_bf16 v[52:67], v[84:87], v[88:91], v[52:67]
    v_lshrrev_b32_e64 v222, 5, v1
    v_lshl_add_u32 v222, v222, 2, s83
    v_mul_u32_u24 v223, 3277, v222
    v_lshrrev_b32 v223, 16, v223
    v_cmp_eq_u32 vcc, v223, v221
    ds_read_b64_tr_b16 v[132:133], v212 offset:36736
    ds_read_b64_tr_b16 v[134:135], v212 offset:38048
    ds_read_b64_tr_b16 v[136:137], v214 offset:36736
    ds_read_b64_tr_b16 v[138:139], v214 offset:38048
    v_mfma_f32_32x32x16_bf16 v[68:83], v[92:95], v[96:99], v[68:83]
    v_lshl_add_u32 v222, v222, 2, v220
    v_cndmask_b32 v235, v5, v222, vcc
    v_and_b32 v220, 31, v1
    v_add_u32_e64 v220, 48, v220
    v_mul_u32_u24 v221, 3277, v220
    ds_read_b64_tr_b16 v[140:141], v216 offset:36736
    ds_read_b64_tr_b16 v[142:143], v216 offset:38048
    ds_read_b64_tr_b16 v[144:145], v218 offset:36736
    ds_read_b64_tr_b16 v[146:147], v218 offset:38048
    s_waitcnt lgkmcnt(15)
    v_mfma_f32_32x32x16_bf16 v[52:67], v[100:103], v[104:107], v[52:67]
    v_lshrrev_b32 v221, 16, v221
    v_sub_u32_e64 v220, v220, v221
    v_mul_u32_u24 v220, 80, v220
    v_add_u32 v220, 84992, v220
    s_cmp_eq_u32 s72, 0
    ds_read_b64_tr_b16 v[84:85], v213 offset:0
    ds_read_b64_tr_b16 v[86:87], v213 offset:1312
    ds_read_b64_tr_b16 v[88:89], v215 offset:0
    ds_read_b64_tr_b16 v[90:91], v215 offset:1312
    v_mfma_f32_32x32x16_bf16 v[68:83], v[108:111], v[112:115], v[68:83]
    s_cselect_b64 s[4:5], -1, 0
    s_mov_b32 s84, 820
    s_cselect_b32 s84, 3277, s84
    v_and_b32_e64 v4, 31, v1
    v_cndmask_b32 v221, v4, v221, s[4:5]
    ds_read_b64_tr_b16 v[92:93], v217 offset:0
    ds_read_b64_tr_b16 v[94:95], v217 offset:1312
    ds_read_b64_tr_b16 v[96:97], v219 offset:0
    ds_read_b64_tr_b16 v[98:99], v219 offset:1312
    s_waitcnt lgkmcnt(15)
    v_mfma_f32_32x32x16_bf16 v[52:67], v[116:119], v[120:123], v[52:67]
    v_mov_b32 v4, 91392
    v_cndmask_b32 v220, v4, v220, s[4:5]
    s_lshl_b32 s83, s96, 5
    s_add_u32 s83, s83, 0
    v_lshrrev_b32 v222, 5, v1
    ds_read_b64_tr_b16 v[100:101], v213 offset:5248
    ds_read_b64_tr_b16 v[102:103], v213 offset:6560
    ds_read_b64_tr_b16 v[104:105], v215 offset:5248
    ds_read_b64_tr_b16 v[106:107], v215 offset:6560
    v_mfma_f32_32x32x16_bf16 v[68:83], v[124:127], v[128:131], v[68:83]
    v_lshl_add_u32 v222, v222, 2, s83
    v_mul_u32_u24 v223, s84, v222
    v_lshrrev_b32 v223, 16, v223
    v_cmp_eq_u32 vcc, v223, v221
    v_lshl_add_u32 v222, v222, 2, v220
    ds_read_b64_tr_b16 v[108:109], v217 offset:5248
    ds_read_b64_tr_b16 v[110:111], v217 offset:6560
    ds_read_b64_tr_b16 v[112:113], v219 offset:5248
    ds_read_b64_tr_b16 v[114:115], v219 offset:6560
    s_waitcnt lgkmcnt(15)
    v_mfma_f32_32x32x16_bf16 v[52:67], v[132:135], v[136:139], v[52:67]
    v_cndmask_b32 v236, v5, v222, vcc
    s_lshl_b32 s83, s96, 5
    s_add_u32 s83, s83, 8
    v_lshrrev_b32 v222, 5, v1
    v_lshl_add_u32 v222, v222, 2, s83
    ds_read_b64_tr_b16 v[116:117], v213 offset:10496
    ds_read_b64_tr_b16 v[118:119], v213 offset:11808
    ds_read_b64_tr_b16 v[120:121], v215 offset:10496
    ds_read_b64_tr_b16 v[122:123], v215 offset:11808
    v_mfma_f32_32x32x16_bf16 v[68:83], v[140:143], v[144:147], v[68:83]
    v_mul_u32_u24 v223, s84, v222
    v_lshrrev_b32 v223, 16, v223
    v_cmp_eq_u32 vcc, v223, v221
    v_lshl_add_u32 v222, v222, 2, v220
    s_nop 0
    v_cndmask_b32_e64 v237, v5, v222, vcc
    ds_read_b64_tr_b16 v[124:125], v217 offset:10496
    ds_read_b64_tr_b16 v[126:127], v217 offset:11808
    ds_read_b64_tr_b16 v[128:129], v219 offset:10496
    ds_read_b64_tr_b16 v[130:131], v219 offset:11808
    s_waitcnt lgkmcnt(15)
    v_mfma_f32_32x32x16_bf16 v[52:67], v[84:87], v[88:91], v[52:67]
    s_lshl_b32 s83, s96, 5
    s_add_u32 s83, s83, 16
    v_lshrrev_b32 v222, 5, v1
    v_lshl_add_u32 v222, v222, 2, s83
    v_mul_u32_u24_e64 v223, s84, v222
    ds_read_b64_tr_b16 v[132:133], v213 offset:15744
    ds_read_b64_tr_b16 v[134:135], v213 offset:17056
    ds_read_b64_tr_b16 v[136:137], v215 offset:15744
    ds_read_b64_tr_b16 v[138:139], v215 offset:17056
    v_mfma_f32_32x32x16_bf16 v[68:83], v[92:95], v[96:99], v[68:83]
    v_lshrrev_b32 v223, 16, v223
    v_cmp_eq_u32 vcc, v223, v221
    v_lshl_add_u32 v222, v222, 2, v220
    s_nop 0
    v_cndmask_b32 v238, v5, v222, vcc
    s_lshl_b32 s83, s96, 5
    ds_read_b64_tr_b16 v[140:141], v217 offset:15744
    ds_read_b64_tr_b16 v[142:143], v217 offset:17056
    ds_read_b64_tr_b16 v[144:145], v219 offset:15744
    ds_read_b64_tr_b16 v[146:147], v219 offset:17056
    s_waitcnt lgkmcnt(15)
    v_mfma_f32_32x32x16_bf16 v[52:67], v[100:103], v[104:107], v[52:67]
    s_add_u32 s83, s83, 24
    v_lshrrev_b32 v222, 5, v1
    v_lshl_add_u32 v222, v222, 2, s83
    v_mul_u32_u24 v223, s84, v222
    v_lshrrev_b32 v223, 16, v223
    ds_read_b64_tr_b16 v[84:85], v213 offset:20992
    ds_read_b64_tr_b16 v[86:87], v213 offset:22304
    ds_read_b64_tr_b16 v[88:89], v215 offset:20992
    ds_read_b64_tr_b16 v[90:91], v215 offset:22304
    v_mfma_f32_32x32x16_bf16 v[68:83], v[108:111], v[112:115], v[68:83]
    v_cmp_eq_u32 vcc, v223, v221
    v_lshl_add_u32 v222, v222, 2, v220
    s_nop 0
    v_cndmask_b32 v239, v5, v222, vcc
    s_lshl_b32 s83, s74, 8
    s_lshl_b32 s84, s72, 6
    ds_read_b64_tr_b16 v[92:93], v217 offset:20992
    ds_read_b64_tr_b16 v[94:95], v217 offset:22304
    ds_read_b64_tr_b16 v[96:97], v219 offset:20992
    ds_read_b64_tr_b16 v[98:99], v219 offset:22304
    s_waitcnt lgkmcnt(15)
    v_mfma_f32_32x32x16_bf16 v[52:67], v[116:119], v[120:123], v[52:67]
    s_add_u32 s83, s83, s84
    s_lshl_b32 s83, s83, 4
    v_lshrrev_b32_e64 v4, 4, v1
    v_mul_u32_u24 v4, 33024, v4
    v_and_b32_e64 v3, 15, v1
    ds_read_b64_tr_b16 v[100:101], v213 offset:26240
    ds_read_b64_tr_b16 v[102:103], v213 offset:27552
    ds_read_b64_tr_b16 v[104:105], v215 offset:26240
    ds_read_b64_tr_b16 v[106:107], v215 offset:27552
    v_mfma_f32_32x32x16_bf16 v[68:83], v[124:127], v[128:131], v[68:83]
    v_lshl_add_u32 v228, v3, 4, v4
    v_add_u32 v228, s83, v228
    v_lshrrev_b32 v4, 5, v1
    v_mul_u32_u24 v4, 33024, v4
    v_and_b32_e64 v3, 31, v1
    ds_read_b64_tr_b16 v[108:109], v217 offset:26240
    ds_read_b64_tr_b16 v[110:111], v217 offset:27552
    ds_read_b64_tr_b16 v[112:113], v219 offset:26240
    ds_read_b64_tr_b16 v[114:115], v219 offset:27552
    s_waitcnt lgkmcnt(15)
    v_mfma_f32_32x32x16_bf16 v[52:67], v[132:135], v[136:139], v[52:67]
    v_lshl_add_u32 v230, v3, 4, v4
    v_add_u32 v230, s83, v230
    s_mul_i32 s93, s99, 5
    s_lshr_b32 s93, s93, 1
    s_lshr_b32 s92, s99, 1
    ds_read_b64_tr_b16 v[116:117], v213 offset:31488
    ds_read_b64_tr_b16 v[118:119], v213 offset:32800
    ds_read_b64_tr_b16 v[120:121], v215 offset:31488
    ds_read_b64_tr_b16 v[122:123], v215 offset:32800
    v_mfma_f32_32x32x16_bf16 v[68:83], v[140:143], v[144:147], v[68:83]
    s_add_u32 s92, s92, 8
    s_mul_i32 s83, s74, 2048
    s_lshl_b32 s84, s92, 7
    s_add_u32 s83, s83, s84
    s_add_u32 s83, s83, 22241280
    ds_read_b64_tr_b16 v[124:125], v217 offset:31488
    ds_read_b64_tr_b16 v[126:127], v217 offset:32800
    ds_read_b64_tr_b16 v[128:129], v219 offset:31488
    ds_read_b64_tr_b16 v[130:131], v219 offset:32800
    s_waitcnt lgkmcnt(15)
    v_mfma_f32_32x32x16_bf16 v[52:67], v[84:87], v[88:91], v[52:67]
    v_mov_b32 v229, s83
    buffer_load_dword v231, v229, s[64:67], 0 offen sc1
    ds_read_b64_tr_b16 v[132:133], v213 offset:36736
    ds_read_b64_tr_b16 v[134:135], v213 offset:38048
    ds_read_b64_tr_b16 v[136:137], v215 offset:36736
    ds_read_b64_tr_b16 v[138:139], v215 offset:38048
    v_mfma_f32_32x32x16_bf16 v[68:83], v[92:95], v[96:99], v[68:83]
    ds_read_b64_tr_b16 v[140:141], v217 offset:36736
    ds_read_b64_tr_b16 v[142:143], v217 offset:38048
    ds_read_b64_tr_b16 v[144:145], v219 offset:36736
    ds_read_b64_tr_b16 v[146:147], v219 offset:38048
    s_waitcnt lgkmcnt(15)
    v_mfma_f32_32x32x16_bf16 v[52:67], v[100:103], v[104:107], v[52:67]
    v_mfma_f32_32x32x16_bf16 v[68:83], v[108:111], v[112:115], v[68:83]
    s_waitcnt lgkmcnt(12)
    v_mfma_f32_32x32x16_bf16 v[52:67], v[116:119], v[120:123], v[52:67]
    s_waitcnt lgkmcnt(8)
    v_mfma_f32_32x32x16_bf16 v[68:83], v[124:127], v[128:131], v[68:83]
    s_waitcnt lgkmcnt(4)
    v_mfma_f32_32x32x16_bf16 v[52:67], v[132:135], v[136:139], v[52:67]
    s_waitcnt lgkmcnt(0)
    v_mfma_f32_32x32x16_bf16 v[68:83], v[140:143], v[144:147], v[68:83]
    s_lshl_b32 s83, s72, 6
    v_add_u32_e64 v3, s83, v1
    s_mul_i32 s84, s75, 6400
    v_lshl_add_u32 v220, v3, 4, s84
    v_lshlrev_b32_e64 v222, 4, v3
    v_add_u32 v222, 84992, v222
    s_mul_i32 s84, s75, 320
    s_add_u32 s84, s84, 48896
    v_lshl_add_u32 v4, v3, 4, s84
    v_add_u32 v221, 4096, v220
    v_cmp_lt_u32 vcc, 143, v3
    s_nop 1
    v_cndmask_b32 v221, v221, v4, vcc
    v_mov_b32 v4, 2147483648
    v_cmp_lt_u32 vcc, 163, v3
    s_nop 1
    v_cndmask_b32 v221, v221, v4, vcc
    s_mul_i32 s84, s81, 53760
    s_add_u32 s84, s84, 524288
    ds_write_b128 v232, v[52:55]
    ds_write_b128 v233, v[56:59]
    ds_write_b128 v234, v[60:63]
    ds_write_b128 v235, v[64:67]
    ds_write_b128 v236, v[68:71]
    ds_write_b128 v237, v[72:75]
    ds_write_b128 v238, v[76:79]
    ds_write_b128 v239, v[80:83]
    s_waitcnt lgkmcnt(0)
    s_barrier
    ds_read_b128 v[52:55], v222
    ds_read_b128 v[56:59], v222 offset:4096
    s_waitcnt lgkmcnt(0)
    buffer_store_dwordx4 v[52:55], v220, s[64:67], s84 offen sc1
    buffer_store_dwordx4 v[56:59], v221, s[64:67], s84 offen sc1
    s_waitcnt vmcnt(2)
    v_cmp_ne_u32 vcc, s73, v231
    s_mov_b32 s92, 0
    s_cbranch_vccnz G1_DONE
    s_mov_b32 s92, 1
    s_add_u32 s83, s93, 0
    s_mul_i32 s83, s83, 132096
    s_add_u32 s83, s83, 4784128
    buffer_load_dwordx4 v[180:183], v228, s[64:67], s83 offen offset:0 sc1
    buffer_load_dwordx4 v[184:187], v228, s[64:67], s83 offen offset:256 sc1
    buffer_load_dwordx4 v[188:191], v228, s[64:67], s83 offen offset:512 sc1
    buffer_load_dwordx4 v[192:195], v228, s[64:67], s83 offen offset:768 sc1
    s_add_u32 s83, s93, 1
    s_mul_i32 s83, s83, 132096
    s_add_u32 s83, s83, 4784128
    buffer_load_dwordx4 v[196:199], v228, s[64:67], s83 offen offset:0 sc1
    buffer_load_dwordx4 v[200:203], v228, s[64:67], s83 offen offset:256 sc1
    buffer_load_dwordx4 v[204:207], v228, s[64:67], s83 offen offset:512 sc1
    buffer_load_dwordx4 v[208:211], v228, s[64:67], s83 offen offset:768 sc1
    s_add_u32 s83, s93, 2
    s_mul_i32 s83, s83, 132096
    s_add_u32 s83, s83, 4784128
    buffer_load_dwordx4 v[212:215], v228, s[64:67], s83 offen offset:0 sc1
    buffer_load_dwordx4 v[216:219], v228, s[64:67], s83 offen offset:256 sc1
    buffer_load_dwordx4 v[220:223], v228, s[64:67], s83 offen offset:512 sc1
    buffer_load_dwordx4 v[224:227], v228, s[64:67], s83 offen offset:768 sc1
    s_waitcnt vmcnt(12)
    s_branch G1_DRAINED
G1_DONE:
    s_waitcnt vmcnt(0)
G1_DRAINED:
    s_mul_i32 s83, s81, 2048
    s_lshl_b32 s84, s75, 7
    s_add_u32 s83, s83, s84
    s_add_u32 s83, s83, 22241280
    s_barrier
    s_cmp_lg_u32 s72, 0
    s_cbranch_scc1 SK_106
    s_mov_b64 exec, 1
    buffer_store_dword v2, off, s[64:67], s83 sc1
    s_mov_b64 exec, -1
SK_106:
    s_add_u32 s85, s80, 6
    s_cmp_ge_u32 s82, 20
    s_cselect_b32 s11, s85, s80
    s_lshl_b32 s85, s79, 7
    s_lshl_b32 s84, s72, 5
    s_add_u32 s85, s85, s84
    v_and_b32 v6, 31, v1
    v_add_u32 v6, s85, v6
    v_lshrrev_b32 v4, 5, v1
    v_mul_u32_u24 v3, 33024, v4
    v_lshl_add_u32 v7, v6, 4, v3
    v_mul_u32_u24 v3, 1280, v6
    v_lshl_add_u32 v3, v4, 4, v3
    s_lshl_b32 s84, s80, 7
    v_add_u32 v9, s84, v3
    v_lshrrev_b32_e64 v3, 5, v1
    v_bfe_u32 v4, v1, 2, 2
    v_lshl_add_u32 v3, v3, 2, v4
    v_mul_u32_u24 v3, 128, v3
    v_bfe_u32 v4, v1, 4, 1
    v_lshl_add_u32 v3, v4, 5, v3
    v_and_b32_e64 v4, 3, v1
    v_lshl_add_u32 v30, v4, 3, v3
    v_bfe_u32 v3, v1, 3, 1
    v_lshl_add_u32 v30, v3, 6, v30
    v_xor_b32 v31, 64, v30
    v_lshrrev_b32 v3, 5, v1
    v_bfe_u32 v4, v1, 2, 2
    v_lshl_add_u32 v3, v3, 2, v4
    v_mul_u32_u24 v3, 320, v3
    v_bfe_u32 v4, v1, 4, 1
    v_lshl_add_u32 v3, v4, 5, v3
    v_and_b32_e64 v4, 3, v1
    v_lshl_add_u32 v10, v4, 3, v3
    s_lshl_b32 s83, s72, 12
    s_add_u32 s83, s83, 8192
    s_lshl_b32 s84, s72, 13
    s_add_u32 s84, s84, 20480
    s_cmp_ge_u32 s82, 20
    s_cselect_b32 s83, s84, s83
    v_and_b32_e64 v3, 31, v1
    v_bfe_u32 v4, v1, 1, 3
    v_lshrrev_b32 v5, 5, v1
    v_xor_b32 v4, v4, v5
    v_lshlrev_b32 v3, 7, v3
    v_add_u32 v3, s83, v3
    v_xor_b32_e64 v5, 0, v4
    v_lshl_add_u32 v36, v5, 4, v3
    v_xor_b32_e64 v5, 2, v4
    v_lshl_add_u32 v37, v5, 4, v3
    v_xor_b32_e64 v5, 4, v4
    v_lshl_add_u32 v38, v5, 4, v3
    v_xor_b32_e64 v5, 6, v4
    v_lshl_add_u32 v39, v5, 4, v3
    v_lshrrev_b32_e64 v3, 5, v1
    v_lshl_add_u32 v44, v3, 9, v30
    v_lshl_add_u32 v45, v3, 9, v31
    s_cmp_lt_u32 s82, 20
    s_cbranch_scc1 SK_107
    v_mul_u32_u24 v3, 1280, v3
    v_add_u32 v44, v3, v10
SK_107:
    s_waitcnt vmcnt(63)
    s_mov_b32 s90, 200000
MODE_109:
    v_cmp_ne_u32 vcc, s73, v250
    s_cbranch_vccz MODEOK_110
    buffer_load_dwordx2 v[250:251], v252, s[64:67], 0 offen sc1
    s_waitcnt vmcnt(0)
    s_sub_u32 s90, s90, 1
    s_cmp_lg_u32 s90, 0
    s_cbranch_scc1 MODE_109
MODEOK_110:
    v_cmp_ne_u32 vcc, s101, v251
    s_nop 0
    s_cmp_lg_u64 vcc, 0
    s_cselect_b32 s100, 1, 0
SK_108:
    s_cmp_lt_u32 s99, 8
    s_cbranch_scc1 DO_T4
    s_mul_i32 s83, s79, 2048
    s_add_u32 s83, s83, 22085632
    v_lshl_add_u32 v8, v1, 7, s83
    s_cmp_lg_u32 s72, 0
    s_cbranch_scc1 SK_111
    s_mov_b32 s90, 200000
    s_mov_b64 exec, 0x3ff
POLL_112:
    buffer_load_dword v62, v8, s[64:67], 0 offen sc1
    s_waitcnt vmcnt(0)
    v_cmp_ne_u32 vcc, s73, v62
    s_cbranch_vccz POLLD_113
    s_sub_u32 s90, s90, 1
    s_cmp_lg_u32 s90, 0
    s_cbranch_scc1 POLL_112
POLLD_113:
    s_mov_b64 exec, -1
SK_111:
    s_barrier
    s_mov_b32 s83, 7471104
    buffer_load_dwordx4 v[184:187], v7, s[64:67], s83 offen sc1
    s_mov_b32 s83, 7537152
    buffer_load_dwordx4 v[188:191], v7, s[64:67], s83 offen sc1
    s_mov_b32 s83, 7603200
    buffer_load_dwordx4 v[192:195], v7, s[64:67], s83 offen sc1
    s_mov_b32 s83, 7669248
    buffer_load_dwordx4 v[196:199], v7, s[64:67], s83 offen sc1
    s_mov_b32 s83, 7735296
    buffer_load_dwordx4 v[200:203], v7, s[64:67], s83 offen sc1
    s_mov_b32 s83, 7801344
    buffer_load_dwordx4 v[204:207], v7, s[64:67], s83 offen sc1
    s_mov_b32 s83, 7867392
    buffer_load_dwordx4 v[208:211], v7, s[64:67], s83 offen sc1
    s_mov_b32 s83, 7933440
    buffer_load_dwordx4 v[212:215], v7, s[64:67], s83 offen sc1
    s_mov_b32 s83, 7999488
    buffer_load_dwordx4 v[216:219], v7, s[64:67], s83 offen sc1
    s_mov_b32 s83, 8065536
    buffer_load_dwordx4 v[36:39], v7, s[64:67], s83 offen sc1
    s_mov_b32 s83, 8131584
    buffer_load_dwordx4 v[40:43], v7, s[64:67], s83 offen sc1
    s_mov_b32 s83, 8197632
    buffer_load_dwordx4 v[44:47], v7, s[64:67], s83 offen sc1
    v_add_u32 v32, 0, v30
    v_add_u32 v33, 0, v31
    v_add_u32 v34, 16384, v30
    v_add_u32 v35, 16384, v31
    ds_read_b64_tr_b16 v[64:65], v32 offset:0
    ds_read_b64_tr_b16 v[66:67], v32 offset:1024
    ds_read_b64_tr_b16 v[68:69], v33 offset:0
    ds_read_b64_tr_b16 v[70:71], v33 offset:1024
    ds_read_b64_tr_b16 v[72:73], v34 offset:0
    ds_read_b64_tr_b16 v[74:75], v34 offset:1024
    ds_read_b64_tr_b16 v[76:77], v35 offset:0
    ds_read_b64_tr_b16 v[78:79], v35 offset:1024
    s_waitcnt vmcnt(11)
    s_waitcnt lgkmcnt(6)
    v_mfma_f32_32x32x16_bf16 v[104:119], v[64:67], v[184:187], 0
    ds_read_b64_tr_b16 v[80:81], v32 offset:2048
    ds_read_b64_tr_b16 v[82:83], v32 offset:3072
    s_waitcnt lgkmcnt(6)
    v_mfma_f32_32x32x16_bf16 v[120:135], v[68:71], v[184:187], 0
    ds_read_b64_tr_b16 v[84:85], v33 offset:2048
    ds_read_b64_tr_b16 v[86:87], v33 offset:3072
    s_waitcnt lgkmcnt(6)
    v_mfma_f32_32x32x16_bf16 v[136:151], v[72:75], v[184:187], 0
    ds_read_b64_tr_b16 v[88:89], v34 offset:2048
    ds_read_b64_tr_b16 v[90:91], v34 offset:3072
    s_waitcnt lgkmcnt(6)
    v_mfma_f32_32x32x16_bf16 v[152:167], v[76:79], v[184:187], 0
    ds_read_b64_tr_b16 v[92:93], v35 offset:2048
    ds_read_b64_tr_b16 v[94:95], v35 offset:3072
    s_mov_b32 s83, 8263680
    buffer_load_dwordx4 v[96:99], v7, s[64:67], s83 offen sc1
    s_mov_b32 s83, 8329728
    buffer_load_dwordx4 v[100:103], v7, s[64:67], s83 offen sc1
    s_waitcnt vmcnt(12)
    s_waitcnt lgkmcnt(6)
    v_mfma_f32_32x32x16_bf16 v[104:119], v[80:83], v[188:191], v[104:119]
    ds_read_b64_tr_b16 v[64:65], v32 offset:4096
    ds_read_b64_tr_b16 v[66:67], v32 offset:5120
    s_waitcnt lgkmcnt(6)
    v_mfma_f32_32x32x16_bf16 v[120:135], v[84:87], v[188:191], v[120:135]
    ds_read_b64_tr_b16 v[68:69], v33 offset:4096
    ds_read_b64_tr_b16 v[70:71], v33 offset:5120
    s_waitcnt lgkmcnt(6)
    v_mfma_f32_32x32x16_bf16 v[136:151], v[88:91], v[188:191], v[136:151]
    ds_read_b64_tr_b16 v[72:73], v34 offset:4096
    ds_read_b64_tr_b16 v[74:75], v34 offset:5120
    s_waitcnt lgkmcnt(6)
    v_mfma_f32_32x32x16_bf16 v[152:167], v[92:95], v[188:191], v[152:167]
    ds_read_b64_tr_b16 v[76:77], v35 offset:4096
    ds_read_b64_tr_b16 v[78:79], v35 offset:5120
    s_mov_b32 s83, 8395776
    buffer_load_dwordx4 v[52:55], v7, s[64:67], s83 offen sc1
    s_mov_b32 s83, 8461824
    buffer_load_dwordx4 v[56:59], v7, s[64:67], s83 offen sc1
    s_waitcnt vmcnt(13)
    s_waitcnt lgkmcnt(6)
    v_mfma_f32_32x32x16_bf16 v[104:119], v[64:67], v[192:195], v[104:119]
    ds_read_b64_tr_b16 v[80:81], v32 offset:6144
    ds_read_b64_tr_b16 v[82:83], v32 offset:7168
    s_waitcnt lgkmcnt(6)
    v_mfma_f32_32x32x16_bf16 v[120:135], v[68:71], v[192:195], v[120:135]
    ds_read_b64_tr_b16 v[84:85], v33 offset:6144
    ds_read_b64_tr_b16 v[86:87], v33 offset:7168
    s_waitcnt lgkmcnt(6)
    v_mfma_f32_32x32x16_bf16 v[136:151], v[72:75], v[192:195], v[136:151]
    ds_read_b64_tr_b16 v[88:89], v34 offset:6144
    ds_read_b64_tr_b16 v[90:91], v34 offset:7168
    s_waitcnt lgkmcnt(6)
    v_mfma_f32_32x32x16_bf16 v[152:167], v[76:79], v[192:195], v[152:167]
    ds_read_b64_tr_b16 v[92:93], v35 offset:6144
    ds_read_b64_tr_b16 v[94:95], v35 offset:7168
    s_mov_b32 s83, 8527872
    buffer_load_dwordx4 v[184:187], v7, s[64:67], s83 offen sc1
    s_mov_b32 s83, 8593920
    buffer_load_dwordx4 v[188:191], v7, s[64:67], s83 offen sc1
    s_waitcnt vmcnt(14)
    s_waitcnt lgkmcnt(6)
    v_mfma_f32_32x32x16_bf16 v[104:119], v[80:83], v[196:199], v[104:119]
    ds_read_b64_tr_b16 v[64:65], v32 offset:8192
    ds_read_b64_tr_b16 v[66:67], v32 offset:9216
    s_waitcnt lgkmcnt(6)
    v_mfma_f32_32x32x16_bf16 v[120:135], v[84:87], v[196:199], v[120:135]
    ds_read_b64_tr_b16 v[68:69], v33 offset:8192
    ds_read_b64_tr_b16 v[70:71], v33 offset:9216
    s_waitcnt lgkmcnt(6)
    v_mfma_f32_32x32x16_bf16 v[136:151], v[88:91], v[196:199], v[136:151]
    ds_read_b64_tr_b16 v[72:73], v34 offset:8192
    ds_read_b64_tr_b16 v[74:75], v34 offset:9216
    s_waitcnt lgkmcnt(6)
    v_mfma_f32_32x32x16_bf16 v[152:167], v[92:95], v[196:199], v[152:167]
    ds_read_b64_tr_b16 v[76:77], v35 offset:8192
    ds_read_b64_tr_b16 v[78:79], v35 offset:9216
    s_mov_b32 s83, 8659968
    buffer_load_dwordx4 v[192:195], v7, s[64:67], s83 offen sc1
    s_mov_b32 s83, 8726016
    buffer_load_dwordx4 v[196:199], v7, s[64:67], s83 offen sc1
    v_and_b32 v5, 31, v1
    v_lshlrev_b32 v5, 3, v5
    v_add_u32 v5, 147456, v5
    ds_read_b64 v[168:169], v5 offset:0
    v_mov_b32 v170, 0
    v_mov_b32 v171, 0
    ds_read_b64 v[172:173], v5 offset:256
    v_mov_b32 v174, 0
    v_mov_b32 v175, 0
    ds_read_b64 v[176:177], v5 offset:512
    v_mov_b32 v178, 0
    v_mov_b32 v179, 0
    ds_read_b64 v[180:181], v5 offset:768
    v_mov_b32 v182, 0
    v_mov_b32 v183, 0
    s_waitcnt vmcnt(15)
    s_waitcnt lgkmcnt(10)
    v_mfma_f32_32x32x16_bf16 v[104:119], v[64:67], v[200:203], v[104:119]
    ds_read_b64_tr_b16 v[80:81], v32 offset:10240
    ds_read_b64_tr_b16 v[82:83], v32 offset:11264
    s_waitcnt lgkmcnt(10)
    v_mfma_f32_32x32x16_bf16 v[120:135], v[68:71], v[200:203], v[120:135]
    ds_read_b64_tr_b16 v[84:85], v33 offset:10240
    ds_read_b64_tr_b16 v[86:87], v33 offset:11264
    s_waitcnt lgkmcnt(10)
    v_mfma_f32_32x32x16_bf16 v[136:151], v[72:75], v[200:203], v[136:151]
    ds_read_b64_tr_b16 v[88:89], v34 offset:10240
    ds_read_b64_tr_b16 v[90:91], v34 offset:11264
    s_waitcnt lgkmcnt(10)
    v_mfma_f32_32x32x16_bf16 v[152:167], v[76:79], v[200:203], v[152:167]
    ds_read_b64_tr_b16 v[92:93], v35 offset:10240
    ds_read_b64_tr_b16 v[94:95], v35 offset:11264
    s_mov_b32 s83, 8792064
    buffer_load_dwordx4 v[200:203], v7, s[64:67], s83 offen sc1
    s_waitcnt vmcnt(15)
    s_waitcnt lgkmcnt(6)
    v_mfma_f32_32x32x16_bf16 v[104:119], v[80:83], v[204:207], v[104:119]
    ds_read_b64_tr_b16 v[64:65], v32 offset:12288
    ds_read_b64_tr_b16 v[66:67], v32 offset:13312
    s_waitcnt lgkmcnt(6)
    v_mfma_f32_32x32x16_bf16 v[120:135], v[84:87], v[204:207], v[120:135]
    ds_read_b64_tr_b16 v[68:69], v33 offset:12288
    ds_read_b64_tr_b16 v[70:71], v33 offset:13312
    s_waitcnt lgkmcnt(6)
    v_mfma_f32_32x32x16_bf16 v[136:151], v[88:91], v[204:207], v[136:151]
    ds_read_b64_tr_b16 v[72:73], v34 offset:12288
    ds_read_b64_tr_b16 v[74:75], v34 offset:13312
    s_waitcnt lgkmcnt(6)
    v_mfma_f32_32x32x16_bf16 v[152:167], v[92:95], v[204:207], v[152:167]
    ds_read_b64_tr_b16 v[76:77], v35 offset:12288
    ds_read_b64_tr_b16 v[78:79], v35 offset:13312
    s_mov_b32 s83, 8858112
    buffer_load_dwordx4 v[204:207], v7, s[64:67], s83 offen sc1
    s_waitcnt vmcnt(15)
    s_waitcnt lgkmcnt(6)
    v_mfma_f32_32x32x16_bf16 v[104:119], v[64:67], v[208:211], v[104:119]
    ds_read_b64_tr_b16 v[80:81], v32 offset:14336
    ds_read_b64_tr_b16 v[82:83], v32 offset:15360
    s_waitcnt lgkmcnt(6)
    v_mfma_f32_32x32x16_bf16 v[120:135], v[68:71], v[208:211], v[120:135]
    ds_read_b64_tr_b16 v[84:85], v33 offset:14336
    ds_read_b64_tr_b16 v[86:87], v33 offset:15360
    s_waitcnt lgkmcnt(6)
    v_mfma_f32_32x32x16_bf16 v[136:151], v[72:75], v[208:211], v[136:151]
    ds_read_b64_tr_b16 v[88:89], v34 offset:14336
    ds_read_b64_tr_b16 v[90:91], v34 offset:15360
    s_waitcnt lgkmcnt(6)
    v_mfma_f32_32x32x16_bf16 v[152:167], v[76:79], v[208:211], v[152:167]
    ds_read_b64_tr_b16 v[92:93], v35 offset:14336
    ds_read_b64_tr_b16 v[94:95], v35 offset:15360
    s_mov_b32 s83, 8924160
    buffer_load_dwordx4 v[208:211], v7, s[64:67], s83 offen sc1
    s_waitcnt lgkmcnt(0)
    v_add_u32 v32, 32768, v30
    v_add_u32 v33, 32768, v31
    v_add_u32 v34, 49152, v30
    v_add_u32 v35, 49152, v31
    s_barrier
    s_waitcnt vmcnt(15)
    v_mfma_f32_32x32x16_bf16 v[104:119], v[80:83], v[212:215], v[104:119]
    ds_read_b64_tr_b16 v[64:65], v32 offset:0
    ds_read_b64_tr_b16 v[66:67], v32 offset:1024
    v_mfma_f32_32x32x16_bf16 v[120:135], v[84:87], v[212:215], v[120:135]
    ds_read_b64_tr_b16 v[68:69], v33 offset:0
    ds_read_b64_tr_b16 v[70:71], v33 offset:1024
    v_mfma_f32_32x32x16_bf16 v[136:151], v[88:91], v[212:215], v[136:151]
    ds_read_b64_tr_b16 v[72:73], v34 offset:0
    ds_read_b64_tr_b16 v[74:75], v34 offset:1024
    v_mfma_f32_32x32x16_bf16 v[152:167], v[92:95], v[212:215], v[152:167]
    ds_read_b64_tr_b16 v[76:77], v35 offset:0
    ds_read_b64_tr_b16 v[78:79], v35 offset:1024
    s_mov_b32 s83, 8990208
    buffer_load_dwordx4 v[212:215], v7, s[64:67], s83 offen sc1
    s_waitcnt vmcnt(15)
    s_waitcnt lgkmcnt(6)
    v_mfma_f32_32x32x16_bf16 v[104:119], v[64:67], v[216:219], v[104:119]
    ds_read_b64_tr_b16 v[80:81], v32 offset:2048
    ds_read_b64_tr_b16 v[82:83], v32 offset:3072
    s_waitcnt lgkmcnt(6)
    v_mfma_f32_32x32x16_bf16 v[120:135], v[68:71], v[216:219], v[120:135]
    ds_read_b64_tr_b16 v[84:85], v33 offset:2048
    ds_read_b64_tr_b16 v[86:87], v33 offset:3072
    s_waitcnt lgkmcnt(6)
    v_mfma_f32_32x32x16_bf16 v[136:151], v[72:75], v[216:219], v[136:151]
    ds_read_b64_tr_b16 v[88:89], v34 offset:2048
    ds_read_b64_tr_b16 v[90:91], v34 offset:3072
    s_waitcnt lgkmcnt(6)
    v_mfma_f32_32x32x16_bf16 v[152:167], v[76:79], v[216:219], v[152:167]
    ds_read_b64_tr_b16 v[92:93], v35 offset:2048
    ds_read_b64_tr_b16 v[94:95], v35 offset:3072
    s_mov_b32 s83, 9056256
    buffer_load_dwordx4 v[216:219], v7, s[64:67], s83 offen sc1
    s_waitcnt vmcnt(15)
    s_waitcnt lgkmcnt(6)
    v_mfma_f32_32x32x16_bf16 v[104:119], v[80:83], v[36:39], v[104:119]
    ds_read_b64_tr_b16 v[64:65], v32 offset:4096
    ds_read_b64_tr_b16 v[66:67], v32 offset:5120
    s_waitcnt lgkmcnt(6)
    v_mfma_f32_32x32x16_bf16 v[120:135], v[84:87], v[36:39], v[120:135]
    ds_read_b64_tr_b16 v[68:69], v33 offset:4096
    ds_read_b64_tr_b16 v[70:71], v33 offset:5120
    s_waitcnt lgkmcnt(6)
    v_mfma_f32_32x32x16_bf16 v[136:151], v[88:91], v[36:39], v[136:151]
    ds_read_b64_tr_b16 v[72:73], v34 offset:4096
    ds_read_b64_tr_b16 v[74:75], v34 offset:5120
    s_waitcnt lgkmcnt(6)
    v_mfma_f32_32x32x16_bf16 v[152:167], v[92:95], v[36:39], v[152:167]
    ds_read_b64_tr_b16 v[76:77], v35 offset:4096
    ds_read_b64_tr_b16 v[78:79], v35 offset:5120
    s_mov_b32 s83, 9122304
    buffer_load_dwordx4 v[36:39], v7, s[64:67], s83 offen sc1
    s_waitcnt vmcnt(15)
    s_waitcnt lgkmcnt(6)
    v_mfma_f32_32x32x16_bf16 v[104:119], v[64:67], v[40:43], v[104:119]
    ds_read_b64_tr_b16 v[80:81], v32 offset:6144
    ds_read_b64_tr_b16 v[82:83], v32 offset:7168
    s_waitcnt lgkmcnt(6)
    v_mfma_f32_32x32x16_bf16 v[120:135], v[68:71], v[40:43], v[120:135]
    ds_read_b64_tr_b16 v[84:85], v33 offset:6144
    ds_read_b64_tr_b16 v[86:87], v33 offset:7168
    s_waitcnt lgkmcnt(6)
    v_mfma_f32_32x32x16_bf16 v[136:151], v[72:75], v[40:43], v[136:151]
    ds_read_b64_tr_b16 v[88:89], v34 offset:6144
    ds_read_b64_tr_b16 v[90:91], v34 offset:7168
    s_waitcnt lgkmcnt(6)
    v_mfma_f32_32x32x16_bf16 v[152:167], v[76:79], v[40:43], v[152:167]
    ds_read_b64_tr_b16 v[92:93], v35 offset:6144
    ds_read_b64_tr_b16 v[94:95], v35 offset:7168
    s_mov_b32 s83, 9188352
    buffer_load_dwordx4 v[40:43], v7, s[64:67], s83 offen sc1
    s_waitcnt vmcnt(15)
    s_waitcnt lgkmcnt(6)
    v_mfma_f32_32x32x16_bf16 v[104:119], v[80:83], v[44:47], v[104:119]
    ds_read_b64_tr_b16 v[64:65], v32 offset:8192
    ds_read_b64_tr_b16 v[66:67], v32 offset:9216
    s_waitcnt lgkmcnt(6)
    v_mfma_f32_32x32x16_bf16 v[120:135], v[84:87], v[44:47], v[120:135]
    ds_read_b64_tr_b16 v[68:69], v33 offset:8192
    ds_read_b64_tr_b16 v[70:71], v33 offset:9216
    s_waitcnt lgkmcnt(6)
    v_mfma_f32_32x32x16_bf16 v[136:151], v[88:91], v[44:47], v[136:151]
    ds_read_b64_tr_b16 v[72:73], v34 offset:8192
    ds_read_b64_tr_b16 v[74:75], v34 offset:9216
    s_waitcnt lgkmcnt(6)
    v_mfma_f32_32x32x16_bf16 v[152:167], v[92:95], v[44:47], v[152:167]
    ds_read_b64_tr_b16 v[76:77], v35 offset:8192
    ds_read_b64_tr_b16 v[78:79], v35 offset:9216
    s_mov_b32 s83, 9254400
    buffer_load_dwordx4 v[44:47], v7, s[64:67], s83 offen sc1
    s_waitcnt vmcnt(15)
    s_waitcnt lgkmcnt(6)
    v_mfma_f32_32x32x16_bf16 v[104:119], v[64:67], v[96:99], v[104:119]
    ds_read_b64_tr_b16 v[80:81], v32 offset:10240
    ds_read_b64_tr_b16 v[82:83], v32 offset:11264
    s_waitcnt lgkmcnt(6)
    v_mfma_f32_32x32x16_bf16 v[120:135], v[68:71], v[96:99], v[120:135]
    ds_read_b64_tr_b16 v[84:85], v33 offset:10240
    ds_read_b64_tr_b16 v[86:87], v33 offset:11264
    s_waitcnt lgkmcnt(6)
    v_mfma_f32_32x32x16_bf16 v[136:151], v[72:75], v[96:99], v[136:151]
    ds_read_b64_tr_b16 v[88:89], v34 offset:10240
    ds_read_b64_tr_b16 v[90:91], v34 offset:11264
    s_waitcnt lgkmcnt(6)
    v_mfma_f32_32x32x16_bf16 v[152:167], v[76:79], v[96:99], v[152:167]
    ds_read_b64_tr_b16 v[92:93], v35 offset:10240
    ds_read_b64_tr_b16 v[94:95], v35 offset:11264
    s_mov_b32 s83, 9320448
    buffer_load_dwordx4 v[96:99], v7, s[64:67], s83 offen sc1
    s_waitcnt vmcnt(15)
    s_waitcnt lgkmcnt(6)
    v_mfma_f32_32x32x16_bf16 v[104:119], v[80:83], v[100:103], v[104:119]
    ds_read_b64_tr_b16 v[64:65], v32 offset:12288
    ds_read_b64_tr_b16 v[66:67], v32 offset:13312
    s_waitcnt lgkmcnt(6)
    v_mfma_f32_32x32x16_bf16 v[120:135], v[84:87], v[100:103], v[120:135]
    ds_read_b64_tr_b16 v[68:69], v33 offset:12288
    ds_read_b64_tr_b16 v[70:71], v33 offset:13312
    s_waitcnt lgkmcnt(6)
    v_mfma_f32_32x32x16_bf16 v[136:151], v[88:91], v[100:103], v[136:151]
    ds_read_b64_tr_b16 v[72:73], v34 offset:12288
    ds_read_b64_tr_b16 v[74:75], v34 offset:13312
    s_waitcnt lgkmcnt(6)
    v_mfma_f32_32x32x16_bf16 v[152:167], v[92:95], v[100:103], v[152:167]
    ds_read_b64_tr_b16 v[76:77], v35 offset:12288
    ds_read_b64_tr_b16 v[78:79], v35 offset:13312
    s_mov_b32 s83, 9386496
    buffer_load_dwordx4 v[100:103], v7, s[64:67], s83 offen sc1
    s_waitcnt vmcnt(15)
    s_waitcnt lgkmcnt(6)
    v_mfma_f32_32x32x16_bf16 v[104:119], v[64:67], v[52:55], v[104:119]
    ds_read_b64_tr_b16 v[80:81], v32 offset:14336
    ds_read_b64_tr_b16 v[82:83], v32 offset:15360
    s_waitcnt lgkmcnt(6)
    v_mfma_f32_32x32x16_bf16 v[120:135], v[68:71], v[52:55], v[120:135]
    ds_read_b64_tr_b16 v[84:85], v33 offset:14336
    ds_read_b64_tr_b16 v[86:87], v33 offset:15360
    s_waitcnt lgkmcnt(6)
    v_mfma_f32_32x32x16_bf16 v[136:151], v[72:75], v[52:55], v[136:151]
    ds_read_b64_tr_b16 v[88:89], v34 offset:14336
    ds_read_b64_tr_b16 v[90:91], v34 offset:15360
    s_waitcnt lgkmcnt(6)
    v_mfma_f32_32x32x16_bf16 v[152:167], v[76:79], v[52:55], v[152:167]
    ds_read_b64_tr_b16 v[92:93], v35 offset:14336
    ds_read_b64_tr_b16 v[94:95], v35 offset:15360
    s_mov_b32 s83, 9452544
    buffer_load_dwordx4 v[52:55], v7, s[64:67], s83 offen sc1
    v_add_u32 v32, 65536, v30
    v_add_u32 v33, 65536, v31
    v_add_u32 v34, 81920, v30
    v_add_u32 v35, 81920, v31
    s_waitcnt vmcnt(15)
    s_waitcnt lgkmcnt(6)
    v_mfma_f32_32x32x16_bf16 v[104:119], v[80:83], v[56:59], v[104:119]
    ds_read_b64_tr_b16 v[64:65], v32 offset:0
    ds_read_b64_tr_b16 v[66:67], v32 offset:1024
    s_waitcnt lgkmcnt(6)
    v_mfma_f32_32x32x16_bf16 v[120:135], v[84:87], v[56:59], v[120:135]
    ds_read_b64_tr_b16 v[68:69], v33 offset:0
    ds_read_b64_tr_b16 v[70:71], v33 offset:1024
    s_waitcnt lgkmcnt(6)
    v_mfma_f32_32x32x16_bf16 v[136:151], v[88:91], v[56:59], v[136:151]
    ds_read_b64_tr_b16 v[72:73], v34 offset:0
    ds_read_b64_tr_b16 v[74:75], v34 offset:1024
    s_waitcnt lgkmcnt(6)
    v_mfma_f32_32x32x16_bf16 v[152:167], v[92:95], v[56:59], v[152:167]
    ds_read_b64_tr_b16 v[76:77], v35 offset:0
    ds_read_b64_tr_b16 v[78:79], v35 offset:1024
    s_mov_b32 s83, 9518592
    buffer_load_dwordx4 v[56:59], v7, s[64:67], s83 offen sc1
    s_waitcnt vmcnt(15)
    s_waitcnt lgkmcnt(6)
    v_mfma_f32_32x32x16_bf16 v[104:119], v[64:67], v[184:187], v[104:119]
    ds_read_b64_tr_b16 v[80:81], v32 offset:2048
    ds_read_b64_tr_b16 v[82:83], v32 offset:3072
    s_waitcnt lgkmcnt(6)
    v_mfma_f32_32x32x16_bf16 v[120:135], v[68:71], v[184:187], v[120:135]
    ds_read_b64_tr_b16 v[84:85], v33 offset:2048
    ds_read_b64_tr_b16 v[86:87], v33 offset:3072
    s_waitcnt lgkmcnt(6)
    v_mfma_f32_32x32x16_bf16 v[136:151], v[72:75], v[184:187], v[136:151]
    ds_read_b64_tr_b16 v[88:89], v34 offset:2048
    ds_read_b64_tr_b16 v[90:91], v34 offset:3072
    s_waitcnt lgkmcnt(6)
    v_mfma_f32_32x32x16_bf16 v[152:167], v[76:79], v[184:187], v[152:167]
    ds_read_b64_tr_b16 v[92:93], v35 offset:2048
    ds_read_b64_tr_b16 v[94:95], v35 offset:3072
    s_mov_b32 s83, 9584640
    buffer_load_dwordx4 v[184:187], v7, s[64:67], s83 offen sc1
    s_waitcnt vmcnt(15)
    s_waitcnt lgkmcnt(6)
    v_mfma_f32_32x32x16_bf16 v[104:119], v[80:83], v[188:191], v[104:119]
    ds_read_b64_tr_b16 v[64:65], v32 offset:4096
    ds_read_b64_tr_b16 v[66:67], v32 offset:5120
    s_waitcnt lgkmcnt(6)
    v_mfma_f32_32x32x16_bf16 v[120:135], v[84:87], v[188:191], v[120:135]
    ds_read_b64_tr_b16 v[68:69], v33 offset:4096
    ds_read_b64_tr_b16 v[70:71], v33 offset:5120
    s_waitcnt lgkmcnt(6)
    v_mfma_f32_32x32x16_bf16 v[136:151], v[88:91], v[188:191], v[136:151]
    ds_read_b64_tr_b16 v[72:73], v34 offset:4096
    ds_read_b64_tr_b16 v[74:75], v34 offset:5120
    s_waitcnt lgkmcnt(6)
    v_mfma_f32_32x32x16_bf16 v[152:167], v[92:95], v[188:191], v[152:167]
    ds_read_b64_tr_b16 v[76:77], v35 offset:4096
    ds_read_b64_tr_b16 v[78:79], v35 offset:5120
    s_mov_b32 s83, 9650688
    buffer_load_dwordx4 v[188:191], v7, s[64:67], s83 offen sc1
    s_waitcnt vmcnt(15)
    s_waitcnt lgkmcnt(6)
    v_mfma_f32_32x32x16_bf16 v[104:119], v[64:67], v[192:195], v[104:119]
    ds_read_b64_tr_b16 v[80:81], v32 offset:6144
    ds_read_b64_tr_b16 v[82:83], v32 offset:7168
    s_waitcnt lgkmcnt(6)
    v_mfma_f32_32x32x16_bf16 v[120:135], v[68:71], v[192:195], v[120:135]
    ds_read_b64_tr_b16 v[84:85], v33 offset:6144
    ds_read_b64_tr_b16 v[86:87], v33 offset:7168
    s_waitcnt lgkmcnt(6)
    v_mfma_f32_32x32x16_bf16 v[136:151], v[72:75], v[192:195], v[136:151]
    ds_read_b64_tr_b16 v[88:89], v34 offset:6144
    ds_read_b64_tr_b16 v[90:91], v34 offset:7168
    s_waitcnt lgkmcnt(6)
    v_mfma_f32_32x32x16_bf16 v[152:167], v[76:79], v[192:195], v[152:167]
    ds_read_b64_tr_b16 v[92:93], v35 offset:6144
    ds_read_b64_tr_b16 v[94:95], v35 offset:7168
    s_mov_b32 s83, 9716736
    buffer_load_dwordx4 v[192:195], v7, s[64:67], s83 offen sc1
    v_lshrrev_b32 v3, 5, v1
    v_lshlrev_b32_e64 v3, 14, v3
    v_lshl_add_u32 v3, v6, 3, v3
    s_mov_b32 s83, 196608
    buffer_load_dwordx2 v[12:13], v3, s[64:67], s83 offen sc1
    s_mov_b32 s83, 229376
    buffer_load_dwordx2 v[14:15], v3, s[64:67], s83 offen sc1
    s_mov_b32 s83, 262144
    buffer_load_dwordx2 v[16:17], v3, s[64:67], s83 offen sc1
    s_mov_b32 s83, 294912
    buffer_load_dwordx2 v[18:19], v3, s[64:67], s83 offen sc1
    s_mov_b32 s83, 327680
    buffer_load_dwordx2 v[20:21], v3, s[64:67], s83 offen sc1
    s_waitcnt vmcnt(20)
    s_waitcnt lgkmcnt(6)
    v_mfma_f32_32x32x16_bf16 v[104:119], v[80:83], v[196:199], v[104:119]
    ds_read_b64_tr_b16 v[64:65], v32 offset:8192
    ds_read_b64_tr_b16 v[66:67], v32 offset:9216
    s_waitcnt lgkmcnt(6)
    v_mfma_f32_32x32x16_bf16 v[120:135], v[84:87], v[196:199], v[120:135]
    ds_read_b64_tr_b16 v[68:69], v33 offset:8192
    ds_read_b64_tr_b16 v[70:71], v33 offset:9216
    s_waitcnt lgkmcnt(6)
    v_mfma_f32_32x32x16_bf16 v[136:151], v[88:91], v[196:199], v[136:151]
    ds_read_b64_tr_b16 v[72:73], v34 offset:8192
    ds_read_b64_tr_b16 v[74:75], v34 offset:9216
    s_waitcnt lgkmcnt(6)
    v_mfma_f32_32x32x16_bf16 v[152:167], v[92:95], v[196:199], v[152:167]
    ds_read_b64_tr_b16 v[76:77], v35 offset:8192
    ds_read_b64_tr_b16 v[78:79], v35 offset:9216
    s_mov_b32 s83, 9782784
    buffer_load_dwordx4 v[196:199], v7, s[64:67], s83 offen sc1
    s_waitcnt vmcnt(20)
    s_waitcnt lgkmcnt(6)
    v_mfma_f32_32x32x16_bf16 v[104:119], v[64:67], v[200:203], v[104:119]
    ds_read_b64_tr_b16 v[80:81], v32 offset:10240
    ds_read_b64_tr_b16 v[82:83], v32 offset:11264
    s_waitcnt lgkmcnt(6)
    v_mfma_f32_32x32x16_bf16 v[120:135], v[68:71], v[200:203], v[120:135]
    ds_read_b64_tr_b16 v[84:85], v33 offset:10240
    ds_read_b64_tr_b16 v[86:87], v33 offset:11264
    s_waitcnt lgkmcnt(6)
    v_mfma_f32_32x32x16_bf16 v[136:151], v[72:75], v[200:203], v[136:151]
    ds_read_b64_tr_b16 v[88:89], v34 offset:10240
    ds_read_b64_tr_b16 v[90:91], v34 offset:11264
    s_waitcnt lgkmcnt(6)
    v_mfma_f32_32x32x16_bf16 v[152:167], v[76:79], v[200:203], v[152:167]
    ds_read_b64_tr_b16 v[92:93], v35 offset:10240
    ds_read_b64_tr_b16 v[94:95], v35 offset:11264
    s_mov_b32 s83, 9848832
    buffer_load_dwordx4 v[200:203], v7, s[64:67], s83 offen sc1
    s_waitcnt vmcnt(20)
    s_waitcnt lgkmcnt(6)
    v_mfma_f32_32x32x16_bf16 v[104:119], v[80:83], v[204:207], v[104:119]
    ds_read_b64_tr_b16 v[64:65], v32 offset:12288
    ds_read_b64_tr_b16 v[66:67], v32 offset:13312
    s_waitcnt lgkmcnt(6)
    v_mfma_f32_32x32x16_bf16 v[120:135], v[84:87], v[204:207], v[120:135]
    ds_read_b64_tr_b16 v[68:69], v33 offset:12288
    ds_read_b64_tr_b16 v[70:71], v33 offset:13312
    s_waitcnt lgkmcnt(6)
    v_mfma_f32_32x32x16_bf16 v[136:151], v[88:91], v[204:207], v[136:151]
    ds_read_b64_tr_b16 v[72:73], v34 offset:12288
    ds_read_b64_tr_b16 v[74:75], v34 offset:13312
    s_waitcnt lgkmcnt(6)
    v_mfma_f32_32x32x16_bf16 v[152:167], v[92:95], v[204:207], v[152:167]
    ds_read_b64_tr_b16 v[76:77], v35 offset:12288
    ds_read_b64_tr_b16 v[78:79], v35 offset:13312
    s_mov_b32 s83, 9914880
    buffer_load_dwordx4 v[204:207], v7, s[64:67], s83 offen sc1
    s_waitcnt vmcnt(20)
    s_waitcnt lgkmcnt(6)
    v_mfma_f32_32x32x16_bf16 v[104:119], v[64:67], v[208:211], v[104:119]
    ds_read_b64_tr_b16 v[80:81], v32 offset:14336
    ds_read_b64_tr_b16 v[82:83], v32 offset:15360
    s_waitcnt lgkmcnt(6)
    v_mfma_f32_32x32x16_bf16 v[120:135], v[68:71], v[208:211], v[120:135]
    ds_read_b64_tr_b16 v[84:85], v33 offset:14336
    ds_read_b64_tr_b16 v[86:87], v33 offset:15360
    s_waitcnt lgkmcnt(6)
    v_mfma_f32_32x32x16_bf16 v[136:151], v[72:75], v[208:211], v[136:151]
    ds_read_b64_tr_b16 v[88:89], v34 offset:14336
    ds_read_b64_tr_b16 v[90:91], v34 offset:15360
    s_waitcnt lgkmcnt(6)
    v_mfma_f32_32x32x16_bf16 v[152:167], v[76:79], v[208:211], v[152:167]
    ds_read_b64_tr_b16 v[92:93], v35 offset:14336
    ds_read_b64_tr_b16 v[94:95], v35 offset:15360
    s_mov_b32 s83, 9980928
    buffer_load_dwordx4 v[208:211], v7, s[64:67], s83 offen sc1
    v_add_u32 v32, 98304, v30
    v_add_u32 v33, 98304, v31
    v_add_u32 v34, 114688, v30
    v_add_u32 v35, 114688, v31
    s_waitcnt vmcnt(20)
    s_waitcnt lgkmcnt(6)
    v_mfma_f32_32x32x16_bf16 v[104:119], v[80:83], v[212:215], v[104:119]
    ds_read_b64_tr_b16 v[64:65], v32 offset:0
    ds_read_b64_tr_b16 v[66:67], v32 offset:1024
    s_waitcnt lgkmcnt(6)
    v_mfma_f32_32x32x16_bf16 v[120:135], v[84:87], v[212:215], v[120:135]
    ds_read_b64_tr_b16 v[68:69], v33 offset:0
    ds_read_b64_tr_b16 v[70:71], v33 offset:1024
    s_waitcnt lgkmcnt(6)
    v_mfma_f32_32x32x16_bf16 v[136:151], v[88:91], v[212:215], v[136:151]
    ds_read_b64_tr_b16 v[72:73], v34 offset:0
    ds_read_b64_tr_b16 v[74:75], v34 offset:1024
    s_waitcnt lgkmcnt(6)
    v_mfma_f32_32x32x16_bf16 v[152:167], v[92:95], v[212:215], v[152:167]
    ds_read_b64_tr_b16 v[76:77], v35 offset:0
    ds_read_b64_tr_b16 v[78:79], v35 offset:1024
    s_mov_b32 s83, 10046976
    buffer_load_dwordx4 v[212:215], v7, s[64:67], s83 offen sc1
    s_waitcnt vmcnt(20)
    s_waitcnt lgkmcnt(6)
    v_mfma_f32_32x32x16_bf16 v[104:119], v[64:67], v[216:219], v[104:119]
    ds_read_b64_tr_b16 v[80:81], v32 offset:2048
    ds_read_b64_tr_b16 v[82:83], v32 offset:3072
    s_waitcnt lgkmcnt(6)
    v_mfma_f32_32x32x16_bf16 v[120:135], v[68:71], v[216:219], v[120:135]
    ds_read_b64_tr_b16 v[84:85], v33 offset:2048
    ds_read_b64_tr_b16 v[86:87], v33 offset:3072
    s_waitcnt lgkmcnt(6)
    v_mfma_f32_32x32x16_bf16 v[136:151], v[72:75], v[216:219], v[136:151]
    ds_read_b64_tr_b16 v[88:89], v34 offset:2048
    ds_read_b64_tr_b16 v[90:91], v34 offset:3072
    s_waitcnt lgkmcnt(6)
    v_mfma_f32_32x32x16_bf16 v[152:167], v[76:79], v[216:219], v[152:167]
    ds_read_b64_tr_b16 v[92:93], v35 offset:2048
    ds_read_b64_tr_b16 v[94:95], v35 offset:3072
    s_waitcnt vmcnt(19)
    s_waitcnt lgkmcnt(6)
    v_mfma_f32_32x32x16_bf16 v[104:119], v[80:83], v[36:39], v[104:119]
    ds_read_b64_tr_b16 v[64:65], v32 offset:4096
    ds_read_b64_tr_b16 v[66:67], v32 offset:5120
    s_waitcnt lgkmcnt(6)
    v_mfma_f32_32x32x16_bf16 v[120:135], v[84:87], v[36:39], v[120:135]
    ds_read_b64_tr_b16 v[68:69], v33 offset:4096
    ds_read_b64_tr_b16 v[70:71], v33 offset:5120
    s_waitcnt lgkmcnt(6)
    v_mfma_f32_32x32x16_bf16 v[136:151], v[88:91], v[36:39], v[136:151]
    ds_read_b64_tr_b16 v[72:73], v34 offset:4096
    ds_read_b64_tr_b16 v[74:75], v34 offset:5120
    s_waitcnt lgkmcnt(6)
    v_mfma_f32_32x32x16_bf16 v[152:167], v[92:95], v[36:39], v[152:167]
    ds_read_b64_tr_b16 v[76:77], v35 offset:4096
    ds_read_b64_tr_b16 v[78:79], v35 offset:5120
    s_waitcnt vmcnt(18)
    s_waitcnt lgkmcnt(6)
    v_mfma_f32_32x32x16_bf16 v[104:119], v[64:67], v[40:43], v[104:119]
    ds_read_b64_tr_b16 v[80:81], v32 offset:6144
    ds_read_b64_tr_b16 v[82:83], v32 offset:7168
    s_waitcnt lgkmcnt(6)
    v_mfma_f32_32x32x16_bf16 v[120:135], v[68:71], v[40:43], v[120:135]
    ds_read_b64_tr_b16 v[84:85], v33 offset:6144
    ds_read_b64_tr_b16 v[86:87], v33 offset:7168
    s_waitcnt lgkmcnt(6)
    v_mfma_f32_32x32x16_bf16 v[136:151], v[72:75], v[40:43], v[136:151]
    ds_read_b64_tr_b16 v[88:89], v34 offset:6144
    ds_read_b64_tr_b16 v[90:91], v34 offset:7168
    s_waitcnt lgkmcnt(6)
    v_mfma_f32_32x32x16_bf16 v[152:167], v[76:79], v[40:43], v[152:167]
    ds_read_b64_tr_b16 v[92:93], v35 offset:6144
    ds_read_b64_tr_b16 v[94:95], v35 offset:7168
    s_waitcnt vmcnt(17)
    s_waitcnt lgkmcnt(6)
    v_mfma_f32_32x32x16_bf16 v[104:119], v[80:83], v[44:47], v[104:119]
    ds_read_b64_tr_b16 v[64:65], v32 offset:8192
    ds_read_b64_tr_b16 v[66:67], v32 offset:9216
    s_waitcnt lgkmcnt(6)
    v_mfma_f32_32x32x16_bf16 v[120:135], v[84:87], v[44:47], v[120:135]
    ds_read_b64_tr_b16 v[68:69], v33 offset:8192
    ds_read_b64_tr_b16 v[70:71], v33 offset:9216
    s_waitcnt lgkmcnt(6)
    v_mfma_f32_32x32x16_bf16 v[136:151], v[88:91], v[44:47], v[136:151]
    ds_read_b64_tr_b16 v[72:73], v34 offset:8192
    ds_read_b64_tr_b16 v[74:75], v34 offset:9216
    s_waitcnt lgkmcnt(6)
    v_mfma_f32_32x32x16_bf16 v[152:167], v[92:95], v[44:47], v[152:167]
    ds_read_b64_tr_b16 v[76:77], v35 offset:8192
    ds_read_b64_tr_b16 v[78:79], v35 offset:9216
    s_waitcnt vmcnt(16)
    s_waitcnt lgkmcnt(6)
    v_mfma_f32_32x32x16_bf16 v[104:119], v[64:67], v[96:99], v[104:119]
    ds_read_b64_tr_b16 v[80:81], v32 offset:10240
    ds_read_b64_tr_b16 v[82:83], v32 offset:11264
    s_waitcnt lgkmcnt(6)
    v_mfma_f32_32x32x16_bf16 v[120:135], v[68:71], v[96:99], v[120:135]
    ds_read_b64_tr_b16 v[84:85], v33 offset:10240
    ds_read_b64_tr_b16 v[86:87], v33 offset:11264
    s_waitcnt lgkmcnt(6)
    v_mfma_f32_32x32x16_bf16 v[136:151], v[72:75], v[96:99], v[136:151]
    ds_read_b64_tr_b16 v[88:89], v34 offset:10240
    ds_read_b64_tr_b16 v[90:91], v34 offset:11264
    s_waitcnt lgkmcnt(6)
    v_mfma_f32_32x32x16_bf16 v[152:167], v[76:79], v[96:99], v[152:167]
    ds_read_b64_tr_b16 v[92:93], v35 offset:10240
    ds_read_b64_tr_b16 v[94:95], v35 offset:11264
    s_waitcnt vmcnt(15)
    s_waitcnt lgkmcnt(6)
    v_mfma_f32_32x32x16_bf16 v[104:119], v[80:83], v[100:103], v[104:119]
    ds_read_b64_tr_b16 v[64:65], v32 offset:12288
    ds_read_b64_tr_b16 v[66:67], v32 offset:13312
    s_waitcnt lgkmcnt(6)
    v_mfma_f32_32x32x16_bf16 v[120:135], v[84:87], v[100:103], v[120:135]
    ds_read_b64_tr_b16 v[68:69], v33 offset:12288
    ds_read_b64_tr_b16 v[70:71], v33 offset:13312
    s_waitcnt lgkmcnt(6)
    v_mfma_f32_32x32x16_bf16 v[136:151], v[88:91], v[100:103], v[136:151]
    ds_read_b64_tr_b16 v[72:73], v34 offset:12288
    ds_read_b64_tr_b16 v[74:75], v34 offset:13312
    s_waitcnt lgkmcnt(6)
    v_mfma_f32_32x32x16_bf16 v[152:167], v[92:95], v[100:103], v[152:167]
    ds_read_b64_tr_b16 v[76:77], v35 offset:12288
    ds_read_b64_tr_b16 v[78:79], v35 offset:13312
    s_waitcnt vmcnt(14)
    s_waitcnt lgkmcnt(6)
    v_mfma_f32_32x32x16_bf16 v[104:119], v[64:67], v[52:55], v[104:119]
    ds_read_b64_tr_b16 v[80:81], v32 offset:14336
    ds_read_b64_tr_b16 v[82:83], v32 offset:15360
    s_waitcnt lgkmcnt(6)
    v_mfma_f32_32x32x16_bf16 v[120:135], v[68:71], v[52:55], v[120:135]
    ds_read_b64_tr_b16 v[84:85], v33 offset:14336
    ds_read_b64_tr_b16 v[86:87], v33 offset:15360
    s_waitcnt lgkmcnt(6)
    v_mfma_f32_32x32x16_bf16 v[136:151], v[72:75], v[52:55], v[136:151]
    ds_read_b64_tr_b16 v[88:89], v34 offset:14336
    ds_read_b64_tr_b16 v[90:91], v34 offset:15360
    s_waitcnt lgkmcnt(6)
    v_mfma_f32_32x32x16_bf16 v[152:167], v[76:79], v[52:55], v[152:167]
    ds_read_b64_tr_b16 v[92:93], v35 offset:14336
    ds_read_b64_tr_b16 v[94:95], v35 offset:15360
    s_waitcnt lgkmcnt(0)
    v_add_u32 v32, 131072, v30
    v_add_u32 v33, 131072, v31
    v_add_u32 v34, 147456, v30
    v_add_u32 v35, 147456, v31
    s_barrier
    s_waitcnt vmcnt(13)
    v_mfma_f32_32x32x16_bf16 v[104:119], v[80:83], v[56:59], v[104:119]
    ds_read_b64_tr_b16 v[64:65], v32 offset:0
    ds_read_b64_tr_b16 v[66:67], v32 offset:1024
    v_mfma_f32_32x32x16_bf16 v[120:135], v[84:87], v[56:59], v[120:135]
    ds_read_b64_tr_b16 v[68:69], v33 offset:0
    ds_read_b64_tr_b16 v[70:71], v33 offset:1024
    v_mfma_f32_32x32x16_bf16 v[136:151], v[88:91], v[56:59], v[136:151]
    ds_read_b64_tr_b16 v[72:73], v34 offset:0
    ds_read_b64_tr_b16 v[74:75], v34 offset:1024
    v_mfma_f32_32x32x16_bf16 v[152:167], v[92:95], v[56:59], v[152:167]
    ds_read_b64_tr_b16 v[76:77], v35 offset:0
    ds_read_b64_tr_b16 v[78:79], v35 offset:1024
    s_waitcnt vmcnt(12)
    s_waitcnt lgkmcnt(6)
    v_mfma_f32_32x32x16_bf16 v[104:119], v[64:67], v[184:187], v[104:119]
    ds_read_b64_tr_b16 v[80:81], v32 offset:2048
    ds_read_b64_tr_b16 v[82:83], v32 offset:3072
    s_waitcnt lgkmcnt(6)
    v_mfma_f32_32x32x16_bf16 v[120:135], v[68:71], v[184:187], v[120:135]
    ds_read_b64_tr_b16 v[84:85], v33 offset:2048
    ds_read_b64_tr_b16 v[86:87], v33 offset:3072
    s_waitcnt lgkmcnt(6)
    v_mfma_f32_32x32x16_bf16 v[136:151], v[72:75], v[184:187], v[136:151]
    ds_read_b64_tr_b16 v[88:89], v34 offset:2048
    ds_read_b64_tr_b16 v[90:91], v34 offset:3072
    s_waitcnt lgkmcnt(6)
    v_mfma_f32_32x32x16_bf16 v[152:167], v[76:79], v[184:187], v[152:167]
    ds_read_b64_tr_b16 v[92:93], v35 offset:2048
    ds_read_b64_tr_b16 v[94:95], v35 offset:3072
    s_waitcnt vmcnt(5)
    v_pk_add_f32 v[12:13], v[12:13], v[14:15]
    v_pk_add_f32 v[16:17], v[16:17], v[18:19]
    v_pk_add_f32 v[12:13], v[12:13], v[20:21]
    v_pk_add_f32 v[12:13], v[12:13], v[16:17]
    v_mov_b32 v14, v12
    v_mov_b32 v15, v13
    s_waitcnt lgkmcnt(6)
    v_mfma_f32_32x32x16_bf16 v[104:119], v[80:83], v[188:191], v[104:119]
    ds_read_b64_tr_b16 v[64:65], v32 offset:4096
    ds_read_b64_tr_b16 v[66:67], v32 offset:5120
    s_waitcnt lgkmcnt(6)
    v_mfma_f32_32x32x16_bf16 v[120:135], v[84:87], v[188:191], v[120:135]
    ds_read_b64_tr_b16 v[68:69], v33 offset:4096
    ds_read_b64_tr_b16 v[70:71], v33 offset:5120
    s_waitcnt lgkmcnt(6)
    v_mfma_f32_32x32x16_bf16 v[136:151], v[88:91], v[188:191], v[136:151]
    ds_read_b64_tr_b16 v[72:73], v34 offset:4096
    ds_read_b64_tr_b16 v[74:75], v34 offset:5120
    s_waitcnt lgkmcnt(6)
    v_mfma_f32_32x32x16_bf16 v[152:167], v[92:95], v[188:191], v[152:167]
    ds_read_b64_tr_b16 v[76:77], v35 offset:4096
    ds_read_b64_tr_b16 v[78:79], v35 offset:5120
    v_permlane32_swap_b32 v12, v14
    v_permlane32_swap_b32 v13, v15
    v_pk_add_f32 v[12:13], v[12:13], v[14:15]
    v_mul_f32 v12, 0x3acccccd, v12
    v_mul_f32 v13, 0x3acccccd, v13
    v_fma_f32 v13, -v12, v12, v13
    v_max_f32 v13, 0, v13
    v_add_f32 v13, 0x3727c5ac, v13
    v_rsq_f32 v13, v13
    s_waitcnt lgkmcnt(6)
    v_mfma_f32_32x32x16_bf16 v[104:119], v[64:67], v[192:195], v[104:119]
    ds_read_b64_tr_b16 v[80:81], v32 offset:6144
    ds_read_b64_tr_b16 v[82:83], v32 offset:7168
    s_waitcnt lgkmcnt(6)
    v_mfma_f32_32x32x16_bf16 v[120:135], v[68:71], v[192:195], v[120:135]
    ds_read_b64_tr_b16 v[84:85], v33 offset:6144
    ds_read_b64_tr_b16 v[86:87], v33 offset:7168
    s_waitcnt lgkmcnt(6)
    v_mfma_f32_32x32x16_bf16 v[136:151], v[72:75], v[192:195], v[136:151]
    ds_read_b64_tr_b16 v[88:89], v34 offset:6144
    ds_read_b64_tr_b16 v[90:91], v34 offset:7168
    s_waitcnt lgkmcnt(6)
    v_mfma_f32_32x32x16_bf16 v[152:167], v[76:79], v[192:195], v[152:167]
    ds_read_b64_tr_b16 v[92:93], v35 offset:6144
    ds_read_b64_tr_b16 v[94:95], v35 offset:7168
    v_sub_f32 v3, 0, v12
    v_cmp_gt_u32 vcc, 32, v1
    s_nop 1
    v_cndmask_b32_e64 v3, 0, v3, vcc
    v_cvt_pk_bf16_f32 v16, v3, v3
    v_and_b32 v4, 0xffff0000, v16
    v_sub_f32_e64 v4, v3, v4
    v_cvt_pk_bf16_f32 v17, v4, 0
    v_mov_b32 v18, 0
    v_mov_b32 v19, 0
    s_waitcnt vmcnt(4)
    s_waitcnt lgkmcnt(6)
    v_mfma_f32_32x32x16_bf16 v[104:119], v[80:83], v[196:199], v[104:119]
    ds_read_b64_tr_b16 v[64:65], v32 offset:8192
    ds_read_b64_tr_b16 v[66:67], v32 offset:9216
    s_waitcnt lgkmcnt(6)
    v_mfma_f32_32x32x16_bf16 v[120:135], v[84:87], v[196:199], v[120:135]
    ds_read_b64_tr_b16 v[68:69], v33 offset:8192
    ds_read_b64_tr_b16 v[70:71], v33 offset:9216
    s_waitcnt lgkmcnt(6)
    v_mfma_f32_32x32x16_bf16 v[136:151], v[88:91], v[196:199], v[136:151]
    ds_read_b64_tr_b16 v[72:73], v34 offset:8192
    ds_read_b64_tr_b16 v[74:75], v34 offset:9216
    s_waitcnt lgkmcnt(6)
    v_mfma_f32_32x32x16_bf16 v[152:167], v[92:95], v[196:199], v[152:167]
    ds_read_b64_tr_b16 v[76:77], v35 offset:8192
    ds_read_b64_tr_b16 v[78:79], v35 offset:9216
    v_mul_f32 v24, 0xc0135761, v13
    v_mul_f32 v26, v13, v13
    v_rcp_f32 v28, v13
    v_mul_f32 v26, v26, v24
    v_mul_f32 v26, 0x3d372713, v26
    v_mov_b32 v25, v24
    v_mov_b32 v27, v26
    v_mov_b32 v29, v28
    s_waitcnt vmcnt(3)
    s_waitcnt lgkmcnt(6)
    v_mfma_f32_32x32x16_bf16 v[104:119], v[64:67], v[200:203], v[104:119]
    ds_read_b64_tr_b16 v[80:81], v32 offset:10240
    ds_read_b64_tr_b16 v[82:83], v32 offset:11264
    s_waitcnt lgkmcnt(6)
    v_mfma_f32_32x32x16_bf16 v[120:135], v[68:71], v[200:203], v[120:135]
    ds_read_b64_tr_b16 v[84:85], v33 offset:10240
    ds_read_b64_tr_b16 v[86:87], v33 offset:11264
    s_waitcnt lgkmcnt(6)
    v_mfma_f32_32x32x16_bf16 v[136:151], v[72:75], v[200:203], v[136:151]
    ds_read_b64_tr_b16 v[88:89], v34 offset:10240
    ds_read_b64_tr_b16 v[90:91], v34 offset:11264
    s_waitcnt lgkmcnt(6)
    v_mfma_f32_32x32x16_bf16 v[152:167], v[76:79], v[200:203], v[152:167]
    ds_read_b64_tr_b16 v[92:93], v35 offset:10240
    ds_read_b64_tr_b16 v[94:95], v35 offset:11264
    v_mfma_f32_32x32x16_bf16 v[104:119], v[168:171], v[16:19], v[104:119]
    v_mfma_f32_32x32x16_bf16 v[120:135], v[172:175], v[16:19], v[120:135]
    v_mfma_f32_32x32x16_bf16 v[136:151], v[176:179], v[16:19], v[136:151]
    v_mfma_f32_32x32x16_bf16 v[152:167], v[180:183], v[16:19], v[152:167]
    s_waitcnt vmcnt(2)
    s_waitcnt lgkmcnt(6)
    v_mfma_f32_32x32x16_bf16 v[104:119], v[80:83], v[204:207], v[104:119]
    ds_read_b64_tr_b16 v[64:65], v32 offset:12288
    ds_read_b64_tr_b16 v[66:67], v32 offset:13312
    s_waitcnt lgkmcnt(6)
    v_mfma_f32_32x32x16_bf16 v[120:135], v[84:87], v[204:207], v[120:135]
    ds_read_b64_tr_b16 v[68:69], v33 offset:12288
    ds_read_b64_tr_b16 v[70:71], v33 offset:13312
    s_waitcnt lgkmcnt(6)
    v_mfma_f32_32x32x16_bf16 v[136:151], v[88:91], v[204:207], v[136:151]
    ds_read_b64_tr_b16 v[72:73], v34 offset:12288
    ds_read_b64_tr_b16 v[74:75], v34 offset:13312
    s_waitcnt lgkmcnt(6)
    v_mfma_f32_32x32x16_bf16 v[152:167], v[92:95], v[204:207], v[152:167]
    ds_read_b64_tr_b16 v[76:77], v35 offset:12288
    ds_read_b64_tr_b16 v[78:79], v35 offset:13312
    s_mul_i32 s85, s11, 528384
    s_add_u32 s85, s85, 15532032
    s_lshl_b32 s86, s79, 2
    s_add_u32 s86, s86, s72
    s_mul_i32 s86, s86, 2048
    s_add_u32 s86, s86, 1441792
    s_lshl_b32 s8, s11, 7
    s_add_u32 s8, s8, s86
    s_waitcnt vmcnt(1)
    s_waitcnt lgkmcnt(6)
    v_mfma_f32_32x32x16_bf16 v[104:119], v[64:67], v[208:211], v[104:119]
    ds_read_b64_tr_b16 v[80:81], v32 offset:14336
    ds_read_b64_tr_b16 v[82:83], v32 offset:15360
    s_waitcnt lgkmcnt(6)
    v_mfma_f32_32x32x16_bf16 v[120:135], v[68:71], v[208:211], v[120:135]
    ds_read_b64_tr_b16 v[84:85], v33 offset:14336
    ds_read_b64_tr_b16 v[86:87], v33 offset:15360
    s_waitcnt lgkmcnt(6)
    v_mfma_f32_32x32x16_bf16 v[136:151], v[72:75], v[208:211], v[136:151]
    ds_read_b64_tr_b16 v[88:89], v34 offset:14336
    ds_read_b64_tr_b16 v[90:91], v34 offset:15360
    s_waitcnt lgkmcnt(6)
    v_mfma_f32_32x32x16_bf16 v[152:167], v[76:79], v[208:211], v[152:167]
    ds_read_b64_tr_b16 v[92:93], v35 offset:14336
    ds_read_b64_tr_b16 v[94:95], v35 offset:15360
    s_waitcnt lgkmcnt(0)
E3H:
    s_barrier
    s_waitcnt vmcnt(0)
    v_mfma_f32_32x32x16_bf16 v[104:119], v[80:83], v[212:215], v[104:119]
    v_mfma_f32_32x32x16_bf16 v[120:135], v[84:87], v[212:215], v[120:135]
    v_mfma_f32_32x32x16_bf16 v[136:151], v[88:91], v[212:215], v[136:151]
    v_mfma_f32_32x32x16_bf16 v[152:167], v[92:95], v[212:215], v[152:167]
    s_nop 8
    v_pk_mul_f32 v[12:13], v[104:105], v[104:105]
    v_pk_mul_f32 v[14:15], v[106:107], v[106:107]
    v_pk_fma_f32 v[12:13], v[12:13], v[26:27], v[24:25]
    v_pk_fma_f32 v[14:15], v[14:15], v[26:27], v[24:25]
    v_pk_mul_f32 v[12:13], v[12:13], v[104:105]
    v_pk_mul_f32 v[14:15], v[14:15], v[106:107]
    v_exp_f32 v12, v12
    v_exp_f32 v13, v13
    v_exp_f32 v14, v14
    v_exp_f32 v15, v15
    v_pk_fma_f32 v[12:13], v[12:13], v[28:29], v[28:29]
    v_pk_fma_f32 v[14:15], v[14:15], v[28:29], v[28:29]
    v_rcp_f32 v12, v12
    v_rcp_f32 v13, v13
    v_rcp_f32 v14, v14
    v_rcp_f32 v15, v15
    v_pk_mul_f32 v[104:105], v[104:105], v[12:13]
    v_pk_mul_f32 v[106:107], v[106:107], v[14:15]
    v_cvt_pk_bf16_f32 v184, v104, v105
    v_cvt_pk_bf16_f32 v185, v106, v107
    v_pk_mul_f32 v[12:13], v[108:109], v[108:109]
    v_pk_mul_f32 v[14:15], v[110:111], v[110:111]
    v_pk_fma_f32 v[12:13], v[12:13], v[26:27], v[24:25]
    v_pk_fma_f32 v[14:15], v[14:15], v[26:27], v[24:25]
    v_pk_mul_f32 v[12:13], v[12:13], v[108:109]
    v_pk_mul_f32 v[14:15], v[14:15], v[110:111]
    v_exp_f32 v12, v12
    v_exp_f32 v13, v13
    v_exp_f32 v14, v14
    v_exp_f32 v15, v15
    v_pk_fma_f32 v[12:13], v[12:13], v[28:29], v[28:29]
    v_pk_fma_f32 v[14:15], v[14:15], v[28:29], v[28:29]
    v_rcp_f32 v12, v12
    v_rcp_f32 v13, v13
    v_rcp_f32 v14, v14
    v_rcp_f32 v15, v15
    v_pk_mul_f32 v[108:109], v[108:109], v[12:13]
    v_pk_mul_f32 v[110:111], v[110:111], v[14:15]
    v_cvt_pk_bf16_f32 v186, v108, v109
    v_cvt_pk_bf16_f32 v187, v110, v111
    v_pk_mul_f32 v[12:13], v[112:113], v[112:113]
    v_pk_mul_f32 v[14:15], v[114:115], v[114:115]
    v_pk_fma_f32 v[12:13], v[12:13], v[26:27], v[24:25]
    v_pk_fma_f32 v[14:15], v[14:15], v[26:27], v[24:25]
    v_pk_mul_f32 v[12:13], v[12:13], v[112:113]
    v_pk_mul_f32 v[14:15], v[14:15], v[114:115]
    v_exp_f32 v12, v12
    v_exp_f32 v13, v13
    v_exp_f32 v14, v14
    v_exp_f32 v15, v15
    v_pk_fma_f32 v[12:13], v[12:13], v[28:29], v[28:29]
    v_pk_fma_f32 v[14:15], v[14:15], v[28:29], v[28:29]
    v_rcp_f32 v12, v12
    v_rcp_f32 v13, v13
    v_rcp_f32 v14, v14
    v_rcp_f32 v15, v15
    v_pk_mul_f32 v[112:113], v[112:113], v[12:13]
    v_pk_mul_f32 v[114:115], v[114:115], v[14:15]
    v_cvt_pk_bf16_f32 v188, v112, v113
    v_cvt_pk_bf16_f32 v189, v114, v115
    v_pk_mul_f32 v[12:13], v[116:117], v[116:117]
    v_pk_mul_f32 v[14:15], v[118:119], v[118:119]
    v_pk_fma_f32 v[12:13], v[12:13], v[26:27], v[24:25]
    v_pk_fma_f32 v[14:15], v[14:15], v[26:27], v[24:25]
    v_pk_mul_f32 v[12:13], v[12:13], v[116:117]
    v_pk_mul_f32 v[14:15], v[14:15], v[118:119]
    v_exp_f32 v12, v12
    v_exp_f32 v13, v13
    v_exp_f32 v14, v14
    v_exp_f32 v15, v15
    v_pk_fma_f32 v[12:13], v[12:13], v[28:29], v[28:29]
    v_pk_fma_f32 v[14:15], v[14:15], v[28:29], v[28:29]
    v_rcp_f32 v12, v12
    v_rcp_f32 v13, v13
    v_rcp_f32 v14, v14
    v_rcp_f32 v15, v15
    v_pk_mul_f32 v[116:117], v[116:117], v[12:13]
    v_pk_mul_f32 v[118:119], v[118:119], v[14:15]
    v_cvt_pk_bf16_f32 v190, v116, v117
    v_cvt_pk_bf16_f32 v191, v118, v119
    s_add_u32 s83, s85, 0
    s_add_u32 s84, s85, 66048
    buffer_store_dwordx4 v[184:187], v7, s[64:67], s83 offen sc1
    buffer_store_dwordx4 v[188:191], v7, s[64:67], s84 offen sc1
    s_nop 0
    v_pk_mul_f32 v[12:13], v[120:121], v[120:121]
    v_pk_mul_f32 v[14:15], v[122:123], v[122:123]
    v_pk_fma_f32 v[12:13], v[12:13], v[26:27], v[24:25]
    v_pk_fma_f32 v[14:15], v[14:15], v[26:27], v[24:25]
    v_pk_mul_f32 v[12:13], v[12:13], v[120:121]
    v_pk_mul_f32 v[14:15], v[14:15], v[122:123]
    v_exp_f32 v12, v12
    v_exp_f32 v13, v13
    v_exp_f32 v14, v14
    v_exp_f32 v15, v15
    v_pk_fma_f32 v[12:13], v[12:13], v[28:29], v[28:29]
    v_pk_fma_f32 v[14:15], v[14:15], v[28:29], v[28:29]
    v_rcp_f32 v12, v12
    v_rcp_f32 v13, v13
    v_rcp_f32 v14, v14
    v_rcp_f32 v15, v15
    v_pk_mul_f32 v[120:121], v[120:121], v[12:13]
    v_pk_mul_f32 v[122:123], v[122:123], v[14:15]
    v_cvt_pk_bf16_f32 v192, v120, v121
    v_cvt_pk_bf16_f32 v193, v122, v123
    v_pk_mul_f32 v[12:13], v[124:125], v[124:125]
    v_pk_mul_f32 v[14:15], v[126:127], v[126:127]
    v_pk_fma_f32 v[12:13], v[12:13], v[26:27], v[24:25]
    v_pk_fma_f32 v[14:15], v[14:15], v[26:27], v[24:25]
    v_pk_mul_f32 v[12:13], v[12:13], v[124:125]
    v_pk_mul_f32 v[14:15], v[14:15], v[126:127]
    v_exp_f32 v12, v12
    v_exp_f32 v13, v13
    v_exp_f32 v14, v14
    v_exp_f32 v15, v15
    v_pk_fma_f32 v[12:13], v[12:13], v[28:29], v[28:29]
    v_pk_fma_f32 v[14:15], v[14:15], v[28:29], v[28:29]
    v_rcp_f32 v12, v12
    v_rcp_f32 v13, v13
    v_rcp_f32 v14, v14
    v_rcp_f32 v15, v15
    v_pk_mul_f32 v[124:125], v[124:125], v[12:13]
    v_pk_mul_f32 v[126:127], v[126:127], v[14:15]
    v_cvt_pk_bf16_f32 v194, v124, v125
    v_cvt_pk_bf16_f32 v195, v126, v127
    v_pk_mul_f32 v[12:13], v[128:129], v[128:129]
    v_pk_mul_f32 v[14:15], v[130:131], v[130:131]
    v_pk_fma_f32 v[12:13], v[12:13], v[26:27], v[24:25]
    v_pk_fma_f32 v[14:15], v[14:15], v[26:27], v[24:25]
    v_pk_mul_f32 v[12:13], v[12:13], v[128:129]
    v_pk_mul_f32 v[14:15], v[14:15], v[130:131]
    v_exp_f32 v12, v12
    v_exp_f32 v13, v13
    v_exp_f32 v14, v14
    v_exp_f32 v15, v15
    v_pk_fma_f32 v[12:13], v[12:13], v[28:29], v[28:29]
    v_pk_fma_f32 v[14:15], v[14:15], v[28:29], v[28:29]
    v_rcp_f32 v12, v12
    v_rcp_f32 v13, v13
    v_rcp_f32 v14, v14
    v_rcp_f32 v15, v15
    v_pk_mul_f32 v[128:129], v[128:129], v[12:13]
    v_pk_mul_f32 v[130:131], v[130:131], v[14:15]
    v_cvt_pk_bf16_f32 v196, v128, v129
    v_cvt_pk_bf16_f32 v197, v130, v131
    v_pk_mul_f32 v[12:13], v[132:133], v[132:133]
    v_pk_mul_f32 v[14:15], v[134:135], v[134:135]
    v_pk_fma_f32 v[12:13], v[12:13], v[26:27], v[24:25]
    v_pk_fma_f32 v[14:15], v[14:15], v[26:27], v[24:25]
    v_pk_mul_f32 v[12:13], v[12:13], v[132:133]
    v_pk_mul_f32 v[14:15], v[14:15], v[134:135]
    v_exp_f32 v12, v12
    v_exp_f32 v13, v13
    v_exp_f32 v14, v14
    v_exp_f32 v15, v15
    v_pk_fma_f32 v[12:13], v[12:13], v[28:29], v[28:29]
    v_pk_fma_f32 v[14:15], v[14:15], v[28:29], v[28:29]
    v_rcp_f32 v12, v12
    v_rcp_f32 v13, v13
    v_rcp_f32 v14, v14
    v_rcp_f32 v15, v15
    v_pk_mul_f32 v[132:133], v[132:133], v[12:13]
    v_pk_mul_f32 v[134:135], v[134:135], v[14:15]
    v_cvt_pk_bf16_f32 v198, v132, v133
    v_cvt_pk_bf16_f32 v199, v134, v135
    s_add_u32 s83, s85, 132096
    s_add_u32 s84, s85, 198144
    buffer_store_dwordx4 v[192:195], v7, s[64:67], s83 offen sc1
    buffer_store_dwordx4 v[196:199], v7, s[64:67], s84 offen sc1
    v_pk_mul_f32 v[12:13], v[136:137], v[136:137]
    v_pk_mul_f32 v[14:15], v[138:139], v[138:139]
    v_pk_fma_f32 v[12:13], v[12:13], v[26:27], v[24:25]
    v_pk_fma_f32 v[14:15], v[14:15], v[26:27], v[24:25]
    v_pk_mul_f32 v[12:13], v[12:13], v[136:137]
    v_pk_mul_f32 v[14:15], v[14:15], v[138:139]
    v_exp_f32 v12, v12
    v_exp_f32 v13, v13
    v_exp_f32 v14, v14
    v_exp_f32 v15, v15
    v_pk_fma_f32 v[12:13], v[12:13], v[28:29], v[28:29]
    v_pk_fma_f32 v[14:15], v[14:15], v[28:29], v[28:29]
    v_rcp_f32 v12, v12
    v_rcp_f32 v13, v13
    v_rcp_f32 v14, v14
    v_rcp_f32 v15, v15
    v_pk_mul_f32 v[136:137], v[136:137], v[12:13]
    v_pk_mul_f32 v[138:139], v[138:139], v[14:15]
    v_cvt_pk_bf16_f32 v200, v136, v137
    v_cvt_pk_bf16_f32 v201, v138, v139
    v_pk_mul_f32 v[12:13], v[140:141], v[140:141]
    v_pk_mul_f32 v[14:15], v[142:143], v[142:143]
    v_pk_fma_f32 v[12:13], v[12:13], v[26:27], v[24:25]
    v_pk_fma_f32 v[14:15], v[14:15], v[26:27], v[24:25]
    v_pk_mul_f32 v[12:13], v[12:13], v[140:141]
    v_pk_mul_f32 v[14:15], v[14:15], v[142:143]
    v_exp_f32 v12, v12
    v_exp_f32 v13, v13
    v_exp_f32 v14, v14
    v_exp_f32 v15, v15
    v_pk_fma_f32 v[12:13], v[12:13], v[28:29], v[28:29]
    v_pk_fma_f32 v[14:15], v[14:15], v[28:29], v[28:29]
    v_rcp_f32 v12, v12
    v_rcp_f32 v13, v13
    v_rcp_f32 v14, v14
    v_rcp_f32 v15, v15
    v_pk_mul_f32 v[140:141], v[140:141], v[12:13]
    v_pk_mul_f32 v[142:143], v[142:143], v[14:15]
    v_cvt_pk_bf16_f32 v202, v140, v141
    v_cvt_pk_bf16_f32 v203, v142, v143
    v_pk_mul_f32 v[12:13], v[144:145], v[144:145]
    v_pk_mul_f32 v[14:15], v[146:147], v[146:147]
    v_pk_fma_f32 v[12:13], v[12:13], v[26:27], v[24:25]
    v_pk_fma_f32 v[14:15], v[14:15], v[26:27], v[24:25]
    v_pk_mul_f32 v[12:13], v[12:13], v[144:145]
    v_pk_mul_f32 v[14:15], v[14:15], v[146:147]
    v_exp_f32 v12, v12
    v_exp_f32 v13, v13
    v_exp_f32 v14, v14
    v_exp_f32 v15, v15
    v_pk_fma_f32 v[12:13], v[12:13], v[28:29], v[28:29]
    v_pk_fma_f32 v[14:15], v[14:15], v[28:29], v[28:29]
    v_rcp_f32 v12, v12
    v_rcp_f32 v13, v13
    v_rcp_f32 v14, v14
    v_rcp_f32 v15, v15
    v_pk_mul_f32 v[144:145], v[144:145], v[12:13]
    v_pk_mul_f32 v[146:147], v[146:147], v[14:15]
    v_cvt_pk_bf16_f32 v204, v144, v145
    v_cvt_pk_bf16_f32 v205, v146, v147
    v_pk_mul_f32 v[12:13], v[148:149], v[148:149]
    v_pk_mul_f32 v[14:15], v[150:151], v[150:151]
    v_pk_fma_f32 v[12:13], v[12:13], v[26:27], v[24:25]
    v_pk_fma_f32 v[14:15], v[14:15], v[26:27], v[24:25]
    v_pk_mul_f32 v[12:13], v[12:13], v[148:149]
    v_pk_mul_f32 v[14:15], v[14:15], v[150:151]
    v_exp_f32 v12, v12
    v_exp_f32 v13, v13
    v_exp_f32 v14, v14
    v_exp_f32 v15, v15
    v_pk_fma_f32 v[12:13], v[12:13], v[28:29], v[28:29]
    v_pk_fma_f32 v[14:15], v[14:15], v[28:29], v[28:29]
    v_rcp_f32 v12, v12
    v_rcp_f32 v13, v13
    v_rcp_f32 v14, v14
    v_rcp_f32 v15, v15
    v_pk_mul_f32 v[148:149], v[148:149], v[12:13]
    v_pk_mul_f32 v[150:151], v[150:151], v[14:15]
    v_cvt_pk_bf16_f32 v206, v148, v149
    v_cvt_pk_bf16_f32 v207, v150, v151
    s_add_u32 s83, s85, 264192
    s_add_u32 s84, s85, 330240
    buffer_store_dwordx4 v[200:203], v7, s[64:67], s83 offen sc1
    buffer_store_dwordx4 v[204:207], v7, s[64:67], s84 offen sc1
    v_pk_mul_f32 v[12:13], v[152:153], v[152:153]
    v_pk_mul_f32 v[14:15], v[154:155], v[154:155]
    v_pk_fma_f32 v[12:13], v[12:13], v[26:27], v[24:25]
    v_pk_fma_f32 v[14:15], v[14:15], v[26:27], v[24:25]
    v_pk_mul_f32 v[12:13], v[12:13], v[152:153]
    v_pk_mul_f32 v[14:15], v[14:15], v[154:155]
    v_exp_f32 v12, v12
    v_exp_f32 v13, v13
    v_exp_f32 v14, v14
    v_exp_f32 v15, v15
    v_pk_fma_f32 v[12:13], v[12:13], v[28:29], v[28:29]
    v_pk_fma_f32 v[14:15], v[14:15], v[28:29], v[28:29]
    v_rcp_f32 v12, v12
    v_rcp_f32 v13, v13
    v_rcp_f32 v14, v14
    v_rcp_f32 v15, v15
    v_pk_mul_f32 v[152:153], v[152:153], v[12:13]
    v_pk_mul_f32 v[154:155], v[154:155], v[14:15]
    v_cvt_pk_bf16_f32 v208, v152, v153
    v_cvt_pk_bf16_f32 v209, v154, v155
    v_pk_mul_f32 v[12:13], v[156:157], v[156:157]
    v_pk_mul_f32 v[14:15], v[158:159], v[158:159]
    v_pk_fma_f32 v[12:13], v[12:13], v[26:27], v[24:25]
    v_pk_fma_f32 v[14:15], v[14:15], v[26:27], v[24:25]
    v_pk_mul_f32 v[12:13], v[12:13], v[156:157]
    v_pk_mul_f32 v[14:15], v[14:15], v[158:159]
    v_exp_f32 v12, v12
    v_exp_f32 v13, v13
    v_exp_f32 v14, v14
    v_exp_f32 v15, v15
    v_pk_fma_f32 v[12:13], v[12:13], v[28:29], v[28:29]
    v_pk_fma_f32 v[14:15], v[14:15], v[28:29], v[28:29]
    v_rcp_f32 v12, v12
    v_rcp_f32 v13, v13
    v_rcp_f32 v14, v14
    v_rcp_f32 v15, v15
    v_pk_mul_f32 v[156:157], v[156:157], v[12:13]
    v_pk_mul_f32 v[158:159], v[158:159], v[14:15]
    v_cvt_pk_bf16_f32 v210, v156, v157
    v_cvt_pk_bf16_f32 v211, v158, v159
    v_pk_mul_f32 v[12:13], v[160:161], v[160:161]
    v_pk_mul_f32 v[14:15], v[162:163], v[162:163]
    v_pk_fma_f32 v[12:13], v[12:13], v[26:27], v[24:25]
    v_pk_fma_f32 v[14:15], v[14:15], v[26:27], v[24:25]
    v_pk_mul_f32 v[12:13], v[12:13], v[160:161]
    v_pk_mul_f32 v[14:15], v[14:15], v[162:163]
    v_exp_f32 v12, v12
    v_exp_f32 v13, v13
    v_exp_f32 v14, v14
    v_exp_f32 v15, v15
    v_pk_fma_f32 v[12:13], v[12:13], v[28:29], v[28:29]
    v_pk_fma_f32 v[14:15], v[14:15], v[28:29], v[28:29]
    v_rcp_f32 v12, v12
    v_rcp_f32 v13, v13
    v_rcp_f32 v14, v14
    v_rcp_f32 v15, v15
    v_pk_mul_f32 v[160:161], v[160:161], v[12:13]
    v_pk_mul_f32 v[162:163], v[162:163], v[14:15]
    v_cvt_pk_bf16_f32 v212, v160, v161
    v_cvt_pk_bf16_f32 v213, v162, v163
    v_pk_mul_f32 v[12:13], v[164:165], v[164:165]
    v_pk_mul_f32 v[14:15], v[166:167], v[166:167]
    v_pk_fma_f32 v[12:13], v[12:13], v[26:27], v[24:25]
    v_pk_fma_f32 v[14:15], v[14:15], v[26:27], v[24:25]
    v_pk_mul_f32 v[12:13], v[12:13], v[164:165]
    v_pk_mul_f32 v[14:15], v[14:15], v[166:167]
    v_exp_f32 v12, v12
    v_exp_f32 v13, v13
    v_exp_f32 v14, v14
    v_exp_f32 v15, v15
    v_pk_fma_f32 v[12:13], v[12:13], v[28:29], v[28:29]
    v_pk_fma_f32 v[14:15], v[14:15], v[28:29], v[28:29]
    v_rcp_f32 v12, v12
    v_rcp_f32 v13, v13
    v_rcp_f32 v14, v14
    v_rcp_f32 v15, v15
    v_pk_mul_f32 v[164:165], v[164:165], v[12:13]
    v_pk_mul_f32 v[166:167], v[166:167], v[14:15]
    v_cvt_pk_bf16_f32 v214, v164, v165
    v_cvt_pk_bf16_f32 v215, v166, v167
    s_add_u32 s83, s85, 396288
    s_add_u32 s84, s85, 462336
    buffer_store_dwordx4 v[208:211], v7, s[64:67], s83 offen sc1
    buffer_store_dwordx4 v[212:215], v7, s[64:67], s84 offen sc1
    s_waitcnt vmcnt(0)
    s_mov_b64 exec, 1
    s_cmp_lg_u32 s100, 0
    s_cbranch_scc1 SLOW_114
    buffer_store_dword v2, off, s[64:67], s8
    s_branch STE_115
SLOW_114:
    buffer_store_dword v2, off, s[64:67], s8 sc1
STE_115:
    s_mov_b64 exec, -1
    s_barrier
    s_lshl_b32 s84, s79, 1
    s_lshr_b32 s85, s72, 1
    s_add_u32 s84, s84, s85
    s_mul_i32 s84, s84, 2048
    s_add_u32 s84, s84, 1572864
    v_lshl_add_u32 v8, v1, 7, s84
    v_lshrrev_b32_e64 v3, 5, v1
    v_lshl_add_u32 v30, v3, 9, v30
    v_lshl_add_u32 v31, v3, 9, v31
    s_mov_b32 s90, 200000
    s_mov_b64 exec, 0xff
POLL_116:
    buffer_load_dword v52, v8, s[64:67], 0 offen sc1
    s_waitcnt vmcnt(0)
    v_cmp_ne_u32 vcc, s73, v52
    s_cbranch_vccz POLLD_117
    s_sub_u32 s90, s90, 1
    s_cmp_lg_u32 s90, 0
    s_cbranch_scc1 POLL_116
POLLD_117:
    s_mov_b64 exec, -1
    s_mov_b32 s83, 10158080
    buffer_load_dwordx4 v[52:55], v7, s[64:67], s83 offen sc1
    s_mov_b32 s83, 10224128
    buffer_load_dwordx4 v[56:59], v7, s[64:67], s83 offen sc1
    s_mov_b32 s83, 10290176
    buffer_load_dwordx4 v[60:63], v7, s[64:67], s83 offen sc1
    s_mov_b32 s83, 10356224
    buffer_load_dwordx4 v[64:67], v7, s[64:67], s83 offen sc1
    s_mov_b32 s83, 10422272
    buffer_load_dwordx4 v[68:71], v7, s[64:67], s83 offen sc1
    s_mov_b32 s83, 10488320
    buffer_load_dwordx4 v[72:75], v7, s[64:67], s83 offen sc1
    s_mov_b32 s83, 10554368
    buffer_load_dwordx4 v[76:79], v7, s[64:67], s83 offen sc1
    s_mov_b32 s83, 10620416
    buffer_load_dwordx4 v[80:83], v7, s[64:67], s83 offen sc1
    s_mov_b32 s83, 10686464
    buffer_load_dwordx4 v[84:87], v7, s[64:67], s83 offen sc1
    s_mov_b32 s83, 10752512
    buffer_load_dwordx4 v[88:91], v7, s[64:67], s83 offen sc1
    s_mov_b32 s83, 10818560
    buffer_load_dwordx4 v[92:95], v7, s[64:67], s83 offen sc1
    s_mov_b32 s83, 10884608
    buffer_load_dwordx4 v[96:99], v7, s[64:67], s83 offen sc1
    v_add_u32 v32, 0, v30
    v_add_u32_e64 v33, 0, v31
    ds_read_b64_tr_b16 v[148:149], v32 offset:0
    ds_read_b64_tr_b16 v[150:151], v32 offset:512
    ds_read_b64_tr_b16 v[152:153], v33 offset:0
    ds_read_b64_tr_b16 v[154:155], v33 offset:512
    ds_read_b64_tr_b16 v[156:157], v32 offset:2048
    ds_read_b64_tr_b16 v[158:159], v32 offset:2560
    ds_read_b64_tr_b16 v[160:161], v33 offset:2048
    ds_read_b64_tr_b16 v[162:163], v33 offset:2560
    s_waitcnt vmcnt(11)
    s_waitcnt lgkmcnt(6)
    v_mfma_f32_32x32x16_bf16 v[180:195], v[148:151], v[52:55], 0
    ds_read_b64_tr_b16 v[164:165], v32 offset:4096
    ds_read_b64_tr_b16 v[166:167], v32 offset:4608
    s_waitcnt lgkmcnt(6)
    v_mfma_f32_32x32x16_bf16 v[196:211], v[152:155], v[52:55], 0
    ds_read_b64_tr_b16 v[168:169], v33 offset:4096
    ds_read_b64_tr_b16 v[170:171], v33 offset:4608
    s_mov_b32 s83, 10950656
    buffer_load_dwordx4 v[100:103], v7, s[64:67], s83 offen sc1
    s_mov_b32 s83, 11016704
    buffer_load_dwordx4 v[104:107], v7, s[64:67], s83 offen sc1
    s_waitcnt vmcnt(12)
    s_waitcnt lgkmcnt(6)
    v_mfma_f32_32x32x16_bf16 v[180:195], v[156:159], v[56:59], v[180:195]
    ds_read_b64_tr_b16 v[148:149], v32 offset:6144
    ds_read_b64_tr_b16 v[150:151], v32 offset:6656
    s_waitcnt lgkmcnt(6)
    v_mfma_f32_32x32x16_bf16 v[196:211], v[160:163], v[56:59], v[196:211]
    ds_read_b64_tr_b16 v[152:153], v33 offset:6144
    ds_read_b64_tr_b16 v[154:155], v33 offset:6656
    s_mov_b32 s83, 11082752
    buffer_load_dwordx4 v[108:111], v7, s[64:67], s83 offen sc1
    s_mov_b32 s83, 11148800
    buffer_load_dwordx4 v[112:115], v7, s[64:67], s83 offen sc1
    s_waitcnt vmcnt(13)
    s_waitcnt lgkmcnt(6)
    v_mfma_f32_32x32x16_bf16 v[180:195], v[164:167], v[60:63], v[180:195]
    ds_read_b64_tr_b16 v[156:157], v32 offset:8192
    ds_read_b64_tr_b16 v[158:159], v32 offset:8704
    s_waitcnt lgkmcnt(6)
    v_mfma_f32_32x32x16_bf16 v[196:211], v[168:171], v[60:63], v[196:211]
    ds_read_b64_tr_b16 v[160:161], v33 offset:8192
    ds_read_b64_tr_b16 v[162:163], v33 offset:8704
    s_mov_b32 s83, 11214848
    buffer_load_dwordx4 v[116:119], v7, s[64:67], s83 offen sc1
    s_mov_b32 s83, 11280896
    buffer_load_dwordx4 v[120:123], v7, s[64:67], s83 offen sc1
    s_waitcnt vmcnt(14)
    s_waitcnt lgkmcnt(6)
    v_mfma_f32_32x32x16_bf16 v[180:195], v[148:151], v[64:67], v[180:195]
    ds_read_b64_tr_b16 v[164:165], v32 offset:10240
    ds_read_b64_tr_b16 v[166:167], v32 offset:10752
    s_waitcnt lgkmcnt(6)
    v_mfma_f32_32x32x16_bf16 v[196:211], v[152:155], v[64:67], v[196:211]
    ds_read_b64_tr_b16 v[168:169], v33 offset:10240
    ds_read_b64_tr_b16 v[170:171], v33 offset:10752
    s_mov_b32 s83, 11346944
    buffer_load_dwordx4 v[124:127], v7, s[64:67], s83 offen sc1
    s_mov_b32 s83, 11412992
    buffer_load_dwordx4 v[128:131], v7, s[64:67], s83 offen sc1
    s_waitcnt vmcnt(15)
    s_waitcnt lgkmcnt(6)
    v_mfma_f32_32x32x16_bf16 v[180:195], v[156:159], v[68:71], v[180:195]
    ds_read_b64_tr_b16 v[148:149], v32 offset:12288
    ds_read_b64_tr_b16 v[150:151], v32 offset:12800
    s_waitcnt lgkmcnt(6)
    v_mfma_f32_32x32x16_bf16 v[196:211], v[160:163], v[68:71], v[196:211]
    ds_read_b64_tr_b16 v[152:153], v33 offset:12288
    ds_read_b64_tr_b16 v[154:155], v33 offset:12800
    s_mov_b32 s83, 11479040
    buffer_load_dwordx4 v[132:135], v7, s[64:67], s83 offen sc1
    s_mov_b32 s83, 11545088
    buffer_load_dwordx4 v[136:139], v7, s[64:67], s83 offen sc1
    s_waitcnt vmcnt(16)
    s_waitcnt lgkmcnt(6)
    v_mfma_f32_32x32x16_bf16 v[180:195], v[164:167], v[72:75], v[180:195]
    ds_read_b64_tr_b16 v[156:157], v32 offset:14336
    ds_read_b64_tr_b16 v[158:159], v32 offset:14848
    s_waitcnt lgkmcnt(6)
    v_mfma_f32_32x32x16_bf16 v[196:211], v[168:171], v[72:75], v[196:211]
    ds_read_b64_tr_b16 v[160:161], v33 offset:14336
    ds_read_b64_tr_b16 v[162:163], v33 offset:14848
    s_mov_b32 s83, 11611136
    buffer_load_dwordx4 v[140:143], v7, s[64:67], s83 offen sc1
    s_mov_b32 s83, 11677184
    buffer_load_dwordx4 v[144:147], v7, s[64:67], s83 offen sc1
    v_add_u32 v32, 16384, v30
    v_add_u32 v33, 16384, v31
    s_waitcnt vmcnt(17)
    s_waitcnt lgkmcnt(6)
    v_mfma_f32_32x32x16_bf16 v[180:195], v[148:151], v[76:79], v[180:195]
    ds_read_b64_tr_b16 v[164:165], v32 offset:0
    ds_read_b64_tr_b16 v[166:167], v32 offset:512
    s_waitcnt lgkmcnt(6)
    v_mfma_f32_32x32x16_bf16 v[196:211], v[152:155], v[76:79], v[196:211]
    ds_read_b64_tr_b16 v[168:169], v33 offset:0
    ds_read_b64_tr_b16 v[170:171], v33 offset:512
    s_mov_b32 s83, 11743232
    buffer_load_dwordx4 v[52:55], v7, s[64:67], s83 offen sc1
    s_mov_b32 s83, 11809280
    buffer_load_dwordx4 v[56:59], v7, s[64:67], s83 offen sc1
    s_waitcnt vmcnt(18)
    s_waitcnt lgkmcnt(6)
    v_mfma_f32_32x32x16_bf16 v[180:195], v[156:159], v[80:83], v[180:195]
    ds_read_b64_tr_b16 v[148:149], v32 offset:2048
    ds_read_b64_tr_b16 v[150:151], v32 offset:2560
    s_waitcnt lgkmcnt(6)
    v_mfma_f32_32x32x16_bf16 v[196:211], v[160:163], v[80:83], v[196:211]
    ds_read_b64_tr_b16 v[152:153], v33 offset:2048
    ds_read_b64_tr_b16 v[154:155], v33 offset:2560
    s_mov_b32 s83, 11875328
    buffer_load_dwordx4 v[60:63], v7, s[64:67], s83 offen sc1
    s_mov_b32 s83, 11941376
    buffer_load_dwordx4 v[64:67], v7, s[64:67], s83 offen sc1
    s_waitcnt vmcnt(19)
    s_waitcnt lgkmcnt(6)
    v_mfma_f32_32x32x16_bf16 v[180:195], v[164:167], v[84:87], v[180:195]
    ds_read_b64_tr_b16 v[156:157], v32 offset:4096
    ds_read_b64_tr_b16 v[158:159], v32 offset:4608
    s_waitcnt lgkmcnt(6)
    v_mfma_f32_32x32x16_bf16 v[196:211], v[168:171], v[84:87], v[196:211]
    ds_read_b64_tr_b16 v[160:161], v33 offset:4096
    ds_read_b64_tr_b16 v[162:163], v33 offset:4608
    s_mov_b32 s83, 12007424
    buffer_load_dwordx4 v[68:71], v7, s[64:67], s83 offen sc1
    s_mov_b32 s83, 12073472
    buffer_load_dwordx4 v[72:75], v7, s[64:67], s83 offen sc1
    s_waitcnt vmcnt(20)
    s_waitcnt lgkmcnt(6)
    v_mfma_f32_32x32x16_bf16 v[180:195], v[148:151], v[88:91], v[180:195]
    ds_read_b64_tr_b16 v[164:165], v32 offset:6144
    ds_read_b64_tr_b16 v[166:167], v32 offset:6656
    s_waitcnt lgkmcnt(6)
    v_mfma_f32_32x32x16_bf16 v[196:211], v[152:155], v[88:91], v[196:211]
    ds_read_b64_tr_b16 v[168:169], v33 offset:6144
    ds_read_b64_tr_b16 v[170:171], v33 offset:6656
    s_mov_b32 s83, 12139520
    buffer_load_dwordx4 v[76:79], v7, s[64:67], s83 offen sc1
    s_mov_b32 s83, 12205568
    buffer_load_dwordx4 v[80:83], v7, s[64:67], s83 offen sc1
    s_waitcnt vmcnt(21)
    s_waitcnt lgkmcnt(6)
    v_mfma_f32_32x32x16_bf16 v[180:195], v[156:159], v[92:95], v[180:195]
    ds_read_b64_tr_b16 v[148:149], v32 offset:8192
    ds_read_b64_tr_b16 v[150:151], v32 offset:8704
    s_waitcnt lgkmcnt(6)
    v_mfma_f32_32x32x16_bf16 v[196:211], v[160:163], v[92:95], v[196:211]
    ds_read_b64_tr_b16 v[152:153], v33 offset:8192
    ds_read_b64_tr_b16 v[154:155], v33 offset:8704
    s_mov_b32 s83, 12271616
    buffer_load_dwordx4 v[84:87], v7, s[64:67], s83 offen sc1
    s_mov_b32 s83, 12337664
    buffer_load_dwordx4 v[88:91], v7, s[64:67], s83 offen sc1
    s_waitcnt vmcnt(22)
    s_waitcnt lgkmcnt(6)
    v_mfma_f32_32x32x16_bf16 v[180:195], v[164:167], v[96:99], v[180:195]
    ds_read_b64_tr_b16 v[156:157], v32 offset:10240
    ds_read_b64_tr_b16 v[158:159], v32 offset:10752
    s_waitcnt lgkmcnt(6)
    v_mfma_f32_32x32x16_bf16 v[196:211], v[168:171], v[96:99], v[196:211]
    ds_read_b64_tr_b16 v[160:161], v33 offset:10240
    ds_read_b64_tr_b16 v[162:163], v33 offset:10752
    s_mov_b32 s83, 12403712
    buffer_load_dwordx4 v[92:95], v7, s[64:67], s83 offen sc1
    s_mov_b32 s83, 12469760
    buffer_load_dwordx4 v[96:99], v7, s[64:67], s83 offen sc1
    s_waitcnt vmcnt(23)
    s_waitcnt lgkmcnt(6)
    v_mfma_f32_32x32x16_bf16 v[180:195], v[148:151], v[100:103], v[180:195]
    ds_read_b64_tr_b16 v[164:165], v32 offset:12288
    ds_read_b64_tr_b16 v[166:167], v32 offset:12800
    s_waitcnt lgkmcnt(6)
    v_mfma_f32_32x32x16_bf16 v[196:211], v[152:155], v[100:103], v[196:211]
    ds_read_b64_tr_b16 v[168:169], v33 offset:12288
    ds_read_b64_tr_b16 v[170:171], v33 offset:12800
    s_mov_b32 s83, 12535808
    buffer_load_dwordx4 v[100:103], v7, s[64:67], s83 offen sc1
    s_waitcnt vmcnt(23)
    s_waitcnt lgkmcnt(6)
    v_mfma_f32_32x32x16_bf16 v[180:195], v[156:159], v[104:107], v[180:195]
    ds_read_b64_tr_b16 v[148:149], v32 offset:14336
    ds_read_b64_tr_b16 v[150:151], v32 offset:14848
    s_waitcnt lgkmcnt(6)
    v_mfma_f32_32x32x16_bf16 v[196:211], v[160:163], v[104:107], v[196:211]
    ds_read_b64_tr_b16 v[152:153], v33 offset:14336
    ds_read_b64_tr_b16 v[154:155], v33 offset:14848
    s_mov_b32 s83, 12601856
    buffer_load_dwordx4 v[104:107], v7, s[64:67], s83 offen sc1
    v_add_u32 v32, 32768, v30
    v_add_u32 v33, 32768, v31
    s_waitcnt vmcnt(23)
    s_waitcnt lgkmcnt(6)
    v_mfma_f32_32x32x16_bf16 v[180:195], v[164:167], v[108:111], v[180:195]
    ds_read_b64_tr_b16 v[156:157], v32 offset:0
    ds_read_b64_tr_b16 v[158:159], v32 offset:512
    s_waitcnt lgkmcnt(6)
    v_mfma_f32_32x32x16_bf16 v[196:211], v[168:171], v[108:111], v[196:211]
    ds_read_b64_tr_b16 v[160:161], v33 offset:0
    ds_read_b64_tr_b16 v[162:163], v33 offset:512
    s_mov_b32 s83, 12667904
    buffer_load_dwordx4 v[108:111], v7, s[64:67], s83 offen sc1
    s_waitcnt vmcnt(23)
    s_waitcnt lgkmcnt(6)
    v_mfma_f32_32x32x16_bf16 v[180:195], v[148:151], v[112:115], v[180:195]
    ds_read_b64_tr_b16 v[164:165], v32 offset:2048
    ds_read_b64_tr_b16 v[166:167], v32 offset:2560
    s_waitcnt lgkmcnt(6)
    v_mfma_f32_32x32x16_bf16 v[196:211], v[152:155], v[112:115], v[196:211]
    ds_read_b64_tr_b16 v[168:169], v33 offset:2048
    ds_read_b64_tr_b16 v[170:171], v33 offset:2560
    s_mov_b32 s83, 12733952
    buffer_load_dwordx4 v[112:115], v7, s[64:67], s83 offen sc1
    s_waitcnt vmcnt(23)
    s_waitcnt lgkmcnt(6)
    v_mfma_f32_32x32x16_bf16 v[180:195], v[156:159], v[116:119], v[180:195]
    ds_read_b64_tr_b16 v[148:149], v32 offset:4096
    ds_read_b64_tr_b16 v[150:151], v32 offset:4608
    s_waitcnt lgkmcnt(6)
    v_mfma_f32_32x32x16_bf16 v[196:211], v[160:163], v[116:119], v[196:211]
    ds_read_b64_tr_b16 v[152:153], v33 offset:4096
    ds_read_b64_tr_b16 v[154:155], v33 offset:4608
    s_waitcnt vmcnt(22)
    s_waitcnt lgkmcnt(6)
    v_mfma_f32_32x32x16_bf16 v[180:195], v[164:167], v[120:123], v[180:195]
    ds_read_b64_tr_b16 v[156:157], v32 offset:6144
    ds_read_b64_tr_b16 v[158:159], v32 offset:6656
    s_waitcnt lgkmcnt(6)
    v_mfma_f32_32x32x16_bf16 v[196:211], v[168:171], v[120:123], v[196:211]
    ds_read_b64_tr_b16 v[160:161], v33 offset:6144
    ds_read_b64_tr_b16 v[162:163], v33 offset:6656
    s_waitcnt vmcnt(21)
    s_waitcnt lgkmcnt(6)
    v_mfma_f32_32x32x16_bf16 v[180:195], v[148:151], v[124:127], v[180:195]
    ds_read_b64_tr_b16 v[164:165], v32 offset:8192
    ds_read_b64_tr_b16 v[166:167], v32 offset:8704
    s_waitcnt lgkmcnt(6)
    v_mfma_f32_32x32x16_bf16 v[196:211], v[152:155], v[124:127], v[196:211]
    ds_read_b64_tr_b16 v[168:169], v33 offset:8192
    ds_read_b64_tr_b16 v[170:171], v33 offset:8704
    s_waitcnt vmcnt(20)
    s_waitcnt lgkmcnt(6)
    v_mfma_f32_32x32x16_bf16 v[180:195], v[156:159], v[128:131], v[180:195]
    ds_read_b64_tr_b16 v[148:149], v32 offset:10240
    ds_read_b64_tr_b16 v[150:151], v32 offset:10752
    s_waitcnt lgkmcnt(6)
    v_mfma_f32_32x32x16_bf16 v[196:211], v[160:163], v[128:131], v[196:211]
    ds_read_b64_tr_b16 v[152:153], v33 offset:10240
    ds_read_b64_tr_b16 v[154:155], v33 offset:10752
    s_waitcnt vmcnt(19)
    s_waitcnt lgkmcnt(6)
    v_mfma_f32_32x32x16_bf16 v[180:195], v[164:167], v[132:135], v[180:195]
    ds_read_b64_tr_b16 v[156:157], v32 offset:12288
    ds_read_b64_tr_b16 v[158:159], v32 offset:12800
    s_waitcnt lgkmcnt(6)
    v_mfma_f32_32x32x16_bf16 v[196:211], v[168:171], v[132:135], v[196:211]
    ds_read_b64_tr_b16 v[160:161], v33 offset:12288
    ds_read_b64_tr_b16 v[162:163], v33 offset:12800
    s_waitcnt vmcnt(18)
    s_waitcnt lgkmcnt(6)
    v_mfma_f32_32x32x16_bf16 v[180:195], v[148:151], v[136:139], v[180:195]
    ds_read_b64_tr_b16 v[164:165], v32 offset:14336
    ds_read_b64_tr_b16 v[166:167], v32 offset:14848
    s_waitcnt lgkmcnt(6)
    v_mfma_f32_32x32x16_bf16 v[196:211], v[152:155], v[136:139], v[196:211]
    ds_read_b64_tr_b16 v[168:169], v33 offset:14336
    ds_read_b64_tr_b16 v[170:171], v33 offset:14848
    v_add_u32 v32, 49152, v30
    v_add_u32 v33, 49152, v31
    s_waitcnt vmcnt(17)
    s_waitcnt lgkmcnt(6)
    v_mfma_f32_32x32x16_bf16 v[180:195], v[156:159], v[140:143], v[180:195]
    ds_read_b64_tr_b16 v[148:149], v32 offset:0
    ds_read_b64_tr_b16 v[150:151], v32 offset:512
    s_waitcnt lgkmcnt(6)
    v_mfma_f32_32x32x16_bf16 v[196:211], v[160:163], v[140:143], v[196:211]
    ds_read_b64_tr_b16 v[152:153], v33 offset:0
    ds_read_b64_tr_b16 v[154:155], v33 offset:512
    s_waitcnt vmcnt(16)
    s_waitcnt lgkmcnt(6)
    v_mfma_f32_32x32x16_bf16 v[180:195], v[164:167], v[144:147], v[180:195]
    ds_read_b64_tr_b16 v[156:157], v32 offset:2048
    ds_read_b64_tr_b16 v[158:159], v32 offset:2560
    s_waitcnt lgkmcnt(6)
    v_mfma_f32_32x32x16_bf16 v[196:211], v[168:171], v[144:147], v[196:211]
    ds_read_b64_tr_b16 v[160:161], v33 offset:2048
    ds_read_b64_tr_b16 v[162:163], v33 offset:2560
    s_waitcnt vmcnt(15)
    s_waitcnt lgkmcnt(6)
    v_mfma_f32_32x32x16_bf16 v[180:195], v[148:151], v[52:55], v[180:195]
    ds_read_b64_tr_b16 v[164:165], v32 offset:4096
    ds_read_b64_tr_b16 v[166:167], v32 offset:4608
    s_waitcnt lgkmcnt(6)
    v_mfma_f32_32x32x16_bf16 v[196:211], v[152:155], v[52:55], v[196:211]
    ds_read_b64_tr_b16 v[168:169], v33 offset:4096
    ds_read_b64_tr_b16 v[170:171], v33 offset:4608
    s_waitcnt vmcnt(14)
    s_waitcnt lgkmcnt(6)
    v_mfma_f32_32x32x16_bf16 v[180:195], v[156:159], v[56:59], v[180:195]
    ds_read_b64_tr_b16 v[148:149], v32 offset:6144
    ds_read_b64_tr_b16 v[150:151], v32 offset:6656
    s_waitcnt lgkmcnt(6)
    v_mfma_f32_32x32x16_bf16 v[196:211], v[160:163], v[56:59], v[196:211]
    ds_read_b64_tr_b16 v[152:153], v33 offset:6144
    ds_read_b64_tr_b16 v[154:155], v33 offset:6656
    s_waitcnt vmcnt(13)
    s_waitcnt lgkmcnt(6)
    v_mfma_f32_32x32x16_bf16 v[180:195], v[164:167], v[60:63], v[180:195]
    ds_read_b64_tr_b16 v[156:157], v32 offset:8192
    ds_read_b64_tr_b16 v[158:159], v32 offset:8704
    s_waitcnt lgkmcnt(6)
    v_mfma_f32_32x32x16_bf16 v[196:211], v[168:171], v[60:63], v[196:211]
    ds_read_b64_tr_b16 v[160:161], v33 offset:8192
    ds_read_b64_tr_b16 v[162:163], v33 offset:8704
    s_waitcnt vmcnt(12)
    s_waitcnt lgkmcnt(6)
    v_mfma_f32_32x32x16_bf16 v[180:195], v[148:151], v[64:67], v[180:195]
    ds_read_b64_tr_b16 v[164:165], v32 offset:10240
    ds_read_b64_tr_b16 v[166:167], v32 offset:10752
    s_waitcnt lgkmcnt(6)
    v_mfma_f32_32x32x16_bf16 v[196:211], v[152:155], v[64:67], v[196:211]
    ds_read_b64_tr_b16 v[168:169], v33 offset:10240
    ds_read_b64_tr_b16 v[170:171], v33 offset:10752
    s_waitcnt vmcnt(11)
    s_waitcnt lgkmcnt(6)
    v_mfma_f32_32x32x16_bf16 v[180:195], v[156:159], v[68:71], v[180:195]
    ds_read_b64_tr_b16 v[148:149], v32 offset:12288
    ds_read_b64_tr_b16 v[150:151], v32 offset:12800
    s_waitcnt lgkmcnt(6)
    v_mfma_f32_32x32x16_bf16 v[196:211], v[160:163], v[68:71], v[196:211]
    ds_read_b64_tr_b16 v[152:153], v33 offset:12288
    ds_read_b64_tr_b16 v[154:155], v33 offset:12800
    s_waitcnt vmcnt(10)
    s_waitcnt lgkmcnt(6)
    v_mfma_f32_32x32x16_bf16 v[180:195], v[164:167], v[72:75], v[180:195]
    ds_read_b64_tr_b16 v[156:157], v32 offset:14336
    ds_read_b64_tr_b16 v[158:159], v32 offset:14848
    s_waitcnt lgkmcnt(6)
    v_mfma_f32_32x32x16_bf16 v[196:211], v[168:171], v[72:75], v[196:211]
    ds_read_b64_tr_b16 v[160:161], v33 offset:14336
    ds_read_b64_tr_b16 v[162:163], v33 offset:14848
    v_add_u32 v32, 65536, v30
    v_add_u32 v33, 65536, v31
    s_waitcnt vmcnt(9)
    s_waitcnt lgkmcnt(6)
    v_mfma_f32_32x32x16_bf16 v[180:195], v[148:151], v[76:79], v[180:195]
    ds_read_b64_tr_b16 v[164:165], v32 offset:0
    ds_read_b64_tr_b16 v[166:167], v32 offset:512
    s_waitcnt lgkmcnt(6)
    v_mfma_f32_32x32x16_bf16 v[196:211], v[152:155], v[76:79], v[196:211]
    ds_read_b64_tr_b16 v[168:169], v33 offset:0
    ds_read_b64_tr_b16 v[170:171], v33 offset:512
    s_waitcnt vmcnt(8)
    s_waitcnt lgkmcnt(6)
    v_mfma_f32_32x32x16_bf16 v[180:195], v[156:159], v[80:83], v[180:195]
    ds_read_b64_tr_b16 v[148:149], v32 offset:2048
    ds_read_b64_tr_b16 v[150:151], v32 offset:2560
    s_waitcnt lgkmcnt(6)
    v_mfma_f32_32x32x16_bf16 v[196:211], v[160:163], v[80:83], v[196:211]
    ds_read_b64_tr_b16 v[152:153], v33 offset:2048
    ds_read_b64_tr_b16 v[154:155], v33 offset:2560
    s_waitcnt vmcnt(7)
    s_waitcnt lgkmcnt(6)
    v_mfma_f32_32x32x16_bf16 v[180:195], v[164:167], v[84:87], v[180:195]
    ds_read_b64_tr_b16 v[156:157], v32 offset:4096
    ds_read_b64_tr_b16 v[158:159], v32 offset:4608
    s_waitcnt lgkmcnt(6)
    v_mfma_f32_32x32x16_bf16 v[196:211], v[168:171], v[84:87], v[196:211]
    ds_read_b64_tr_b16 v[160:161], v33 offset:4096
    ds_read_b64_tr_b16 v[162:163], v33 offset:4608
    s_waitcnt vmcnt(6)
    s_waitcnt lgkmcnt(6)
    v_mfma_f32_32x32x16_bf16 v[180:195], v[148:151], v[88:91], v[180:195]
    ds_read_b64_tr_b16 v[164:165], v32 offset:6144
    ds_read_b64_tr_b16 v[166:167], v32 offset:6656
    s_waitcnt lgkmcnt(6)
    v_mfma_f32_32x32x16_bf16 v[196:211], v[152:155], v[88:91], v[196:211]
    ds_read_b64_tr_b16 v[168:169], v33 offset:6144
    ds_read_b64_tr_b16 v[170:171], v33 offset:6656
    s_waitcnt vmcnt(5)
    s_waitcnt lgkmcnt(6)
    v_mfma_f32_32x32x16_bf16 v[180:195], v[156:159], v[92:95], v[180:195]
    ds_read_b64_tr_b16 v[148:149], v32 offset:8192
    ds_read_b64_tr_b16 v[150:151], v32 offset:8704
    s_waitcnt lgkmcnt(6)
    v_mfma_f32_32x32x16_bf16 v[196:211], v[160:163], v[92:95], v[196:211]
    ds_read_b64_tr_b16 v[152:153], v33 offset:8192
    ds_read_b64_tr_b16 v[154:155], v33 offset:8704
    s_waitcnt vmcnt(4)
    s_waitcnt lgkmcnt(6)
    v_mfma_f32_32x32x16_bf16 v[180:195], v[164:167], v[96:99], v[180:195]
    ds_read_b64_tr_b16 v[156:157], v32 offset:10240
    ds_read_b64_tr_b16 v[158:159], v32 offset:10752
    s_waitcnt lgkmcnt(6)
    v_mfma_f32_32x32x16_bf16 v[196:211], v[168:171], v[96:99], v[196:211]
    ds_read_b64_tr_b16 v[160:161], v33 offset:10240
    ds_read_b64_tr_b16 v[162:163], v33 offset:10752
    s_waitcnt vmcnt(3)
    s_waitcnt lgkmcnt(6)
    v_mfma_f32_32x32x16_bf16 v[180:195], v[148:151], v[100:103], v[180:195]
    ds_read_b64_tr_b16 v[164:165], v32 offset:12288
    ds_read_b64_tr_b16 v[166:167], v32 offset:12800
    s_waitcnt lgkmcnt(6)
    v_mfma_f32_32x32x16_bf16 v[196:211], v[152:155], v[100:103], v[196:211]
    ds_read_b64_tr_b16 v[168:169], v33 offset:12288
    ds_read_b64_tr_b16 v[170:171], v33 offset:12800
    s_waitcnt vmcnt(2)
    s_waitcnt lgkmcnt(6)
    v_mfma_f32_32x32x16_bf16 v[180:195], v[156:159], v[104:107], v[180:195]
    ds_read_b64_tr_b16 v[148:149], v32 offset:14336
    ds_read_b64_tr_b16 v[150:151], v32 offset:14848
    s_waitcnt lgkmcnt(6)
    v_mfma_f32_32x32x16_bf16 v[196:211], v[160:163], v[104:107], v[196:211]
    ds_read_b64_tr_b16 v[152:153], v33 offset:14336
    ds_read_b64_tr_b16 v[154:155], v33 offset:14848
    s_mul_i32 s85, s80, 264192
    s_add_u32 s85, s85, 13901824
    s_waitcnt vmcnt(1)
    s_waitcnt lgkmcnt(6)
    v_mfma_f32_32x32x16_bf16 v[180:195], v[164:167], v[108:111], v[180:195]
    s_waitcnt lgkmcnt(4)
    v_mfma_f32_32x32x16_bf16 v[196:211], v[168:171], v[108:111], v[196:211]
    s_waitcnt vmcnt(0)
    s_waitcnt lgkmcnt(2)
    v_mfma_f32_32x32x16_bf16 v[180:195], v[148:151], v[112:115], v[180:195]
    s_waitcnt lgkmcnt(0)
    v_mfma_f32_32x32x16_bf16 v[196:211], v[152:155], v[112:115], v[196:211]
    s_nop 9
    s_nop 0
    v_cvt_pk_bf16_f32 v52, v180, v181
    v_cvt_pk_bf16_f32 v53, v182, v183
    v_cvt_pk_bf16_f32 v54, v184, v185
    v_cvt_pk_bf16_f32 v55, v186, v187
    v_cvt_pk_bf16_f32 v56, v188, v189
    v_cvt_pk_bf16_f32 v57, v190, v191
    v_cvt_pk_bf16_f32 v58, v192, v193
    v_cvt_pk_bf16_f32 v59, v194, v195
    s_add_u32 s83, s85, 0
    s_add_u32 s84, s85, 66048
    buffer_store_dwordx4 v[52:55], v7, s[64:67], s83 offen sc1
    buffer_store_dwordx4 v[56:59], v7, s[64:67], s84 offen sc1
    s_nop 0
    v_cvt_pk_bf16_f32 v60, v196, v197
    v_cvt_pk_bf16_f32 v61, v198, v199
    v_cvt_pk_bf16_f32 v62, v200, v201
    v_cvt_pk_bf16_f32 v63, v202, v203
    v_cvt_pk_bf16_f32 v64, v204, v205
    v_cvt_pk_bf16_f32 v65, v206, v207
    v_cvt_pk_bf16_f32 v66, v208, v209
    v_cvt_pk_bf16_f32 v67, v210, v211
    s_add_u32 s83, s85, 132096
    s_add_u32 s84, s85, 198144
    buffer_store_dwordx4 v[60:63], v7, s[64:67], s83 offen sc1
    buffer_store_dwordx4 v[64:67], v7, s[64:67], s84 offen sc1
    s_lshl_b32 s85, s79, 2
    s_add_u32 s85, s85, s72
    s_mul_i32 s83, s85, 2048
    s_lshl_b32 s84, s80, 7
    s_add_u32 s83, s83, s84
    s_add_u32 s83, s83, 22282240
    s_waitcnt vmcnt(0)
    s_mov_b64 exec, 1
    s_cmp_lg_u32 s100, 0
    s_cbranch_scc1 SLOW_118
    buffer_store_dword v2, off, s[64:67], s83
    s_branch STE_119
SLOW_118:
    buffer_store_dword v2, off, s[64:67], s83 sc1
STE_119:
    s_mov_b64 exec, -1
    s_endpgm
DO_T4:
    s_cmp_lg_u32 s92, 0
    s_cbranch_scc1 SK_120
    s_mov_b32 s90, 200000
    s_mov_b64 exec, 0x1
POLL_121:
    buffer_load_dword v52, v229, s[64:67], 0 offen sc1
    s_waitcnt vmcnt(0)
    v_cmp_ne_u32 vcc, s73, v52
    s_cbranch_vccz POLLD_122
    s_sub_u32 s90, s90, 1
    s_cmp_lg_u32 s90, 0
    s_cbranch_scc1 POLL_121
POLLD_122:
    s_mov_b64 exec, -1
    s_add_u32 s83, s93, 0
    s_mul_i32 s83, s83, 132096
    s_add_u32 s83, s83, 4784128
    buffer_load_dwordx4 v[180:183], v228, s[64:67], s83 offen offset:0 sc1
    buffer_load_dwordx4 v[184:187], v228, s[64:67], s83 offen offset:256 sc1
    buffer_load_dwordx4 v[188:191], v228, s[64:67], s83 offen offset:512 sc1
    buffer_load_dwordx4 v[192:195], v228, s[64:67], s83 offen offset:768 sc1
    s_add_u32 s83, s93, 1
    s_mul_i32 s83, s83, 132096
    s_add_u32 s83, s83, 4784128
    buffer_load_dwordx4 v[196:199], v228, s[64:67], s83 offen offset:0 sc1
    buffer_load_dwordx4 v[200:203], v228, s[64:67], s83 offen offset:256 sc1
    buffer_load_dwordx4 v[204:207], v228, s[64:67], s83 offen offset:512 sc1
    buffer_load_dwordx4 v[208:211], v228, s[64:67], s83 offen offset:768 sc1
    s_add_u32 s83, s93, 2
    s_mul_i32 s83, s83, 132096
    s_add_u32 s83, s83, 4784128
    buffer_load_dwordx4 v[212:215], v228, s[64:67], s83 offen offset:0 sc1
    buffer_load_dwordx4 v[216:219], v228, s[64:67], s83 offen offset:256 sc1
    buffer_load_dwordx4 v[220:223], v228, s[64:67], s83 offen offset:512 sc1
    buffer_load_dwordx4 v[224:227], v228, s[64:67], s83 offen offset:768 sc1
SK_120:
    s_lshl_b32 s83, s99, 7
    s_add_u32 s83, s83, 22241280
    v_mul_u32_u24 v3, 2048, v1
    v_add_u32 v229, s83, v3
    s_lshl_b32 s83, s72, 6
    v_add_u32 v3, s83, v1
    s_mul_i32 s84, s99, 6400
    v_lshl_add_u32 v52, v3, 4, s84
    v_lshlrev_b32_e64 v54, 3, v3
    v_add_u32 v54, 81920, v54
    s_mul_i32 s85, s99, 320
    s_add_u32 s85, s85, 48896
    v_lshl_add_u32 v4, v3, 4, s85
    v_add_u32 v53, 4096, v52
    v_cmp_lt_u32 vcc, 143, v3
    s_nop 1
    v_cndmask_b32 v53, v53, v4, vcc
    v_mov_b32 v4, 2147483648
    v_cmp_lt_u32 vcc, 163, v3
    s_nop 1
    v_cndmask_b32 v53, v53, v4, vcc
    v_lshlrev_b32_e64 v3, 4, v1
    v_add_u32 v3, 147456, v3
    ds_read_b128 v[120:123], v3 offset:0
    ds_read_b128 v[124:127], v3 offset:1024
    ds_read_b128 v[128:131], v3 offset:2048
    ds_read_b128 v[132:135], v3 offset:3072
    ds_read_b128 v[136:139], v3 offset:4096
    ds_read_b128 v[140:143], v3 offset:5120
    ds_read_b128 v[144:147], v3 offset:6144
    ds_read_b128 v[148:151], v3 offset:7168
    s_waitcnt lgkmcnt(0)
    s_cmp_lg_u32 s72, 0
    s_cbranch_scc1 SK_123
    s_mov_b32 s90, 200000
    s_mov_b64 exec, 0xff
POLL_124:
    buffer_load_dword v55, v229, s[64:67], 0 offen sc1
    s_waitcnt vmcnt(0)
    v_cmp_ne_u32 vcc, s73, v55
    s_cbranch_vccz POLLD_125
    s_sub_u32 s90, s90, 1
    s_cmp_lg_u32 s90, 0
    s_cbranch_scc1 POLL_124
POLLD_125:
    s_mov_b64 exec, -1
SK_123:
    s_barrier
    s_mov_b32 s83, 524288
    buffer_load_dwordx4 v[56:59], v52, s[64:67], s83 offen sc1
    buffer_load_dwordx4 v[60:63], v53, s[64:67], s83 offen sc1
    s_mov_b32 s83, 578048
    buffer_load_dwordx4 v[64:67], v52, s[64:67], s83 offen sc1
    buffer_load_dwordx4 v[68:71], v53, s[64:67], s83 offen sc1
    s_mov_b32 s83, 631808
    buffer_load_dwordx4 v[72:75], v52, s[64:67], s83 offen sc1
    buffer_load_dwordx4 v[76:79], v53, s[64:67], s83 offen sc1
    s_mov_b32 s83, 685568
    buffer_load_dwordx4 v[80:83], v52, s[64:67], s83 offen sc1
    buffer_load_dwordx4 v[84:87], v53, s[64:67], s83 offen sc1
    s_mov_b32 s83, 739328
    buffer_load_dwordx4 v[88:91], v52, s[64:67], s83 offen sc1
    buffer_load_dwordx4 v[92:95], v53, s[64:67], s83 offen sc1
    s_mov_b32 s83, 793088
    buffer_load_dwordx4 v[96:99], v52, s[64:67], s83 offen sc1
    buffer_load_dwordx4 v[100:103], v53, s[64:67], s83 offen sc1
    s_mov_b32 s83, 846848
    buffer_load_dwordx4 v[104:107], v52, s[64:67], s83 offen sc1
    buffer_load_dwordx4 v[108:111], v53, s[64:67], s83 offen sc1
    s_mov_b32 s83, 900608
    buffer_load_dwordx4 v[112:115], v52, s[64:67], s83 offen sc1
    buffer_load_dwordx4 v[116:119], v53, s[64:67], s83 offen sc1
    s_waitcnt vmcnt(12)
    v_pk_add_f32 v[56:57], v[56:57], v[64:65]
    v_pk_add_f32 v[58:59], v[58:59], v[66:67]
    v_pk_add_f32 v[60:61], v[60:61], v[68:69]
    v_pk_add_f32 v[62:63], v[62:63], v[70:71]
    s_waitcnt vmcnt(10)
    v_pk_add_f32 v[56:57], v[56:57], v[72:73]
    v_pk_add_f32 v[58:59], v[58:59], v[74:75]
    v_pk_add_f32 v[60:61], v[60:61], v[76:77]
    v_pk_add_f32 v[62:63], v[62:63], v[78:79]
    s_waitcnt vmcnt(8)
    v_pk_add_f32 v[56:57], v[56:57], v[80:81]
    v_pk_add_f32 v[58:59], v[58:59], v[82:83]
    v_pk_add_f32 v[60:61], v[60:61], v[84:85]
    v_pk_add_f32 v[62:63], v[62:63], v[86:87]
    s_waitcnt vmcnt(6)
    v_pk_add_f32 v[56:57], v[56:57], v[88:89]
    v_pk_add_f32 v[58:59], v[58:59], v[90:91]
    v_pk_add_f32 v[60:61], v[60:61], v[92:93]
    v_pk_add_f32 v[62:63], v[62:63], v[94:95]
    s_waitcnt vmcnt(4)
    v_pk_add_f32 v[56:57], v[56:57], v[96:97]
    v_pk_add_f32 v[58:59], v[58:59], v[98:99]
    v_pk_add_f32 v[60:61], v[60:61], v[100:101]
    v_pk_add_f32 v[62:63], v[62:63], v[102:103]
    s_waitcnt vmcnt(2)
    v_pk_add_f32 v[56:57], v[56:57], v[104:105]
    v_pk_add_f32 v[58:59], v[58:59], v[106:107]
    v_pk_add_f32 v[60:61], v[60:61], v[108:109]
    v_pk_add_f32 v[62:63], v[62:63], v[110:111]
    s_waitcnt vmcnt(0)
    v_pk_add_f32 v[56:57], v[56:57], v[112:113]
    v_pk_add_f32 v[58:59], v[58:59], v[114:115]
    v_pk_add_f32 v[60:61], v[60:61], v[116:117]
    v_pk_add_f32 v[62:63], v[62:63], v[118:119]
    v_cvt_pk_bf16_f32 v64, v56, v57
    v_cvt_pk_bf16_f32 v65, v58, v59
    v_cvt_pk_bf16_f32 v66, v60, v61
    v_cvt_pk_bf16_f32 v67, v62, v63
    ds_write_b64 v54, v[64:65]
    ds_write_b64 v54, v[66:67] offset:2048
    s_waitcnt lgkmcnt(0)
    s_barrier
    ds_read_b64 v[100:101], v142
    ds_read_b64 v[102:103], v143
    ds_read_b64 v[104:105], v144
    ds_read_b64 v[106:107], v145
    ds_read_b64 v[108:109], v146
    ds_read_b64 v[110:111], v147
    ds_read_b64 v[112:113], v148
    ds_read_b64 v[114:115], v149
    ds_read_b64 v[116:117], v150
    ds_read_b64 v[118:119], v151
    ds_read_b64 v[56:57], v120
    ds_read_b64 v[58:59], v121
    ds_read_b64 v[60:61], v122
    ds_read_b64 v[62:63], v123
    ds_read_b64 v[64:65], v124
    ds_read_b64 v[66:67], v125
    ds_read_b64 v[68:69], v126
    ds_read_b64 v[70:71], v127
    ds_read_b64 v[72:73], v128
    ds_read_b64 v[74:75], v129
    ds_read_b64 v[76:77], v130
    ds_read_b64 v[78:79], v131
    ds_read_b64 v[80:81], v132
    ds_read_b64 v[82:83], v133
    ds_read_b64 v[84:85], v134
    ds_read_b64 v[86:87], v135
    ds_read_b64 v[88:89], v136
    ds_read_b64 v[90:91], v137
    ds_read_b64 v[92:93], v138
    ds_read_b64 v[94:95], v139
    ds_read_b64 v[96:97], v140
    ds_read_b64 v[98:99], v141
    s_mul_i32 s85, s99, 330240
    s_add_u32 s85, s85, 10158080
    s_waitcnt lgkmcnt(0)
    s_barrier
    v_mfma_f32_16x16x32_bf16 v[172:175], v[100:103], v[180:183], 0
    v_mfma_f32_16x16x32_bf16 v[172:175], v[104:107], v[196:199], v[172:175]
    v_mfma_f32_16x16x32_bf16 v[172:175], v[108:111], v[212:215], v[172:175]
    v_mfma_f32_16x16x32_bf16 v[176:179], v[112:115], v[196:199], 0
    v_mfma_f32_16x16x32_bf16 v[176:179], v[116:119], v[212:215], v[176:179]
    v_mfma_f32_16x16x32_bf16 v[152:155], v[56:59], v[180:183], 0
    v_mfma_f32_16x16x32_bf16 v[152:155], v[60:63], v[196:199], v[152:155]
    v_mfma_f32_16x16x32_bf16 v[156:159], v[64:67], v[180:183], 0
    v_mfma_f32_16x16x32_bf16 v[156:159], v[68:71], v[196:199], v[156:159]
    v_mfma_f32_16x16x32_bf16 v[160:163], v[72:75], v[180:183], 0
    v_mfma_f32_16x16x32_bf16 v[160:163], v[76:79], v[196:199], v[160:163]
    v_mfma_f32_16x16x32_bf16 v[160:163], v[80:83], v[212:215], v[160:163]
    v_mfma_f32_16x16x32_bf16 v[164:167], v[84:87], v[196:199], 0
    v_mfma_f32_16x16x32_bf16 v[164:167], v[88:91], v[212:215], v[164:167]
    v_mfma_f32_16x16x32_bf16 v[168:171], v[92:95], v[196:199], 0
    v_mfma_f32_16x16x32_bf16 v[168:171], v[96:99], v[212:215], v[168:171]
    v_mfma_f32_16x16x32_bf16 v[140:143], v[100:103], v[184:187], 0
    v_mfma_f32_16x16x32_bf16 v[140:143], v[104:107], v[200:203], v[140:143]
    v_mfma_f32_16x16x32_bf16 v[140:143], v[108:111], v[216:219], v[140:143]
    v_mfma_f32_16x16x32_bf16 v[144:147], v[112:115], v[200:203], 0
    v_add_f32 v172, 0x358637bd, v172
    v_add_f32 v173, 0x358637bd, v173
    v_add_f32 v174, 0x358637bd, v174
    v_mfma_f32_16x16x32_bf16 v[144:147], v[116:119], v[216:219], v[144:147]
    v_add_f32 v175, 0x358637bd, v175
    v_add_f32 v176, 0x358637bd, v176
    v_rcp_f32_e64 v172, v172
    v_mfma_f32_16x16x32_bf16 v[120:123], v[56:59], v[184:187], 0
    v_rcp_f32 v173, v173
    v_rcp_f32 v174, v174
    v_rcp_f32_e64 v175, v175
    v_mfma_f32_16x16x32_bf16 v[120:123], v[60:63], v[200:203], v[120:123]
    v_rcp_f32_e64 v176, v176
    v_pk_mul_f32 v[152:153], v[152:153], v[172:173] op_sel_hi:[1,0]
    v_pk_mul_f32 v[154:155], v[154:155], v[172:173] op_sel_hi:[1,0]
    v_mfma_f32_16x16x32_bf16 v[124:127], v[64:67], v[184:187], 0
    v_pk_mul_f32 v[156:157], v[156:157], v[172:173] op_sel:[0,1] op_sel_hi:[1,1]
    v_pk_mul_f32 v[158:159], v[158:159], v[172:173] op_sel:[0,1] op_sel_hi:[1,1]
    v_pk_mul_f32 v[160:161], v[160:161], v[174:175] op_sel_hi:[1,0]
    v_mfma_f32_16x16x32_bf16 v[124:127], v[68:71], v[200:203], v[124:127]
    v_pk_mul_f32 v[162:163], v[162:163], v[174:175] op_sel_hi:[1,0]
    v_pk_mul_f32 v[164:165], v[164:165], v[174:175] op_sel:[0,1] op_sel_hi:[1,1]
    v_pk_mul_f32 v[166:167], v[166:167], v[174:175] op_sel:[0,1] op_sel_hi:[1,1]
    v_mfma_f32_16x16x32_bf16 v[128:131], v[72:75], v[184:187], 0
    v_pk_mul_f32 v[168:169], v[168:169], v[176:177] op_sel_hi:[1,0]
    v_pk_mul_f32 v[170:171], v[170:171], v[176:177] op_sel_hi:[1,0]
    v_cvt_pk_bf16_f32 v32, v152, v153
    v_mfma_f32_16x16x32_bf16 v[128:131], v[76:79], v[200:203], v[128:131]
    v_cvt_pk_bf16_f32 v33, v154, v155
    v_cvt_pk_bf16_f32 v36, v156, v157
    v_cvt_pk_bf16_f32 v37, v158, v159
    v_mfma_f32_16x16x32_bf16 v[128:131], v[80:83], v[216:219], v[128:131]
    v_cvt_pk_bf16_f32 v40, v160, v161
    v_cvt_pk_bf16_f32 v41, v162, v163
    v_cvt_pk_bf16_f32 v44, v164, v165
    v_mfma_f32_16x16x32_bf16 v[132:135], v[84:87], v[200:203], 0
    v_cvt_pk_bf16_f32 v45, v166, v167
    v_cvt_pk_bf16_f32 v48, v168, v169
    v_cvt_pk_bf16_f32 v49, v170, v171
    v_mfma_f32_16x16x32_bf16 v[132:135], v[88:91], v[216:219], v[132:135]
    v_mfma_f32_16x16x32_bf16 v[136:139], v[92:95], v[200:203], 0
    v_mfma_f32_16x16x32_bf16 v[136:139], v[96:99], v[216:219], v[136:139]
    v_mfma_f32_16x16x32_bf16 v[172:175], v[100:103], v[188:191], 0
    v_mfma_f32_16x16x32_bf16 v[172:175], v[104:107], v[204:207], v[172:175]
    v_mfma_f32_16x16x32_bf16 v[172:175], v[108:111], v[220:223], v[172:175]
    v_mfma_f32_16x16x32_bf16 v[176:179], v[112:115], v[204:207], 0
    v_add_f32 v140, 0x358637bd, v140
    v_add_f32 v141, 0x358637bd, v141
    v_add_f32 v142, 0x358637bd, v142
    v_add_f32 v143, 0x358637bd, v143
    v_mfma_f32_16x16x32_bf16 v[176:179], v[116:119], v[220:223], v[176:179]
    v_add_f32 v144, 0x358637bd, v144
    v_rcp_f32 v140, v140
    v_rcp_f32 v141, v141
    v_rcp_f32_e64 v142, v142
    v_mfma_f32_16x16x32_bf16 v[152:155], v[56:59], v[188:191], 0
    v_rcp_f32 v143, v143
    v_rcp_f32 v144, v144
    v_pk_mul_f32 v[120:121], v[120:121], v[140:141] op_sel_hi:[1,0]
    v_pk_mul_f32 v[122:123], v[122:123], v[140:141] op_sel_hi:[1,0]
    v_mfma_f32_16x16x32_bf16 v[152:155], v[60:63], v[204:207], v[152:155]
    v_pk_mul_f32 v[124:125], v[124:125], v[140:141] op_sel:[0,1] op_sel_hi:[1,1]
    v_pk_mul_f32 v[126:127], v[126:127], v[140:141] op_sel:[0,1] op_sel_hi:[1,1]
    v_pk_mul_f32 v[128:129], v[128:129], v[142:143] op_sel_hi:[1,0]
    v_pk_mul_f32 v[130:131], v[130:131], v[142:143] op_sel_hi:[1,0]
    v_mfma_f32_16x16x32_bf16 v[156:159], v[64:67], v[188:191], 0
    v_pk_mul_f32 v[132:133], v[132:133], v[142:143] op_sel:[0,1] op_sel_hi:[1,1]
    v_pk_mul_f32 v[134:135], v[134:135], v[142:143] op_sel:[0,1] op_sel_hi:[1,1]
    v_pk_mul_f32 v[136:137], v[136:137], v[144:145] op_sel_hi:[1,0]
    v_pk_mul_f32 v[138:139], v[138:139], v[144:145] op_sel_hi:[1,0]
    v_mfma_f32_16x16x32_bf16 v[156:159], v[68:71], v[204:207], v[156:159]
    v_cvt_pk_bf16_f32 v34, v120, v121
    v_cvt_pk_bf16_f32 v35, v122, v123
    v_cvt_pk_bf16_f32 v38, v124, v125
    v_cvt_pk_bf16_f32 v39, v126, v127
    v_mfma_f32_16x16x32_bf16 v[160:163], v[72:75], v[188:191], 0
    v_cvt_pk_bf16_f32 v42, v128, v129
    v_cvt_pk_bf16_f32 v43, v130, v131
    v_cvt_pk_bf16_f32 v46, v132, v133
    v_cvt_pk_bf16_f32 v47, v134, v135
    v_mfma_f32_16x16x32_bf16 v[160:163], v[76:79], v[204:207], v[160:163]
    v_cvt_pk_bf16_f32 v50, v136, v137
    v_cvt_pk_bf16_f32 v51, v138, v139
    v_permlane16_swap_b32 v32, v34
    v_permlane16_swap_b32 v33, v35
    v_mfma_f32_16x16x32_bf16 v[160:163], v[80:83], v[220:223], v[160:163]
    s_add_u32 s83, s85, 0
    buffer_store_dwordx4 v[32:35], v230, s[64:67], s83 offen offset:0 sc1
    v_permlane16_swap_b32 v36, v38
    v_permlane16_swap_b32 v37, v39
    v_mfma_f32_16x16x32_bf16 v[164:167], v[84:87], v[204:207], 0
    s_add_u32 s83, s85, 66048
    buffer_store_dwordx4 v[36:39], v230, s[64:67], s83 offen offset:0 sc1
    v_permlane16_swap_b32 v40, v42
    v_permlane16_swap_b32 v41, v43
    v_mfma_f32_16x16x32_bf16 v[164:167], v[88:91], v[220:223], v[164:167]
    s_add_u32 s83, s85, 132096
    buffer_store_dwordx4 v[40:43], v230, s[64:67], s83 offen offset:0 sc1
    v_permlane16_swap_b32 v44, v46
    v_permlane16_swap_b32 v45, v47
    v_mfma_f32_16x16x32_bf16 v[168:171], v[92:95], v[204:207], 0
    s_add_u32 s83, s85, 198144
    buffer_store_dwordx4 v[44:47], v230, s[64:67], s83 offen offset:0 sc1
    v_permlane16_swap_b32 v48, v50
    v_permlane16_swap_b32 v49, v51
    v_mfma_f32_16x16x32_bf16 v[168:171], v[96:99], v[220:223], v[168:171]
    s_add_u32 s83, s85, 264192
    buffer_store_dwordx4 v[48:51], v230, s[64:67], s83 offen offset:0 sc1
    v_mfma_f32_16x16x32_bf16 v[140:143], v[100:103], v[192:195], 0
    v_mfma_f32_16x16x32_bf16 v[140:143], v[104:107], v[208:211], v[140:143]
    v_mfma_f32_16x16x32_bf16 v[140:143], v[108:111], v[224:227], v[140:143]
    v_mfma_f32_16x16x32_bf16 v[144:147], v[112:115], v[208:211], 0
    v_add_f32 v172, 0x358637bd, v172
    v_add_f32 v173, 0x358637bd, v173
    v_add_f32 v174, 0x358637bd, v174
    v_mfma_f32_16x16x32_bf16 v[144:147], v[116:119], v[224:227], v[144:147]
    v_add_f32 v175, 0x358637bd, v175
    v_add_f32 v176, 0x358637bd, v176
    v_rcp_f32 v172, v172
    v_mfma_f32_16x16x32_bf16 v[120:123], v[56:59], v[192:195], 0
    v_rcp_f32 v173, v173
    v_rcp_f32 v174, v174
    v_rcp_f32_e64 v175, v175
    v_mfma_f32_16x16x32_bf16 v[120:123], v[60:63], v[208:211], v[120:123]
    v_rcp_f32_e64 v176, v176
    v_pk_mul_f32 v[152:153], v[152:153], v[172:173] op_sel_hi:[1,0]
    v_pk_mul_f32 v[154:155], v[154:155], v[172:173] op_sel_hi:[1,0]
    v_mfma_f32_16x16x32_bf16 v[124:127], v[64:67], v[192:195], 0
    v_pk_mul_f32 v[156:157], v[156:157], v[172:173] op_sel:[0,1] op_sel_hi:[1,1]
    v_pk_mul_f32 v[158:159], v[158:159], v[172:173] op_sel:[0,1] op_sel_hi:[1,1]
    v_pk_mul_f32 v[160:161], v[160:161], v[174:175] op_sel_hi:[1,0]
    v_mfma_f32_16x16x32_bf16 v[124:127], v[68:71], v[208:211], v[124:127]
    v_pk_mul_f32 v[162:163], v[162:163], v[174:175] op_sel_hi:[1,0]
    v_pk_mul_f32 v[164:165], v[164:165], v[174:175] op_sel:[0,1] op_sel_hi:[1,1]
    v_pk_mul_f32 v[166:167], v[166:167], v[174:175] op_sel:[0,1] op_sel_hi:[1,1]
    v_mfma_f32_16x16x32_bf16 v[128:131], v[72:75], v[192:195], 0
    v_pk_mul_f32 v[168:169], v[168:169], v[176:177] op_sel_hi:[1,0]
    v_pk_mul_f32 v[170:171], v[170:171], v[176:177] op_sel_hi:[1,0]
    v_cvt_pk_bf16_f32 v32, v152, v153
    v_mfma_f32_16x16x32_bf16 v[128:131], v[76:79], v[208:211], v[128:131]
    v_cvt_pk_bf16_f32 v33, v154, v155
    v_cvt_pk_bf16_f32 v36, v156, v157
    v_cvt_pk_bf16_f32 v37, v158, v159
    v_mfma_f32_16x16x32_bf16 v[128:131], v[80:83], v[224:227], v[128:131]
    v_cvt_pk_bf16_f32 v40, v160, v161
    v_cvt_pk_bf16_f32 v41, v162, v163
    v_cvt_pk_bf16_f32 v44, v164, v165
    v_mfma_f32_16x16x32_bf16 v[132:135], v[84:87], v[208:211], 0
    v_cvt_pk_bf16_f32 v45, v166, v167
    v_cvt_pk_bf16_f32 v48, v168, v169
    v_cvt_pk_bf16_f32 v49, v170, v171
    v_mfma_f32_16x16x32_bf16 v[132:135], v[88:91], v[224:227], v[132:135]
    v_mfma_f32_16x16x32_bf16 v[136:139], v[92:95], v[208:211], 0
    v_mfma_f32_16x16x32_bf16 v[136:139], v[96:99], v[224:227], v[136:139]
    v_add_f32 v140, 0x358637bd, v140
    v_add_f32 v141, 0x358637bd, v141
    v_add_f32 v142, 0x358637bd, v142
    v_add_f32 v143, 0x358637bd, v143
    v_add_f32 v144, 0x358637bd, v144
    v_rcp_f32 v140, v140
    v_rcp_f32 v141, v141
    v_rcp_f32 v142, v142
    v_rcp_f32 v143, v143
    v_rcp_f32_e64 v144, v144
    v_pk_mul_f32 v[120:121], v[120:121], v[140:141] op_sel_hi:[1,0]
    v_pk_mul_f32 v[122:123], v[122:123], v[140:141] op_sel_hi:[1,0]
    v_pk_mul_f32 v[124:125], v[124:125], v[140:141] op_sel:[0,1] op_sel_hi:[1,1]
    v_pk_mul_f32 v[126:127], v[126:127], v[140:141] op_sel:[0,1] op_sel_hi:[1,1]
    v_pk_mul_f32 v[128:129], v[128:129], v[142:143] op_sel_hi:[1,0]
    v_pk_mul_f32 v[130:131], v[130:131], v[142:143] op_sel_hi:[1,0]
    v_pk_mul_f32 v[132:133], v[132:133], v[142:143] op_sel:[0,1] op_sel_hi:[1,1]
    v_pk_mul_f32 v[134:135], v[134:135], v[142:143] op_sel:[0,1] op_sel_hi:[1,1]
    v_pk_mul_f32 v[136:137], v[136:137], v[144:145] op_sel_hi:[1,0]
    v_pk_mul_f32 v[138:139], v[138:139], v[144:145] op_sel_hi:[1,0]
    v_cvt_pk_bf16_f32 v34, v120, v121
    v_cvt_pk_bf16_f32 v35, v122, v123
    v_cvt_pk_bf16_f32 v38, v124, v125
    v_cvt_pk_bf16_f32 v39, v126, v127
    v_cvt_pk_bf16_f32 v42, v128, v129
    v_cvt_pk_bf16_f32 v43, v130, v131
    v_cvt_pk_bf16_f32 v46, v132, v133
    v_cvt_pk_bf16_f32 v47, v134, v135
    v_cvt_pk_bf16_f32 v50, v136, v137
    v_cvt_pk_bf16_f32 v51, v138, v139
    v_permlane16_swap_b32 v32, v34
    v_permlane16_swap_b32 v33, v35
    s_add_u32 s83, s85, 0
    buffer_store_dwordx4 v[32:35], v230, s[64:67], s83 offen offset:512 sc1
    v_permlane16_swap_b32 v36, v38
    v_permlane16_swap_b32 v37, v39
    s_add_u32 s83, s85, 66048
    buffer_store_dwordx4 v[36:39], v230, s[64:67], s83 offen offset:512 sc1
    v_permlane16_swap_b32 v40, v42
    v_permlane16_swap_b32 v41, v43
    s_add_u32 s83, s85, 132096
    buffer_store_dwordx4 v[40:43], v230, s[64:67], s83 offen offset:512 sc1
    v_permlane16_swap_b32 v44, v46
    v_permlane16_swap_b32 v45, v47
    s_add_u32 s83, s85, 198144
    buffer_store_dwordx4 v[44:47], v230, s[64:67], s83 offen offset:512 sc1
    v_permlane16_swap_b32 v48, v50
    v_permlane16_swap_b32 v49, v51
    s_add_u32 s83, s85, 264192
    buffer_store_dwordx4 v[48:51], v230, s[64:67], s83 offen offset:512 sc1
    s_lshl_b32 s85, s74, 2
    s_add_u32 s85, s85, s72
    s_mul_i32 s83, s85, 2048
    s_lshl_b32 s84, s99, 7
    s_add_u32 s83, s83, s84
    s_add_u32 s83, s83, 1572864
    s_waitcnt vmcnt(0)
    s_mov_b64 exec, 1
    s_cmp_lg_u32 s100, 0
    s_cbranch_scc1 SLOW_126
    buffer_store_dword v2, off, s[64:67], s83
    s_branch STE_127
SLOW_126:
    buffer_store_dword v2, off, s[64:67], s83 sc1
STE_127:
    s_mov_b64 exec, -1
    s_lshl_b32 s84, s79, 1
    s_lshr_b32 s85, s72, 1
    s_add_u32 s84, s84, s85
    s_mul_i32 s84, s84, 2048
    s_add_u32 s84, s84, 1572864
    v_lshl_add_u32 v8, v1, 7, s84
    v_lshrrev_b32_e64 v3, 5, v1
    v_lshl_add_u32 v30, v3, 9, v30
    v_lshl_add_u32 v31, v3, 9, v31
    s_mov_b32 s90, 200000
    s_mov_b64 exec, 0xff
POLL_128:
    buffer_load_dword v52, v8, s[64:67], 0 offen sc1
    s_waitcnt vmcnt(0)
    v_cmp_ne_u32 vcc, s73, v52
    s_cbranch_vccz POLLD_129
    s_sub_u32 s90, s90, 1
    s_cmp_lg_u32 s90, 0
    s_cbranch_scc1 POLL_128
POLLD_129:
    s_mov_b64 exec, -1
    s_mov_b32 s83, 10158080
    buffer_load_dwordx4 v[52:55], v7, s[64:67], s83 offen sc1
    s_mov_b32 s83, 10224128
    buffer_load_dwordx4 v[56:59], v7, s[64:67], s83 offen sc1
    s_mov_b32 s83, 10290176
    buffer_load_dwordx4 v[60:63], v7, s[64:67], s83 offen sc1
    s_mov_b32 s83, 10356224
    buffer_load_dwordx4 v[64:67], v7, s[64:67], s83 offen sc1
    s_mov_b32 s83, 10422272
    buffer_load_dwordx4 v[68:71], v7, s[64:67], s83 offen sc1
    s_mov_b32 s83, 10488320
    buffer_load_dwordx4 v[72:75], v7, s[64:67], s83 offen sc1
    s_mov_b32 s83, 10554368
    buffer_load_dwordx4 v[76:79], v7, s[64:67], s83 offen sc1
    s_mov_b32 s83, 10620416
    buffer_load_dwordx4 v[80:83], v7, s[64:67], s83 offen sc1
    s_mov_b32 s83, 10686464
    buffer_load_dwordx4 v[84:87], v7, s[64:67], s83 offen sc1
    s_mov_b32 s83, 10752512
    buffer_load_dwordx4 v[88:91], v7, s[64:67], s83 offen sc1
    s_mov_b32 s83, 10818560
    buffer_load_dwordx4 v[92:95], v7, s[64:67], s83 offen sc1
    s_mov_b32 s83, 10884608
    buffer_load_dwordx4 v[96:99], v7, s[64:67], s83 offen sc1
    v_add_u32 v32, 98304, v30
    v_add_u32 v33, 98304, v31
    v_add_u32 v34, 114688, v30
    v_add_u32 v35, 114688, v31
    ds_read_b64_tr_b16 v[148:149], v32 offset:0
    ds_read_b64_tr_b16 v[150:151], v32 offset:512
    ds_read_b64_tr_b16 v[152:153], v33 offset:0
    ds_read_b64_tr_b16 v[154:155], v33 offset:512
    ds_read_b64_tr_b16 v[156:157], v34 offset:0
    ds_read_b64_tr_b16 v[158:159], v34 offset:512
    ds_read_b64_tr_b16 v[160:161], v35 offset:0
    ds_read_b64_tr_b16 v[162:163], v35 offset:512
    s_waitcnt vmcnt(11)
    s_waitcnt lgkmcnt(6)
    v_mfma_f32_32x32x16_bf16 v[180:195], v[148:151], v[52:55], 0
    ds_read_b64_tr_b16 v[164:165], v32 offset:2048
    ds_read_b64_tr_b16 v[166:167], v32 offset:2560
    s_waitcnt lgkmcnt(6)
    v_mfma_f32_32x32x16_bf16 v[196:211], v[152:155], v[52:55], 0
    ds_read_b64_tr_b16 v[168:169], v33 offset:2048
    ds_read_b64_tr_b16 v[170:171], v33 offset:2560
    s_waitcnt lgkmcnt(6)
    v_mfma_f32_32x32x16_bf16 v[212:227], v[156:159], v[52:55], 0
    ds_read_b64_tr_b16 v[172:173], v34 offset:2048
    ds_read_b64_tr_b16 v[174:175], v34 offset:2560
    s_waitcnt lgkmcnt(6)
    v_mfma_f32_32x32x16_bf16 v[228:243], v[160:163], v[52:55], 0
    ds_read_b64_tr_b16 v[176:177], v35 offset:2048
    ds_read_b64_tr_b16 v[178:179], v35 offset:2560
    s_mov_b32 s83, 10950656
    buffer_load_dwordx4 v[100:103], v7, s[64:67], s83 offen sc1
    s_mov_b32 s83, 11016704
    buffer_load_dwordx4 v[104:107], v7, s[64:67], s83 offen sc1
    s_waitcnt vmcnt(12)
    s_waitcnt lgkmcnt(6)
    v_mfma_f32_32x32x16_bf16 v[180:195], v[164:167], v[56:59], v[180:195]
    ds_read_b64_tr_b16 v[148:149], v32 offset:4096
    ds_read_b64_tr_b16 v[150:151], v32 offset:4608
    s_waitcnt lgkmcnt(6)
    v_mfma_f32_32x32x16_bf16 v[196:211], v[168:171], v[56:59], v[196:211]
    ds_read_b64_tr_b16 v[152:153], v33 offset:4096
    ds_read_b64_tr_b16 v[154:155], v33 offset:4608
    s_waitcnt lgkmcnt(6)
    v_mfma_f32_32x32x16_bf16 v[212:227], v[172:175], v[56:59], v[212:227]
    ds_read_b64_tr_b16 v[156:157], v34 offset:4096
    ds_read_b64_tr_b16 v[158:159], v34 offset:4608
    s_waitcnt lgkmcnt(6)
    v_mfma_f32_32x32x16_bf16 v[228:243], v[176:179], v[56:59], v[228:243]
    ds_read_b64_tr_b16 v[160:161], v35 offset:4096
    ds_read_b64_tr_b16 v[162:163], v35 offset:4608
    s_mov_b32 s83, 11082752
    buffer_load_dwordx4 v[108:111], v7, s[64:67], s83 offen sc1
    s_mov_b32 s83, 11148800
    buffer_load_dwordx4 v[112:115], v7, s[64:67], s83 offen sc1
    s_waitcnt vmcnt(13)
    s_waitcnt lgkmcnt(6)
    v_mfma_f32_32x32x16_bf16 v[180:195], v[148:151], v[60:63], v[180:195]
    ds_read_b64_tr_b16 v[164:165], v32 offset:6144
    ds_read_b64_tr_b16 v[166:167], v32 offset:6656
    s_waitcnt lgkmcnt(6)
    v_mfma_f32_32x32x16_bf16 v[196:211], v[152:155], v[60:63], v[196:211]
    ds_read_b64_tr_b16 v[168:169], v33 offset:6144
    ds_read_b64_tr_b16 v[170:171], v33 offset:6656
    s_waitcnt lgkmcnt(6)
    v_mfma_f32_32x32x16_bf16 v[212:227], v[156:159], v[60:63], v[212:227]
    ds_read_b64_tr_b16 v[172:173], v34 offset:6144
    ds_read_b64_tr_b16 v[174:175], v34 offset:6656
    s_waitcnt lgkmcnt(6)
    v_mfma_f32_32x32x16_bf16 v[228:243], v[160:163], v[60:63], v[228:243]
    ds_read_b64_tr_b16 v[176:177], v35 offset:6144
    ds_read_b64_tr_b16 v[178:179], v35 offset:6656
    s_mov_b32 s83, 11214848
    buffer_load_dwordx4 v[116:119], v7, s[64:67], s83 offen sc1
    s_mov_b32 s83, 11280896
    buffer_load_dwordx4 v[120:123], v7, s[64:67], s83 offen sc1
    s_waitcnt vmcnt(14)
    s_waitcnt lgkmcnt(6)
    v_mfma_f32_32x32x16_bf16 v[180:195], v[164:167], v[64:67], v[180:195]
    ds_read_b64_tr_b16 v[148:149], v32 offset:8192
    ds_read_b64_tr_b16 v[150:151], v32 offset:8704
    s_waitcnt lgkmcnt(6)
    v_mfma_f32_32x32x16_bf16 v[196:211], v[168:171], v[64:67], v[196:211]
    ds_read_b64_tr_b16 v[152:153], v33 offset:8192
    ds_read_b64_tr_b16 v[154:155], v33 offset:8704
    s_waitcnt lgkmcnt(6)
    v_mfma_f32_32x32x16_bf16 v[212:227], v[172:175], v[64:67], v[212:227]
    ds_read_b64_tr_b16 v[156:157], v34 offset:8192
    ds_read_b64_tr_b16 v[158:159], v34 offset:8704
    s_waitcnt lgkmcnt(6)
    v_mfma_f32_32x32x16_bf16 v[228:243], v[176:179], v[64:67], v[228:243]
    ds_read_b64_tr_b16 v[160:161], v35 offset:8192
    ds_read_b64_tr_b16 v[162:163], v35 offset:8704
    s_mov_b32 s83, 11346944
    buffer_load_dwordx4 v[124:127], v7, s[64:67], s83 offen sc1
    s_mov_b32 s83, 11412992
    buffer_load_dwordx4 v[128:131], v7, s[64:67], s83 offen sc1
    s_waitcnt vmcnt(15)
    s_waitcnt lgkmcnt(6)
    v_mfma_f32_32x32x16_bf16 v[180:195], v[148:151], v[68:71], v[180:195]
    ds_read_b64_tr_b16 v[164:165], v32 offset:10240
    ds_read_b64_tr_b16 v[166:167], v32 offset:10752
    s_waitcnt lgkmcnt(6)
    v_mfma_f32_32x32x16_bf16 v[196:211], v[152:155], v[68:71], v[196:211]
    ds_read_b64_tr_b16 v[168:169], v33 offset:10240
    ds_read_b64_tr_b16 v[170:171], v33 offset:10752
    s_waitcnt lgkmcnt(6)
    v_mfma_f32_32x32x16_bf16 v[212:227], v[156:159], v[68:71], v[212:227]
    ds_read_b64_tr_b16 v[172:173], v34 offset:10240
    ds_read_b64_tr_b16 v[174:175], v34 offset:10752
    s_waitcnt lgkmcnt(6)
    v_mfma_f32_32x32x16_bf16 v[228:243], v[160:163], v[68:71], v[228:243]
    ds_read_b64_tr_b16 v[176:177], v35 offset:10240
    ds_read_b64_tr_b16 v[178:179], v35 offset:10752
    s_mov_b32 s83, 11479040
    buffer_load_dwordx4 v[132:135], v7, s[64:67], s83 offen sc1
    s_mov_b32 s83, 11545088
    buffer_load_dwordx4 v[136:139], v7, s[64:67], s83 offen sc1
    s_waitcnt vmcnt(16)
    s_waitcnt lgkmcnt(6)
    v_mfma_f32_32x32x16_bf16 v[180:195], v[164:167], v[72:75], v[180:195]
    ds_read_b64_tr_b16 v[148:149], v32 offset:12288
    ds_read_b64_tr_b16 v[150:151], v32 offset:12800
    s_waitcnt lgkmcnt(6)
    v_mfma_f32_32x32x16_bf16 v[196:211], v[168:171], v[72:75], v[196:211]
    ds_read_b64_tr_b16 v[152:153], v33 offset:12288
    ds_read_b64_tr_b16 v[154:155], v33 offset:12800
    s_waitcnt lgkmcnt(6)
    v_mfma_f32_32x32x16_bf16 v[212:227], v[172:175], v[72:75], v[212:227]
    ds_read_b64_tr_b16 v[156:157], v34 offset:12288
    ds_read_b64_tr_b16 v[158:159], v34 offset:12800
    s_waitcnt lgkmcnt(6)
    v_mfma_f32_32x32x16_bf16 v[228:243], v[176:179], v[72:75], v[228:243]
    ds_read_b64_tr_b16 v[160:161], v35 offset:12288
    ds_read_b64_tr_b16 v[162:163], v35 offset:12800
    s_mov_b32 s83, 11611136
    buffer_load_dwordx4 v[140:143], v7, s[64:67], s83 offen sc1
    s_mov_b32 s83, 11677184
    buffer_load_dwordx4 v[144:147], v7, s[64:67], s83 offen sc1
    s_waitcnt vmcnt(17)
    s_waitcnt lgkmcnt(6)
    v_mfma_f32_32x32x16_bf16 v[180:195], v[148:151], v[76:79], v[180:195]
    ds_read_b64_tr_b16 v[164:165], v32 offset:14336
    ds_read_b64_tr_b16 v[166:167], v32 offset:14848
    s_waitcnt lgkmcnt(6)
    v_mfma_f32_32x32x16_bf16 v[196:211], v[152:155], v[76:79], v[196:211]
    ds_read_b64_tr_b16 v[168:169], v33 offset:14336
    ds_read_b64_tr_b16 v[170:171], v33 offset:14848
    s_waitcnt lgkmcnt(6)
    v_mfma_f32_32x32x16_bf16 v[212:227], v[156:159], v[76:79], v[212:227]
    ds_read_b64_tr_b16 v[172:173], v34 offset:14336
    ds_read_b64_tr_b16 v[174:175], v34 offset:14848
    s_waitcnt lgkmcnt(6)
    v_mfma_f32_32x32x16_bf16 v[228:243], v[160:163], v[76:79], v[228:243]
    ds_read_b64_tr_b16 v[176:177], v35 offset:14336
    ds_read_b64_tr_b16 v[178:179], v35 offset:14848
    s_mov_b32 s83, 11743232
    buffer_load_dwordx4 v[52:55], v7, s[64:67], s83 offen sc1
    s_mov_b32 s83, 11809280
    buffer_load_dwordx4 v[56:59], v7, s[64:67], s83 offen sc1
    v_add_u32 v32, 131072, v30
    v_add_u32 v33, 131072, v31
    v_add_u32 v34, 147456, v30
    v_add_u32 v35, 147456, v31
    s_waitcnt vmcnt(18)
    s_waitcnt lgkmcnt(6)
    v_mfma_f32_32x32x16_bf16 v[180:195], v[164:167], v[80:83], v[180:195]
    ds_read_b64_tr_b16 v[148:149], v32 offset:0
    ds_read_b64_tr_b16 v[150:151], v32 offset:512
    s_waitcnt lgkmcnt(6)
    v_mfma_f32_32x32x16_bf16 v[196:211], v[168:171], v[80:83], v[196:211]
    ds_read_b64_tr_b16 v[152:153], v33 offset:0
    ds_read_b64_tr_b16 v[154:155], v33 offset:512
    s_waitcnt lgkmcnt(6)
    v_mfma_f32_32x32x16_bf16 v[212:227], v[172:175], v[80:83], v[212:227]
    ds_read_b64_tr_b16 v[156:157], v34 offset:0
    ds_read_b64_tr_b16 v[158:159], v34 offset:512
    s_waitcnt lgkmcnt(6)
    v_mfma_f32_32x32x16_bf16 v[228:243], v[176:179], v[80:83], v[228:243]
    ds_read_b64_tr_b16 v[160:161], v35 offset:0
    ds_read_b64_tr_b16 v[162:163], v35 offset:512
    s_mov_b32 s83, 11875328
    buffer_load_dwordx4 v[60:63], v7, s[64:67], s83 offen sc1
    s_mov_b32 s83, 11941376
    buffer_load_dwordx4 v[64:67], v7, s[64:67], s83 offen sc1
    s_waitcnt vmcnt(19)
    s_waitcnt lgkmcnt(6)
    v_mfma_f32_32x32x16_bf16 v[180:195], v[148:151], v[84:87], v[180:195]
    ds_read_b64_tr_b16 v[164:165], v32 offset:2048
    ds_read_b64_tr_b16 v[166:167], v32 offset:2560
    s_waitcnt lgkmcnt(6)
    v_mfma_f32_32x32x16_bf16 v[196:211], v[152:155], v[84:87], v[196:211]
    ds_read_b64_tr_b16 v[168:169], v33 offset:2048
    ds_read_b64_tr_b16 v[170:171], v33 offset:2560
    s_waitcnt lgkmcnt(6)
    v_mfma_f32_32x32x16_bf16 v[212:227], v[156:159], v[84:87], v[212:227]
    ds_read_b64_tr_b16 v[172:173], v34 offset:2048
    ds_read_b64_tr_b16 v[174:175], v34 offset:2560
    s_waitcnt lgkmcnt(6)
    v_mfma_f32_32x32x16_bf16 v[228:243], v[160:163], v[84:87], v[228:243]
    ds_read_b64_tr_b16 v[176:177], v35 offset:2048
    ds_read_b64_tr_b16 v[178:179], v35 offset:2560
    s_mov_b32 s83, 12007424
    buffer_load_dwordx4 v[68:71], v7, s[64:67], s83 offen sc1
    s_mov_b32 s83, 12073472
    buffer_load_dwordx4 v[72:75], v7, s[64:67], s83 offen sc1
    s_waitcnt vmcnt(20)
    s_waitcnt lgkmcnt(6)
    v_mfma_f32_32x32x16_bf16 v[180:195], v[164:167], v[88:91], v[180:195]
    ds_read_b64_tr_b16 v[148:149], v32 offset:4096
    ds_read_b64_tr_b16 v[150:151], v32 offset:4608
    s_waitcnt lgkmcnt(6)
    v_mfma_f32_32x32x16_bf16 v[196:211], v[168:171], v[88:91], v[196:211]
    ds_read_b64_tr_b16 v[152:153], v33 offset:4096
    ds_read_b64_tr_b16 v[154:155], v33 offset:4608
    s_waitcnt lgkmcnt(6)
    v_mfma_f32_32x32x16_bf16 v[212:227], v[172:175], v[88:91], v[212:227]
    ds_read_b64_tr_b16 v[156:157], v34 offset:4096
    ds_read_b64_tr_b16 v[158:159], v34 offset:4608
    s_waitcnt lgkmcnt(6)
    v_mfma_f32_32x32x16_bf16 v[228:243], v[176:179], v[88:91], v[228:243]
    ds_read_b64_tr_b16 v[160:161], v35 offset:4096
    ds_read_b64_tr_b16 v[162:163], v35 offset:4608
    s_mov_b32 s83, 12139520
    buffer_load_dwordx4 v[76:79], v7, s[64:67], s83 offen sc1
    s_mov_b32 s83, 12205568
    buffer_load_dwordx4 v[80:83], v7, s[64:67], s83 offen sc1
    s_waitcnt vmcnt(21)
    s_waitcnt lgkmcnt(6)
    v_mfma_f32_32x32x16_bf16 v[180:195], v[148:151], v[92:95], v[180:195]
    ds_read_b64_tr_b16 v[164:165], v32 offset:6144
    ds_read_b64_tr_b16 v[166:167], v32 offset:6656
    s_waitcnt lgkmcnt(6)
    v_mfma_f32_32x32x16_bf16 v[196:211], v[152:155], v[92:95], v[196:211]
    ds_read_b64_tr_b16 v[168:169], v33 offset:6144
    ds_read_b64_tr_b16 v[170:171], v33 offset:6656
    s_waitcnt lgkmcnt(6)
    v_mfma_f32_32x32x16_bf16 v[212:227], v[156:159], v[92:95], v[212:227]
    ds_read_b64_tr_b16 v[172:173], v34 offset:6144
    ds_read_b64_tr_b16 v[174:175], v34 offset:6656
    s_waitcnt lgkmcnt(6)
    v_mfma_f32_32x32x16_bf16 v[228:243], v[160:163], v[92:95], v[228:243]
    ds_read_b64_tr_b16 v[176:177], v35 offset:6144
    ds_read_b64_tr_b16 v[178:179], v35 offset:6656
    s_mov_b32 s83, 12271616
    buffer_load_dwordx4 v[84:87], v7, s[64:67], s83 offen sc1
    s_mov_b32 s83, 12337664
    buffer_load_dwordx4 v[88:91], v7, s[64:67], s83 offen sc1
    s_waitcnt vmcnt(22)
    s_waitcnt lgkmcnt(6)
    v_mfma_f32_32x32x16_bf16 v[180:195], v[164:167], v[96:99], v[180:195]
    ds_read_b64_tr_b16 v[148:149], v32 offset:8192
    ds_read_b64_tr_b16 v[150:151], v32 offset:8704
    s_waitcnt lgkmcnt(6)
    v_mfma_f32_32x32x16_bf16 v[196:211], v[168:171], v[96:99], v[196:211]
    ds_read_b64_tr_b16 v[152:153], v33 offset:8192
    ds_read_b64_tr_b16 v[154:155], v33 offset:8704
    s_waitcnt lgkmcnt(6)
    v_mfma_f32_32x32x16_bf16 v[212:227], v[172:175], v[96:99], v[212:227]
    ds_read_b64_tr_b16 v[156:157], v34 offset:8192
    ds_read_b64_tr_b16 v[158:159], v34 offset:8704
    s_waitcnt lgkmcnt(6)
    v_mfma_f32_32x32x16_bf16 v[228:243], v[176:179], v[96:99], v[228:243]
    ds_read_b64_tr_b16 v[160:161], v35 offset:8192
    ds_read_b64_tr_b16 v[162:163], v35 offset:8704
    s_mov_b32 s83, 12403712
    buffer_load_dwordx4 v[92:95], v7, s[64:67], s83 offen sc1
    s_mov_b32 s83, 12469760
    buffer_load_dwordx4 v[96:99], v7, s[64:67], s83 offen sc1
    s_waitcnt vmcnt(23)
    s_waitcnt lgkmcnt(6)
    v_mfma_f32_32x32x16_bf16 v[180:195], v[148:151], v[100:103], v[180:195]
    ds_read_b64_tr_b16 v[164:165], v32 offset:10240
    ds_read_b64_tr_b16 v[166:167], v32 offset:10752
    s_waitcnt lgkmcnt(6)
    v_mfma_f32_32x32x16_bf16 v[196:211], v[152:155], v[100:103], v[196:211]
    ds_read_b64_tr_b16 v[168:169], v33 offset:10240
    ds_read_b64_tr_b16 v[170:171], v33 offset:10752
    s_waitcnt lgkmcnt(6)
    v_mfma_f32_32x32x16_bf16 v[212:227], v[156:159], v[100:103], v[212:227]
    ds_read_b64_tr_b16 v[172:173], v34 offset:10240
    ds_read_b64_tr_b16 v[174:175], v34 offset:10752
    s_waitcnt lgkmcnt(6)
    v_mfma_f32_32x32x16_bf16 v[228:243], v[160:163], v[100:103], v[228:243]
    ds_read_b64_tr_b16 v[176:177], v35 offset:10240
    ds_read_b64_tr_b16 v[178:179], v35 offset:10752
    s_mov_b32 s83, 12535808
    buffer_load_dwordx4 v[100:103], v7, s[64:67], s83 offen sc1
    s_waitcnt vmcnt(23)
    s_waitcnt lgkmcnt(6)
    v_mfma_f32_32x32x16_bf16 v[180:195], v[164:167], v[104:107], v[180:195]
    ds_read_b64_tr_b16 v[148:149], v32 offset:12288
    ds_read_b64_tr_b16 v[150:151], v32 offset:12800
    s_waitcnt lgkmcnt(6)
    v_mfma_f32_32x32x16_bf16 v[196:211], v[168:171], v[104:107], v[196:211]
    ds_read_b64_tr_b16 v[152:153], v33 offset:12288
    ds_read_b64_tr_b16 v[154:155], v33 offset:12800
    s_waitcnt lgkmcnt(6)
    v_mfma_f32_32x32x16_bf16 v[212:227], v[172:175], v[104:107], v[212:227]
    ds_read_b64_tr_b16 v[156:157], v34 offset:12288
    ds_read_b64_tr_b16 v[158:159], v34 offset:12800
    s_waitcnt lgkmcnt(6)
    v_mfma_f32_32x32x16_bf16 v[228:243], v[176:179], v[104:107], v[228:243]
    ds_read_b64_tr_b16 v[160:161], v35 offset:12288
    ds_read_b64_tr_b16 v[162:163], v35 offset:12800
    s_mov_b32 s83, 12601856
    buffer_load_dwordx4 v[104:107], v7, s[64:67], s83 offen sc1
    s_waitcnt vmcnt(23)
    s_waitcnt lgkmcnt(6)
    v_mfma_f32_32x32x16_bf16 v[180:195], v[148:151], v[108:111], v[180:195]
    ds_read_b64_tr_b16 v[164:165], v32 offset:14336
    ds_read_b64_tr_b16 v[166:167], v32 offset:14848
    s_waitcnt lgkmcnt(6)
    v_mfma_f32_32x32x16_bf16 v[196:211], v[152:155], v[108:111], v[196:211]
    ds_read_b64_tr_b16 v[168:169], v33 offset:14336
    ds_read_b64_tr_b16 v[170:171], v33 offset:14848
    s_waitcnt lgkmcnt(6)
    v_mfma_f32_32x32x16_bf16 v[212:227], v[156:159], v[108:111], v[212:227]
    ds_read_b64_tr_b16 v[172:173], v34 offset:14336
    ds_read_b64_tr_b16 v[174:175], v34 offset:14848
    s_waitcnt lgkmcnt(6)
    v_mfma_f32_32x32x16_bf16 v[228:243], v[160:163], v[108:111], v[228:243]
    ds_read_b64_tr_b16 v[176:177], v35 offset:14336
    ds_read_b64_tr_b16 v[178:179], v35 offset:14848
    s_mov_b32 s83, 12667904
    buffer_load_dwordx4 v[108:111], v7, s[64:67], s83 offen sc1
    v_add_u32 v32, 0, v30
    v_add_u32 v33, 0, v31
    v_add_u32 v34, 16384, v30
    v_add_u32 v35, 16384, v31
    s_barrier
    s_waitcnt vmcnt(23)
    s_waitcnt lgkmcnt(6)
    v_mfma_f32_32x32x16_bf16 v[180:195], v[164:167], v[112:115], v[180:195]
    ds_read_b64_tr_b16 v[148:149], v32 offset:0
    ds_read_b64_tr_b16 v[150:151], v32 offset:512
    s_waitcnt lgkmcnt(6)
    v_mfma_f32_32x32x16_bf16 v[196:211], v[168:171], v[112:115], v[196:211]
    ds_read_b64_tr_b16 v[152:153], v33 offset:0
    ds_read_b64_tr_b16 v[154:155], v33 offset:512
    s_waitcnt lgkmcnt(6)
    v_mfma_f32_32x32x16_bf16 v[212:227], v[172:175], v[112:115], v[212:227]
    ds_read_b64_tr_b16 v[156:157], v34 offset:0
    ds_read_b64_tr_b16 v[158:159], v34 offset:512
    s_waitcnt lgkmcnt(6)
    v_mfma_f32_32x32x16_bf16 v[228:243], v[176:179], v[112:115], v[228:243]
    ds_read_b64_tr_b16 v[160:161], v35 offset:0
    ds_read_b64_tr_b16 v[162:163], v35 offset:512
    s_mov_b32 s83, 12733952
    buffer_load_dwordx4 v[112:115], v7, s[64:67], s83 offen sc1
    s_waitcnt vmcnt(23)
    s_waitcnt lgkmcnt(6)
    v_mfma_f32_32x32x16_bf16 v[180:195], v[148:151], v[116:119], v[180:195]
    ds_read_b64_tr_b16 v[164:165], v32 offset:2048
    ds_read_b64_tr_b16 v[166:167], v32 offset:2560
    s_waitcnt lgkmcnt(6)
    v_mfma_f32_32x32x16_bf16 v[196:211], v[152:155], v[116:119], v[196:211]
    ds_read_b64_tr_b16 v[168:169], v33 offset:2048
    ds_read_b64_tr_b16 v[170:171], v33 offset:2560
    s_waitcnt lgkmcnt(6)
    v_mfma_f32_32x32x16_bf16 v[212:227], v[156:159], v[116:119], v[212:227]
    ds_read_b64_tr_b16 v[172:173], v34 offset:2048
    ds_read_b64_tr_b16 v[174:175], v34 offset:2560
    s_waitcnt lgkmcnt(6)
    v_mfma_f32_32x32x16_bf16 v[228:243], v[160:163], v[116:119], v[228:243]
    ds_read_b64_tr_b16 v[176:177], v35 offset:2048
    ds_read_b64_tr_b16 v[178:179], v35 offset:2560
    s_waitcnt vmcnt(22)
    s_waitcnt lgkmcnt(6)
    v_mfma_f32_32x32x16_bf16 v[180:195], v[164:167], v[120:123], v[180:195]
    ds_read_b64_tr_b16 v[148:149], v32 offset:4096
    ds_read_b64_tr_b16 v[150:151], v32 offset:4608
    s_waitcnt lgkmcnt(6)
    v_mfma_f32_32x32x16_bf16 v[196:211], v[168:171], v[120:123], v[196:211]
    ds_read_b64_tr_b16 v[152:153], v33 offset:4096
    ds_read_b64_tr_b16 v[154:155], v33 offset:4608
    s_waitcnt lgkmcnt(6)
    v_mfma_f32_32x32x16_bf16 v[212:227], v[172:175], v[120:123], v[212:227]
    ds_read_b64_tr_b16 v[156:157], v34 offset:4096
    ds_read_b64_tr_b16 v[158:159], v34 offset:4608
    s_waitcnt lgkmcnt(6)
    v_mfma_f32_32x32x16_bf16 v[228:243], v[176:179], v[120:123], v[228:243]
    ds_read_b64_tr_b16 v[160:161], v35 offset:4096
    ds_read_b64_tr_b16 v[162:163], v35 offset:4608
    s_waitcnt vmcnt(21)
    s_waitcnt lgkmcnt(6)
    v_mfma_f32_32x32x16_bf16 v[180:195], v[148:151], v[124:127], v[180:195]
    ds_read_b64_tr_b16 v[164:165], v32 offset:6144
    ds_read_b64_tr_b16 v[166:167], v32 offset:6656
    s_waitcnt lgkmcnt(6)
    v_mfma_f32_32x32x16_bf16 v[196:211], v[152:155], v[124:127], v[196:211]
    ds_read_b64_tr_b16 v[168:169], v33 offset:6144
    ds_read_b64_tr_b16 v[170:171], v33 offset:6656
    s_waitcnt lgkmcnt(6)
    v_mfma_f32_32x32x16_bf16 v[212:227], v[156:159], v[124:127], v[212:227]
    ds_read_b64_tr_b16 v[172:173], v34 offset:6144
    ds_read_b64_tr_b16 v[174:175], v34 offset:6656
    s_waitcnt lgkmcnt(6)
    v_mfma_f32_32x32x16_bf16 v[228:243], v[160:163], v[124:127], v[228:243]
    ds_read_b64_tr_b16 v[176:177], v35 offset:6144
    ds_read_b64_tr_b16 v[178:179], v35 offset:6656
    s_waitcnt vmcnt(20)
    s_waitcnt lgkmcnt(6)
    v_mfma_f32_32x32x16_bf16 v[180:195], v[164:167], v[128:131], v[180:195]
    ds_read_b64_tr_b16 v[148:149], v32 offset:8192
    ds_read_b64_tr_b16 v[150:151], v32 offset:8704
    s_waitcnt lgkmcnt(6)
    v_mfma_f32_32x32x16_bf16 v[196:211], v[168:171], v[128:131], v[196:211]
    ds_read_b64_tr_b16 v[152:153], v33 offset:8192
    ds_read_b64_tr_b16 v[154:155], v33 offset:8704
    s_waitcnt lgkmcnt(6)
    v_mfma_f32_32x32x16_bf16 v[212:227], v[172:175], v[128:131], v[212:227]
    ds_read_b64_tr_b16 v[156:157], v34 offset:8192
    ds_read_b64_tr_b16 v[158:159], v34 offset:8704
    s_waitcnt lgkmcnt(6)
    v_mfma_f32_32x32x16_bf16 v[228:243], v[176:179], v[128:131], v[228:243]
    ds_read_b64_tr_b16 v[160:161], v35 offset:8192
    ds_read_b64_tr_b16 v[162:163], v35 offset:8704
    s_waitcnt vmcnt(19)
    s_waitcnt lgkmcnt(6)
    v_mfma_f32_32x32x16_bf16 v[180:195], v[148:151], v[132:135], v[180:195]
    ds_read_b64_tr_b16 v[164:165], v32 offset:10240
    ds_read_b64_tr_b16 v[166:167], v32 offset:10752
    s_waitcnt lgkmcnt(6)
    v_mfma_f32_32x32x16_bf16 v[196:211], v[152:155], v[132:135], v[196:211]
    ds_read_b64_tr_b16 v[168:169], v33 offset:10240
    ds_read_b64_tr_b16 v[170:171], v33 offset:10752
    s_waitcnt lgkmcnt(6)
    v_mfma_f32_32x32x16_bf16 v[212:227], v[156:159], v[132:135], v[212:227]
    ds_read_b64_tr_b16 v[172:173], v34 offset:10240
    ds_read_b64_tr_b16 v[174:175], v34 offset:10752
    s_waitcnt lgkmcnt(6)
    v_mfma_f32_32x32x16_bf16 v[228:243], v[160:163], v[132:135], v[228:243]
    ds_read_b64_tr_b16 v[176:177], v35 offset:10240
    ds_read_b64_tr_b16 v[178:179], v35 offset:10752
    s_waitcnt vmcnt(18)
    s_waitcnt lgkmcnt(6)
    v_mfma_f32_32x32x16_bf16 v[180:195], v[164:167], v[136:139], v[180:195]
    ds_read_b64_tr_b16 v[148:149], v32 offset:12288
    ds_read_b64_tr_b16 v[150:151], v32 offset:12800
    s_waitcnt lgkmcnt(6)
    v_mfma_f32_32x32x16_bf16 v[196:211], v[168:171], v[136:139], v[196:211]
    ds_read_b64_tr_b16 v[152:153], v33 offset:12288
    ds_read_b64_tr_b16 v[154:155], v33 offset:12800
    s_waitcnt lgkmcnt(6)
    v_mfma_f32_32x32x16_bf16 v[212:227], v[172:175], v[136:139], v[212:227]
    ds_read_b64_tr_b16 v[156:157], v34 offset:12288
    ds_read_b64_tr_b16 v[158:159], v34 offset:12800
    s_waitcnt lgkmcnt(6)
    v_mfma_f32_32x32x16_bf16 v[228:243], v[176:179], v[136:139], v[228:243]
    ds_read_b64_tr_b16 v[160:161], v35 offset:12288
    ds_read_b64_tr_b16 v[162:163], v35 offset:12800
    s_waitcnt vmcnt(17)
    s_waitcnt lgkmcnt(6)
    v_mfma_f32_32x32x16_bf16 v[180:195], v[148:151], v[140:143], v[180:195]
    ds_read_b64_tr_b16 v[164:165], v32 offset:14336
    ds_read_b64_tr_b16 v[166:167], v32 offset:14848
    s_waitcnt lgkmcnt(6)
    v_mfma_f32_32x32x16_bf16 v[196:211], v[152:155], v[140:143], v[196:211]
    ds_read_b64_tr_b16 v[168:169], v33 offset:14336
    ds_read_b64_tr_b16 v[170:171], v33 offset:14848
    s_waitcnt lgkmcnt(6)
    v_mfma_f32_32x32x16_bf16 v[212:227], v[156:159], v[140:143], v[212:227]
    ds_read_b64_tr_b16 v[172:173], v34 offset:14336
    ds_read_b64_tr_b16 v[174:175], v34 offset:14848
    s_waitcnt lgkmcnt(6)
    v_mfma_f32_32x32x16_bf16 v[228:243], v[160:163], v[140:143], v[228:243]
    ds_read_b64_tr_b16 v[176:177], v35 offset:14336
    ds_read_b64_tr_b16 v[178:179], v35 offset:14848
    v_add_u32 v32, 32768, v30
    v_add_u32 v33, 32768, v31
    v_add_u32 v34, 49152, v30
    v_add_u32 v35, 49152, v31
    s_waitcnt vmcnt(16)
    s_waitcnt lgkmcnt(6)
    v_mfma_f32_32x32x16_bf16 v[180:195], v[164:167], v[144:147], v[180:195]
    ds_read_b64_tr_b16 v[148:149], v32 offset:0
    ds_read_b64_tr_b16 v[150:151], v32 offset:512
    s_waitcnt lgkmcnt(6)
    v_mfma_f32_32x32x16_bf16 v[196:211], v[168:171], v[144:147], v[196:211]
    ds_read_b64_tr_b16 v[152:153], v33 offset:0
    ds_read_b64_tr_b16 v[154:155], v33 offset:512
    s_waitcnt lgkmcnt(6)
    v_mfma_f32_32x32x16_bf16 v[212:227], v[172:175], v[144:147], v[212:227]
    ds_read_b64_tr_b16 v[156:157], v34 offset:0
    ds_read_b64_tr_b16 v[158:159], v34 offset:512
    s_waitcnt lgkmcnt(6)
    v_mfma_f32_32x32x16_bf16 v[228:243], v[176:179], v[144:147], v[228:243]
    ds_read_b64_tr_b16 v[160:161], v35 offset:0
    ds_read_b64_tr_b16 v[162:163], v35 offset:512
    s_waitcnt vmcnt(15)
    s_waitcnt lgkmcnt(6)
    v_mfma_f32_32x32x16_bf16 v[180:195], v[148:151], v[52:55], v[180:195]
    ds_read_b64_tr_b16 v[164:165], v32 offset:2048
    ds_read_b64_tr_b16 v[166:167], v32 offset:2560
    s_waitcnt lgkmcnt(6)
    v_mfma_f32_32x32x16_bf16 v[196:211], v[152:155], v[52:55], v[196:211]
    ds_read_b64_tr_b16 v[168:169], v33 offset:2048
    ds_read_b64_tr_b16 v[170:171], v33 offset:2560
    s_waitcnt lgkmcnt(6)
    v_mfma_f32_32x32x16_bf16 v[212:227], v[156:159], v[52:55], v[212:227]
    ds_read_b64_tr_b16 v[172:173], v34 offset:2048
    ds_read_b64_tr_b16 v[174:175], v34 offset:2560
    s_waitcnt lgkmcnt(6)
    v_mfma_f32_32x32x16_bf16 v[228:243], v[160:163], v[52:55], v[228:243]
    ds_read_b64_tr_b16 v[176:177], v35 offset:2048
    ds_read_b64_tr_b16 v[178:179], v35 offset:2560
    s_waitcnt vmcnt(14)
    s_waitcnt lgkmcnt(6)
    v_mfma_f32_32x32x16_bf16 v[180:195], v[164:167], v[56:59], v[180:195]
    ds_read_b64_tr_b16 v[148:149], v32 offset:4096
    ds_read_b64_tr_b16 v[150:151], v32 offset:4608
    s_waitcnt lgkmcnt(6)
    v_mfma_f32_32x32x16_bf16 v[196:211], v[168:171], v[56:59], v[196:211]
    ds_read_b64_tr_b16 v[152:153], v33 offset:4096
    ds_read_b64_tr_b16 v[154:155], v33 offset:4608
    s_waitcnt lgkmcnt(6)
    v_mfma_f32_32x32x16_bf16 v[212:227], v[172:175], v[56:59], v[212:227]
    ds_read_b64_tr_b16 v[156:157], v34 offset:4096
    ds_read_b64_tr_b16 v[158:159], v34 offset:4608
    s_waitcnt lgkmcnt(6)
    v_mfma_f32_32x32x16_bf16 v[228:243], v[176:179], v[56:59], v[228:243]
    ds_read_b64_tr_b16 v[160:161], v35 offset:4096
    ds_read_b64_tr_b16 v[162:163], v35 offset:4608
    s_waitcnt vmcnt(13)
    s_waitcnt lgkmcnt(6)
    v_mfma_f32_32x32x16_bf16 v[180:195], v[148:151], v[60:63], v[180:195]
    ds_read_b64_tr_b16 v[164:165], v32 offset:6144
    ds_read_b64_tr_b16 v[166:167], v32 offset:6656
    s_waitcnt lgkmcnt(6)
    v_mfma_f32_32x32x16_bf16 v[196:211], v[152:155], v[60:63], v[196:211]
    ds_read_b64_tr_b16 v[168:169], v33 offset:6144
    ds_read_b64_tr_b16 v[170:171], v33 offset:6656
    s_waitcnt lgkmcnt(6)
    v_mfma_f32_32x32x16_bf16 v[212:227], v[156:159], v[60:63], v[212:227]
    ds_read_b64_tr_b16 v[172:173], v34 offset:6144
    ds_read_b64_tr_b16 v[174:175], v34 offset:6656
    s_waitcnt lgkmcnt(6)
    v_mfma_f32_32x32x16_bf16 v[228:243], v[160:163], v[60:63], v[228:243]
    ds_read_b64_tr_b16 v[176:177], v35 offset:6144
    ds_read_b64_tr_b16 v[178:179], v35 offset:6656
    s_waitcnt vmcnt(12)
    s_waitcnt lgkmcnt(6)
    v_mfma_f32_32x32x16_bf16 v[180:195], v[164:167], v[64:67], v[180:195]
    ds_read_b64_tr_b16 v[148:149], v32 offset:8192
    ds_read_b64_tr_b16 v[150:151], v32 offset:8704
    s_waitcnt lgkmcnt(6)
    v_mfma_f32_32x32x16_bf16 v[196:211], v[168:171], v[64:67], v[196:211]
    ds_read_b64_tr_b16 v[152:153], v33 offset:8192
    ds_read_b64_tr_b16 v[154:155], v33 offset:8704
    s_waitcnt lgkmcnt(6)
    v_mfma_f32_32x32x16_bf16 v[212:227], v[172:175], v[64:67], v[212:227]
    ds_read_b64_tr_b16 v[156:157], v34 offset:8192
    ds_read_b64_tr_b16 v[158:159], v34 offset:8704
    s_waitcnt lgkmcnt(6)
    v_mfma_f32_32x32x16_bf16 v[228:243], v[176:179], v[64:67], v[228:243]
    ds_read_b64_tr_b16 v[160:161], v35 offset:8192
    ds_read_b64_tr_b16 v[162:163], v35 offset:8704
    s_waitcnt vmcnt(11)
    s_waitcnt lgkmcnt(6)
    v_mfma_f32_32x32x16_bf16 v[180:195], v[148:151], v[68:71], v[180:195]
    ds_read_b64_tr_b16 v[164:165], v32 offset:10240
    ds_read_b64_tr_b16 v[166:167], v32 offset:10752
    s_waitcnt lgkmcnt(6)
    v_mfma_f32_32x32x16_bf16 v[196:211], v[152:155], v[68:71], v[196:211]
    ds_read_b64_tr_b16 v[168:169], v33 offset:10240
    ds_read_b64_tr_b16 v[170:171], v33 offset:10752
    s_waitcnt lgkmcnt(6)
    v_mfma_f32_32x32x16_bf16 v[212:227], v[156:159], v[68:71], v[212:227]
    ds_read_b64_tr_b16 v[172:173], v34 offset:10240
    ds_read_b64_tr_b16 v[174:175], v34 offset:10752
    s_waitcnt lgkmcnt(6)
    v_mfma_f32_32x32x16_bf16 v[228:243], v[160:163], v[68:71], v[228:243]
    ds_read_b64_tr_b16 v[176:177], v35 offset:10240
    ds_read_b64_tr_b16 v[178:179], v35 offset:10752
    s_waitcnt vmcnt(10)
    s_waitcnt lgkmcnt(6)
    v_mfma_f32_32x32x16_bf16 v[180:195], v[164:167], v[72:75], v[180:195]
    ds_read_b64_tr_b16 v[148:149], v32 offset:12288
    ds_read_b64_tr_b16 v[150:151], v32 offset:12800
    s_waitcnt lgkmcnt(6)
    v_mfma_f32_32x32x16_bf16 v[196:211], v[168:171], v[72:75], v[196:211]
    ds_read_b64_tr_b16 v[152:153], v33 offset:12288
    ds_read_b64_tr_b16 v[154:155], v33 offset:12800
    s_waitcnt lgkmcnt(6)
    v_mfma_f32_32x32x16_bf16 v[212:227], v[172:175], v[72:75], v[212:227]
    ds_read_b64_tr_b16 v[156:157], v34 offset:12288
    ds_read_b64_tr_b16 v[158:159], v34 offset:12800
    s_waitcnt lgkmcnt(6)
    v_mfma_f32_32x32x16_bf16 v[228:243], v[176:179], v[72:75], v[228:243]
    ds_read_b64_tr_b16 v[160:161], v35 offset:12288
    ds_read_b64_tr_b16 v[162:163], v35 offset:12800
    s_waitcnt vmcnt(9)
    s_waitcnt lgkmcnt(6)
    v_mfma_f32_32x32x16_bf16 v[180:195], v[148:151], v[76:79], v[180:195]
    ds_read_b64_tr_b16 v[164:165], v32 offset:14336
    ds_read_b64_tr_b16 v[166:167], v32 offset:14848
    s_waitcnt lgkmcnt(6)
    v_mfma_f32_32x32x16_bf16 v[196:211], v[152:155], v[76:79], v[196:211]
    ds_read_b64_tr_b16 v[168:169], v33 offset:14336
    ds_read_b64_tr_b16 v[170:171], v33 offset:14848
    s_waitcnt lgkmcnt(6)
    v_mfma_f32_32x32x16_bf16 v[212:227], v[156:159], v[76:79], v[212:227]
    ds_read_b64_tr_b16 v[172:173], v34 offset:14336
    ds_read_b64_tr_b16 v[174:175], v34 offset:14848
    s_waitcnt lgkmcnt(6)
    v_mfma_f32_32x32x16_bf16 v[228:243], v[160:163], v[76:79], v[228:243]
    ds_read_b64_tr_b16 v[176:177], v35 offset:14336
    ds_read_b64_tr_b16 v[178:179], v35 offset:14848
    v_add_u32 v32, 65536, v30
    v_add_u32 v33, 65536, v31
    v_add_u32 v34, 81920, v30
    v_add_u32 v35, 81920, v31
    s_waitcnt vmcnt(8)
    s_waitcnt lgkmcnt(6)
    v_mfma_f32_32x32x16_bf16 v[180:195], v[164:167], v[80:83], v[180:195]
    ds_read_b64_tr_b16 v[148:149], v32 offset:0
    ds_read_b64_tr_b16 v[150:151], v32 offset:512
    s_waitcnt lgkmcnt(6)
    v_mfma_f32_32x32x16_bf16 v[196:211], v[168:171], v[80:83], v[196:211]
    ds_read_b64_tr_b16 v[152:153], v33 offset:0
    ds_read_b64_tr_b16 v[154:155], v33 offset:512
    s_waitcnt lgkmcnt(6)
    v_mfma_f32_32x32x16_bf16 v[212:227], v[172:175], v[80:83], v[212:227]
    ds_read_b64_tr_b16 v[156:157], v34 offset:0
    ds_read_b64_tr_b16 v[158:159], v34 offset:512
    s_waitcnt lgkmcnt(6)
    v_mfma_f32_32x32x16_bf16 v[228:243], v[176:179], v[80:83], v[228:243]
    ds_read_b64_tr_b16 v[160:161], v35 offset:0
    ds_read_b64_tr_b16 v[162:163], v35 offset:512
    s_waitcnt vmcnt(7)
    s_waitcnt lgkmcnt(6)
    v_mfma_f32_32x32x16_bf16 v[180:195], v[148:151], v[84:87], v[180:195]
    ds_read_b64_tr_b16 v[164:165], v32 offset:2048
    ds_read_b64_tr_b16 v[166:167], v32 offset:2560
    s_waitcnt lgkmcnt(6)
    v_mfma_f32_32x32x16_bf16 v[196:211], v[152:155], v[84:87], v[196:211]
    ds_read_b64_tr_b16 v[168:169], v33 offset:2048
    ds_read_b64_tr_b16 v[170:171], v33 offset:2560
    s_waitcnt lgkmcnt(6)
    v_mfma_f32_32x32x16_bf16 v[212:227], v[156:159], v[84:87], v[212:227]
    ds_read_b64_tr_b16 v[172:173], v34 offset:2048
    ds_read_b64_tr_b16 v[174:175], v34 offset:2560
    s_waitcnt lgkmcnt(6)
    v_mfma_f32_32x32x16_bf16 v[228:243], v[160:163], v[84:87], v[228:243]
    ds_read_b64_tr_b16 v[176:177], v35 offset:2048
    ds_read_b64_tr_b16 v[178:179], v35 offset:2560
    s_waitcnt vmcnt(6)
    s_waitcnt lgkmcnt(6)
    v_mfma_f32_32x32x16_bf16 v[180:195], v[164:167], v[88:91], v[180:195]
    ds_read_b64_tr_b16 v[148:149], v32 offset:4096
    ds_read_b64_tr_b16 v[150:151], v32 offset:4608
    s_waitcnt lgkmcnt(6)
    v_mfma_f32_32x32x16_bf16 v[196:211], v[168:171], v[88:91], v[196:211]
    ds_read_b64_tr_b16 v[152:153], v33 offset:4096
    ds_read_b64_tr_b16 v[154:155], v33 offset:4608
    s_waitcnt lgkmcnt(6)
    v_mfma_f32_32x32x16_bf16 v[212:227], v[172:175], v[88:91], v[212:227]
    ds_read_b64_tr_b16 v[156:157], v34 offset:4096
    ds_read_b64_tr_b16 v[158:159], v34 offset:4608
    s_waitcnt lgkmcnt(6)
    v_mfma_f32_32x32x16_bf16 v[228:243], v[176:179], v[88:91], v[228:243]
    ds_read_b64_tr_b16 v[160:161], v35 offset:4096
    ds_read_b64_tr_b16 v[162:163], v35 offset:4608
    s_waitcnt vmcnt(5)
    s_waitcnt lgkmcnt(6)
    v_mfma_f32_32x32x16_bf16 v[180:195], v[148:151], v[92:95], v[180:195]
    ds_read_b64_tr_b16 v[164:165], v32 offset:6144
    ds_read_b64_tr_b16 v[166:167], v32 offset:6656
    s_waitcnt lgkmcnt(6)
    v_mfma_f32_32x32x16_bf16 v[196:211], v[152:155], v[92:95], v[196:211]
    ds_read_b64_tr_b16 v[168:169], v33 offset:6144
    ds_read_b64_tr_b16 v[170:171], v33 offset:6656
    s_waitcnt lgkmcnt(6)
    v_mfma_f32_32x32x16_bf16 v[212:227], v[156:159], v[92:95], v[212:227]
    ds_read_b64_tr_b16 v[172:173], v34 offset:6144
    ds_read_b64_tr_b16 v[174:175], v34 offset:6656
    s_waitcnt lgkmcnt(6)
    v_mfma_f32_32x32x16_bf16 v[228:243], v[160:163], v[92:95], v[228:243]
    ds_read_b64_tr_b16 v[176:177], v35 offset:6144
    ds_read_b64_tr_b16 v[178:179], v35 offset:6656
    s_waitcnt vmcnt(4)
    s_waitcnt lgkmcnt(6)
    v_mfma_f32_32x32x16_bf16 v[180:195], v[164:167], v[96:99], v[180:195]
    ds_read_b64_tr_b16 v[148:149], v32 offset:8192
    ds_read_b64_tr_b16 v[150:151], v32 offset:8704
    s_waitcnt lgkmcnt(6)
    v_mfma_f32_32x32x16_bf16 v[196:211], v[168:171], v[96:99], v[196:211]
    ds_read_b64_tr_b16 v[152:153], v33 offset:8192
    ds_read_b64_tr_b16 v[154:155], v33 offset:8704
    s_waitcnt lgkmcnt(6)
    v_mfma_f32_32x32x16_bf16 v[212:227], v[172:175], v[96:99], v[212:227]
    ds_read_b64_tr_b16 v[156:157], v34 offset:8192
    ds_read_b64_tr_b16 v[158:159], v34 offset:8704
    s_waitcnt lgkmcnt(6)
    v_mfma_f32_32x32x16_bf16 v[228:243], v[176:179], v[96:99], v[228:243]
    ds_read_b64_tr_b16 v[160:161], v35 offset:8192
    ds_read_b64_tr_b16 v[162:163], v35 offset:8704
    s_waitcnt vmcnt(3)
    s_waitcnt lgkmcnt(6)
    v_mfma_f32_32x32x16_bf16 v[180:195], v[148:151], v[100:103], v[180:195]
    ds_read_b64_tr_b16 v[164:165], v32 offset:10240
    ds_read_b64_tr_b16 v[166:167], v32 offset:10752
    s_waitcnt lgkmcnt(6)
    v_mfma_f32_32x32x16_bf16 v[196:211], v[152:155], v[100:103], v[196:211]
    ds_read_b64_tr_b16 v[168:169], v33 offset:10240
    ds_read_b64_tr_b16 v[170:171], v33 offset:10752
    s_waitcnt lgkmcnt(6)
    v_mfma_f32_32x32x16_bf16 v[212:227], v[156:159], v[100:103], v[212:227]
    ds_read_b64_tr_b16 v[172:173], v34 offset:10240
    ds_read_b64_tr_b16 v[174:175], v34 offset:10752
    s_waitcnt lgkmcnt(6)
    v_mfma_f32_32x32x16_bf16 v[228:243], v[160:163], v[100:103], v[228:243]
    ds_read_b64_tr_b16 v[176:177], v35 offset:10240
    ds_read_b64_tr_b16 v[178:179], v35 offset:10752
    s_waitcnt vmcnt(2)
    s_waitcnt lgkmcnt(6)
    v_mfma_f32_32x32x16_bf16 v[180:195], v[164:167], v[104:107], v[180:195]
    ds_read_b64_tr_b16 v[148:149], v32 offset:12288
    ds_read_b64_tr_b16 v[150:151], v32 offset:12800
    s_waitcnt lgkmcnt(6)
    v_mfma_f32_32x32x16_bf16 v[196:211], v[168:171], v[104:107], v[196:211]
    ds_read_b64_tr_b16 v[152:153], v33 offset:12288
    ds_read_b64_tr_b16 v[154:155], v33 offset:12800
    s_waitcnt lgkmcnt(6)
    v_mfma_f32_32x32x16_bf16 v[212:227], v[172:175], v[104:107], v[212:227]
    ds_read_b64_tr_b16 v[156:157], v34 offset:12288
    ds_read_b64_tr_b16 v[158:159], v34 offset:12800
    s_waitcnt lgkmcnt(6)
    v_mfma_f32_32x32x16_bf16 v[228:243], v[176:179], v[104:107], v[228:243]
    ds_read_b64_tr_b16 v[160:161], v35 offset:12288
    ds_read_b64_tr_b16 v[162:163], v35 offset:12800
    s_waitcnt vmcnt(1)
    s_waitcnt lgkmcnt(6)
    v_mfma_f32_32x32x16_bf16 v[180:195], v[148:151], v[108:111], v[180:195]
    ds_read_b64_tr_b16 v[164:165], v32 offset:14336
    ds_read_b64_tr_b16 v[166:167], v32 offset:14848
    s_waitcnt lgkmcnt(6)
    v_mfma_f32_32x32x16_bf16 v[196:211], v[152:155], v[108:111], v[196:211]
    ds_read_b64_tr_b16 v[168:169], v33 offset:14336
    ds_read_b64_tr_b16 v[170:171], v33 offset:14848
    s_waitcnt lgkmcnt(6)
    v_mfma_f32_32x32x16_bf16 v[212:227], v[156:159], v[108:111], v[212:227]
    ds_read_b64_tr_b16 v[172:173], v34 offset:14336
    ds_read_b64_tr_b16 v[174:175], v34 offset:14848
    s_waitcnt lgkmcnt(6)
    v_mfma_f32_32x32x16_bf16 v[228:243], v[160:163], v[108:111], v[228:243]
    ds_read_b64_tr_b16 v[176:177], v35 offset:14336
    ds_read_b64_tr_b16 v[178:179], v35 offset:14848
E5A:
    s_mul_i32 s85, s80, 528384
    s_add_u32 s85, s85, 12845056
    s_waitcnt vmcnt(0)
    s_waitcnt lgkmcnt(6)
    v_mfma_f32_32x32x16_bf16 v[180:195], v[164:167], v[112:115], v[180:195]
    s_waitcnt lgkmcnt(4)
    v_mfma_f32_32x32x16_bf16 v[196:211], v[168:171], v[112:115], v[196:211]
    s_waitcnt lgkmcnt(2)
    v_mfma_f32_32x32x16_bf16 v[212:227], v[172:175], v[112:115], v[212:227]
    s_waitcnt lgkmcnt(0)
    v_mfma_f32_32x32x16_bf16 v[228:243], v[176:179], v[112:115], v[228:243]
    s_nop 5
    s_nop 0
    v_cvt_pk_bf16_f32 v52, v180, v181
    v_cvt_pk_bf16_f32 v53, v182, v183
    v_cvt_pk_bf16_f32 v54, v184, v185
    v_cvt_pk_bf16_f32 v55, v186, v187
    v_cvt_pk_bf16_f32 v56, v188, v189
    v_cvt_pk_bf16_f32 v57, v190, v191
    v_cvt_pk_bf16_f32 v58, v192, v193
    v_cvt_pk_bf16_f32 v59, v194, v195
    s_add_u32 s83, s85, 0
    s_add_u32 s84, s85, 66048
    buffer_store_dwordx4 v[52:55], v7, s[64:67], s83 offen sc1
    buffer_store_dwordx4 v[56:59], v7, s[64:67], s84 offen sc1
    s_nop 0
    v_cvt_pk_bf16_f32 v60, v196, v197
    v_cvt_pk_bf16_f32 v61, v198, v199
    v_cvt_pk_bf16_f32 v62, v200, v201
    v_cvt_pk_bf16_f32 v63, v202, v203
    v_cvt_pk_bf16_f32 v64, v204, v205
    v_cvt_pk_bf16_f32 v65, v206, v207
    v_cvt_pk_bf16_f32 v66, v208, v209
    v_cvt_pk_bf16_f32 v67, v210, v211
    s_add_u32 s83, s85, 132096
    s_add_u32 s84, s85, 198144
    buffer_store_dwordx4 v[60:63], v7, s[64:67], s83 offen sc1
    buffer_store_dwordx4 v[64:67], v7, s[64:67], s84 offen sc1
    v_cvt_pk_bf16_f32 v52, v212, v213
    v_cvt_pk_bf16_f32 v53, v214, v215
    v_cvt_pk_bf16_f32 v54, v216, v217
    v_cvt_pk_bf16_f32 v55, v218, v219
    v_cvt_pk_bf16_f32 v56, v220, v221
    v_cvt_pk_bf16_f32 v57, v222, v223
    v_cvt_pk_bf16_f32 v58, v224, v225
    v_cvt_pk_bf16_f32 v59, v226, v227
    s_add_u32 s83, s85, 264192
    s_add_u32 s84, s85, 330240
    buffer_store_dwordx4 v[52:55], v7, s[64:67], s83 offen sc1
    buffer_store_dwordx4 v[56:59], v7, s[64:67], s84 offen sc1
    v_cvt_pk_bf16_f32 v60, v228, v229
    v_cvt_pk_bf16_f32 v61, v230, v231
    v_cvt_pk_bf16_f32 v62, v232, v233
    v_cvt_pk_bf16_f32 v63, v234, v235
    v_cvt_pk_bf16_f32 v64, v236, v237
    v_cvt_pk_bf16_f32 v65, v238, v239
    v_cvt_pk_bf16_f32 v66, v240, v241
    v_cvt_pk_bf16_f32 v67, v242, v243
    s_add_u32 s83, s85, 396288
    s_add_u32 s84, s85, 462336
    buffer_store_dwordx4 v[60:63], v7, s[64:67], s83 offen sc1
    buffer_store_dwordx4 v[64:67], v7, s[64:67], s84 offen sc1
    s_lshl_b32 s85, s79, 2
    s_add_u32 s85, s85, s72
    s_mul_i32 s83, s85, 2048
    s_lshl_b32 s84, s80, 7
    s_add_u32 s83, s83, s84
    s_add_u32 s83, s83, 22282240
    s_waitcnt vmcnt(0)
    s_mov_b64 exec, 1
    s_cmp_lg_u32 s100, 0
    s_cbranch_scc1 SLOW_130
    buffer_store_dword v2, off, s[64:67], s83
    s_branch STE_131
SLOW_130:
    buffer_store_dword v2, off, s[64:67], s83 sc1
STE_131:
    s_mov_b64 exec, -1
C_SPARE:
L_END:
    s_endpgm
L_CODE1:
    .fill 2048, 4, 0xbf810000
.section .rodata,"a"
.p2align 6
.amdhsa_kernel recurrent_scan__linear_attn_block__mixer_s_mlp__prompt_kernel
  .amdhsa_next_free_vgpr 256
  .amdhsa_next_free_sgpr 102
  .amdhsa_accum_offset 256
  .amdhsa_group_segment_fixed_size 0
  .amdhsa_kernarg_size 88
  .amdhsa_user_sgpr_count 2
  .amdhsa_user_sgpr_kernarg_segment_ptr 1
  .amdhsa_system_sgpr_workgroup_id_x 1
.end_amdhsa_kernel
```
